```python
import torch

def _softmax(x, axis=-1):
    return torch.softmax(x, dim=axis)

def _gelu(x):
    return torch.nn.functional.gelu(x, approximate='tanh')

def _silu(x):
    return torch.nn.functional.silu(x)

def _sigmoid(x):
    return torch.sigmoid(x)

def _layernorm(x, axis=-1, eps=1e-05):
    m = x.mean(dim=axis, keepdim=True)
    v = x.var(dim=axis, keepdim=True, unbiased=False)
    return (x - m) / torch.sqrt(v + eps)

def _scatter_add(tgt, idx, src, axis=0):
    return tgt.clone().index_add_(axis, idx, src)

def _segment_sum(src, seg, n):
    out = torch.zeros((n,) + src.shape[1:], dtype=src.dtype)
    return out.index_add_(0, seg, src)

def _pad(x, pw):
    flat = tuple((v for pair in reversed(pw) for v in pair))
    return torch.nn.functional.pad(x, flat)
kernel_name = 'adaLN_cond__memory_aug_recurrent_mem_tr__swiglu_ffn__prompt'

def setup_inputs():

    _w = lambda a: (lambda t: t.to(torch.bfloat16) if t.is_floating_point() else t)(torch.as_tensor(a))

    def _A_setup():
        B, S, Dm = (1, 2048, 512)
        H, Dh = (32, 128)
        M, seg = (8, 32)
        seg = min(seg, S)
        S = S // seg * seg
        return {'x': _w((lambda *s: torch.randn(*s, dtype=torch.bfloat16) * 0.05)(B, S, Dm)), 'mem0': _w((lambda *s: torch.randn(*s, dtype=torch.bfloat16) * 0.4)(B, M, Dm)), 'Wq': _w((lambda *s: torch.randn(*s, dtype=torch.bfloat16) * 3.2)(Dm, H, Dh) * Dm ** (-0.5)), 'Wk': _w((lambda *s: torch.randn(*s, dtype=torch.bfloat16) * 3.2)(Dm, H, Dh) * Dm ** (-0.5)), 'Wv': _w((lambda *s: torch.randn(*s, dtype=torch.bfloat16) * 0.4)(Dm, H, Dh) * Dm ** (-0.5)), 'Wo': _w((lambda *s: torch.randn(*s, dtype=torch.bfloat16) * 0.4)(H, Dh, Dm) * (H * Dh) ** (-0.5)), 'seg_len': seg}
    _A_in = _A_setup()

    def _B_setup():
        B, S, D, F = (1, 2048, 512, 1792)
        return {'x': _w((lambda *s: torch.randn(*s, dtype=torch.bfloat16) * 0.05)(B, S, D)), 'w_gate': _w((lambda *s: torch.randn(*s, dtype=torch.bfloat16) * 0.05)(D, F)), 'w_up': _w((lambda *s: torch.randn(*s, dtype=torch.bfloat16) * 0.05)(D, F)), 'w_down': _w((lambda *s: torch.randn(*s, dtype=torch.bfloat16) * 0.05)(F, D))}
    _B_in = _B_setup()
    return {'A_x': _A_in['x'], 'A_mem0': _A_in['mem0'], 'A_Wq': _A_in['Wq'], 'A_Wk': _A_in['Wk'], 'A_Wv': _A_in['Wv'], 'A_Wo': _A_in['Wo'], 'A_seg_len': _A_in['seg_len'], 'B_x': _B_in['x'], 'B_w_gate': _B_in['w_gate'], 'B_w_up': _B_in['w_up'], 'B_w_down': _B_in['w_down'], 'c': _w((lambda *s: torch.randn(*s, dtype=torch.bfloat16) * 0.1)(1, 512) * 8.0), 'w_mod': _w((lambda *s: torch.randn(*s, dtype=torch.bfloat16) * 0.1)(512, 6 * 512) * 512 ** (-0.5) * 8.0)}

def reference(A_x, A_mem0, A_Wq, A_Wk, A_Wv, A_Wo, A_seg_len, B_x, B_w_gate, B_w_up, B_w_down, c, w_mod):

    def _A_ref(x, mem0, Wq, Wk, Wv, Wo, seg_len):
        B, S, Dm = x.shape
        H, Dh = (Wq.shape[1], Wq.shape[2])
        M = mem0.shape[1]
        scale = Dh ** (-0.5)
        n_seg = S // seg_len
        L = M + seg_len
        idx = torch.arange(L)
        mask = (idx[:, None] < M) | (idx[:, None] >= idx[None, :])
        mem = mem0
        outs = []
        for s in range(n_seg):
            xs = x[:, s * seg_len:(s + 1) * seg_len, :].clone()
            h = torch.concatenate([mem, xs], axis=1)
            q = torch.einsum('btd,dhe->bhte', h, Wq)
            k = torch.einsum('btd,dhe->bhte', h, Wk)
            v = torch.einsum('btd,dhe->bhte', h, Wv)
            scores = torch.einsum('bhqe,bhke->bhqk', q, k) * scale
            scores = torch.where(mask[None, None], scores, -1000000000.0)
            p = _softmax(scores, axis=-1)
            o = torch.einsum('bhqk,bhke->bhqe', p, v)
            o = torch.einsum('bhte,hed->btd', o, Wo)
            mem = o[:, :M, :].clone()
            outs.append(o[:, M:, :])
        return torch.concatenate(outs, axis=1)

    def _B_ref(x, w_gate, w_up, w_down):
        g = _silu(x @ w_gate)
        u = x @ w_up
        return g * u @ w_down
    x = A_x
    mod = (_silu(c) @ w_mod).reshape(c.shape[0], 6, 1, -1)
    sa, ca, ga, sb, cb, gb = (mod[:, 0].clone(), mod[:, 1].clone(), mod[:, 2].clone(), mod[:, 3].clone(), mod[:, 4].clone(), mod[:, 5].clone())
    h = _layernorm(x, axis=-1) * (1 + ca) + sa
    x = x + ga * _A_ref(h, A_mem0, A_Wq, A_Wk, A_Wv, A_Wo, A_seg_len)
    h = _layernorm(x, axis=-1) * (1 + cb) + sb
    x = x + gb * _B_ref(h, B_w_gate, B_w_up, B_w_down)
    return x
```

```asm
; @launch grid=(256,1,1) block=(256,1,1) lds=163840
.amdgcn_target "amdgcn-amd-amdhsa--gfx950"
.text
.globl adaLN_cond__memory_aug_recurrent_mem_tr__swiglu_ffn__prompt_kernel
.p2align 8
.type adaLN_cond__memory_aug_recurrent_mem_tr__swiglu_ffn__prompt_kernel,@function
adaLN_cond__memory_aug_recurrent_mem_tr__swiglu_ffn__prompt_kernel:
    s_cmp_ge_u32 s2, 256
    s_cbranch_scc1 L_exit
    s_load_dwordx8 s[4:11], s[0:1], 0
    s_load_dwordx4 s[12:15], s[0:1], 32
    s_load_dwordx8 s[16:23], s[0:1], 64
    s_load_dwordx8 s[24:31], s[0:1], 96
    v_lshrrev_b32 v1, 6, v0
    s_nop 0
    v_readfirstlane_b32 s40, v1
    s_waitcnt lgkmcnt(0)
    s_mov_b32 s32, s30
    s_and_b32 s33, s31, 0xffff
    s_mov_b32 s34, 0x10000000
    s_mov_b32 s35, 0x00020000
    s_mov_b32 s36, s28
    s_and_b32 s37, s29, 0xffff
    s_mov_b32 s38, 256
    s_mov_b32 s39, 0x00020000
    s_and_b32 s3, s2, 7
    s_cmp_eq_u32 s3, 0
    s_cbranch_scc0 L_worker
    s_lshr_b32 s41, s2, 3
    s_mov_b32 s59, 0
    v_and_b32 v104, 63, v0
    v_bfe_u32 v106, v104, 0, 1
    v_bfe_u32 v107, v104, 1, 1
    v_bfe_u32 v108, v104, 2, 1
    v_bfe_u32 v109, v104, 3, 1
    v_bfe_u32 v110, v104, 4, 1
    v_bfe_u32 v111, v104, 5, 1
    v_and_b32 v105, 15, v104
    s_mov_b32 s60, 0x0
    s_lshr_b32 s61, s40, 0
    s_and_b32 s61, s61, 0x3
    s_mul_i32 s61, s61, 0x20000
    s_add_u32 s60, s60, s61
    v_mov_b32 v112, s60
    s_mov_b32 s61, 0x2000
    v_mad_u32_u24 v112, v110, s61, v112
    s_mov_b32 s61, 0x4000
    v_mad_u32_u24 v112, v111, s61, v112
    s_mov_b32 s60, 0x0
    s_lshr_b32 s61, s40, 0
    s_and_b32 s61, s61, 0x1
    s_mul_i32 s61, s61, 0x8
    s_add_u32 s60, s60, s61
    v_mov_b32 v100, s60
    s_mov_b32 s61, 0x2
    v_mad_u32_u24 v100, v111, s61, v100
    v_xor_b32 v100, v100, v105
    v_lshl_add_u32 v112, v100, 4, v112
    s_mov_b32 s60, 0x8000
    s_lshr_b32 s61, s40, 0
    s_and_b32 s61, s61, 0x3
    s_mul_i32 s61, s61, 0x20000
    s_add_u32 s60, s60, s61
    v_mov_b32 v113, s60
    s_mov_b32 s61, 0x2000
    v_mad_u32_u24 v113, v110, s61, v113
    s_mov_b32 s61, 0x4000
    v_mad_u32_u24 v113, v111, s61, v113
    s_mov_b32 s60, 0x4
    s_lshr_b32 s61, s40, 0
    s_and_b32 s61, s61, 0x1
    s_mul_i32 s61, s61, 0x8
    s_add_u32 s60, s60, s61
    v_mov_b32 v100, s60
    s_mov_b32 s61, 0x2
    v_mad_u32_u24 v100, v111, s61, v100
    v_xor_b32 v100, v100, v105
    v_lshl_add_u32 v113, v100, 4, v113
    s_mov_b32 s60, 0x10000
    s_lshr_b32 s61, s40, 0
    s_and_b32 s61, s61, 0x3
    s_mul_i32 s61, s61, 0x20000
    s_add_u32 s60, s60, s61
    v_mov_b32 v114, s60
    s_mov_b32 s61, 0x2000
    v_mad_u32_u24 v114, v110, s61, v114
    s_mov_b32 s61, 0x4000
    v_mad_u32_u24 v114, v111, s61, v114
    s_mov_b32 s60, 0x0
    s_lshr_b32 s61, s40, 0
    s_and_b32 s61, s61, 0x1
    s_mul_i32 s61, s61, 0x8
    s_add_u32 s60, s60, s61
    v_mov_b32 v100, s60
    s_mov_b32 s61, 0x2
    v_mad_u32_u24 v100, v111, s61, v100
    v_xor_b32 v100, v100, v105
    v_lshl_add_u32 v114, v100, 4, v114
    s_mov_b32 s60, 0x18000
    s_lshr_b32 s61, s40, 0
    s_and_b32 s61, s61, 0x3
    s_mul_i32 s61, s61, 0x20000
    s_add_u32 s60, s60, s61
    v_mov_b32 v115, s60
    s_mov_b32 s61, 0x2000
    v_mad_u32_u24 v115, v110, s61, v115
    s_mov_b32 s61, 0x4000
    v_mad_u32_u24 v115, v111, s61, v115
    s_mov_b32 s60, 0x4
    s_lshr_b32 s61, s40, 0
    s_and_b32 s61, s61, 0x1
    s_mul_i32 s61, s61, 0x8
    s_add_u32 s60, s60, s61
    v_mov_b32 v100, s60
    s_mov_b32 s61, 0x2
    v_mad_u32_u24 v100, v111, s61, v100
    v_xor_b32 v100, v100, v105
    v_lshl_add_u32 v115, v100, 4, v115
    s_lshl_b32 s60, s41, 8
    s_add_u32 s60, s60, 2097152
    s_add_u32 s64, s8, s60
    s_addc_u32 s65, s9, 0
    s_lshl_b32 s61, s40, 12
    s_add_u32 m0, s61, 0
    s_nop 0
    global_load_lds_dwordx4 v112, s[64:65]
    s_add_u32 m0, s61, 1024
    s_nop 0
    global_load_lds_dwordx4 v113, s[64:65]
    s_add_u32 m0, s61, 2048
    s_nop 0
    global_load_lds_dwordx4 v114, s[64:65]
    s_add_u32 m0, s61, 3072
    s_nop 0
    global_load_lds_dwordx4 v115, s[64:65]
    s_mov_b32 s60, 0x0
    s_lshr_b32 s61, s40, 0
    s_and_b32 s61, s61, 0x3
    s_mul_i32 s61, s61, 0x100
    s_add_u32 s60, s60, s61
    s_lshr_b32 s61, s41, 3
    s_and_b32 s61, s61, 0x3
    s_mul_i32 s61, s61, 0x40
    s_add_u32 s60, s60, s61
    s_lshr_b32 s61, s41, 0
    s_and_b32 s61, s61, 0x1
    s_mul_i32 s61, s61, 0x10
    s_add_u32 s60, s60, s61
    s_lshr_b32 s61, s41, 1
    s_and_b32 s61, s61, 0x3
    s_mul_i32 s61, s61, 0x800
    s_add_u32 s60, s60, s61
    v_mov_b32 v100, s60
    s_mov_b32 s61, 0x4
    v_mad_u32_u24 v100, v106, s61, v100
    s_mov_b32 s61, 0x8
    v_mad_u32_u24 v100, v107, s61, v100
    s_mov_b32 s61, 0x400
    v_mad_u32_u24 v100, v110, s61, v100
    s_mov_b32 s61, 0x2
    v_mad_u32_u24 v100, v111, s61, v100
    global_load_ushort v98, v100, s[6:7]
    global_load_ushort v99, v100, s[6:7] offset:32
    s_lshl_b32 s60, s41, 8
    s_add_u32 s60, s60, 2621440
    s_add_u32 s64, s8, s60
    s_addc_u32 s65, s9, 0
    s_lshl_b32 s61, s40, 12
    s_add_u32 m0, s61, 16384
    s_nop 0
    global_load_lds_dwordx4 v112, s[64:65]
    s_add_u32 m0, s61, 17408
    s_nop 0
    global_load_lds_dwordx4 v113, s[64:65]
    s_add_u32 m0, s61, 18432
    s_nop 0
    global_load_lds_dwordx4 v114, s[64:65]
    s_add_u32 m0, s61, 19456
    s_nop 0
    global_load_lds_dwordx4 v115, s[64:65]
    s_lshl_b32 s60, s41, 8
    s_add_u32 s60, s60, 3145728
    s_add_u32 s64, s8, s60
    s_addc_u32 s65, s9, 0
    s_lshl_b32 s61, s40, 12
    s_add_u32 m0, s61, 32768
    s_nop 0
    global_load_lds_dwordx4 v112, s[64:65]
    s_add_u32 m0, s61, 33792
    s_nop 0
    global_load_lds_dwordx4 v113, s[64:65]
    s_add_u32 m0, s61, 34816
    s_nop 0
    global_load_lds_dwordx4 v114, s[64:65]
    s_add_u32 m0, s61, 35840
    s_nop 0
    global_load_lds_dwordx4 v115, s[64:65]
    s_lshl_b32 s60, s41, 8
    s_add_u32 s60, s60, 3670016
    s_add_u32 s64, s8, s60
    s_addc_u32 s65, s9, 0
    s_lshl_b32 s61, s40, 12
    s_add_u32 m0, s61, 49152
    s_nop 0
    global_load_lds_dwordx4 v112, s[64:65]
    s_add_u32 m0, s61, 50176
    s_nop 0
    global_load_lds_dwordx4 v113, s[64:65]
    s_add_u32 m0, s61, 51200
    s_nop 0
    global_load_lds_dwordx4 v114, s[64:65]
    s_add_u32 m0, s61, 52224
    s_nop 0
    global_load_lds_dwordx4 v115, s[64:65]
    s_lshl_b32 s60, s41, 8
    s_add_u32 s60, s60, 0
    s_add_u32 s64, s10, s60
    s_addc_u32 s65, s11, 0
    s_lshl_b32 s61, s40, 12
    s_add_u32 m0, s61, 65536
    s_nop 0
    global_load_lds_dwordx4 v112, s[64:65]
    s_add_u32 m0, s61, 66560
    s_nop 0
    global_load_lds_dwordx4 v113, s[64:65]
    s_add_u32 m0, s61, 67584
    s_nop 0
    global_load_lds_dwordx4 v114, s[64:65]
    s_add_u32 m0, s61, 68608
    s_nop 0
    global_load_lds_dwordx4 v115, s[64:65]
    s_lshl_b32 s60, s41, 8
    s_add_u32 s60, s60, 524288
    s_add_u32 s64, s10, s60
    s_addc_u32 s65, s11, 0
    s_lshl_b32 s61, s40, 12
    s_add_u32 m0, s61, 81920
    s_nop 0
    global_load_lds_dwordx4 v112, s[64:65]
    s_add_u32 m0, s61, 82944
    s_nop 0
    global_load_lds_dwordx4 v113, s[64:65]
    s_add_u32 m0, s61, 83968
    s_nop 0
    global_load_lds_dwordx4 v114, s[64:65]
    s_add_u32 m0, s61, 84992
    s_nop 0
    global_load_lds_dwordx4 v115, s[64:65]
    s_lshl_b32 s60, s41, 8
    s_add_u32 s60, s60, 1048576
    s_add_u32 s64, s10, s60
    s_addc_u32 s65, s11, 0
    s_lshl_b32 s61, s40, 12
    s_add_u32 m0, s61, 98304
    s_nop 0
    global_load_lds_dwordx4 v112, s[64:65]
    s_add_u32 m0, s61, 99328
    s_nop 0
    global_load_lds_dwordx4 v113, s[64:65]
    s_add_u32 m0, s61, 100352
    s_nop 0
    global_load_lds_dwordx4 v114, s[64:65]
    s_add_u32 m0, s61, 101376
    s_nop 0
    global_load_lds_dwordx4 v115, s[64:65]
    s_mov_b32 s60, 0x0
    s_lshr_b32 s61, s40, 0
    s_and_b32 s61, s61, 0x3
    s_mul_i32 s61, s61, 0x4000
    s_add_u32 s60, s60, s61
    v_mov_b32 v116, s60
    s_mov_b32 s61, 0x400
    v_mad_u32_u24 v116, v110, s61, v116
    s_mov_b32 s61, 0x800
    v_mad_u32_u24 v116, v111, s61, v116
    s_mov_b32 s60, 0x0
    v_mov_b32 v100, s60
    s_mov_b32 s61, 0x2
    v_mad_u32_u24 v100, v110, s61, v100
    v_xor_b32 v100, v100, v105
    v_lshl_add_u32 v116, v100, 4, v116
    s_mov_b32 s60, 0x1000
    s_lshr_b32 s61, s40, 0
    s_and_b32 s61, s61, 0x3
    s_mul_i32 s61, s61, 0x4000
    s_add_u32 s60, s60, s61
    v_mov_b32 v117, s60
    s_mov_b32 s61, 0x400
    v_mad_u32_u24 v117, v110, s61, v117
    s_mov_b32 s61, 0x800
    v_mad_u32_u24 v117, v111, s61, v117
    s_mov_b32 s60, 0x4
    v_mov_b32 v100, s60
    s_mov_b32 s61, 0x2
    v_mad_u32_u24 v100, v110, s61, v100
    v_xor_b32 v100, v100, v105
    v_lshl_add_u32 v117, v100, 4, v117
    s_mov_b32 s60, 0x2000
    s_lshr_b32 s61, s40, 0
    s_and_b32 s61, s61, 0x3
    s_mul_i32 s61, s61, 0x4000
    s_add_u32 s60, s60, s61
    v_mov_b32 v118, s60
    s_mov_b32 s61, 0x400
    v_mad_u32_u24 v118, v110, s61, v118
    s_mov_b32 s61, 0x800
    v_mad_u32_u24 v118, v111, s61, v118
    s_mov_b32 s60, 0x8
    v_mov_b32 v100, s60
    s_mov_b32 s61, 0x2
    v_mad_u32_u24 v100, v110, s61, v100
    v_xor_b32 v100, v100, v105
    v_lshl_add_u32 v118, v100, 4, v118
    s_mov_b32 s60, 0x3000
    s_lshr_b32 s61, s40, 0
    s_and_b32 s61, s61, 0x3
    s_mul_i32 s61, s61, 0x4000
    s_add_u32 s60, s60, s61
    v_mov_b32 v119, s60
    s_mov_b32 s61, 0x400
    v_mad_u32_u24 v119, v110, s61, v119
    s_mov_b32 s61, 0x800
    v_mad_u32_u24 v119, v111, s61, v119
    s_mov_b32 s60, 0xc
    v_mov_b32 v100, s60
    s_mov_b32 s61, 0x2
    v_mad_u32_u24 v100, v110, s61, v100
    v_xor_b32 v100, v100, v105
    v_lshl_add_u32 v119, v100, 4, v119
    s_mov_b32 s60, 0x0
    v_mov_b32 v102, s60
    s_mov_b32 s61, 0x4
    v_mad_u32_u24 v102, v108, s61, v102
    s_mov_b32 s61, 0x2
    v_mad_u32_u24 v102, v109, s61, v102
    s_mov_b32 s61, 0x1
    v_mad_u32_u24 v102, v110, s61, v102
    s_mov_b32 s60, 0x0
    v_mov_b32 v120, s60
    s_mov_b32 s61, 0x8
    v_mad_u32_u24 v120, v106, s61, v120
    s_mov_b32 s61, 0x10
    v_mad_u32_u24 v120, v107, s61, v120
    s_mov_b32 s61, 0x1000
    v_mad_u32_u24 v120, v108, s61, v120
    s_mov_b32 s61, 0x400
    v_mad_u32_u24 v120, v109, s61, v120
    s_mov_b32 s61, 0x200
    v_mad_u32_u24 v120, v110, s61, v120
    s_mov_b32 s61, 0x800
    v_mad_u32_u24 v120, v111, s61, v120
    s_lshl_b32 s60, s40, 1
    s_add_u32 s60, s60, 0
    v_xor_b32 v101, s60, v102
    v_lshl_add_u32 v120, v101, 5, v120
    s_mov_b32 s60, 0x0
    v_mov_b32 v121, s60
    s_mov_b32 s61, 0x8
    v_mad_u32_u24 v121, v106, s61, v121
    s_mov_b32 s61, 0x10
    v_mad_u32_u24 v121, v107, s61, v121
    s_mov_b32 s61, 0x1000
    v_mad_u32_u24 v121, v108, s61, v121
    s_mov_b32 s61, 0x400
    v_mad_u32_u24 v121, v109, s61, v121
    s_mov_b32 s61, 0x200
    v_mad_u32_u24 v121, v110, s61, v121
    s_mov_b32 s61, 0x800
    v_mad_u32_u24 v121, v111, s61, v121
    s_lshl_b32 s60, s40, 1
    s_add_u32 s60, s60, 1
    v_xor_b32 v101, s60, v102
    v_lshl_add_u32 v121, v101, 5, v121
    s_mov_b32 s60, 0x0
    v_mov_b32 v102, s60
    s_mov_b32 s61, 0x1
    v_mad_u32_u24 v102, v108, s61, v102
    s_mov_b32 s61, 0x2
    v_mad_u32_u24 v102, v110, s61, v102
    s_mov_b32 s61, 0x4
    v_mad_u32_u24 v102, v111, s61, v102
    s_mov_b32 s60, 0x0
    s_lshr_b32 s61, s40, 0
    s_and_b32 s61, s61, 0x3
    s_mul_i32 s61, s61, 0x2
    s_add_u32 s60, s60, s61
    v_mov_b32 v103, s60
    s_mov_b32 s61, 0x1
    v_mad_u32_u24 v103, v109, s61, v103
    v_xor_b32 v101, v103, v102
    s_mov_b32 s60, 0x0
    v_mov_b32 v122, s60
    s_mov_b32 s61, 0x8
    v_mad_u32_u24 v122, v106, s61, v122
    s_mov_b32 s61, 0x10
    v_mad_u32_u24 v122, v107, s61, v122
    s_mov_b32 s61, 0x100
    v_mad_u32_u24 v122, v108, s61, v122
    s_mov_b32 s61, 0x400
    v_mad_u32_u24 v122, v110, s61, v122
    s_mov_b32 s61, 0x800
    v_mad_u32_u24 v122, v111, s61, v122
    v_lshl_add_u32 v122, v101, 5, v122
    s_mov_b32 s60, 0x2000
    v_mov_b32 v123, s60
    s_mov_b32 s61, 0x8
    v_mad_u32_u24 v123, v106, s61, v123
    s_mov_b32 s61, 0x10
    v_mad_u32_u24 v123, v107, s61, v123
    s_mov_b32 s61, 0x100
    v_mad_u32_u24 v123, v108, s61, v123
    s_mov_b32 s61, 0x400
    v_mad_u32_u24 v123, v110, s61, v123
    s_mov_b32 s61, 0x800
    v_mad_u32_u24 v123, v111, s61, v123
    v_lshl_add_u32 v123, v101, 5, v123
    v_cmp_ne_u32 vcc, 0, v107
    v_mov_b32 v101, 0x44444444
    v_mov_b32 v102, 0xeeeeeeee
    v_cndmask_b32 v0, v101, v102, vcc
    s_mov_b32 s60, 0x120000
    s_lshr_b32 s61, s40, 0
    s_and_b32 s61, s61, 0x3
    s_mul_i32 s61, s61, 0x4000
    s_add_u32 s60, s60, s61
    s_lshr_b32 s61, s41, 0
    s_and_b32 s61, s61, 0x1f
    s_mul_i32 s61, s61, 0x40
    s_add_u32 s60, s60, s61
    v_mov_b32 v1, s60
    s_mov_b32 s61, 0x8
    v_mad_u32_u24 v1, v106, s61, v1
    s_mov_b32 s61, 0x10
    v_mad_u32_u24 v1, v107, s61, v1
    s_mov_b32 s61, 0x20
    v_mad_u32_u24 v1, v108, s61, v1
    s_mov_b32 s61, 0x800
    v_mad_u32_u24 v1, v109, s61, v1
    s_mov_b32 s61, 0x1000
    v_mad_u32_u24 v1, v110, s61, v1
    s_mov_b32 s61, 0x2000
    v_mad_u32_u24 v1, v111, s61, v1
    s_mov_b32 s60, 0x120000
    s_lshr_b32 s61, s40, 0
    s_and_b32 s61, s61, 0x3
    s_mul_i32 s61, s61, 0x10000
    s_add_u32 s60, s60, s61
    s_lshr_b32 s61, s41, 0
    s_and_b32 s61, s61, 0x1f
    s_mul_i32 s61, s61, 0x800
    s_add_u32 s60, s60, s61
    v_mov_b32 v2, s60
    s_mov_b32 s61, 0x10
    v_mad_u32_u24 v2, v106, s61, v2
    s_mov_b32 s61, 0x20
    v_mad_u32_u24 v2, v107, s61, v2
    s_mov_b32 s61, 0x40
    v_mad_u32_u24 v2, v108, s61, v2
    s_mov_b32 s61, 0x80
    v_mad_u32_u24 v2, v109, s61, v2
    s_mov_b32 s61, 0x100
    v_mad_u32_u24 v2, v110, s61, v2
    s_mov_b32 s61, 0x200
    v_mad_u32_u24 v2, v111, s61, v2
    s_mov_b32 s60, 0x40000
    s_lshr_b32 s61, s40, 0
    s_and_b32 s61, s61, 0x3
    s_mul_i32 s61, s61, 0x800
    s_add_u32 s60, s60, s61
    s_lshr_b32 s61, s41, 3
    s_and_b32 s61, s61, 0x3
    s_mul_i32 s61, s61, 0x200
    s_add_u32 s60, s60, s61
    s_lshr_b32 s61, s41, 0
    s_and_b32 s61, s61, 0x1
    s_mul_i32 s61, s61, 0x100
    s_add_u32 s60, s60, s61
    s_lshr_b32 s61, s41, 1
    s_and_b32 s61, s61, 0x3
    s_mul_i32 s61, s61, 0x40
    s_add_u32 s60, s60, s61
    v_mov_b32 v3, s60
    s_mov_b32 s61, 0x8
    v_mad_u32_u24 v3, v106, s61, v3
    s_mov_b32 s61, 0x20
    v_mad_u32_u24 v3, v107, s61, v3
    s_mov_b32 s61, 0x10
    v_mad_u32_u24 v3, v110, s61, v3
    s_mov_b32 s61, 0x4
    v_mad_u32_u24 v3, v111, s61, v3
    s_mov_b32 s60, 0x20000
    v_mov_b32 v10, s60
    s_mov_b32 s61, 0x10
    v_mad_u32_u24 v10, v106, s61, v10
    s_mov_b32 s61, 0x20
    v_mad_u32_u24 v10, v107, s61, v10
    s_mov_b32 s61, 0x40
    v_mad_u32_u24 v10, v108, s61, v10
    s_mov_b32 s61, 0x80
    v_mad_u32_u24 v10, v109, s61, v10
    s_mov_b32 s61, 0x100
    v_mad_u32_u24 v10, v110, s61, v10
    s_mov_b32 s61, 0x200
    v_mad_u32_u24 v10, v111, s61, v10
    s_mov_b32 s60, 0x26000
    s_lshr_b32 s61, s40, 0
    s_and_b32 s61, s61, 0x3
    s_mul_i32 s61, s61, 0x400
    s_add_u32 s60, s60, s61
    v_mov_b32 v4, s60
    s_mov_b32 s61, 0x20
    v_mad_u32_u24 v4, v106, s61, v4
    s_mov_b32 s61, 0x40
    v_mad_u32_u24 v4, v107, s61, v4
    s_mov_b32 s61, 0x80
    v_mad_u32_u24 v4, v108, s61, v4
    s_mov_b32 s61, 0x100
    v_mad_u32_u24 v4, v109, s61, v4
    s_mov_b32 s61, 0x8
    v_mad_u32_u24 v4, v110, s61, v4
    s_mov_b32 s61, 0x10
    v_mad_u32_u24 v4, v111, s61, v4
    s_mov_b32 s60, 0x26000
    v_mov_b32 v5, s60
    s_mov_b32 s61, 0x8
    v_mad_u32_u24 v5, v106, s61, v5
    s_mov_b32 s61, 0x10
    v_mad_u32_u24 v5, v107, s61, v5
    s_mov_b32 s61, 0x20
    v_mad_u32_u24 v5, v108, s61, v5
    s_mov_b32 s61, 0x40
    v_mad_u32_u24 v5, v109, s61, v5
    s_mov_b32 s61, 0x80
    v_mad_u32_u24 v5, v110, s61, v5
    s_mov_b32 s61, 0x200
    v_mad_u32_u24 v5, v111, s61, v5
    s_mov_b32 s60, 0x27000
    s_lshr_b32 s61, s40, 0
    s_and_b32 s61, s61, 0x3
    s_mul_i32 s61, s61, 0x40
    s_add_u32 s60, s60, s61
    v_mov_b32 v6, s60
    s_mov_b32 s61, 0x140
    v_mad_u32_u24 v6, v106, s61, v6
    s_mov_b32 s61, 0x280
    v_mad_u32_u24 v6, v108, s61, v6
    s_mov_b32 s61, 0x500
    v_mad_u32_u24 v6, v109, s61, v6
    s_mov_b32 s61, 0x8
    v_mad_u32_u24 v6, v110, s61, v6
    s_mov_b32 s61, 0x10
    v_mad_u32_u24 v6, v111, s61, v6
    s_mov_b32 s60, 0x27000
    v_mov_b32 v7, s60
    s_mov_b32 s61, 0x140
    v_mad_u32_u24 v7, v106, s61, v7
    s_mov_b32 s61, 0x280
    v_mad_u32_u24 v7, v108, s61, v7
    s_mov_b32 s61, 0x500
    v_mad_u32_u24 v7, v109, s61, v7
    s_mov_b32 s61, 0x10
    v_mad_u32_u24 v7, v110, s61, v7
    s_mov_b32 s61, 0x20
    v_mad_u32_u24 v7, v111, s61, v7
    s_mov_b32 s60, 0x0
    s_lshr_b32 s61, s40, 0
    s_and_b32 s61, s61, 0x3
    s_mul_i32 s61, s61, 0x800
    s_add_u32 s60, s60, s61
    v_mov_b32 v8, s60
    s_mov_b32 s61, 0x10
    v_mad_u32_u24 v8, v106, s61, v8
    s_mov_b32 s61, 0x20
    v_mad_u32_u24 v8, v107, s61, v8
    s_mov_b32 s61, 0x40
    v_mad_u32_u24 v8, v108, s61, v8
    s_mov_b32 s61, 0x80
    v_mad_u32_u24 v8, v109, s61, v8
    s_mov_b32 s61, 0x100
    v_mad_u32_u24 v8, v110, s61, v8
    s_mov_b32 s61, 0x200
    v_mad_u32_u24 v8, v111, s61, v8
    s_mov_b32 s60, 0x10000
    s_lshr_b32 s61, s40, 0
    s_and_b32 s61, s61, 0x3
    s_mul_i32 s61, s61, 0x800
    s_add_u32 s60, s60, s61
    v_mov_b32 v9, s60
    s_mov_b32 s61, 0x10
    v_mad_u32_u24 v9, v106, s61, v9
    s_mov_b32 s61, 0x20
    v_mad_u32_u24 v9, v107, s61, v9
    s_mov_b32 s61, 0x40
    v_mad_u32_u24 v9, v108, s61, v9
    s_mov_b32 s61, 0x80
    v_mad_u32_u24 v9, v109, s61, v9
    s_mov_b32 s61, 0x100
    v_mad_u32_u24 v9, v110, s61, v9
    s_mov_b32 s61, 0x200
    v_mad_u32_u24 v9, v111, s61, v9
    s_mov_b32 s45, 0xffbfffbf
    v_mov_b32 v24, s45
    v_mov_b32 v25, s45
    v_mov_b32 v26, s45
    v_mov_b32 v27, s45
    s_mov_b32 s63, 0
    buffer_store_dwordx4 v[24:27], v2, s[32:35], s63 offen offset:0 sc1
    buffer_store_dwordx4 v[24:27], v2, s[32:35], s63 offen offset:1024 sc1
    s_mov_b32 s63, 262144
    buffer_store_dwordx4 v[24:27], v2, s[32:35], s63 offen offset:0 sc1
    buffer_store_dwordx4 v[24:27], v2, s[32:35], s63 offen offset:1024 sc1
    s_mov_b32 s63, 8192
    buffer_store_dword v24, v3, s[32:35], s63 offen sc1
    s_mov_b32 s63, 16384
    buffer_store_dword v24, v3, s[32:35], s63 offen sc1
    s_mov_b32 s63, 24576
    buffer_store_dword v24, v3, s[32:35], s63 offen sc1
    s_waitcnt vmcnt(31)
    v_lshl_or_b32 v101, v99, 16, v98
    v_cmp_eq_u32 vcc, s45, v101
    v_mov_b32 v102, -1
    s_nop 0
    v_cndmask_b32 v101, v101, v102, vcc
    buffer_store_dword v101, v3, s[32:35], 0 offen sc1
    s_waitcnt vmcnt(32) lgkmcnt(0)
    s_barrier
    s_lshl_b32 s60, s41, 8
    s_add_u32 s60, s60, 1572864
    s_add_u32 s64, s10, s60
    s_addc_u32 s65, s11, 0
    s_lshl_b32 s61, s40, 12
    s_add_u32 m0, s61, 114688
    s_nop 0
    global_load_lds_dwordx4 v112, s[64:65]
    s_add_u32 m0, s61, 115712
    s_nop 0
    global_load_lds_dwordx4 v113, s[64:65]
    s_add_u32 m0, s61, 116736
    s_nop 0
    global_load_lds_dwordx4 v114, s[64:65]
    s_add_u32 m0, s61, 117760
    s_nop 0
    global_load_lds_dwordx4 v115, s[64:65]
    v_add_u32 v124, 0, v120
    ds_read_b64_tr_b16 a[0:1], v124 offset:0
    ds_read_b64_tr_b16 a[2:3], v124 offset:256
    ds_read_b64_tr_b16 a[4:5], v124 offset:8192
    ds_read_b64_tr_b16 a[6:7], v124 offset:8448
    v_add_u32 v125, 0, v121
    ds_read_b64_tr_b16 a[8:9], v125 offset:0
    ds_read_b64_tr_b16 a[10:11], v125 offset:256
    ds_read_b64_tr_b16 a[12:13], v125 offset:8192
    ds_read_b64_tr_b16 a[14:15], v125 offset:8448
    s_waitcnt vmcnt(32) lgkmcnt(0)
    s_barrier
    s_lshl_b32 s60, s41, 8
    s_add_u32 s60, s60, 2097152
    s_add_u32 s64, s10, s60
    s_addc_u32 s65, s11, 0
    s_lshl_b32 s61, s40, 12
    s_add_u32 m0, s61, 0
    s_nop 0
    global_load_lds_dwordx4 v112, s[64:65]
    s_add_u32 m0, s61, 1024
    s_nop 0
    global_load_lds_dwordx4 v113, s[64:65]
    s_add_u32 m0, s61, 2048
    s_nop 0
    global_load_lds_dwordx4 v114, s[64:65]
    s_add_u32 m0, s61, 3072
    s_nop 0
    global_load_lds_dwordx4 v115, s[64:65]
    v_add_u32 v124, 16384, v120
    ds_read_b64_tr_b16 a[16:17], v124 offset:0
    ds_read_b64_tr_b16 a[18:19], v124 offset:256
    ds_read_b64_tr_b16 a[20:21], v124 offset:8192
    ds_read_b64_tr_b16 a[22:23], v124 offset:8448
    v_add_u32 v125, 16384, v121
    ds_read_b64_tr_b16 a[24:25], v125 offset:0
    ds_read_b64_tr_b16 a[26:27], v125 offset:256
    ds_read_b64_tr_b16 a[28:29], v125 offset:8192
    ds_read_b64_tr_b16 a[30:31], v125 offset:8448
    s_waitcnt vmcnt(32) lgkmcnt(0)
    s_barrier
    s_lshl_b32 s60, s41, 8
    s_add_u32 s60, s60, 2621440
    s_add_u32 s64, s10, s60
    s_addc_u32 s65, s11, 0
    s_lshl_b32 s61, s40, 12
    s_add_u32 m0, s61, 16384
    s_nop 0
    global_load_lds_dwordx4 v112, s[64:65]
    s_add_u32 m0, s61, 17408
    s_nop 0
    global_load_lds_dwordx4 v113, s[64:65]
    s_add_u32 m0, s61, 18432
    s_nop 0
    global_load_lds_dwordx4 v114, s[64:65]
    s_add_u32 m0, s61, 19456
    s_nop 0
    global_load_lds_dwordx4 v115, s[64:65]
    v_add_u32 v124, 32768, v120
    ds_read_b64_tr_b16 a[32:33], v124 offset:0
    ds_read_b64_tr_b16 a[34:35], v124 offset:256
    ds_read_b64_tr_b16 a[36:37], v124 offset:8192
    ds_read_b64_tr_b16 a[38:39], v124 offset:8448
    v_add_u32 v125, 32768, v121
    ds_read_b64_tr_b16 a[40:41], v125 offset:0
    ds_read_b64_tr_b16 a[42:43], v125 offset:256
    ds_read_b64_tr_b16 a[44:45], v125 offset:8192
    ds_read_b64_tr_b16 a[46:47], v125 offset:8448
    s_waitcnt vmcnt(32) lgkmcnt(0)
    s_barrier
    s_lshl_b32 s60, s41, 8
    s_add_u32 s60, s60, 3145728
    s_add_u32 s64, s10, s60
    s_addc_u32 s65, s11, 0
    s_lshl_b32 s61, s40, 12
    s_add_u32 m0, s61, 32768
    s_nop 0
    global_load_lds_dwordx4 v112, s[64:65]
    s_add_u32 m0, s61, 33792
    s_nop 0
    global_load_lds_dwordx4 v113, s[64:65]
    s_add_u32 m0, s61, 34816
    s_nop 0
    global_load_lds_dwordx4 v114, s[64:65]
    s_add_u32 m0, s61, 35840
    s_nop 0
    global_load_lds_dwordx4 v115, s[64:65]
    v_add_u32 v124, 49152, v120
    ds_read_b64_tr_b16 a[48:49], v124 offset:0
    ds_read_b64_tr_b16 a[50:51], v124 offset:256
    ds_read_b64_tr_b16 a[52:53], v124 offset:8192
    ds_read_b64_tr_b16 a[54:55], v124 offset:8448
    v_add_u32 v125, 49152, v121
    ds_read_b64_tr_b16 a[56:57], v125 offset:0
    ds_read_b64_tr_b16 a[58:59], v125 offset:256
    ds_read_b64_tr_b16 a[60:61], v125 offset:8192
    ds_read_b64_tr_b16 a[62:63], v125 offset:8448
    s_waitcnt vmcnt(32) lgkmcnt(0)
    s_barrier
    s_lshl_b32 s60, s41, 8
    s_add_u32 s60, s60, 3670016
    s_add_u32 s64, s10, s60
    s_addc_u32 s65, s11, 0
    s_lshl_b32 s61, s40, 12
    s_add_u32 m0, s61, 49152
    s_nop 0
    global_load_lds_dwordx4 v112, s[64:65]
    s_add_u32 m0, s61, 50176
    s_nop 0
    global_load_lds_dwordx4 v113, s[64:65]
    s_add_u32 m0, s61, 51200
    s_nop 0
    global_load_lds_dwordx4 v114, s[64:65]
    s_add_u32 m0, s61, 52224
    s_nop 0
    global_load_lds_dwordx4 v115, s[64:65]
    v_add_u32 v124, 65536, v120
    ds_read_b64_tr_b16 a[64:65], v124 offset:0
    ds_read_b64_tr_b16 a[66:67], v124 offset:256
    ds_read_b64_tr_b16 a[68:69], v124 offset:8192
    ds_read_b64_tr_b16 a[70:71], v124 offset:8448
    v_add_u32 v125, 65536, v121
    ds_read_b64_tr_b16 a[72:73], v125 offset:0
    ds_read_b64_tr_b16 a[74:75], v125 offset:256
    ds_read_b64_tr_b16 a[76:77], v125 offset:8192
    ds_read_b64_tr_b16 a[78:79], v125 offset:8448
    s_waitcnt vmcnt(32) lgkmcnt(0)
    s_barrier
    s_lshl_b32 s60, s41, 8
    s_add_u32 s60, s60, 0
    s_add_u32 s64, s12, s60
    s_addc_u32 s65, s13, 0
    s_lshl_b32 s61, s40, 12
    s_add_u32 m0, s61, 65536
    s_nop 0
    global_load_lds_dwordx4 v112, s[64:65]
    s_add_u32 m0, s61, 66560
    s_nop 0
    global_load_lds_dwordx4 v113, s[64:65]
    s_add_u32 m0, s61, 67584
    s_nop 0
    global_load_lds_dwordx4 v114, s[64:65]
    s_add_u32 m0, s61, 68608
    s_nop 0
    global_load_lds_dwordx4 v115, s[64:65]
    v_add_u32 v124, 81920, v120
    ds_read_b64_tr_b16 a[80:81], v124 offset:0
    ds_read_b64_tr_b16 a[82:83], v124 offset:256
    ds_read_b64_tr_b16 a[84:85], v124 offset:8192
    ds_read_b64_tr_b16 a[86:87], v124 offset:8448
    v_add_u32 v125, 81920, v121
    ds_read_b64_tr_b16 a[88:89], v125 offset:0
    ds_read_b64_tr_b16 a[90:91], v125 offset:256
    ds_read_b64_tr_b16 a[92:93], v125 offset:8192
    ds_read_b64_tr_b16 a[94:95], v125 offset:8448
    s_waitcnt vmcnt(32) lgkmcnt(0)
    s_barrier
    s_lshl_b32 s60, s41, 8
    s_add_u32 s60, s60, 524288
    s_add_u32 s64, s12, s60
    s_addc_u32 s65, s13, 0
    s_lshl_b32 s61, s40, 12
    s_add_u32 m0, s61, 81920
    s_nop 0
    global_load_lds_dwordx4 v112, s[64:65]
    s_add_u32 m0, s61, 82944
    s_nop 0
    global_load_lds_dwordx4 v113, s[64:65]
    s_add_u32 m0, s61, 83968
    s_nop 0
    global_load_lds_dwordx4 v114, s[64:65]
    s_add_u32 m0, s61, 84992
    s_nop 0
    global_load_lds_dwordx4 v115, s[64:65]
    v_add_u32 v124, 98304, v120
    ds_read_b64_tr_b16 a[96:97], v124 offset:0
    ds_read_b64_tr_b16 a[98:99], v124 offset:256
    ds_read_b64_tr_b16 a[100:101], v124 offset:8192
    ds_read_b64_tr_b16 a[102:103], v124 offset:8448
    v_add_u32 v125, 98304, v121
    ds_read_b64_tr_b16 a[104:105], v125 offset:0
    ds_read_b64_tr_b16 a[106:107], v125 offset:256
    ds_read_b64_tr_b16 a[108:109], v125 offset:8192
    ds_read_b64_tr_b16 a[110:111], v125 offset:8448
    s_waitcnt vmcnt(24) lgkmcnt(0)
    s_barrier
    s_lshl_b32 s60, s41, 8
    s_add_u32 s60, s60, 1048576
    s_add_u32 s64, s12, s60
    s_addc_u32 s65, s13, 0
    s_lshl_b32 s61, s40, 12
    s_add_u32 m0, s61, 98304
    s_nop 0
    global_load_lds_dwordx4 v112, s[64:65]
    s_add_u32 m0, s61, 99328
    s_nop 0
    global_load_lds_dwordx4 v113, s[64:65]
    s_add_u32 m0, s61, 100352
    s_nop 0
    global_load_lds_dwordx4 v114, s[64:65]
    s_add_u32 m0, s61, 101376
    s_nop 0
    global_load_lds_dwordx4 v115, s[64:65]
    v_add_u32 v124, 114688, v120
    ds_read_b64_tr_b16 a[112:113], v124 offset:0
    ds_read_b64_tr_b16 a[114:115], v124 offset:256
    ds_read_b64_tr_b16 a[116:117], v124 offset:8192
    ds_read_b64_tr_b16 a[118:119], v124 offset:8448
    v_add_u32 v125, 114688, v121
    ds_read_b64_tr_b16 a[120:121], v125 offset:0
    ds_read_b64_tr_b16 a[122:123], v125 offset:256
    ds_read_b64_tr_b16 a[124:125], v125 offset:8192
    ds_read_b64_tr_b16 a[126:127], v125 offset:8448
    s_waitcnt vmcnt(24) lgkmcnt(0)
    s_barrier
    s_cmp_lg_u32 s40, 0
    s_cbranch_scc1 L_hs_2
    s_getreg_b32 s60, hwreg(HW_REG_XCC_ID)
    s_and_b32 s60, s60, 15
    s_add_u32 s60, s60, 1
    v_mov_b32 v100, s60
    v_mov_b32 v101, s41
    s_mov_b64 exec, 1
    buffer_store_byte v100, v101, s[36:39], 0 offen sc1
    s_mov_b64 exec, -1
L_hs_2:
    s_lshl_b32 s60, s41, 8
    s_add_u32 s60, s60, 1572864
    s_add_u32 s64, s12, s60
    s_addc_u32 s65, s13, 0
    s_lshl_b32 s61, s40, 12
    s_add_u32 m0, s61, 114688
    s_nop 0
    global_load_lds_dwordx4 v112, s[64:65]
    s_add_u32 m0, s61, 115712
    s_nop 0
    global_load_lds_dwordx4 v113, s[64:65]
    s_add_u32 m0, s61, 116736
    s_nop 0
    global_load_lds_dwordx4 v114, s[64:65]
    s_add_u32 m0, s61, 117760
    s_nop 0
    global_load_lds_dwordx4 v115, s[64:65]
    v_add_u32 v124, 0, v120
    ds_read_b64_tr_b16 a[128:129], v124 offset:0
    ds_read_b64_tr_b16 a[130:131], v124 offset:256
    ds_read_b64_tr_b16 a[132:133], v124 offset:8192
    ds_read_b64_tr_b16 a[134:135], v124 offset:8448
    v_add_u32 v125, 0, v121
    ds_read_b64_tr_b16 a[136:137], v125 offset:0
    ds_read_b64_tr_b16 a[138:139], v125 offset:256
    ds_read_b64_tr_b16 a[140:141], v125 offset:8192
    ds_read_b64_tr_b16 a[142:143], v125 offset:8448
    s_waitcnt vmcnt(24) lgkmcnt(0)
    s_barrier
    s_lshl_b32 s60, s41, 8
    s_add_u32 s60, s60, 2097152
    s_add_u32 s64, s12, s60
    s_addc_u32 s65, s13, 0
    s_lshl_b32 s61, s40, 12
    s_add_u32 m0, s61, 0
    s_nop 0
    global_load_lds_dwordx4 v112, s[64:65]
    s_add_u32 m0, s61, 1024
    s_nop 0
    global_load_lds_dwordx4 v113, s[64:65]
    s_add_u32 m0, s61, 2048
    s_nop 0
    global_load_lds_dwordx4 v114, s[64:65]
    s_add_u32 m0, s61, 3072
    s_nop 0
    global_load_lds_dwordx4 v115, s[64:65]
    v_add_u32 v124, 16384, v120
    ds_read_b64_tr_b16 a[144:145], v124 offset:0
    ds_read_b64_tr_b16 a[146:147], v124 offset:256
    ds_read_b64_tr_b16 a[148:149], v124 offset:8192
    ds_read_b64_tr_b16 a[150:151], v124 offset:8448
    v_add_u32 v125, 16384, v121
    ds_read_b64_tr_b16 a[152:153], v125 offset:0
    ds_read_b64_tr_b16 a[154:155], v125 offset:256
    ds_read_b64_tr_b16 a[156:157], v125 offset:8192
    ds_read_b64_tr_b16 a[158:159], v125 offset:8448
    s_waitcnt vmcnt(24) lgkmcnt(0)
    s_barrier
    s_lshl_b32 s60, s41, 8
    s_add_u32 s60, s60, 2621440
    s_add_u32 s64, s12, s60
    s_addc_u32 s65, s13, 0
    s_lshl_b32 s61, s40, 12
    s_add_u32 m0, s61, 16384
    s_nop 0
    global_load_lds_dwordx4 v112, s[64:65]
    s_add_u32 m0, s61, 17408
    s_nop 0
    global_load_lds_dwordx4 v113, s[64:65]
    s_add_u32 m0, s61, 18432
    s_nop 0
    global_load_lds_dwordx4 v114, s[64:65]
    s_add_u32 m0, s61, 19456
    s_nop 0
    global_load_lds_dwordx4 v115, s[64:65]
    v_add_u32 v124, 32768, v120
    ds_read_b64_tr_b16 a[160:161], v124 offset:0
    ds_read_b64_tr_b16 a[162:163], v124 offset:256
    ds_read_b64_tr_b16 a[164:165], v124 offset:8192
    ds_read_b64_tr_b16 a[166:167], v124 offset:8448
    v_add_u32 v125, 32768, v121
    ds_read_b64_tr_b16 a[168:169], v125 offset:0
    ds_read_b64_tr_b16 a[170:171], v125 offset:256
    ds_read_b64_tr_b16 a[172:173], v125 offset:8192
    ds_read_b64_tr_b16 a[174:175], v125 offset:8448
    s_waitcnt vmcnt(24) lgkmcnt(0)
    s_barrier
    s_lshl_b32 s60, s41, 8
    s_add_u32 s60, s60, 3145728
    s_add_u32 s64, s12, s60
    s_addc_u32 s65, s13, 0
    s_lshl_b32 s61, s40, 12
    s_add_u32 m0, s61, 32768
    s_nop 0
    global_load_lds_dwordx4 v112, s[64:65]
    s_add_u32 m0, s61, 33792
    s_nop 0
    global_load_lds_dwordx4 v113, s[64:65]
    s_add_u32 m0, s61, 34816
    s_nop 0
    global_load_lds_dwordx4 v114, s[64:65]
    s_add_u32 m0, s61, 35840
    s_nop 0
    global_load_lds_dwordx4 v115, s[64:65]
    v_add_u32 v124, 49152, v120
    ds_read_b64_tr_b16 a[176:177], v124 offset:0
    ds_read_b64_tr_b16 a[178:179], v124 offset:256
    ds_read_b64_tr_b16 a[180:181], v124 offset:8192
    ds_read_b64_tr_b16 a[182:183], v124 offset:8448
    v_add_u32 v125, 49152, v121
    ds_read_b64_tr_b16 a[184:185], v125 offset:0
    ds_read_b64_tr_b16 a[186:187], v125 offset:256
    ds_read_b64_tr_b16 a[188:189], v125 offset:8192
    ds_read_b64_tr_b16 a[190:191], v125 offset:8448
    s_waitcnt vmcnt(24) lgkmcnt(0)
    s_barrier
    s_lshl_b32 s60, s41, 8
    s_add_u32 s60, s60, 3670016
    s_add_u32 s64, s12, s60
    s_addc_u32 s65, s13, 0
    s_lshl_b32 s61, s40, 12
    s_add_u32 m0, s61, 49152
    s_nop 0
    global_load_lds_dwordx4 v112, s[64:65]
    s_add_u32 m0, s61, 50176
    s_nop 0
    global_load_lds_dwordx4 v113, s[64:65]
    s_add_u32 m0, s61, 51200
    s_nop 0
    global_load_lds_dwordx4 v114, s[64:65]
    s_add_u32 m0, s61, 52224
    s_nop 0
    global_load_lds_dwordx4 v115, s[64:65]
    v_add_u32 v124, 65536, v120
    ds_read_b64_tr_b16 a[192:193], v124 offset:0
    ds_read_b64_tr_b16 a[194:195], v124 offset:256
    ds_read_b64_tr_b16 a[196:197], v124 offset:8192
    ds_read_b64_tr_b16 a[198:199], v124 offset:8448
    v_add_u32 v125, 65536, v121
    ds_read_b64_tr_b16 a[200:201], v125 offset:0
    ds_read_b64_tr_b16 a[202:203], v125 offset:256
    ds_read_b64_tr_b16 a[204:205], v125 offset:8192
    ds_read_b64_tr_b16 a[206:207], v125 offset:8448
    s_waitcnt vmcnt(24) lgkmcnt(0)
    s_barrier
    s_lshl_b32 s60, s41, 17
    s_add_u32 s60, s60, 0
    s_add_u32 s64, s14, s60
    s_addc_u32 s65, s15, 0
    s_lshl_b32 s61, s40, 12
    s_add_u32 m0, s61, 65536
    s_nop 0
    global_load_lds_dwordx4 v116, s[64:65]
    s_add_u32 m0, s61, 66560
    s_nop 0
    global_load_lds_dwordx4 v117, s[64:65]
    s_add_u32 m0, s61, 67584
    s_nop 0
    global_load_lds_dwordx4 v118, s[64:65]
    s_add_u32 m0, s61, 68608
    s_nop 0
    global_load_lds_dwordx4 v119, s[64:65]
    v_add_u32 v124, 81920, v120
    ds_read_b64_tr_b16 a[208:209], v124 offset:0
    ds_read_b64_tr_b16 a[210:211], v124 offset:256
    ds_read_b64_tr_b16 a[212:213], v124 offset:8192
    ds_read_b64_tr_b16 a[214:215], v124 offset:8448
    v_add_u32 v125, 81920, v121
    ds_read_b64_tr_b16 a[216:217], v125 offset:0
    ds_read_b64_tr_b16 a[218:219], v125 offset:256
    ds_read_b64_tr_b16 a[220:221], v125 offset:8192
    ds_read_b64_tr_b16 a[222:223], v125 offset:8448
    s_waitcnt vmcnt(24) lgkmcnt(0)
    s_barrier
    s_lshl_b32 s60, s41, 17
    s_add_u32 s60, s60, 256
    s_add_u32 s64, s14, s60
    s_addc_u32 s65, s15, 0
    s_lshl_b32 s61, s40, 12
    s_add_u32 m0, s61, 81920
    s_nop 0
    global_load_lds_dwordx4 v116, s[64:65]
    s_add_u32 m0, s61, 82944
    s_nop 0
    global_load_lds_dwordx4 v117, s[64:65]
    s_add_u32 m0, s61, 83968
    s_nop 0
    global_load_lds_dwordx4 v118, s[64:65]
    s_add_u32 m0, s61, 84992
    s_nop 0
    global_load_lds_dwordx4 v119, s[64:65]
    v_add_u32 v124, 98304, v120
    ds_read_b64_tr_b16 a[224:225], v124 offset:0
    ds_read_b64_tr_b16 a[226:227], v124 offset:256
    ds_read_b64_tr_b16 a[228:229], v124 offset:8192
    ds_read_b64_tr_b16 a[230:231], v124 offset:8448
    v_add_u32 v125, 98304, v121
    ds_read_b64_tr_b16 a[232:233], v125 offset:0
    ds_read_b64_tr_b16 a[234:235], v125 offset:256
    ds_read_b64_tr_b16 a[236:237], v125 offset:8192
    ds_read_b64_tr_b16 a[238:239], v125 offset:8448
    s_waitcnt vmcnt(24) lgkmcnt(0)
    s_barrier
    s_lshl_b32 s60, s41, 17
    s_add_u32 s60, s60, 65536
    s_add_u32 s64, s14, s60
    s_addc_u32 s65, s15, 0
    s_lshl_b32 s61, s40, 12
    s_add_u32 m0, s61, 98304
    s_nop 0
    global_load_lds_dwordx4 v116, s[64:65]
    s_add_u32 m0, s61, 99328
    s_nop 0
    global_load_lds_dwordx4 v117, s[64:65]
    s_add_u32 m0, s61, 100352
    s_nop 0
    global_load_lds_dwordx4 v118, s[64:65]
    s_add_u32 m0, s61, 101376
    s_nop 0
    global_load_lds_dwordx4 v119, s[64:65]
    v_add_u32 v124, 114688, v120
    ds_read_b64_tr_b16 a[240:241], v124 offset:0
    ds_read_b64_tr_b16 a[242:243], v124 offset:256
    ds_read_b64_tr_b16 a[244:245], v124 offset:8192
    ds_read_b64_tr_b16 a[246:247], v124 offset:8448
    v_add_u32 v125, 114688, v121
    ds_read_b64_tr_b16 a[248:249], v125 offset:0
    ds_read_b64_tr_b16 a[250:251], v125 offset:256
    ds_read_b64_tr_b16 a[252:253], v125 offset:8192
    ds_read_b64_tr_b16 a[254:255], v125 offset:8448
    s_waitcnt vmcnt(24) lgkmcnt(0)
    s_barrier
    s_lshl_b32 s60, s41, 17
    s_add_u32 s60, s60, 65792
    s_add_u32 s64, s14, s60
    s_addc_u32 s65, s15, 0
    s_lshl_b32 s61, s40, 12
    s_add_u32 m0, s61, 114688
    s_nop 0
    global_load_lds_dwordx4 v116, s[64:65]
    s_add_u32 m0, s61, 115712
    s_nop 0
    global_load_lds_dwordx4 v117, s[64:65]
    s_add_u32 m0, s61, 116736
    s_nop 0
    global_load_lds_dwordx4 v118, s[64:65]
    s_add_u32 m0, s61, 117760
    s_nop 0
    global_load_lds_dwordx4 v119, s[64:65]
    v_add_u32 v124, 0, v120
    ds_read_b64_tr_b16 v[128:129], v124 offset:0
    ds_read_b64_tr_b16 v[130:131], v124 offset:256
    ds_read_b64_tr_b16 v[132:133], v124 offset:8192
    ds_read_b64_tr_b16 v[134:135], v124 offset:8448
    v_add_u32 v125, 0, v121
    ds_read_b64_tr_b16 v[136:137], v125 offset:0
    ds_read_b64_tr_b16 v[138:139], v125 offset:256
    ds_read_b64_tr_b16 v[140:141], v125 offset:8192
    ds_read_b64_tr_b16 v[142:143], v125 offset:8448
    s_waitcnt vmcnt(24) lgkmcnt(0)
    s_barrier
    s_lshl_b32 s60, s41, 8
    s_add_u32 s60, s60, 0
    s_add_u32 s64, s8, s60
    s_addc_u32 s65, s9, 0
    s_lshl_b32 s61, s40, 12
    s_add_u32 m0, s61, 0
    s_nop 0
    global_load_lds_dwordx4 v112, s[64:65]
    s_add_u32 m0, s61, 1024
    s_nop 0
    global_load_lds_dwordx4 v113, s[64:65]
    s_add_u32 m0, s61, 2048
    s_nop 0
    global_load_lds_dwordx4 v114, s[64:65]
    s_add_u32 m0, s61, 3072
    s_nop 0
    global_load_lds_dwordx4 v115, s[64:65]
    v_add_u32 v124, 16384, v120
    ds_read_b64_tr_b16 v[144:145], v124 offset:0
    ds_read_b64_tr_b16 v[146:147], v124 offset:256
    ds_read_b64_tr_b16 v[148:149], v124 offset:8192
    ds_read_b64_tr_b16 v[150:151], v124 offset:8448
    v_add_u32 v125, 16384, v121
    ds_read_b64_tr_b16 v[152:153], v125 offset:0
    ds_read_b64_tr_b16 v[154:155], v125 offset:256
    ds_read_b64_tr_b16 v[156:157], v125 offset:8192
    ds_read_b64_tr_b16 v[158:159], v125 offset:8448
    s_waitcnt vmcnt(24) lgkmcnt(0)
    s_barrier
    s_lshl_b32 s60, s41, 8
    s_add_u32 s60, s60, 524288
    s_add_u32 s64, s8, s60
    s_addc_u32 s65, s9, 0
    s_lshl_b32 s61, s40, 12
    s_add_u32 m0, s61, 16384
    s_nop 0
    global_load_lds_dwordx4 v112, s[64:65]
    s_add_u32 m0, s61, 17408
    s_nop 0
    global_load_lds_dwordx4 v113, s[64:65]
    s_add_u32 m0, s61, 18432
    s_nop 0
    global_load_lds_dwordx4 v114, s[64:65]
    s_add_u32 m0, s61, 19456
    s_nop 0
    global_load_lds_dwordx4 v115, s[64:65]
    v_add_u32 v124, 32768, v120
    ds_read_b64_tr_b16 v[160:161], v124 offset:0
    ds_read_b64_tr_b16 v[162:163], v124 offset:256
    ds_read_b64_tr_b16 v[164:165], v124 offset:8192
    ds_read_b64_tr_b16 v[166:167], v124 offset:8448
    v_add_u32 v125, 32768, v121
    ds_read_b64_tr_b16 v[168:169], v125 offset:0
    ds_read_b64_tr_b16 v[170:171], v125 offset:256
    ds_read_b64_tr_b16 v[172:173], v125 offset:8192
    ds_read_b64_tr_b16 v[174:175], v125 offset:8448
    s_waitcnt vmcnt(24) lgkmcnt(0)
    s_barrier
    s_lshl_b32 s60, s41, 8
    s_add_u32 s60, s60, 1048576
    s_add_u32 s64, s8, s60
    s_addc_u32 s65, s9, 0
    s_lshl_b32 s61, s40, 12
    s_add_u32 m0, s61, 32768
    s_nop 0
    global_load_lds_dwordx4 v112, s[64:65]
    s_add_u32 m0, s61, 33792
    s_nop 0
    global_load_lds_dwordx4 v113, s[64:65]
    s_add_u32 m0, s61, 34816
    s_nop 0
    global_load_lds_dwordx4 v114, s[64:65]
    s_add_u32 m0, s61, 35840
    s_nop 0
    global_load_lds_dwordx4 v115, s[64:65]
    v_add_u32 v124, 49152, v120
    ds_read_b64_tr_b16 v[176:177], v124 offset:0
    ds_read_b64_tr_b16 v[178:179], v124 offset:256
    ds_read_b64_tr_b16 v[180:181], v124 offset:8192
    ds_read_b64_tr_b16 v[182:183], v124 offset:8448
    v_add_u32 v125, 49152, v121
    ds_read_b64_tr_b16 v[184:185], v125 offset:0
    ds_read_b64_tr_b16 v[186:187], v125 offset:256
    ds_read_b64_tr_b16 v[188:189], v125 offset:8192
    ds_read_b64_tr_b16 v[190:191], v125 offset:8448
    s_waitcnt vmcnt(24) lgkmcnt(0)
    s_barrier
    s_lshl_b32 s60, s41, 8
    s_add_u32 s60, s60, 1572864
    s_add_u32 s64, s8, s60
    s_addc_u32 s65, s9, 0
    s_lshl_b32 s61, s40, 12
    s_add_u32 m0, s61, 49152
    s_nop 0
    global_load_lds_dwordx4 v112, s[64:65]
    s_add_u32 m0, s61, 50176
    s_nop 0
    global_load_lds_dwordx4 v113, s[64:65]
    s_add_u32 m0, s61, 51200
    s_nop 0
    global_load_lds_dwordx4 v114, s[64:65]
    s_add_u32 m0, s61, 52224
    s_nop 0
    global_load_lds_dwordx4 v115, s[64:65]
    v_add_u32 v124, 65536, v122
    ds_read_b64_tr_b16 v[192:193], v124 offset:0
    ds_read_b64_tr_b16 v[194:195], v124 offset:512
    ds_read_b64_tr_b16 v[196:197], v124 offset:4096
    ds_read_b64_tr_b16 v[198:199], v124 offset:4608
    v_add_u32 v125, 65536, v123
    ds_read_b64_tr_b16 v[200:201], v125 offset:0
    ds_read_b64_tr_b16 v[202:203], v125 offset:512
    ds_read_b64_tr_b16 v[204:205], v125 offset:4096
    ds_read_b64_tr_b16 v[206:207], v125 offset:4608
    s_waitcnt vmcnt(24) lgkmcnt(0)
    s_barrier
    s_lshl_b32 s60, s41, 17
    s_add_u32 s60, s60, 512
    s_add_u32 s64, s14, s60
    s_addc_u32 s65, s15, 0
    s_lshl_b32 s61, s40, 12
    s_add_u32 m0, s61, 65536
    s_nop 0
    global_load_lds_dwordx4 v116, s[64:65]
    s_add_u32 m0, s61, 66560
    s_nop 0
    global_load_lds_dwordx4 v117, s[64:65]
    s_add_u32 m0, s61, 67584
    s_nop 0
    global_load_lds_dwordx4 v118, s[64:65]
    s_add_u32 m0, s61, 68608
    s_nop 0
    global_load_lds_dwordx4 v119, s[64:65]
    v_add_u32 v124, 81920, v122
    ds_read_b64_tr_b16 v[224:225], v124 offset:0
    ds_read_b64_tr_b16 v[226:227], v124 offset:512
    ds_read_b64_tr_b16 v[228:229], v124 offset:4096
    ds_read_b64_tr_b16 v[230:231], v124 offset:4608
    v_add_u32 v125, 81920, v123
    ds_read_b64_tr_b16 v[232:233], v125 offset:0
    ds_read_b64_tr_b16 v[234:235], v125 offset:512
    ds_read_b64_tr_b16 v[236:237], v125 offset:4096
    ds_read_b64_tr_b16 v[238:239], v125 offset:4608
    s_waitcnt vmcnt(24) lgkmcnt(0)
    s_barrier
    s_lshl_b32 s60, s41, 17
    s_add_u32 s60, s60, 66048
    s_add_u32 s64, s14, s60
    s_addc_u32 s65, s15, 0
    s_lshl_b32 s61, s40, 12
    s_add_u32 m0, s61, 81920
    s_nop 0
    global_load_lds_dwordx4 v116, s[64:65]
    s_add_u32 m0, s61, 82944
    s_nop 0
    global_load_lds_dwordx4 v117, s[64:65]
    s_add_u32 m0, s61, 83968
    s_nop 0
    global_load_lds_dwordx4 v118, s[64:65]
    s_add_u32 m0, s61, 84992
    s_nop 0
    global_load_lds_dwordx4 v119, s[64:65]
    v_add_u32 v124, 98304, v122
    ds_read_b64_tr_b16 v[208:209], v124 offset:0
    ds_read_b64_tr_b16 v[210:211], v124 offset:512
    ds_read_b64_tr_b16 v[212:213], v124 offset:4096
    ds_read_b64_tr_b16 v[214:215], v124 offset:4608
    v_add_u32 v125, 98304, v123
    ds_read_b64_tr_b16 v[216:217], v125 offset:0
    ds_read_b64_tr_b16 v[218:219], v125 offset:512
    ds_read_b64_tr_b16 v[220:221], v125 offset:4096
    ds_read_b64_tr_b16 v[222:223], v125 offset:4608
    s_waitcnt vmcnt(24) lgkmcnt(0)
    s_barrier
    s_lshl_b32 s60, s41, 17
    s_add_u32 s60, s60, 768
    s_add_u32 s64, s14, s60
    s_addc_u32 s65, s15, 0
    s_lshl_b32 s61, s40, 12
    s_add_u32 m0, s61, 98304
    s_nop 0
    global_load_lds_dwordx4 v116, s[64:65]
    s_add_u32 m0, s61, 99328
    s_nop 0
    global_load_lds_dwordx4 v117, s[64:65]
    s_add_u32 m0, s61, 100352
    s_nop 0
    global_load_lds_dwordx4 v118, s[64:65]
    s_add_u32 m0, s61, 101376
    s_nop 0
    global_load_lds_dwordx4 v119, s[64:65]
    v_add_u32 v124, 114688, v122
    ds_read_b64_tr_b16 v[240:241], v124 offset:0
    ds_read_b64_tr_b16 v[242:243], v124 offset:512
    ds_read_b64_tr_b16 v[244:245], v124 offset:4096
    ds_read_b64_tr_b16 v[246:247], v124 offset:4608
    v_add_u32 v125, 114688, v123
    ds_read_b64_tr_b16 v[248:249], v125 offset:0
    ds_read_b64_tr_b16 v[250:251], v125 offset:512
    ds_read_b64_tr_b16 v[252:253], v125 offset:4096
    ds_read_b64_tr_b16 v[254:255], v125 offset:4608
    s_waitcnt vmcnt(24) lgkmcnt(0)
    s_barrier
    s_lshl_b32 s60, s41, 17
    s_add_u32 s60, s60, 66304
    s_add_u32 s64, s14, s60
    s_addc_u32 s65, s15, 0
    s_lshl_b32 s61, s40, 12
    s_add_u32 m0, s61, 114688
    s_nop 0
    global_load_lds_dwordx4 v116, s[64:65]
    s_add_u32 m0, s61, 115712
    s_nop 0
    global_load_lds_dwordx4 v117, s[64:65]
    s_add_u32 m0, s61, 116736
    s_nop 0
    global_load_lds_dwordx4 v118, s[64:65]
    s_add_u32 m0, s61, 117760
    s_nop 0
    global_load_lds_dwordx4 v119, s[64:65]
    v_add_u32 v124, 0, v120
    ds_read_b64_tr_b16 v[24:25], v124 offset:0
    ds_read_b64_tr_b16 v[26:27], v124 offset:256
    ds_read_b64_tr_b16 v[28:29], v124 offset:8192
    ds_read_b64_tr_b16 v[30:31], v124 offset:8448
    v_add_u32 v125, 0, v121
    ds_read_b64_tr_b16 v[32:33], v125 offset:0
    ds_read_b64_tr_b16 v[34:35], v125 offset:256
    ds_read_b64_tr_b16 v[36:37], v125 offset:8192
    ds_read_b64_tr_b16 v[38:39], v125 offset:8448
    s_waitcnt vmcnt(24) lgkmcnt(0)
    s_barrier
    v_add_u32 v124, 16384, v120
    ds_read_b64_tr_b16 v[40:41], v124 offset:0
    ds_read_b64_tr_b16 v[42:43], v124 offset:256
    ds_read_b64_tr_b16 v[44:45], v124 offset:8192
    ds_read_b64_tr_b16 v[46:47], v124 offset:8448
    v_add_u32 v125, 16384, v121
    ds_read_b64_tr_b16 v[48:49], v125 offset:0
    ds_read_b64_tr_b16 v[50:51], v125 offset:256
    ds_read_b64_tr_b16 v[52:53], v125 offset:8192
    ds_read_b64_tr_b16 v[54:55], v125 offset:8448
    s_waitcnt vmcnt(20) lgkmcnt(0)
    s_barrier
    v_add_u32 v124, 32768, v120
    ds_read_b64_tr_b16 v[56:57], v124 offset:0
    ds_read_b64_tr_b16 v[58:59], v124 offset:256
    ds_read_b64_tr_b16 v[60:61], v124 offset:8192
    ds_read_b64_tr_b16 v[62:63], v124 offset:8448
    v_add_u32 v125, 32768, v121
    ds_read_b64_tr_b16 v[64:65], v125 offset:0
    ds_read_b64_tr_b16 v[66:67], v125 offset:256
    ds_read_b64_tr_b16 v[68:69], v125 offset:8192
    ds_read_b64_tr_b16 v[70:71], v125 offset:8448
    s_waitcnt vmcnt(16) lgkmcnt(0)
    s_barrier
    v_add_u32 v124, 49152, v120
    ds_read_b64_tr_b16 v[72:73], v124 offset:0
    ds_read_b64_tr_b16 v[74:75], v124 offset:256
    ds_read_b64_tr_b16 v[76:77], v124 offset:8192
    ds_read_b64_tr_b16 v[78:79], v124 offset:8448
    v_add_u32 v125, 49152, v121
    ds_read_b64_tr_b16 v[80:81], v125 offset:0
    ds_read_b64_tr_b16 v[82:83], v125 offset:256
    ds_read_b64_tr_b16 v[84:85], v125 offset:8192
    ds_read_b64_tr_b16 v[86:87], v125 offset:8448
    s_waitcnt vmcnt(12) lgkmcnt(0)
    s_barrier
    ds_write_b128 v8, v[24:27] offset:0
    ds_write_b128 v8, v[28:31] offset:1024
    ds_write_b128 v8, v[32:35] offset:8192
    ds_write_b128 v8, v[36:39] offset:9216
    ds_write_b128 v8, v[40:43] offset:16384
    ds_write_b128 v8, v[44:47] offset:17408
    ds_write_b128 v8, v[48:51] offset:24576
    ds_write_b128 v8, v[52:55] offset:25600
    ds_write_b128 v8, v[56:59] offset:32768
    ds_write_b128 v8, v[60:63] offset:33792
    ds_write_b128 v8, v[64:67] offset:40960
    ds_write_b128 v8, v[68:71] offset:41984
    ds_write_b128 v8, v[72:75] offset:49152
    ds_write_b128 v8, v[76:79] offset:50176
    ds_write_b128 v8, v[80:83] offset:57344
    ds_write_b128 v8, v[84:87] offset:58368
    v_add_u32 v124, 65536, v122
    ds_read_b64_tr_b16 v[24:25], v124 offset:0
    ds_read_b64_tr_b16 v[26:27], v124 offset:512
    ds_read_b64_tr_b16 v[28:29], v124 offset:4096
    ds_read_b64_tr_b16 v[30:31], v124 offset:4608
    v_add_u32 v125, 65536, v123
    ds_read_b64_tr_b16 v[32:33], v125 offset:0
    ds_read_b64_tr_b16 v[34:35], v125 offset:512
    ds_read_b64_tr_b16 v[36:37], v125 offset:4096
    ds_read_b64_tr_b16 v[38:39], v125 offset:4608
    s_waitcnt vmcnt(8) lgkmcnt(0)
    s_barrier
    v_add_u32 v124, 81920, v122
    ds_read_b64_tr_b16 v[40:41], v124 offset:0
    ds_read_b64_tr_b16 v[42:43], v124 offset:512
    ds_read_b64_tr_b16 v[44:45], v124 offset:4096
    ds_read_b64_tr_b16 v[46:47], v124 offset:4608
    v_add_u32 v125, 81920, v123
    ds_read_b64_tr_b16 v[48:49], v125 offset:0
    ds_read_b64_tr_b16 v[50:51], v125 offset:512
    ds_read_b64_tr_b16 v[52:53], v125 offset:4096
    ds_read_b64_tr_b16 v[54:55], v125 offset:4608
    s_waitcnt vmcnt(4) lgkmcnt(0)
    s_barrier
    v_add_u32 v124, 98304, v122
    ds_read_b64_tr_b16 v[56:57], v124 offset:0
    ds_read_b64_tr_b16 v[58:59], v124 offset:512
    ds_read_b64_tr_b16 v[60:61], v124 offset:4096
    ds_read_b64_tr_b16 v[62:63], v124 offset:4608
    v_add_u32 v125, 98304, v123
    ds_read_b64_tr_b16 v[64:65], v125 offset:0
    ds_read_b64_tr_b16 v[66:67], v125 offset:512
    ds_read_b64_tr_b16 v[68:69], v125 offset:4096
    ds_read_b64_tr_b16 v[70:71], v125 offset:4608
    s_waitcnt vmcnt(0) lgkmcnt(0)
    s_barrier
    v_add_u32 v124, 114688, v122
    ds_read_b64_tr_b16 v[72:73], v124 offset:0
    ds_read_b64_tr_b16 v[74:75], v124 offset:512
    ds_read_b64_tr_b16 v[76:77], v124 offset:4096
    ds_read_b64_tr_b16 v[78:79], v124 offset:4608
    v_add_u32 v125, 114688, v123
    ds_read_b64_tr_b16 v[80:81], v125 offset:0
    ds_read_b64_tr_b16 v[82:83], v125 offset:512
    ds_read_b64_tr_b16 v[84:85], v125 offset:4096
    ds_read_b64_tr_b16 v[86:87], v125 offset:4608
    s_waitcnt lgkmcnt(0)
    s_barrier
    ds_write_b128 v9, v[24:27] offset:0
    ds_write_b128 v9, v[28:31] offset:1024
    ds_write_b128 v9, v[32:35] offset:8192
    ds_write_b128 v9, v[36:39] offset:9216
    ds_write_b128 v9, v[40:43] offset:16384
    ds_write_b128 v9, v[44:47] offset:17408
    ds_write_b128 v9, v[48:51] offset:24576
    ds_write_b128 v9, v[52:55] offset:25600
    ds_write_b128 v9, v[56:59] offset:32768
    ds_write_b128 v9, v[60:63] offset:33792
    ds_write_b128 v9, v[64:67] offset:40960
    ds_write_b128 v9, v[68:71] offset:41984
    ds_write_b128 v9, v[72:75] offset:49152
    ds_write_b128 v9, v[76:79] offset:50176
    ds_write_b128 v9, v[80:83] offset:57344
    ds_write_b128 v9, v[84:87] offset:58368
    s_waitcnt lgkmcnt(0)
    s_mov_b32 s42, 0
    s_mov_b32 s43, 0
    s_mov_b32 s44, 0x3e0293ee
    s_mov_b32 s66, 0x3e0293ee
    s_mov_b32 s67, 0x3e0293ee
    s_mov_b32 s48, 0
    s_mov_b32 s49, 65536
    s_mov_b32 s50, 131072
    s_mov_b32 s51, 196608
    s_mov_b32 s57, 262144
    s_lshl_b32 s60, s41, 9
    s_add_u32 s68, s60, 393216
    s_mov_b32 s92, 0x110011
    s_mov_b32 s93, 0x110011
    s_mov_b32 s94, 0x220022
    s_mov_b32 s95, 0x220022
    s_mov_b32 s96, 0x11001100
    s_mov_b32 s97, 0x11001100
    s_mov_b32 s98, 0x22002200
    s_mov_b32 s99, 0x22002200
    s_mov_b32 s46, 0xf0f0f0f0
    s_mov_b32 s47, 0xf0f0f0f0
    s_mov_b32 s70, 0xcccccccc
    s_mov_b32 s71, 0xcccccccc
    s_mov_b32 s54, 131072
    s_mov_b32 s55, 135168
    s_mov_b32 s52, 8192
    s_mov_b32 s53, 24576
    s_lshl_b32 s60, s41, 12
    s_add_u32 s58, s60, 8257536
    s_mov_b32 s101, s58
    s_lshl_b32 s60, s41, 13
    s_lshl_b32 s61, s40, 11
    s_add_u32 s60, s60, s61
    s_add_u32 s56, s60, 41811968
    s_add_u32 s69, s60, 58589184
    s_lshl_b32 s60, s41, 2
    s_add_u32 s60, s60, s40
    s_lshl_b32 s60, s60, 12
    s_add_u32 s72, s60, 524288
    v_mov_b64 v[104:105], 0
    v_mov_b64 v[106:107], 0
    v_mov_b64 v[108:109], 0
    v_mov_b64 v[110:111], 0
    v_mov_b64 v[112:113], 0
    v_mov_b64 v[114:115], 0
    v_mov_b64 v[116:117], 0
    v_mov_b64 v[118:119], 0
    ds_read_b128 v[12:15], v8 offset:0
    ds_read_b128 v[16:19], v8 offset:1024
    ds_read_b128 v[120:123], v8 offset:8192
    ds_read_b128 v[124:127], v8 offset:9216
    ds_read_b128 v[72:75], v8 offset:16384
    ds_read_b128 v[76:79], v8 offset:17408
    ds_read_b128 v[80:83], v8 offset:24576
    ds_read_b128 v[84:87], v8 offset:25600
    ds_read_b128 v[88:91], v8 offset:32768
    ds_read_b128 v[92:95], v8 offset:33792
    ds_read_b128 v[96:99], v8 offset:40960
    ds_read_b128 v[100:103], v8 offset:41984
    ds_read_b128 v[56:59], v8 offset:49152
    ds_read_b128 v[60:63], v8 offset:50176
    ds_read_b128 v[64:67], v8 offset:57344
    ds_read_b128 v[68:71], v8 offset:58368
    v_subrev_u32 v25, 131072, v10
    v_lshrrev_b32 v25, 2, v25
    v_and_b32 v25, 0x7f, v25
L_hsw_3:
    buffer_load_dword v24, v25, s[36:39], 0 offen sc1
    s_waitcnt vmcnt(0)
    v_subrev_u32 v26, 0x01010101, v24
    v_not_b32 v27, v24
    v_and_b32 v26, v26, v27
    v_and_b32 v26, 0x80808080, v26
    v_cmp_ne_u32 vcc, 0, v26
    s_nop 0
    s_and_b32 s60, vcc_lo, 0xff
    v_cmp_gt_u32 vcc, 96, v24
    s_nop 0
    s_and_b32 s61, vcc_lo, 0x10000
    s_or_b32 s60, s60, s61
    s_cmp_eq_u32 s60, 0
    s_cbranch_scc1 L_hsok_4
    s_add_u32 s59, s59, 1
    s_cmp_gt_u32 s59, 262144
    s_cbranch_scc1 L_chain_abort_1
    s_sleep 2
    s_branch L_hsw_3
L_hsok_4:
    v_readfirstlane_b32 s60, v24
    s_nop 0
    s_and_b32 s60, s60, 0xff
    s_mul_i32 s60, s60, 0x01010101
    v_cmp_ne_u32 vcc, s60, v24
    s_nop 0
    s_and_b32 s63, vcc_lo, 0xff
L_av0_6:
    buffer_load_dword v11, off, s[32:35], s68 sc1
    s_waitcnt vmcnt(0)
    v_cmp_gt_u32 vcc, 2, v11
    s_cbranch_vccz L_av0ok_7
    s_add_u32 s59, s59, 1
    s_cmp_gt_u32 s59, 262144
    s_cbranch_scc1 L_chain_abort_1
    s_sleep 4
    s_branch L_av0_6
L_av0ok_7:
    s_lshl_b32 s61, s40, 11
    s_add_u32 m0, s61, 139264
    s_nop 0
    buffer_load_dwordx4 v10, s[32:35], s56 offen sc1 lds
    buffer_load_dwordx4 v10, s[32:35], s56 offen offset:1024 sc1 lds
    s_add_u32 m0, s61, 147456
    s_nop 0
    buffer_load_dwordx4 v10, s[32:35], s69 offen sc1 lds
    buffer_load_dwordx4 v10, s[32:35], s69 offen offset:1024 sc1 lds
    s_add_u32 s56, s56, 262144
    s_add_u32 s69, s69, 262144
    s_waitcnt vmcnt(0) lgkmcnt(0)
    s_mov_b32 s73, 0
    s_mov_b32 s62, 2
    s_mov_b32 s101, 0
    s_cmp_lg_u32 s63, 0
    s_mov_b32 s63, 0
    s_cbranch_scc1 L_chain_slow_5
L_fast_loops:
    s_cmp_eq_u32 s40, 1
    s_cbranch_scc1 L_cl_0_1_9
    s_cmp_eq_u32 s40, 2
    s_cbranch_scc1 L_cl_0_2_10
    s_cmp_eq_u32 s40, 3
    s_cbranch_scc1 L_cl_0_3_11
L_cl_0_0_8:
    buffer_load_dwordx4 v[48:51], v10, s[32:35], s54 offen offset:0 sc1
    buffer_load_dwordx4 v[52:55], v10, s[32:35], s54 offen offset:1024 sc1
L_chain_loop_w0_16:
    s_mov_b32 s60, 0
L_poll_18:
    buffer_load_dwordx4 v[48:51], v10, s[32:35], s54 offen offset:0 sc1
    buffer_load_dwordx4 v[52:55], v10, s[32:35], s54 offen offset:1024 sc1
    s_add_u32 s60, s60, 1
    s_cmp_gt_u32 s60, 64
    s_cbranch_scc1 L_pexact_19
    s_waitcnt vmcnt(2)
    v_max3_u32 v47, v48, v49, v50
    v_max3_u32 v47, v47, v51, v52
    ds_write_b128 v10, v[48:51] offset:0
    v_max3_u32 v47, v47, v53, v54
    v_max_u32 v47, v47, v55
    ds_write_b128 v10, v[52:55] offset:1024
    v_cmp_le_u32 vcc, s45, v47
    s_nop 0
    s_and_b64 exec, exec, vcc
    s_cbranch_scc1 L_poll_18
L_pout_20:
    s_mov_b64 exec, -1
    s_waitcnt lgkmcnt(0)
    s_barrier
    ds_read_b128 v[24:27], v10 offset:0
    ds_read_b128 v[28:31], v10 offset:1024
    ds_read_b128 v[32:35], v10 offset:2048
    ds_read_b128 v[36:39], v10 offset:3072
    s_cmp_eq_u32 s42, 63
    s_cbranch_scc1 L_chain_last_17
    s_waitcnt lgkmcnt(3)
    v_smfmac_f32_16x16x64_bf16 v[104:107], v[24:27], v[12:19], v0
    v_smfmac_f32_16x16x64_bf16 v[108:111], v[24:27], v[120:127], v0
    ds_read_b128 v[12:15], v10 offset:16384
    s_waitcnt lgkmcnt(3)
    v_smfmac_f32_16x16x64_bf16 v[104:107], v[28:31], v[72:79], v0
    ds_read_b128 v[16:19], v10 offset:17408
    v_smfmac_f32_16x16x64_bf16 v[108:111], v[28:31], v[80:87], v0
    ds_read_b128 v[72:75], v10 offset:8192
    v_mov_b32 v20, s42
    s_waitcnt lgkmcnt(4)
    v_smfmac_f32_16x16x64_bf16 v[104:107], v[32:35], v[88:95], v0
    ds_read_b128 v[76:79], v10 offset:9216
    v_smfmac_f32_16x16x64_bf16 v[108:111], v[32:35], v[96:103], v0
    ds_read_b128 v[80:83], v10 offset:10240
    s_waitcnt lgkmcnt(5)
    v_smfmac_f32_16x16x64_bf16 v[104:107], v[36:39], v[56:63], v0
    ds_read_b128 v[84:87], v10 offset:11264
    v_smfmac_f32_16x16x64_bf16 v[108:111], v[36:39], v[64:71], v0
    ds_read_b128 v[88:91], v10 offset:12288
    v_smfmac_f32_16x16x64_bf16 v[112:115], v[24:27], a[64:71], v0
    ds_read_b128 v[92:95], v10 offset:13312
    v_smfmac_f32_16x16x64_bf16 v[116:119], v[24:27], a[72:79], v0
    ds_read_b128 v[96:99], v10 offset:14336
    v_smfmac_f32_16x16x64_bf16 v[112:115], v[28:31], a[80:87], v0
    ds_read_b128 v[100:103], v10 offset:15360
    v_smfmac_f32_16x16x64_bf16 v[116:119], v[28:31], a[88:95], v0
    s_waitcnt vmcnt(0)
    ds_read_b128 v[40:43], v10 offset:4096
    v_smfmac_f32_16x16x64_bf16 v[112:115], v[32:35], a[96:103], v0
    s_waitcnt vmcnt(0)
    s_mov_b32 m0, 139264
    ds_read_b128 v[44:47], v10 offset:5120
    v_smfmac_f32_16x16x64_bf16 v[116:119], v[32:35], a[104:111], v0
    s_waitcnt lgkmcnt(2)
    s_barrier
    v_smfmac_f32_16x16x64_bf16 v[112:115], v[36:39], a[112:119], v0
    buffer_load_dwordx4 v10, s[32:35], s56 offen sc1 lds
    v_mov_b64 v[120:121], 0
    v_smfmac_f32_16x16x64_bf16 v[116:119], v[36:39], a[120:127], v0
    ds_read_b128 v[48:51], v10 offset:6144
    v_mov_b64 v[122:123], 0
    s_waitcnt lgkmcnt(2)
    v_smfmac_f32_16x16x64_bf16 v[104:107], v[40:43], a[0:7], v0
    ds_read_b128 v[52:55], v10 offset:7168
    v_mov_b64 v[124:125], 0
    v_smfmac_f32_16x16x64_bf16 v[108:111], v[40:43], a[8:15], v0
    v_mov_b64 v[126:127], 0
    v_smfmac_f32_16x16x64_bf16 v[112:115], v[40:43], a[128:135], v0
    buffer_load_dwordx4 v10, s[32:35], s56 offen offset:1024 sc1 lds
    s_mov_b32 m0, 147456
    v_smfmac_f32_16x16x64_bf16 v[116:119], v[40:43], a[136:143], v0
    s_waitcnt lgkmcnt(2)
    v_smfmac_f32_16x16x64_bf16 v[104:107], v[44:47], a[16:23], v0
    buffer_store_dword v20, off, s[32:35], s68 offset:384 sc1
    v_mov_b32 v56, s45
    v_smfmac_f32_16x16x64_bf16 v[108:111], v[44:47], a[24:31], v0
    buffer_load_dword v11, off, s[32:35], s68 sc1
    v_mov_b32 v57, s45
    v_smfmac_f32_16x16x64_bf16 v[112:115], v[44:47], a[144:151], v0
    buffer_load_dwordx4 v10, s[32:35], s69 offen sc1 lds
    v_mov_b64 v[58:59], v[56:57]
    v_smfmac_f32_16x16x64_bf16 v[116:119], v[44:47], a[152:159], v0
    s_waitcnt lgkmcnt(1)
    v_smfmac_f32_16x16x64_bf16 v[104:107], v[48:51], a[32:39], v0
    v_smfmac_f32_16x16x64_bf16 v[108:111], v[48:51], a[40:47], v0
    s_waitcnt lgkmcnt(0)
    v_smfmac_f32_16x16x64_bf16 v[104:107], v[52:55], a[48:55], v0
    buffer_load_dwordx4 v10, s[32:35], s69 offen offset:1024 sc1 lds
    v_smfmac_f32_16x16x64_bf16 v[108:111], v[52:55], a[56:63], v0
    v_smfmac_f32_16x16x64_bf16 v[112:115], v[48:51], a[160:167], v0
    v_smfmac_f32_16x16x64_bf16 v[116:119], v[48:51], a[168:175], v0
    v_add_f32 v104, v104, v106
    v_smfmac_f32_16x16x64_bf16 v[112:115], v[52:55], a[176:183], v0
    v_add_f32 v105, v105, v107
    v_smfmac_f32_16x16x64_bf16 v[116:119], v[52:55], a[184:191], v0
    v_add_f32 v108, v108, v110
    v_smfmac_f32_16x16x64_bf16 v[120:123], v[24:27], a[192:199], v0
    v_add_f32 v109, v109, v111
    v_smfmac_f32_16x16x64_bf16 v[124:127], v[24:27], a[200:207], v0
    v_cvt_pk_bf16_f32 v104, v104, v105
    v_add_f32 v112, v112, v114
    v_add_f32 v113, v113, v115
    v_cvt_pk_bf16_f32 v21, v112, v113
    ds_write2_b32 v4, v21, v104 offset0:0 offset1:1
    v_pk_add_f32 v[116:117], v[116:117], v[118:119]
    v_cvt_pk_bf16_f32 v108, v108, v109
    v_cvt_pk_bf16_f32 v23, v116, v117
    ds_write2_b32 v4, v23, v108 offset0:128 offset1:129
    v_smfmac_f32_16x16x64_bf16 v[120:123], v[28:31], a[208:215], v0
    buffer_store_dwordx4 v[56:59], v2, s[32:35], s57 offen offset:0
    v_smfmac_f32_16x16x64_bf16 v[124:127], v[28:31], a[216:223], v0
    v_smfmac_f32_16x16x64_bf16 v[120:123], v[32:35], a[224:231], v0
    buffer_store_dwordx4 v[56:59], v2, s[32:35], s57 offen offset:1024
    v_smfmac_f32_16x16x64_bf16 v[124:127], v[32:35], a[232:239], v0
    s_waitcnt lgkmcnt(0)
    s_barrier
    ds_read_b64_tr_b16 v[56:57], v5 offset:0
    ds_read_b64_tr_b16 v[58:59], v5 offset:256
    v_smfmac_f32_16x16x64_bf16 v[120:123], v[36:39], a[240:247], v0
    ds_read_b64_tr_b16 v[60:61], v5 offset:1024
    ds_read_b64_tr_b16 v[62:63], v5 offset:1280
    v_smfmac_f32_16x16x64_bf16 v[124:127], v[36:39], a[248:255], v0
    ds_read_b64_tr_b16 v[64:65], v5 offset:2048
    ds_read_b64_tr_b16 v[66:67], v5 offset:2304
    v_smfmac_f32_16x16x64_bf16 v[120:123], v[40:43], v[128:135], v0
    ds_read_b64_tr_b16 v[68:69], v5 offset:3072
    ds_read_b64_tr_b16 v[70:71], v5 offset:3328
    v_smfmac_f32_16x16x64_bf16 v[124:127], v[40:43], v[136:143], v0
    s_waitcnt lgkmcnt(6)
    v_mfma_f32_16x16x32_bf16 v[112:115], v[56:59], v[56:59], 0
    ds_read_b128 v[24:27], v9 offset:0
    v_mfma_f32_16x16x32_bf16 v[104:107], v[72:75], v[56:59], 0
    ds_read_b128 v[28:31], v9 offset:1024
    v_mfma_f32_16x16x32_bf16 v[108:111], v[88:91], v[56:59], 0
    s_waitcnt lgkmcnt(6)
    v_mfma_f32_16x16x32_bf16 v[112:115], v[60:63], v[60:63], v[112:115]
    ds_read_b128 v[32:35], v9 offset:8192
    v_mfma_f32_16x16x32_bf16 v[104:107], v[76:79], v[60:63], v[104:107]
    ds_read_b128 v[36:39], v9 offset:9216
    v_mfma_f32_16x16x32_bf16 v[108:111], v[92:95], v[60:63], v[108:111]
    s_waitcnt lgkmcnt(6)
    v_mfma_f32_16x16x32_bf16 v[112:115], v[64:67], v[64:67], v[112:115]
    ds_read_b128 v[72:75], v9 offset:16384
    v_mfma_f32_16x16x32_bf16 v[104:107], v[80:83], v[64:67], v[104:107]
    ds_read_b128 v[76:79], v9 offset:17408
    v_mfma_f32_16x16x32_bf16 v[108:111], v[96:99], v[64:67], v[108:111]
    s_waitcnt lgkmcnt(6)
    v_mfma_f32_16x16x32_bf16 v[112:115], v[68:71], v[68:71], v[112:115]
    ds_read_b128 v[88:91], v9 offset:24576
    v_mfma_f32_16x16x32_bf16 v[104:107], v[84:87], v[68:71], v[104:107]
    ds_read_b128 v[92:95], v9 offset:25600
    v_mfma_f32_16x16x32_bf16 v[108:111], v[100:103], v[68:71], v[108:111]
    v_smfmac_f32_16x16x64_bf16 v[120:123], v[44:47], v[144:151], v0
    v_mov_b32 v84, 0x3f803f80
    v_smfmac_f32_16x16x64_bf16 v[124:127], v[44:47], v[152:159], v0
    v_max3_f32 v116, v112, v113, v104
    v_max3_f32 v117, v105, v106, v107
    v_max3_f32 v116, v116, v108, v109
    v_max3_f32 v117, v117, v110, v111
    v_max_f32 v116, v116, v117
    v_max_f32 v117, v116, v117
    v_smfmac_f32_16x16x64_bf16 v[120:123], v[48:51], v[160:167], v0
    v_permlane32_swap_b32 v116, v117
    v_max_f32 v116, v116, v117
    v_max_f32 v117, v116, v117
    v_smfmac_f32_16x16x64_bf16 v[124:127], v[48:51], v[168:175], v0
    v_permlane16_swap_b32 v116, v117
    v_smfmac_f32_16x16x64_bf16 v[120:123], v[52:55], v[176:183], v0
    v_max_f32 v116, v116, v117
    v_smfmac_f32_16x16x64_bf16 v[124:127], v[52:55], v[184:191], v0
    v_mul_f32 v116, s44, v116
    v_mov_b32 v85, 0x3f803f80
    v_pk_fma_f32 v[104:105], v[104:105], s[66:67], v[116:117] op_sel_hi:[1,1,0] neg_lo:[0,0,1] neg_hi:[0,0,1]
    v_pk_fma_f32 v[106:107], v[106:107], s[66:67], v[116:117] op_sel_hi:[1,1,0] neg_lo:[0,0,1] neg_hi:[0,0,1]
    v_exp_f32 v104, v104
    v_exp_f32 v105, v105
    v_pk_fma_f32 v[108:109], v[108:109], s[66:67], v[116:117] op_sel_hi:[1,1,0] neg_lo:[0,0,1] neg_hi:[0,0,1]
    v_exp_f32 v106, v106
    v_exp_f32 v107, v107
    v_pk_fma_f32 v[110:111], v[110:111], s[66:67], v[116:117] op_sel_hi:[1,1,0] neg_lo:[0,0,1] neg_hi:[0,0,1]
    v_cvt_pk_bf16_f32 v60, v104, v105
    v_exp_f32 v108, v108
    v_exp_f32 v109, v109
    v_cvt_pk_bf16_f32 v61, v106, v107
    v_pk_fma_f32 v[112:113], v[112:113], s[66:67], v[116:117] op_sel_hi:[1,1,0] neg_lo:[0,0,1] neg_hi:[0,0,1]
    v_exp_f32 v110, v110
    v_exp_f32 v111, v111
    v_cvt_pk_bf16_f32 v62, v108, v109
    v_exp_f32 v112, v112
    v_cvt_pk_bf16_f32 v63, v110, v111
    v_exp_f32 v113, v113
    v_mov_b64 v[86:87], v[84:85]
    v_mfma_f32_16x16x32_bf16 v[96:99], v[12:15], v[60:63], 0
    v_cvt_pk_bf16_f32 v56, v112, v113
    v_mov_b32 v57, 0
    v_mfma_f32_16x16x32_bf16 v[80:83], v[84:87], v[60:63], 0
    v_add_f32 v120, v120, v122
    v_add_f32 v121, v121, v123
    v_mfma_f32_16x16x32_bf16 v[100:103], v[16:19], v[60:63], 0
    v_cvt_pk_bf16_f32 v20, v120, v121
    v_add_f32 v124, v124, v126
    v_add_f32 v125, v125, v127
    v_mfma_f32_16x16x16_bf16 v[96:99], v[20:21], v[56:57], v[96:99]
    v_cvt_pk_bf16_f32 v22, v124, v125
    v_mfma_f32_16x16x16_bf16 v[80:83], v[84:85], v[56:57], v[80:83]
    s_nop 0
    v_mfma_f32_16x16x16_bf16 v[100:103], v[22:23], v[56:57], v[100:103]
    ds_read_b128 v[40:43], v9 offset:32768
    ds_read_b128 v[44:47], v9 offset:33792
    buffer_store_dwordx4 v[20:23], v10, s[32:35], s58 offen offset:0 sc1
    s_nop 2
    v_rcp_f32 v118, v80
    s_mov_b64 exec, s[70:71]
    v_pk_mul_f32 v[96:97], v[96:97], v[118:119] op_sel_hi:[1,0]
    v_cvt_pk_bf16_f32 v96, v96, v97
    v_pk_mul_f32 v[98:99], v[98:99], v[118:119] op_sel_hi:[1,0]
    v_cvt_pk_bf16_f32 v97, v98, v99
    v_pk_mul_f32 v[100:101], v[100:101], v[118:119] op_sel_hi:[1,0]
    v_cvt_pk_bf16_f32 v98, v100, v101
    v_pk_mul_f32 v[102:103], v[102:103], v[118:119] op_sel_hi:[1,0]
    v_cvt_pk_bf16_f32 v99, v102, v103
    ds_write2_b64 v6, v[96:97], v[98:99] offset0:0 offset1:4
    s_mov_b64 exec, -1
    v_mov_b64 v[104:105], 0
    v_mov_b64 v[106:107], 0
    v_mov_b64 v[108:109], 0
    v_mov_b64 v[110:111], 0
    v_mov_b64 v[112:113], 0
    v_mov_b64 v[114:115], 0
    v_mov_b64 v[116:117], 0
    v_mov_b64 v[118:119], 0
    s_waitcnt lgkmcnt(0)
    s_barrier
    ds_read_b128 v[56:59], v7 offset:0
    ds_read_b128 v[60:63], v7 offset:64
    ds_read_b128 v[64:67], v7 offset:128
    ds_read_b128 v[68:71], v7 offset:192
    s_add_u32 s54, s52, 131072
    s_add_u32 s55, s54, 4096
    s_cmp_lt_u32 s42, 62
    s_cselect_b32 s60, 262144, 0
    s_add_u32 s56, s56, s60
    s_add_u32 s69, s69, s60
    s_mov_b32 s57, s43
    s_waitcnt lgkmcnt(3)
    v_smfmac_f32_16x16x64_bf16 v[104:107], v[56:59], v[192:199], v0
    v_mov_b32 v20, 0x3f80
    v_smfmac_f32_16x16x64_bf16 v[108:111], v[56:59], v[224:231], v0
    v_mov_b32 v21, 0x3f800000
    s_waitcnt lgkmcnt(2)
    v_smfmac_f32_16x16x64_bf16 v[104:107], v[60:63], v[200:207], v0
    ds_read_b128 v[48:51], v9 offset:40960
    v_cndmask_b32 v20, v20, v21, s[46:47]
    v_smfmac_f32_16x16x64_bf16 v[108:111], v[60:63], v[232:239], v0
    ds_read_b128 v[52:55], v9 offset:41984
    v_cndmask_b32 v80, 0, v20, s[92:93]
    s_waitcnt lgkmcnt(3)
    v_smfmac_f32_16x16x64_bf16 v[104:107], v[64:67], v[208:215], v0
    ds_read_b128 v[12:15], v9 offset:49152
    v_cndmask_b32 v81, 0, v20, s[94:95]
    v_smfmac_f32_16x16x64_bf16 v[108:111], v[64:67], v[240:247], v0
    ds_read_b128 v[16:19], v9 offset:50176
    v_cndmask_b32 v82, 0, v20, s[96:97]
    s_waitcnt lgkmcnt(4)
    v_smfmac_f32_16x16x64_bf16 v[104:107], v[68:71], v[216:223], v0
    ds_read_b128 v[120:123], v9 offset:57344
    v_cndmask_b32 v83, 0, v20, s[98:99]
    v_smfmac_f32_16x16x64_bf16 v[108:111], v[68:71], v[248:255], v0
    ds_read_b128 v[124:127], v9 offset:58368
    v_smfmac_f32_16x16x64_bf16 v[112:115], v[56:59], v[24:31], v0
    v_smfmac_f32_16x16x64_bf16 v[112:115], v[60:63], v[32:39], v0
    v_cvt_pk_bf16_f32 v96, v104, v105
    v_smfmac_f32_16x16x64_bf16 v[112:115], v[64:67], v[72:79], v0
    v_cvt_pk_bf16_f32 v97, v106, v107
    v_smfmac_f32_16x16x64_bf16 v[112:115], v[68:71], v[88:95], v0
    buffer_store_dwordx2 v[96:97], v1, s[32:35], s48 offen
    v_cvt_pk_bf16_f32 v98, v108, v109
    v_smfmac_f32_16x16x64_bf16 v[116:119], v[56:59], v[40:47], v0
    v_cvt_pk_bf16_f32 v99, v110, v111
    s_waitcnt lgkmcnt(4)
    v_smfmac_f32_16x16x64_bf16 v[116:119], v[60:63], v[48:55], v0
    buffer_store_dwordx2 v[98:99], v1, s[32:35], s49 offen
    s_waitcnt lgkmcnt(2)
    v_smfmac_f32_16x16x64_bf16 v[116:119], v[64:67], v[12:19], v0
    v_cvt_pk_bf16_f32 v100, v112, v113
    s_waitcnt lgkmcnt(0)
    v_smfmac_f32_16x16x64_bf16 v[116:119], v[68:71], v[120:127], v0
    v_cvt_pk_bf16_f32 v101, v114, v115
    buffer_store_dwordx2 v[100:101], v1, s[32:35], s50 offen
    s_nop 5
    v_cvt_pk_bf16_f32 v102, v116, v117
    v_cvt_pk_bf16_f32 v103, v118, v119
    buffer_store_dwordx2 v[102:103], v1, s[32:35], s51 offen
    v_mov_b64 v[104:105], 0
    v_mov_b64 v[106:107], 0
    v_mov_b64 v[108:109], 0
    v_mov_b64 v[110:111], 0
    v_mov_b64 v[112:113], 0
    v_mov_b64 v[114:115], 0
    v_mov_b64 v[116:117], 0
    v_mov_b64 v[118:119], 0
    s_xor_b32 s48, s48, 0x40000
    s_xor_b32 s49, s49, 0x40000
    s_xor_b32 s50, s50, 0x40000
    s_xor_b32 s51, s51, 0x40000
    v_mov_b32 v46, s45
    ds_read_b128 v[56:59], v8 offset:49152
    ds_read_b128 v[60:63], v8 offset:50176
    ds_read_b128 v[64:67], v8 offset:57344
    ds_read_b128 v[68:71], v8 offset:58368
    ds_read_b128 v[72:75], v8 offset:16384
    ds_read_b128 v[76:79], v8 offset:17408
    ds_read_b128 v[88:91], v8 offset:32768
    ds_read_b128 v[92:95], v8 offset:33792
    ds_read_b128 v[12:15], v8 offset:0
    ds_read_b128 v[16:19], v8 offset:1024
    buffer_load_dwordx4 v[24:27], v2, s[32:35], s43 offen offset:0 sc1
    buffer_load_dwordx4 v[28:31], v2, s[32:35], s43 offen offset:1024 sc1
    ds_read_b128 v[120:123], v8 offset:8192
    ds_read_b128 v[124:127], v8 offset:9216
    ds_read_b128 v[96:99], v8 offset:40960
    ds_read_b128 v[100:103], v8 offset:41984
    s_nop 3
    s_mov_b32 s60, 0
L_poll_22:
    buffer_load_dwordx4 v[24:27], v2, s[32:35], s43 offen offset:0 sc1
    buffer_load_dwordx4 v[28:31], v2, s[32:35], s43 offen offset:1024 sc1
    s_add_u32 s60, s60, 1
    s_cmp_gt_u32 s60, 64
    s_cbranch_scc1 L_pexact_23
    s_waitcnt vmcnt(2)
    v_max3_u32 v47, v24, v25, v26
    v_max3_u32 v47, v47, v27, v28
    v_max3_u32 v47, v47, v29, v30
    v_max_u32 v47, v47, v31
    v_cmp_le_u32 vcc, s45, v47
    s_nop 0
    s_and_b64 exec, exec, vcc
    s_cbranch_scc1 L_poll_22
L_pout_24:
    s_mov_b64 exec, -1
    v_mfma_f32_16x16x32_bf16 v[84:87], v[80:83], v[24:27], 0
    v_mfma_f32_16x16x32_bf16 v[84:87], v[80:83], v[28:31], v[84:87]
    s_nop 7
    v_add_f32_dpp v84, v84, v84 row_ror:8 row_mask:0xf bank_mask:0xf
    v_add_f32_dpp v85, v85, v85 row_ror:8 row_mask:0xf bank_mask:0xf
    s_nop 0
    v_add_f32_dpp v84, v84, v84 row_ror:4 row_mask:0xf bank_mask:0xf
    v_add_f32_dpp v85, v85, v85 row_ror:4 row_mask:0xf bank_mask:0xf
    v_cvt_pk_bf16_f32 v44, v84, v85
    buffer_store_dword v44, v3, s[32:35], s52 offen
    buffer_store_dword v46, v3, s[32:35], s53 offen
    ds_read_b128 v[80:83], v8 offset:24576
    ds_read_b128 v[84:87], v8 offset:25600
    s_add_u32 s62, s42, 3
    s_min_u32 s62, s62, 64
    v_cmp_gt_u32 vcc, s62, v11
    s_cbranch_vccnz L_avslow_26
L_avok_27:
    s_add_u32 s42, s42, 1
    s_xor_b32 s43, s43, 0x40000
    s_add_u32 s52, s52, 8192
    s_and_b32 s52, s52, 0x7fff
    s_add_u32 s53, s53, 8192
    s_and_b32 s53, s53, 0x7fff
    s_add_u32 s58, s58, 131072
    s_nop 15
    s_nop 15
    s_nop 15
    s_nop 1
    buffer_load_dwordx4 v[48:51], v10, s[32:35], s54 offen offset:0 sc1
    buffer_load_dwordx4 v[52:55], v10, s[32:35], s54 offen offset:1024 sc1
    s_branch L_chain_loop_w0_16
L_chain_last_17:
    v_mov_b32 v20, 63
    buffer_store_dword v20, off, s[32:35], s68 offset:384 sc1
    s_waitcnt vmcnt(1)
    ds_read_b128 v[40:43], v10 offset:4096
    ds_read_b128 v[44:47], v10 offset:5120
    ds_read_b128 v[48:51], v10 offset:6144
    ds_read_b128 v[52:55], v10 offset:7168
    v_mov_b64 v[120:121], 0
    v_mov_b64 v[122:123], 0
    v_mov_b64 v[124:125], 0
    v_mov_b64 v[126:127], 0
    s_waitcnt lgkmcnt(7)
    v_smfmac_f32_16x16x64_bf16 v[112:115], v[24:27], a[64:71], v0
    v_smfmac_f32_16x16x64_bf16 v[116:119], v[24:27], a[72:79], v0
    v_smfmac_f32_16x16x64_bf16 v[120:123], v[24:27], a[192:199], v0
    v_smfmac_f32_16x16x64_bf16 v[124:127], v[24:27], a[200:207], v0
    s_waitcnt lgkmcnt(6)
    v_smfmac_f32_16x16x64_bf16 v[112:115], v[28:31], a[80:87], v0
    v_smfmac_f32_16x16x64_bf16 v[116:119], v[28:31], a[88:95], v0
    v_smfmac_f32_16x16x64_bf16 v[120:123], v[28:31], a[208:215], v0
    v_smfmac_f32_16x16x64_bf16 v[124:127], v[28:31], a[216:223], v0
    s_waitcnt lgkmcnt(5)
    v_smfmac_f32_16x16x64_bf16 v[112:115], v[32:35], a[96:103], v0
    v_smfmac_f32_16x16x64_bf16 v[116:119], v[32:35], a[104:111], v0
    v_smfmac_f32_16x16x64_bf16 v[120:123], v[32:35], a[224:231], v0
    v_smfmac_f32_16x16x64_bf16 v[124:127], v[32:35], a[232:239], v0
    s_waitcnt lgkmcnt(4)
    v_smfmac_f32_16x16x64_bf16 v[112:115], v[36:39], a[112:119], v0
    v_smfmac_f32_16x16x64_bf16 v[116:119], v[36:39], a[120:127], v0
    v_smfmac_f32_16x16x64_bf16 v[120:123], v[36:39], a[240:247], v0
    v_smfmac_f32_16x16x64_bf16 v[124:127], v[36:39], a[248:255], v0
    s_waitcnt lgkmcnt(3)
    v_smfmac_f32_16x16x64_bf16 v[112:115], v[40:43], a[128:135], v0
    v_smfmac_f32_16x16x64_bf16 v[116:119], v[40:43], a[136:143], v0
    v_smfmac_f32_16x16x64_bf16 v[120:123], v[40:43], v[128:135], v0
    v_smfmac_f32_16x16x64_bf16 v[124:127], v[40:43], v[136:143], v0
    s_waitcnt lgkmcnt(2)
    v_smfmac_f32_16x16x64_bf16 v[112:115], v[44:47], a[144:151], v0
    v_smfmac_f32_16x16x64_bf16 v[116:119], v[44:47], a[152:159], v0
    v_smfmac_f32_16x16x64_bf16 v[120:123], v[44:47], v[144:151], v0
    v_smfmac_f32_16x16x64_bf16 v[124:127], v[44:47], v[152:159], v0
    s_waitcnt lgkmcnt(1)
    v_smfmac_f32_16x16x64_bf16 v[112:115], v[48:51], a[160:167], v0
    v_smfmac_f32_16x16x64_bf16 v[116:119], v[48:51], a[168:175], v0
    v_smfmac_f32_16x16x64_bf16 v[120:123], v[48:51], v[160:167], v0
    v_smfmac_f32_16x16x64_bf16 v[124:127], v[48:51], v[168:175], v0
    s_waitcnt lgkmcnt(0)
    v_smfmac_f32_16x16x64_bf16 v[112:115], v[52:55], a[176:183], v0
    v_smfmac_f32_16x16x64_bf16 v[116:119], v[52:55], a[184:191], v0
    v_smfmac_f32_16x16x64_bf16 v[120:123], v[52:55], v[176:183], v0
    v_smfmac_f32_16x16x64_bf16 v[124:127], v[52:55], v[184:191], v0
    v_add_f32 v112, v112, v114
    v_add_f32 v113, v113, v115
    v_cvt_pk_bf16_f32 v21, v112, v113
    v_add_f32 v116, v116, v118
    v_add_f32 v117, v117, v119
    v_cvt_pk_bf16_f32 v23, v116, v117
    v_add_f32 v120, v120, v122
    v_add_f32 v121, v121, v123
    v_cvt_pk_bf16_f32 v20, v120, v121
    v_add_f32 v124, v124, v126
    v_add_f32 v125, v125, v127
    v_cvt_pk_bf16_f32 v22, v124, v125
    buffer_store_dwordx4 v[20:23], v10, s[32:35], s58 offen offset:0 sc1
    s_waitcnt vmcnt(0)
    s_barrier
    v_mov_b32 v80, 64
    buffer_store_dword v80, off, s[32:35], s68 offset:384 sc1
    s_waitcnt vmcnt(0)
    s_endpgm
L_pexact_19:
    s_add_u32 s59, s59, 1
    s_cmp_gt_u32 s59, 262144
    s_cbranch_scc1 L_chain_abort_1
    s_waitcnt vmcnt(0)
    v_cmp_eq_u32 vcc, s45, v48
    v_cmp_eq_u32 s[100:101], s45, v49
    s_nop 0
    s_or_b64 vcc, vcc, s[100:101]
    v_cmp_eq_u32 s[100:101], s45, v50
    s_nop 0
    s_or_b64 vcc, vcc, s[100:101]
    v_cmp_eq_u32 s[100:101], s45, v51
    s_nop 0
    s_or_b64 vcc, vcc, s[100:101]
    v_cmp_eq_u32 s[100:101], s45, v52
    s_nop 0
    s_or_b64 vcc, vcc, s[100:101]
    v_cmp_eq_u32 s[100:101], s45, v53
    s_nop 0
    s_or_b64 vcc, vcc, s[100:101]
    v_cmp_eq_u32 s[100:101], s45, v54
    s_nop 0
    s_or_b64 vcc, vcc, s[100:101]
    v_cmp_eq_u32 s[100:101], s45, v55
    s_nop 0
    s_or_b64 vcc, vcc, s[100:101]
    ds_write_b128 v10, v[48:51] offset:0
    ds_write_b128 v10, v[52:55] offset:1024
    s_and_b64 exec, exec, vcc
    s_cbranch_scc0 L_pout_20
    buffer_load_dwordx4 v[48:51], v10, s[32:35], s54 offen offset:0 sc1
    buffer_load_dwordx4 v[52:55], v10, s[32:35], s54 offen offset:1024 sc1
    s_branch L_pexact_19
L_pexact_23:
    s_add_u32 s59, s59, 1
    s_cmp_gt_u32 s59, 262144
    s_cbranch_scc1 L_chain_abort_1
    s_waitcnt vmcnt(0)
    v_cmp_eq_u32 vcc, s45, v24
    v_cmp_eq_u32 s[100:101], s45, v25
    s_nop 0
    s_or_b64 vcc, vcc, s[100:101]
    v_cmp_eq_u32 s[100:101], s45, v26
    s_nop 0
    s_or_b64 vcc, vcc, s[100:101]
    v_cmp_eq_u32 s[100:101], s45, v27
    s_nop 0
    s_or_b64 vcc, vcc, s[100:101]
    v_cmp_eq_u32 s[100:101], s45, v28
    s_nop 0
    s_or_b64 vcc, vcc, s[100:101]
    v_cmp_eq_u32 s[100:101], s45, v29
    s_nop 0
    s_or_b64 vcc, vcc, s[100:101]
    v_cmp_eq_u32 s[100:101], s45, v30
    s_nop 0
    s_or_b64 vcc, vcc, s[100:101]
    v_cmp_eq_u32 s[100:101], s45, v31
    s_nop 0
    s_or_b64 vcc, vcc, s[100:101]
    s_and_b64 exec, exec, vcc
    s_cbranch_scc0 L_pout_24
    buffer_load_dwordx4 v[24:27], v2, s[32:35], s43 offen offset:0 sc1
    buffer_load_dwordx4 v[28:31], v2, s[32:35], s43 offen offset:1024 sc1
    s_branch L_pexact_23
L_avslow_26:
    s_add_u32 s59, s59, 1
    s_cmp_gt_u32 s59, 262144
    s_cbranch_scc1 L_chain_abort_1
    s_sleep 4
    buffer_load_dword v11, off, s[32:35], s68 sc1
    s_waitcnt vmcnt(0)
    v_cmp_gt_u32 vcc, s62, v11
    s_cbranch_vccnz L_avslow_26
    s_branch L_avok_27
L_cl_0_1_9:
    buffer_load_dwordx4 v[48:51], v10, s[32:35], s54 offen offset:2048 sc1
    buffer_load_dwordx4 v[52:55], v10, s[32:35], s54 offen offset:3072 sc1
L_chain_loop_w1_28:
    s_mov_b32 s60, 0
L_poll_30:
    buffer_load_dwordx4 v[48:51], v10, s[32:35], s54 offen offset:2048 sc1
    buffer_load_dwordx4 v[52:55], v10, s[32:35], s54 offen offset:3072 sc1
    s_add_u32 s60, s60, 1
    s_cmp_gt_u32 s60, 64
    s_cbranch_scc1 L_pexact_31
    s_waitcnt vmcnt(2)
    v_max3_u32 v47, v48, v49, v50
    v_max3_u32 v47, v47, v51, v52
    ds_write_b128 v10, v[48:51] offset:2048
    v_max3_u32 v47, v47, v53, v54
    v_max_u32 v47, v47, v55
    ds_write_b128 v10, v[52:55] offset:3072
    v_cmp_le_u32 vcc, s45, v47
    s_nop 0
    s_and_b64 exec, exec, vcc
    s_cbranch_scc1 L_poll_30
L_pout_32:
    s_mov_b64 exec, -1
    s_waitcnt lgkmcnt(0)
    s_barrier
    ds_read_b128 v[24:27], v10 offset:0
    ds_read_b128 v[28:31], v10 offset:1024
    ds_read_b128 v[32:35], v10 offset:2048
    ds_read_b128 v[36:39], v10 offset:3072
    s_cmp_eq_u32 s42, 63
    s_cbranch_scc1 L_chain_last_29
    s_waitcnt lgkmcnt(3)
    v_smfmac_f32_16x16x64_bf16 v[104:107], v[24:27], v[12:19], v0
    v_smfmac_f32_16x16x64_bf16 v[108:111], v[24:27], v[120:127], v0
    ds_read_b128 v[12:15], v10 offset:18432
    s_waitcnt lgkmcnt(3)
    v_smfmac_f32_16x16x64_bf16 v[104:107], v[28:31], v[72:79], v0
    ds_read_b128 v[16:19], v10 offset:19456
    v_smfmac_f32_16x16x64_bf16 v[108:111], v[28:31], v[80:87], v0
    ds_read_b128 v[72:75], v10 offset:8192
    s_waitcnt lgkmcnt(4)
    v_smfmac_f32_16x16x64_bf16 v[104:107], v[32:35], v[88:95], v0
    ds_read_b128 v[76:79], v10 offset:9216
    v_smfmac_f32_16x16x64_bf16 v[108:111], v[32:35], v[96:103], v0
    ds_read_b128 v[80:83], v10 offset:10240
    s_waitcnt lgkmcnt(5)
    v_smfmac_f32_16x16x64_bf16 v[104:107], v[36:39], v[56:63], v0
    ds_read_b128 v[84:87], v10 offset:11264
    v_smfmac_f32_16x16x64_bf16 v[108:111], v[36:39], v[64:71], v0
    ds_read_b128 v[88:91], v10 offset:12288
    v_smfmac_f32_16x16x64_bf16 v[112:115], v[24:27], a[64:71], v0
    ds_read_b128 v[92:95], v10 offset:13312
    v_smfmac_f32_16x16x64_bf16 v[116:119], v[24:27], a[72:79], v0
    ds_read_b128 v[96:99], v10 offset:14336
    v_smfmac_f32_16x16x64_bf16 v[112:115], v[28:31], a[80:87], v0
    ds_read_b128 v[100:103], v10 offset:15360
    v_smfmac_f32_16x16x64_bf16 v[116:119], v[28:31], a[88:95], v0
    s_waitcnt vmcnt(0)
    ds_read_b128 v[40:43], v10 offset:4096
    v_smfmac_f32_16x16x64_bf16 v[112:115], v[32:35], a[96:103], v0
    s_waitcnt vmcnt(0)
    s_mov_b32 m0, 141312
    ds_read_b128 v[44:47], v10 offset:5120
    v_smfmac_f32_16x16x64_bf16 v[116:119], v[32:35], a[104:111], v0
    s_waitcnt lgkmcnt(2)
    s_barrier
    v_smfmac_f32_16x16x64_bf16 v[112:115], v[36:39], a[112:119], v0
    ds_read_b128 v[48:51], v10 offset:6144
    v_mov_b64 v[120:121], 0
    v_smfmac_f32_16x16x64_bf16 v[116:119], v[36:39], a[120:127], v0
    buffer_load_dwordx4 v10, s[32:35], s56 offen sc1 lds
    v_mov_b64 v[122:123], 0
    s_waitcnt lgkmcnt(2)
    v_smfmac_f32_16x16x64_bf16 v[104:107], v[40:43], a[0:7], v0
    ds_read_b128 v[52:55], v10 offset:7168
    v_mov_b64 v[124:125], 0
    v_smfmac_f32_16x16x64_bf16 v[108:111], v[40:43], a[8:15], v0
    v_mov_b64 v[126:127], 0
    v_smfmac_f32_16x16x64_bf16 v[112:115], v[40:43], a[128:135], v0
    v_smfmac_f32_16x16x64_bf16 v[116:119], v[40:43], a[136:143], v0
    buffer_load_dwordx4 v10, s[32:35], s56 offen offset:1024 sc1 lds
    s_mov_b32 m0, 149504
    s_waitcnt lgkmcnt(2)
    v_smfmac_f32_16x16x64_bf16 v[104:107], v[44:47], a[16:23], v0
    v_mov_b32 v56, s45
    v_smfmac_f32_16x16x64_bf16 v[108:111], v[44:47], a[24:31], v0
    v_mov_b32 v57, s45
    v_smfmac_f32_16x16x64_bf16 v[112:115], v[44:47], a[144:151], v0
    v_mov_b64 v[58:59], v[56:57]
    v_smfmac_f32_16x16x64_bf16 v[116:119], v[44:47], a[152:159], v0
    buffer_load_dwordx4 v10, s[32:35], s69 offen sc1 lds
    s_waitcnt lgkmcnt(1)
    v_smfmac_f32_16x16x64_bf16 v[104:107], v[48:51], a[32:39], v0
    v_smfmac_f32_16x16x64_bf16 v[108:111], v[48:51], a[40:47], v0
    s_waitcnt lgkmcnt(0)
    v_smfmac_f32_16x16x64_bf16 v[104:107], v[52:55], a[48:55], v0
    v_smfmac_f32_16x16x64_bf16 v[108:111], v[52:55], a[56:63], v0
    buffer_load_dwordx4 v10, s[32:35], s69 offen offset:1024 sc1 lds
    v_smfmac_f32_16x16x64_bf16 v[112:115], v[48:51], a[160:167], v0
    v_smfmac_f32_16x16x64_bf16 v[116:119], v[48:51], a[168:175], v0
    v_add_f32 v104, v104, v106
    v_smfmac_f32_16x16x64_bf16 v[112:115], v[52:55], a[176:183], v0
    v_add_f32 v105, v105, v107
    v_smfmac_f32_16x16x64_bf16 v[116:119], v[52:55], a[184:191], v0
    v_add_f32 v108, v108, v110
    v_smfmac_f32_16x16x64_bf16 v[120:123], v[24:27], a[192:199], v0
    v_add_f32 v109, v109, v111
    v_smfmac_f32_16x16x64_bf16 v[124:127], v[24:27], a[200:207], v0
    v_cvt_pk_bf16_f32 v104, v104, v105
    v_add_f32 v112, v112, v114
    v_add_f32 v113, v113, v115
    v_cvt_pk_bf16_f32 v21, v112, v113
    ds_write2_b32 v4, v21, v104 offset0:0 offset1:1
    v_pk_add_f32 v[116:117], v[116:117], v[118:119]
    v_cvt_pk_bf16_f32 v108, v108, v109
    v_cvt_pk_bf16_f32 v23, v116, v117
    ds_write2_b32 v4, v23, v108 offset0:128 offset1:129
    v_smfmac_f32_16x16x64_bf16 v[120:123], v[28:31], a[208:215], v0
    v_smfmac_f32_16x16x64_bf16 v[124:127], v[28:31], a[216:223], v0
    buffer_store_dwordx4 v[56:59], v2, s[32:35], s57 offen offset:0
    v_smfmac_f32_16x16x64_bf16 v[120:123], v[32:35], a[224:231], v0
    v_smfmac_f32_16x16x64_bf16 v[124:127], v[32:35], a[232:239], v0
    buffer_store_dwordx4 v[56:59], v2, s[32:35], s57 offen offset:1024
    s_waitcnt lgkmcnt(0)
    s_barrier
    ds_read_b64_tr_b16 v[56:57], v5 offset:0
    ds_read_b64_tr_b16 v[58:59], v5 offset:256
    v_smfmac_f32_16x16x64_bf16 v[120:123], v[36:39], a[240:247], v0
    ds_read_b64_tr_b16 v[60:61], v5 offset:1024
    ds_read_b64_tr_b16 v[62:63], v5 offset:1280
    v_smfmac_f32_16x16x64_bf16 v[124:127], v[36:39], a[248:255], v0
    ds_read_b64_tr_b16 v[64:65], v5 offset:2048
    ds_read_b64_tr_b16 v[66:67], v5 offset:2304
    v_smfmac_f32_16x16x64_bf16 v[120:123], v[40:43], v[128:135], v0
    ds_read_b64_tr_b16 v[68:69], v5 offset:3072
    ds_read_b64_tr_b16 v[70:71], v5 offset:3328
    v_smfmac_f32_16x16x64_bf16 v[124:127], v[40:43], v[136:143], v0
    s_waitcnt lgkmcnt(6)
    v_mfma_f32_16x16x32_bf16 v[112:115], v[56:59], v[56:59], 0
    ds_read_b128 v[24:27], v9 offset:0
    v_mfma_f32_16x16x32_bf16 v[104:107], v[72:75], v[56:59], 0
    ds_read_b128 v[28:31], v9 offset:1024
    v_mfma_f32_16x16x32_bf16 v[108:111], v[88:91], v[56:59], 0
    s_waitcnt lgkmcnt(6)
    v_mfma_f32_16x16x32_bf16 v[112:115], v[60:63], v[60:63], v[112:115]
    ds_read_b128 v[32:35], v9 offset:8192
    v_mfma_f32_16x16x32_bf16 v[104:107], v[76:79], v[60:63], v[104:107]
    ds_read_b128 v[36:39], v9 offset:9216
    v_mfma_f32_16x16x32_bf16 v[108:111], v[92:95], v[60:63], v[108:111]
    s_waitcnt lgkmcnt(6)
    v_mfma_f32_16x16x32_bf16 v[112:115], v[64:67], v[64:67], v[112:115]
    ds_read_b128 v[72:75], v9 offset:16384
    v_mfma_f32_16x16x32_bf16 v[104:107], v[80:83], v[64:67], v[104:107]
    ds_read_b128 v[76:79], v9 offset:17408
    v_mfma_f32_16x16x32_bf16 v[108:111], v[96:99], v[64:67], v[108:111]
    s_waitcnt lgkmcnt(6)
    v_mfma_f32_16x16x32_bf16 v[112:115], v[68:71], v[68:71], v[112:115]
    ds_read_b128 v[88:91], v9 offset:24576
    v_mfma_f32_16x16x32_bf16 v[104:107], v[84:87], v[68:71], v[104:107]
    ds_read_b128 v[92:95], v9 offset:25600
    v_mfma_f32_16x16x32_bf16 v[108:111], v[100:103], v[68:71], v[108:111]
    v_smfmac_f32_16x16x64_bf16 v[120:123], v[44:47], v[144:151], v0
    v_mov_b32 v84, 0x3f803f80
    v_smfmac_f32_16x16x64_bf16 v[124:127], v[44:47], v[152:159], v0
    v_max3_f32 v116, v112, v113, v104
    v_max3_f32 v117, v105, v106, v107
    v_max3_f32 v116, v116, v108, v109
    v_max3_f32 v117, v117, v110, v111
    v_max_f32 v116, v116, v117
    v_max_f32 v117, v116, v117
    v_smfmac_f32_16x16x64_bf16 v[120:123], v[48:51], v[160:167], v0
    v_permlane32_swap_b32 v116, v117
    v_max_f32 v116, v116, v117
    v_max_f32 v117, v116, v117
    v_smfmac_f32_16x16x64_bf16 v[124:127], v[48:51], v[168:175], v0
    v_permlane16_swap_b32 v116, v117
    v_smfmac_f32_16x16x64_bf16 v[120:123], v[52:55], v[176:183], v0
    v_max_f32 v116, v116, v117
    v_smfmac_f32_16x16x64_bf16 v[124:127], v[52:55], v[184:191], v0
    v_mul_f32 v116, s44, v116
    v_mov_b32 v85, 0x3f803f80
    v_pk_fma_f32 v[104:105], v[104:105], s[66:67], v[116:117] op_sel_hi:[1,1,0] neg_lo:[0,0,1] neg_hi:[0,0,1]
    v_pk_fma_f32 v[106:107], v[106:107], s[66:67], v[116:117] op_sel_hi:[1,1,0] neg_lo:[0,0,1] neg_hi:[0,0,1]
    v_exp_f32 v104, v104
    v_exp_f32 v105, v105
    v_pk_fma_f32 v[108:109], v[108:109], s[66:67], v[116:117] op_sel_hi:[1,1,0] neg_lo:[0,0,1] neg_hi:[0,0,1]
    v_exp_f32 v106, v106
    v_exp_f32 v107, v107
    v_pk_fma_f32 v[110:111], v[110:111], s[66:67], v[116:117] op_sel_hi:[1,1,0] neg_lo:[0,0,1] neg_hi:[0,0,1]
    v_cvt_pk_bf16_f32 v60, v104, v105
    v_exp_f32 v108, v108
    v_exp_f32 v109, v109
    v_cvt_pk_bf16_f32 v61, v106, v107
    v_pk_fma_f32 v[112:113], v[112:113], s[66:67], v[116:117] op_sel_hi:[1,1,0] neg_lo:[0,0,1] neg_hi:[0,0,1]
    v_exp_f32 v110, v110
    v_exp_f32 v111, v111
    v_cvt_pk_bf16_f32 v62, v108, v109
    v_exp_f32 v112, v112
    v_cvt_pk_bf16_f32 v63, v110, v111
    v_exp_f32 v113, v113
    v_mov_b64 v[86:87], v[84:85]
    v_mfma_f32_16x16x32_bf16 v[96:99], v[12:15], v[60:63], 0
    v_cvt_pk_bf16_f32 v56, v112, v113
    v_mov_b32 v57, 0
    v_mfma_f32_16x16x32_bf16 v[80:83], v[84:87], v[60:63], 0
    v_add_f32 v120, v120, v122
    v_add_f32 v121, v121, v123
    v_mfma_f32_16x16x32_bf16 v[100:103], v[16:19], v[60:63], 0
    v_cvt_pk_bf16_f32 v20, v120, v121
    v_add_f32 v124, v124, v126
    v_add_f32 v125, v125, v127
    v_mfma_f32_16x16x16_bf16 v[96:99], v[20:21], v[56:57], v[96:99]
    v_cvt_pk_bf16_f32 v22, v124, v125
    v_mfma_f32_16x16x16_bf16 v[80:83], v[84:85], v[56:57], v[80:83]
    s_nop 0
    v_mfma_f32_16x16x16_bf16 v[100:103], v[22:23], v[56:57], v[100:103]
    ds_read_b128 v[40:43], v9 offset:32768
    ds_read_b128 v[44:47], v9 offset:33792
    buffer_store_dwordx4 v[20:23], v10, s[32:35], s58 offen offset:1024 sc1
    s_nop 2
    v_rcp_f32 v118, v80
    s_mov_b64 exec, s[70:71]
    v_pk_mul_f32 v[96:97], v[96:97], v[118:119] op_sel_hi:[1,0]
    v_cvt_pk_bf16_f32 v96, v96, v97
    v_pk_mul_f32 v[98:99], v[98:99], v[118:119] op_sel_hi:[1,0]
    v_cvt_pk_bf16_f32 v97, v98, v99
    v_pk_mul_f32 v[100:101], v[100:101], v[118:119] op_sel_hi:[1,0]
    v_cvt_pk_bf16_f32 v98, v100, v101
    v_pk_mul_f32 v[102:103], v[102:103], v[118:119] op_sel_hi:[1,0]
    v_cvt_pk_bf16_f32 v99, v102, v103
    ds_write2_b64 v6, v[96:97], v[98:99] offset0:0 offset1:4
    s_mov_b64 exec, -1
    v_mov_b64 v[104:105], 0
    v_mov_b64 v[106:107], 0
    v_mov_b64 v[108:109], 0
    v_mov_b64 v[110:111], 0
    v_mov_b64 v[112:113], 0
    v_mov_b64 v[114:115], 0
    v_mov_b64 v[116:117], 0
    v_mov_b64 v[118:119], 0
    s_waitcnt lgkmcnt(0)
    s_barrier
    ds_read_b128 v[56:59], v7 offset:0
    ds_read_b128 v[60:63], v7 offset:64
    ds_read_b128 v[64:67], v7 offset:128
    ds_read_b128 v[68:71], v7 offset:192
    s_add_u32 s54, s52, 131072
    s_add_u32 s55, s54, 4096
    s_cmp_lt_u32 s42, 62
    s_cselect_b32 s60, 262144, 0
    s_add_u32 s56, s56, s60
    s_add_u32 s69, s69, s60
    s_mov_b32 s57, s43
    s_waitcnt lgkmcnt(3)
    v_smfmac_f32_16x16x64_bf16 v[104:107], v[56:59], v[192:199], v0
    v_mov_b32 v20, 0x3f80
    v_smfmac_f32_16x16x64_bf16 v[108:111], v[56:59], v[224:231], v0
    v_mov_b32 v21, 0x3f800000
    s_waitcnt lgkmcnt(2)
    v_smfmac_f32_16x16x64_bf16 v[104:107], v[60:63], v[200:207], v0
    ds_read_b128 v[48:51], v9 offset:40960
    v_cndmask_b32 v20, v20, v21, s[46:47]
    v_smfmac_f32_16x16x64_bf16 v[108:111], v[60:63], v[232:239], v0
    ds_read_b128 v[52:55], v9 offset:41984
    v_cndmask_b32 v80, 0, v20, s[92:93]
    s_waitcnt lgkmcnt(3)
    v_smfmac_f32_16x16x64_bf16 v[104:107], v[64:67], v[208:215], v0
    ds_read_b128 v[12:15], v9 offset:49152
    v_cndmask_b32 v81, 0, v20, s[94:95]
    v_smfmac_f32_16x16x64_bf16 v[108:111], v[64:67], v[240:247], v0
    ds_read_b128 v[16:19], v9 offset:50176
    v_cndmask_b32 v82, 0, v20, s[96:97]
    s_waitcnt lgkmcnt(4)
    v_smfmac_f32_16x16x64_bf16 v[104:107], v[68:71], v[216:223], v0
    ds_read_b128 v[120:123], v9 offset:57344
    v_cndmask_b32 v83, 0, v20, s[98:99]
    v_smfmac_f32_16x16x64_bf16 v[108:111], v[68:71], v[248:255], v0
    ds_read_b128 v[124:127], v9 offset:58368
    v_smfmac_f32_16x16x64_bf16 v[112:115], v[56:59], v[24:31], v0
    v_smfmac_f32_16x16x64_bf16 v[112:115], v[60:63], v[32:39], v0
    v_cvt_pk_bf16_f32 v96, v104, v105
    v_smfmac_f32_16x16x64_bf16 v[112:115], v[64:67], v[72:79], v0
    v_cvt_pk_bf16_f32 v97, v106, v107
    v_smfmac_f32_16x16x64_bf16 v[112:115], v[68:71], v[88:95], v0
    buffer_store_dwordx2 v[96:97], v1, s[32:35], s48 offen
    v_cvt_pk_bf16_f32 v98, v108, v109
    v_smfmac_f32_16x16x64_bf16 v[116:119], v[56:59], v[40:47], v0
    v_cvt_pk_bf16_f32 v99, v110, v111
    s_waitcnt lgkmcnt(4)
    v_smfmac_f32_16x16x64_bf16 v[116:119], v[60:63], v[48:55], v0
    buffer_store_dwordx2 v[98:99], v1, s[32:35], s49 offen
    s_waitcnt lgkmcnt(2)
    v_smfmac_f32_16x16x64_bf16 v[116:119], v[64:67], v[12:19], v0
    v_cvt_pk_bf16_f32 v100, v112, v113
    s_waitcnt lgkmcnt(0)
    v_smfmac_f32_16x16x64_bf16 v[116:119], v[68:71], v[120:127], v0
    v_cvt_pk_bf16_f32 v101, v114, v115
    buffer_store_dwordx2 v[100:101], v1, s[32:35], s50 offen
    s_nop 5
    v_cvt_pk_bf16_f32 v102, v116, v117
    v_cvt_pk_bf16_f32 v103, v118, v119
    buffer_store_dwordx2 v[102:103], v1, s[32:35], s51 offen
    v_mov_b64 v[104:105], 0
    v_mov_b64 v[106:107], 0
    v_mov_b64 v[108:109], 0
    v_mov_b64 v[110:111], 0
    v_mov_b64 v[112:113], 0
    v_mov_b64 v[114:115], 0
    v_mov_b64 v[116:117], 0
    v_mov_b64 v[118:119], 0
    s_xor_b32 s48, s48, 0x40000
    s_xor_b32 s49, s49, 0x40000
    s_xor_b32 s50, s50, 0x40000
    s_xor_b32 s51, s51, 0x40000
    v_mov_b32 v46, s45
    ds_read_b128 v[56:59], v8 offset:49152
    ds_read_b128 v[60:63], v8 offset:50176
    ds_read_b128 v[64:67], v8 offset:57344
    ds_read_b128 v[68:71], v8 offset:58368
    ds_read_b128 v[72:75], v8 offset:16384
    ds_read_b128 v[76:79], v8 offset:17408
    ds_read_b128 v[88:91], v8 offset:32768
    ds_read_b128 v[92:95], v8 offset:33792
    ds_read_b128 v[12:15], v8 offset:0
    ds_read_b128 v[16:19], v8 offset:1024
    ds_read_b128 v[120:123], v8 offset:8192
    buffer_load_dwordx4 v[24:27], v2, s[32:35], s43 offen offset:0 sc1
    buffer_load_dwordx4 v[28:31], v2, s[32:35], s43 offen offset:1024 sc1
    ds_read_b128 v[124:127], v8 offset:9216
    ds_read_b128 v[96:99], v8 offset:40960
    ds_read_b128 v[100:103], v8 offset:41984
    s_nop 7
    s_mov_b32 s60, 0
L_poll_34:
    buffer_load_dwordx4 v[24:27], v2, s[32:35], s43 offen offset:0 sc1
    buffer_load_dwordx4 v[28:31], v2, s[32:35], s43 offen offset:1024 sc1
    s_add_u32 s60, s60, 1
    s_cmp_gt_u32 s60, 64
    s_cbranch_scc1 L_pexact_35
    s_waitcnt vmcnt(2)
    v_max3_u32 v47, v24, v25, v26
    v_max3_u32 v47, v47, v27, v28
    v_max3_u32 v47, v47, v29, v30
    v_max_u32 v47, v47, v31
    v_cmp_le_u32 vcc, s45, v47
    s_nop 0
    s_and_b64 exec, exec, vcc
    s_cbranch_scc1 L_poll_34
L_pout_36:
    s_mov_b64 exec, -1
    v_mfma_f32_16x16x32_bf16 v[84:87], v[80:83], v[24:27], 0
    v_mfma_f32_16x16x32_bf16 v[84:87], v[80:83], v[28:31], v[84:87]
    s_nop 7
    v_add_f32_dpp v84, v84, v84 row_ror:8 row_mask:0xf bank_mask:0xf
    v_add_f32_dpp v85, v85, v85 row_ror:8 row_mask:0xf bank_mask:0xf
    s_nop 0
    v_add_f32_dpp v84, v84, v84 row_ror:4 row_mask:0xf bank_mask:0xf
    v_add_f32_dpp v85, v85, v85 row_ror:4 row_mask:0xf bank_mask:0xf
    v_cvt_pk_bf16_f32 v44, v84, v85
    buffer_store_dword v44, v3, s[32:35], s52 offen
    buffer_store_dword v46, v3, s[32:35], s53 offen
    ds_read_b128 v[80:83], v8 offset:24576
    ds_read_b128 v[84:87], v8 offset:25600
    s_add_u32 s42, s42, 1
    s_xor_b32 s43, s43, 0x40000
    s_add_u32 s52, s52, 8192
    s_and_b32 s52, s52, 0x7fff
    s_add_u32 s53, s53, 8192
    s_and_b32 s53, s53, 0x7fff
    s_add_u32 s58, s58, 131072
    s_nop 15
    s_nop 15
    s_nop 12
    buffer_load_dwordx4 v[48:51], v10, s[32:35], s54 offen offset:2048 sc1
    buffer_load_dwordx4 v[52:55], v10, s[32:35], s54 offen offset:3072 sc1
    s_branch L_chain_loop_w1_28
L_chain_last_29:
    s_waitcnt vmcnt(0)
    ds_read_b128 v[40:43], v10 offset:4096
    ds_read_b128 v[44:47], v10 offset:5120
    ds_read_b128 v[48:51], v10 offset:6144
    ds_read_b128 v[52:55], v10 offset:7168
    v_mov_b64 v[120:121], 0
    v_mov_b64 v[122:123], 0
    v_mov_b64 v[124:125], 0
    v_mov_b64 v[126:127], 0
    s_waitcnt lgkmcnt(7)
    v_smfmac_f32_16x16x64_bf16 v[112:115], v[24:27], a[64:71], v0
    v_smfmac_f32_16x16x64_bf16 v[116:119], v[24:27], a[72:79], v0
    v_smfmac_f32_16x16x64_bf16 v[120:123], v[24:27], a[192:199], v0
    v_smfmac_f32_16x16x64_bf16 v[124:127], v[24:27], a[200:207], v0
    s_waitcnt lgkmcnt(6)
    v_smfmac_f32_16x16x64_bf16 v[112:115], v[28:31], a[80:87], v0
    v_smfmac_f32_16x16x64_bf16 v[116:119], v[28:31], a[88:95], v0
    v_smfmac_f32_16x16x64_bf16 v[120:123], v[28:31], a[208:215], v0
    v_smfmac_f32_16x16x64_bf16 v[124:127], v[28:31], a[216:223], v0
    s_waitcnt lgkmcnt(5)
    v_smfmac_f32_16x16x64_bf16 v[112:115], v[32:35], a[96:103], v0
    v_smfmac_f32_16x16x64_bf16 v[116:119], v[32:35], a[104:111], v0
    v_smfmac_f32_16x16x64_bf16 v[120:123], v[32:35], a[224:231], v0
    v_smfmac_f32_16x16x64_bf16 v[124:127], v[32:35], a[232:239], v0
    s_waitcnt lgkmcnt(4)
    v_smfmac_f32_16x16x64_bf16 v[112:115], v[36:39], a[112:119], v0
    v_smfmac_f32_16x16x64_bf16 v[116:119], v[36:39], a[120:127], v0
    v_smfmac_f32_16x16x64_bf16 v[120:123], v[36:39], a[240:247], v0
    v_smfmac_f32_16x16x64_bf16 v[124:127], v[36:39], a[248:255], v0
    s_waitcnt lgkmcnt(3)
    v_smfmac_f32_16x16x64_bf16 v[112:115], v[40:43], a[128:135], v0
    v_smfmac_f32_16x16x64_bf16 v[116:119], v[40:43], a[136:143], v0
    v_smfmac_f32_16x16x64_bf16 v[120:123], v[40:43], v[128:135], v0
    v_smfmac_f32_16x16x64_bf16 v[124:127], v[40:43], v[136:143], v0
    s_waitcnt lgkmcnt(2)
    v_smfmac_f32_16x16x64_bf16 v[112:115], v[44:47], a[144:151], v0
    v_smfmac_f32_16x16x64_bf16 v[116:119], v[44:47], a[152:159], v0
    v_smfmac_f32_16x16x64_bf16 v[120:123], v[44:47], v[144:151], v0
    v_smfmac_f32_16x16x64_bf16 v[124:127], v[44:47], v[152:159], v0
    s_waitcnt lgkmcnt(1)
    v_smfmac_f32_16x16x64_bf16 v[112:115], v[48:51], a[160:167], v0
    v_smfmac_f32_16x16x64_bf16 v[116:119], v[48:51], a[168:175], v0
    v_smfmac_f32_16x16x64_bf16 v[120:123], v[48:51], v[160:167], v0
    v_smfmac_f32_16x16x64_bf16 v[124:127], v[48:51], v[168:175], v0
    s_waitcnt lgkmcnt(0)
    v_smfmac_f32_16x16x64_bf16 v[112:115], v[52:55], a[176:183], v0
    v_smfmac_f32_16x16x64_bf16 v[116:119], v[52:55], a[184:191], v0
    v_smfmac_f32_16x16x64_bf16 v[120:123], v[52:55], v[176:183], v0
    v_smfmac_f32_16x16x64_bf16 v[124:127], v[52:55], v[184:191], v0
    v_add_f32 v112, v112, v114
    v_add_f32 v113, v113, v115
    v_cvt_pk_bf16_f32 v21, v112, v113
    v_add_f32 v116, v116, v118
    v_add_f32 v117, v117, v119
    v_cvt_pk_bf16_f32 v23, v116, v117
    v_add_f32 v120, v120, v122
    v_add_f32 v121, v121, v123
    v_cvt_pk_bf16_f32 v20, v120, v121
    v_add_f32 v124, v124, v126
    v_add_f32 v125, v125, v127
    v_cvt_pk_bf16_f32 v22, v124, v125
    buffer_store_dwordx4 v[20:23], v10, s[32:35], s58 offen offset:1024 sc1
    s_waitcnt vmcnt(0)
    s_barrier
    s_endpgm
L_pexact_31:
    s_add_u32 s59, s59, 1
    s_cmp_gt_u32 s59, 262144
    s_cbranch_scc1 L_chain_abort_1
    s_waitcnt vmcnt(0)
    v_cmp_eq_u32 vcc, s45, v48
    v_cmp_eq_u32 s[100:101], s45, v49
    s_nop 0
    s_or_b64 vcc, vcc, s[100:101]
    v_cmp_eq_u32 s[100:101], s45, v50
    s_nop 0
    s_or_b64 vcc, vcc, s[100:101]
    v_cmp_eq_u32 s[100:101], s45, v51
    s_nop 0
    s_or_b64 vcc, vcc, s[100:101]
    v_cmp_eq_u32 s[100:101], s45, v52
    s_nop 0
    s_or_b64 vcc, vcc, s[100:101]
    v_cmp_eq_u32 s[100:101], s45, v53
    s_nop 0
    s_or_b64 vcc, vcc, s[100:101]
    v_cmp_eq_u32 s[100:101], s45, v54
    s_nop 0
    s_or_b64 vcc, vcc, s[100:101]
    v_cmp_eq_u32 s[100:101], s45, v55
    s_nop 0
    s_or_b64 vcc, vcc, s[100:101]
    ds_write_b128 v10, v[48:51] offset:2048
    ds_write_b128 v10, v[52:55] offset:3072
    s_and_b64 exec, exec, vcc
    s_cbranch_scc0 L_pout_32
    buffer_load_dwordx4 v[48:51], v10, s[32:35], s54 offen offset:2048 sc1
    buffer_load_dwordx4 v[52:55], v10, s[32:35], s54 offen offset:3072 sc1
    s_branch L_pexact_31
L_pexact_35:
    s_add_u32 s59, s59, 1
    s_cmp_gt_u32 s59, 262144
    s_cbranch_scc1 L_chain_abort_1
    s_waitcnt vmcnt(0)
    v_cmp_eq_u32 vcc, s45, v24
    v_cmp_eq_u32 s[100:101], s45, v25
    s_nop 0
    s_or_b64 vcc, vcc, s[100:101]
    v_cmp_eq_u32 s[100:101], s45, v26
    s_nop 0
    s_or_b64 vcc, vcc, s[100:101]
    v_cmp_eq_u32 s[100:101], s45, v27
    s_nop 0
    s_or_b64 vcc, vcc, s[100:101]
    v_cmp_eq_u32 s[100:101], s45, v28
    s_nop 0
    s_or_b64 vcc, vcc, s[100:101]
    v_cmp_eq_u32 s[100:101], s45, v29
    s_nop 0
    s_or_b64 vcc, vcc, s[100:101]
    v_cmp_eq_u32 s[100:101], s45, v30
    s_nop 0
    s_or_b64 vcc, vcc, s[100:101]
    v_cmp_eq_u32 s[100:101], s45, v31
    s_nop 0
    s_or_b64 vcc, vcc, s[100:101]
    s_and_b64 exec, exec, vcc
    s_cbranch_scc0 L_pout_36
    buffer_load_dwordx4 v[24:27], v2, s[32:35], s43 offen offset:0 sc1
    buffer_load_dwordx4 v[28:31], v2, s[32:35], s43 offen offset:1024 sc1
    s_branch L_pexact_35
L_cl_0_2_10:
    buffer_load_dwordx4 v[48:51], v10, s[32:35], s55 offen offset:0 sc1
    buffer_load_dwordx4 v[52:55], v10, s[32:35], s55 offen offset:1024 sc1
L_chain_loop_w2_38:
    s_mov_b32 s60, 0
L_poll_40:
    buffer_load_dwordx4 v[48:51], v10, s[32:35], s55 offen offset:0 sc1
    buffer_load_dwordx4 v[52:55], v10, s[32:35], s55 offen offset:1024 sc1
    s_add_u32 s60, s60, 1
    s_cmp_gt_u32 s60, 64
    s_cbranch_scc1 L_pexact_41
    s_waitcnt vmcnt(2)
    v_max3_u32 v47, v48, v49, v50
    v_max3_u32 v47, v47, v51, v52
    ds_write_b128 v10, v[48:51] offset:4096
    v_max3_u32 v47, v47, v53, v54
    v_max_u32 v47, v47, v55
    ds_write_b128 v10, v[52:55] offset:5120
    v_cmp_le_u32 vcc, s45, v47
    s_nop 0
    s_and_b64 exec, exec, vcc
    s_cbranch_scc1 L_poll_40
L_pout_42:
    s_mov_b64 exec, -1
    s_waitcnt lgkmcnt(0)
    s_barrier
    ds_read_b128 v[24:27], v10 offset:0
    ds_read_b128 v[28:31], v10 offset:1024
    ds_read_b128 v[32:35], v10 offset:2048
    ds_read_b128 v[36:39], v10 offset:3072
    s_cmp_eq_u32 s42, 63
    s_cbranch_scc1 L_chain_last_39
    s_waitcnt lgkmcnt(3)
    v_smfmac_f32_16x16x64_bf16 v[104:107], v[24:27], v[12:19], v0
    v_smfmac_f32_16x16x64_bf16 v[108:111], v[24:27], v[120:127], v0
    ds_read_b128 v[12:15], v10 offset:20480
    s_waitcnt lgkmcnt(3)
    v_smfmac_f32_16x16x64_bf16 v[104:107], v[28:31], v[72:79], v0
    ds_read_b128 v[16:19], v10 offset:21504
    v_smfmac_f32_16x16x64_bf16 v[108:111], v[28:31], v[80:87], v0
    ds_read_b128 v[72:75], v10 offset:8192
    s_waitcnt lgkmcnt(4)
    v_smfmac_f32_16x16x64_bf16 v[104:107], v[32:35], v[88:95], v0
    ds_read_b128 v[76:79], v10 offset:9216
    v_smfmac_f32_16x16x64_bf16 v[108:111], v[32:35], v[96:103], v0
    ds_read_b128 v[80:83], v10 offset:10240
    s_waitcnt lgkmcnt(5)
    v_smfmac_f32_16x16x64_bf16 v[104:107], v[36:39], v[56:63], v0
    ds_read_b128 v[84:87], v10 offset:11264
    v_smfmac_f32_16x16x64_bf16 v[108:111], v[36:39], v[64:71], v0
    ds_read_b128 v[88:91], v10 offset:12288
    v_smfmac_f32_16x16x64_bf16 v[112:115], v[24:27], a[64:71], v0
    ds_read_b128 v[92:95], v10 offset:13312
    v_smfmac_f32_16x16x64_bf16 v[116:119], v[24:27], a[72:79], v0
    ds_read_b128 v[96:99], v10 offset:14336
    v_smfmac_f32_16x16x64_bf16 v[112:115], v[28:31], a[80:87], v0
    ds_read_b128 v[100:103], v10 offset:15360
    v_smfmac_f32_16x16x64_bf16 v[116:119], v[28:31], a[88:95], v0
    s_waitcnt vmcnt(0)
    ds_read_b128 v[40:43], v10 offset:4096
    v_smfmac_f32_16x16x64_bf16 v[112:115], v[32:35], a[96:103], v0
    s_waitcnt vmcnt(0)
    s_mov_b32 m0, 143360
    ds_read_b128 v[44:47], v10 offset:5120
    v_smfmac_f32_16x16x64_bf16 v[116:119], v[32:35], a[104:111], v0
    s_waitcnt lgkmcnt(2)
    s_barrier
    v_smfmac_f32_16x16x64_bf16 v[112:115], v[36:39], a[112:119], v0
    ds_read_b128 v[48:51], v10 offset:6144
    v_mov_b64 v[120:121], 0
    v_smfmac_f32_16x16x64_bf16 v[116:119], v[36:39], a[120:127], v0
    ds_read_b128 v[52:55], v10 offset:7168
    v_mov_b64 v[122:123], 0
    s_waitcnt lgkmcnt(3)
    v_smfmac_f32_16x16x64_bf16 v[104:107], v[40:43], a[0:7], v0
    buffer_load_dwordx4 v10, s[32:35], s56 offen sc1 lds
    v_mov_b64 v[124:125], 0
    v_smfmac_f32_16x16x64_bf16 v[108:111], v[40:43], a[8:15], v0
    v_mov_b64 v[126:127], 0
    v_smfmac_f32_16x16x64_bf16 v[112:115], v[40:43], a[128:135], v0
    v_smfmac_f32_16x16x64_bf16 v[116:119], v[40:43], a[136:143], v0
    s_waitcnt lgkmcnt(2)
    v_smfmac_f32_16x16x64_bf16 v[104:107], v[44:47], a[16:23], v0
    buffer_load_dwordx4 v10, s[32:35], s56 offen offset:1024 sc1 lds
    s_mov_b32 m0, 151552
    v_mov_b32 v56, s45
    v_smfmac_f32_16x16x64_bf16 v[108:111], v[44:47], a[24:31], v0
    v_mov_b32 v57, s45
    v_smfmac_f32_16x16x64_bf16 v[112:115], v[44:47], a[144:151], v0
    v_mov_b64 v[58:59], v[56:57]
    v_smfmac_f32_16x16x64_bf16 v[116:119], v[44:47], a[152:159], v0
    s_waitcnt lgkmcnt(1)
    v_smfmac_f32_16x16x64_bf16 v[104:107], v[48:51], a[32:39], v0
    buffer_load_dwordx4 v10, s[32:35], s69 offen sc1 lds
    v_smfmac_f32_16x16x64_bf16 v[108:111], v[48:51], a[40:47], v0
    s_waitcnt lgkmcnt(0)
    v_smfmac_f32_16x16x64_bf16 v[104:107], v[52:55], a[48:55], v0
    v_smfmac_f32_16x16x64_bf16 v[108:111], v[52:55], a[56:63], v0
    v_smfmac_f32_16x16x64_bf16 v[112:115], v[48:51], a[160:167], v0
    buffer_load_dwordx4 v10, s[32:35], s69 offen offset:1024 sc1 lds
    v_smfmac_f32_16x16x64_bf16 v[116:119], v[48:51], a[168:175], v0
    v_add_f32 v104, v104, v106
    v_smfmac_f32_16x16x64_bf16 v[112:115], v[52:55], a[176:183], v0
    v_add_f32 v105, v105, v107
    v_smfmac_f32_16x16x64_bf16 v[116:119], v[52:55], a[184:191], v0
    v_add_f32 v108, v108, v110
    v_smfmac_f32_16x16x64_bf16 v[120:123], v[24:27], a[192:199], v0
    v_add_f32 v109, v109, v111
    v_smfmac_f32_16x16x64_bf16 v[124:127], v[24:27], a[200:207], v0
    v_cvt_pk_bf16_f32 v104, v104, v105
    v_add_f32 v112, v112, v114
    v_add_f32 v113, v113, v115
    v_cvt_pk_bf16_f32 v21, v112, v113
    ds_write2_b32 v4, v21, v104 offset0:0 offset1:1
    v_pk_add_f32 v[116:117], v[116:117], v[118:119]
    v_cvt_pk_bf16_f32 v108, v108, v109
    v_cvt_pk_bf16_f32 v23, v116, v117
    ds_write2_b32 v4, v23, v108 offset0:128 offset1:129
    v_smfmac_f32_16x16x64_bf16 v[120:123], v[28:31], a[208:215], v0
    buffer_store_dwordx4 v[56:59], v2, s[32:35], s57 offen offset:1024
    v_smfmac_f32_16x16x64_bf16 v[124:127], v[28:31], a[216:223], v0
    v_smfmac_f32_16x16x64_bf16 v[120:123], v[32:35], a[224:231], v0
    buffer_store_dwordx4 v[56:59], v2, s[32:35], s57 offen offset:0
    v_smfmac_f32_16x16x64_bf16 v[124:127], v[32:35], a[232:239], v0
    s_waitcnt lgkmcnt(0)
    s_barrier
    ds_read_b64_tr_b16 v[56:57], v5 offset:0
    ds_read_b64_tr_b16 v[58:59], v5 offset:256
    v_smfmac_f32_16x16x64_bf16 v[120:123], v[36:39], a[240:247], v0
    ds_read_b64_tr_b16 v[60:61], v5 offset:1024
    ds_read_b64_tr_b16 v[62:63], v5 offset:1280
    v_smfmac_f32_16x16x64_bf16 v[124:127], v[36:39], a[248:255], v0
    ds_read_b64_tr_b16 v[64:65], v5 offset:2048
    ds_read_b64_tr_b16 v[66:67], v5 offset:2304
    v_smfmac_f32_16x16x64_bf16 v[120:123], v[40:43], v[128:135], v0
    ds_read_b64_tr_b16 v[68:69], v5 offset:3072
    ds_read_b64_tr_b16 v[70:71], v5 offset:3328
    v_smfmac_f32_16x16x64_bf16 v[124:127], v[40:43], v[136:143], v0
    s_waitcnt lgkmcnt(6)
    v_mfma_f32_16x16x32_bf16 v[112:115], v[56:59], v[56:59], 0
    ds_read_b128 v[24:27], v9 offset:0
    v_mfma_f32_16x16x32_bf16 v[104:107], v[72:75], v[56:59], 0
    ds_read_b128 v[28:31], v9 offset:1024
    v_mfma_f32_16x16x32_bf16 v[108:111], v[88:91], v[56:59], 0
    s_waitcnt lgkmcnt(6)
    v_mfma_f32_16x16x32_bf16 v[112:115], v[60:63], v[60:63], v[112:115]
    ds_read_b128 v[32:35], v9 offset:8192
    v_mfma_f32_16x16x32_bf16 v[104:107], v[76:79], v[60:63], v[104:107]
    ds_read_b128 v[36:39], v9 offset:9216
    v_mfma_f32_16x16x32_bf16 v[108:111], v[92:95], v[60:63], v[108:111]
    s_waitcnt lgkmcnt(6)
    v_mfma_f32_16x16x32_bf16 v[112:115], v[64:67], v[64:67], v[112:115]
    ds_read_b128 v[72:75], v9 offset:16384
    v_mfma_f32_16x16x32_bf16 v[104:107], v[80:83], v[64:67], v[104:107]
    ds_read_b128 v[76:79], v9 offset:17408
    v_mfma_f32_16x16x32_bf16 v[108:111], v[96:99], v[64:67], v[108:111]
    s_waitcnt lgkmcnt(6)
    v_mfma_f32_16x16x32_bf16 v[112:115], v[68:71], v[68:71], v[112:115]
    ds_read_b128 v[88:91], v9 offset:24576
    v_mfma_f32_16x16x32_bf16 v[104:107], v[84:87], v[68:71], v[104:107]
    ds_read_b128 v[92:95], v9 offset:25600
    v_mfma_f32_16x16x32_bf16 v[108:111], v[100:103], v[68:71], v[108:111]
    v_smfmac_f32_16x16x64_bf16 v[120:123], v[44:47], v[144:151], v0
    v_mov_b32 v84, 0x3f803f80
    v_smfmac_f32_16x16x64_bf16 v[124:127], v[44:47], v[152:159], v0
    v_max3_f32 v116, v112, v113, v104
    v_max3_f32 v117, v105, v106, v107
    v_max3_f32 v116, v116, v108, v109
    v_max3_f32 v117, v117, v110, v111
    v_max_f32 v116, v116, v117
    v_max_f32 v117, v116, v117
    v_smfmac_f32_16x16x64_bf16 v[120:123], v[48:51], v[160:167], v0
    v_permlane32_swap_b32 v116, v117
    v_max_f32 v116, v116, v117
    v_max_f32 v117, v116, v117
    v_smfmac_f32_16x16x64_bf16 v[124:127], v[48:51], v[168:175], v0
    v_permlane16_swap_b32 v116, v117
    v_smfmac_f32_16x16x64_bf16 v[120:123], v[52:55], v[176:183], v0
    v_max_f32 v116, v116, v117
    v_smfmac_f32_16x16x64_bf16 v[124:127], v[52:55], v[184:191], v0
    v_mul_f32 v116, s44, v116
    v_mov_b32 v85, 0x3f803f80
    v_pk_fma_f32 v[104:105], v[104:105], s[66:67], v[116:117] op_sel_hi:[1,1,0] neg_lo:[0,0,1] neg_hi:[0,0,1]
    v_pk_fma_f32 v[106:107], v[106:107], s[66:67], v[116:117] op_sel_hi:[1,1,0] neg_lo:[0,0,1] neg_hi:[0,0,1]
    v_exp_f32 v104, v104
    v_exp_f32 v105, v105
    v_pk_fma_f32 v[108:109], v[108:109], s[66:67], v[116:117] op_sel_hi:[1,1,0] neg_lo:[0,0,1] neg_hi:[0,0,1]
    v_exp_f32 v106, v106
    v_exp_f32 v107, v107
    v_pk_fma_f32 v[110:111], v[110:111], s[66:67], v[116:117] op_sel_hi:[1,1,0] neg_lo:[0,0,1] neg_hi:[0,0,1]
    v_cvt_pk_bf16_f32 v60, v104, v105
    v_exp_f32 v108, v108
    v_exp_f32 v109, v109
    v_cvt_pk_bf16_f32 v61, v106, v107
    v_pk_fma_f32 v[112:113], v[112:113], s[66:67], v[116:117] op_sel_hi:[1,1,0] neg_lo:[0,0,1] neg_hi:[0,0,1]
    v_exp_f32 v110, v110
    v_exp_f32 v111, v111
    v_cvt_pk_bf16_f32 v62, v108, v109
    v_exp_f32 v112, v112
    v_cvt_pk_bf16_f32 v63, v110, v111
    v_exp_f32 v113, v113
    v_mov_b64 v[86:87], v[84:85]
    v_mfma_f32_16x16x32_bf16 v[96:99], v[12:15], v[60:63], 0
    v_cvt_pk_bf16_f32 v56, v112, v113
    v_mov_b32 v57, 0
    v_mfma_f32_16x16x32_bf16 v[80:83], v[84:87], v[60:63], 0
    v_add_f32 v120, v120, v122
    v_add_f32 v121, v121, v123
    v_mfma_f32_16x16x32_bf16 v[100:103], v[16:19], v[60:63], 0
    v_cvt_pk_bf16_f32 v20, v120, v121
    v_add_f32 v124, v124, v126
    v_add_f32 v125, v125, v127
    v_mfma_f32_16x16x16_bf16 v[96:99], v[20:21], v[56:57], v[96:99]
    v_cvt_pk_bf16_f32 v22, v124, v125
    v_mfma_f32_16x16x16_bf16 v[80:83], v[84:85], v[56:57], v[80:83]
    s_nop 0
    v_mfma_f32_16x16x16_bf16 v[100:103], v[22:23], v[56:57], v[100:103]
    ds_read_b128 v[40:43], v9 offset:32768
    ds_read_b128 v[44:47], v9 offset:33792
    s_nop 3
    v_rcp_f32 v118, v80
    s_mov_b64 exec, s[70:71]
    v_pk_mul_f32 v[96:97], v[96:97], v[118:119] op_sel_hi:[1,0]
    v_cvt_pk_bf16_f32 v96, v96, v97
    v_pk_mul_f32 v[98:99], v[98:99], v[118:119] op_sel_hi:[1,0]
    v_cvt_pk_bf16_f32 v97, v98, v99
    v_pk_mul_f32 v[100:101], v[100:101], v[118:119] op_sel_hi:[1,0]
    v_cvt_pk_bf16_f32 v98, v100, v101
    v_pk_mul_f32 v[102:103], v[102:103], v[118:119] op_sel_hi:[1,0]
    v_cvt_pk_bf16_f32 v99, v102, v103
    ds_write2_b64 v6, v[96:97], v[98:99] offset0:0 offset1:4
    s_mov_b64 exec, -1
    buffer_store_dwordx4 v[20:23], v10, s[32:35], s58 offen offset:2048 sc1
    v_mov_b64 v[104:105], 0
    v_mov_b64 v[106:107], 0
    v_mov_b64 v[108:109], 0
    v_mov_b64 v[110:111], 0
    v_mov_b64 v[112:113], 0
    v_mov_b64 v[114:115], 0
    v_mov_b64 v[116:117], 0
    v_mov_b64 v[118:119], 0
    s_waitcnt lgkmcnt(0)
    s_barrier
    ds_read_b128 v[56:59], v7 offset:0
    ds_read_b128 v[60:63], v7 offset:64
    ds_read_b128 v[64:67], v7 offset:128
    ds_read_b128 v[68:71], v7 offset:192
    s_add_u32 s54, s52, 131072
    s_add_u32 s55, s54, 4096
    s_cmp_lt_u32 s42, 62
    s_cselect_b32 s60, 262144, 0
    s_add_u32 s56, s56, s60
    s_add_u32 s69, s69, s60
    s_mov_b32 s57, s43
    s_waitcnt lgkmcnt(3)
    v_smfmac_f32_16x16x64_bf16 v[104:107], v[56:59], v[192:199], v0
    v_mov_b32 v20, 0x3f80
    v_smfmac_f32_16x16x64_bf16 v[108:111], v[56:59], v[224:231], v0
    v_mov_b32 v21, 0x3f800000
    s_waitcnt lgkmcnt(2)
    v_smfmac_f32_16x16x64_bf16 v[104:107], v[60:63], v[200:207], v0
    ds_read_b128 v[48:51], v9 offset:40960
    v_cndmask_b32 v20, v20, v21, s[46:47]
    v_smfmac_f32_16x16x64_bf16 v[108:111], v[60:63], v[232:239], v0
    ds_read_b128 v[52:55], v9 offset:41984
    v_cndmask_b32 v80, 0, v20, s[92:93]
    s_waitcnt lgkmcnt(3)
    v_smfmac_f32_16x16x64_bf16 v[104:107], v[64:67], v[208:215], v0
    ds_read_b128 v[12:15], v9 offset:49152
    v_cndmask_b32 v81, 0, v20, s[94:95]
    v_smfmac_f32_16x16x64_bf16 v[108:111], v[64:67], v[240:247], v0
    ds_read_b128 v[16:19], v9 offset:50176
    v_cndmask_b32 v82, 0, v20, s[96:97]
    s_waitcnt lgkmcnt(4)
    v_smfmac_f32_16x16x64_bf16 v[104:107], v[68:71], v[216:223], v0
    ds_read_b128 v[120:123], v9 offset:57344
    v_cndmask_b32 v83, 0, v20, s[98:99]
    v_smfmac_f32_16x16x64_bf16 v[108:111], v[68:71], v[248:255], v0
    ds_read_b128 v[124:127], v9 offset:58368
    v_smfmac_f32_16x16x64_bf16 v[112:115], v[56:59], v[24:31], v0
    v_smfmac_f32_16x16x64_bf16 v[112:115], v[60:63], v[32:39], v0
    v_cvt_pk_bf16_f32 v96, v104, v105
    v_smfmac_f32_16x16x64_bf16 v[112:115], v[64:67], v[72:79], v0
    v_cvt_pk_bf16_f32 v97, v106, v107
    v_smfmac_f32_16x16x64_bf16 v[112:115], v[68:71], v[88:95], v0
    buffer_store_dwordx2 v[96:97], v1, s[32:35], s48 offen
    v_cvt_pk_bf16_f32 v98, v108, v109
    v_smfmac_f32_16x16x64_bf16 v[116:119], v[56:59], v[40:47], v0
    v_cvt_pk_bf16_f32 v99, v110, v111
    s_waitcnt lgkmcnt(4)
    v_smfmac_f32_16x16x64_bf16 v[116:119], v[60:63], v[48:55], v0
    buffer_store_dwordx2 v[98:99], v1, s[32:35], s49 offen
    s_waitcnt lgkmcnt(2)
    v_smfmac_f32_16x16x64_bf16 v[116:119], v[64:67], v[12:19], v0
    v_cvt_pk_bf16_f32 v100, v112, v113
    s_waitcnt lgkmcnt(0)
    v_smfmac_f32_16x16x64_bf16 v[116:119], v[68:71], v[120:127], v0
    v_cvt_pk_bf16_f32 v101, v114, v115
    buffer_store_dwordx2 v[100:101], v1, s[32:35], s50 offen
    s_nop 5
    v_cvt_pk_bf16_f32 v102, v116, v117
    v_cvt_pk_bf16_f32 v103, v118, v119
    buffer_store_dwordx2 v[102:103], v1, s[32:35], s51 offen
    v_mov_b64 v[104:105], 0
    v_mov_b64 v[106:107], 0
    v_mov_b64 v[108:109], 0
    v_mov_b64 v[110:111], 0
    v_mov_b64 v[112:113], 0
    v_mov_b64 v[114:115], 0
    v_mov_b64 v[116:117], 0
    v_mov_b64 v[118:119], 0
    s_xor_b32 s48, s48, 0x40000
    s_xor_b32 s49, s49, 0x40000
    s_xor_b32 s50, s50, 0x40000
    s_xor_b32 s51, s51, 0x40000
    v_mov_b32 v46, s45
    ds_read_b128 v[56:59], v8 offset:49152
    ds_read_b128 v[60:63], v8 offset:50176
    ds_read_b128 v[64:67], v8 offset:57344
    ds_read_b128 v[68:71], v8 offset:58368
    ds_read_b128 v[72:75], v8 offset:16384
    ds_read_b128 v[76:79], v8 offset:17408
    ds_read_b128 v[88:91], v8 offset:32768
    ds_read_b128 v[92:95], v8 offset:33792
    ds_read_b128 v[12:15], v8 offset:0
    ds_read_b128 v[16:19], v8 offset:1024
    ds_read_b128 v[120:123], v8 offset:8192
    ds_read_b128 v[124:127], v8 offset:9216
    buffer_load_dwordx4 v[24:27], v2, s[32:35], s43 offen offset:0 sc1
    buffer_load_dwordx4 v[28:31], v2, s[32:35], s43 offen offset:1024 sc1
    ds_read_b128 v[96:99], v8 offset:40960
    ds_read_b128 v[100:103], v8 offset:41984
    s_nop 11
    s_mov_b32 s60, 0
L_poll_44:
    buffer_load_dwordx4 v[24:27], v2, s[32:35], s43 offen offset:0 sc1
    buffer_load_dwordx4 v[28:31], v2, s[32:35], s43 offen offset:1024 sc1
    s_add_u32 s60, s60, 1
    s_cmp_gt_u32 s60, 64
    s_cbranch_scc1 L_pexact_45
    s_waitcnt vmcnt(2)
    v_max3_u32 v47, v24, v25, v26
    v_max3_u32 v47, v47, v27, v28
    v_max3_u32 v47, v47, v29, v30
    v_max_u32 v47, v47, v31
    v_cmp_le_u32 vcc, s45, v47
    s_nop 0
    s_and_b64 exec, exec, vcc
    s_cbranch_scc1 L_poll_44
L_pout_46:
    s_mov_b64 exec, -1
    v_mfma_f32_16x16x32_bf16 v[84:87], v[80:83], v[24:27], 0
    v_mfma_f32_16x16x32_bf16 v[84:87], v[80:83], v[28:31], v[84:87]
    s_nop 7
    v_add_f32_dpp v84, v84, v84 row_ror:8 row_mask:0xf bank_mask:0xf
    v_add_f32_dpp v85, v85, v85 row_ror:8 row_mask:0xf bank_mask:0xf
    s_nop 0
    v_add_f32_dpp v84, v84, v84 row_ror:4 row_mask:0xf bank_mask:0xf
    v_add_f32_dpp v85, v85, v85 row_ror:4 row_mask:0xf bank_mask:0xf
    v_cvt_pk_bf16_f32 v44, v84, v85
    buffer_store_dword v44, v3, s[32:35], s52 offen
    buffer_store_dword v46, v3, s[32:35], s53 offen
    ds_read_b128 v[80:83], v8 offset:24576
    ds_read_b128 v[84:87], v8 offset:25600
    s_add_u32 s42, s42, 1
    s_xor_b32 s43, s43, 0x40000
    s_add_u32 s52, s52, 8192
    s_and_b32 s52, s52, 0x7fff
    s_add_u32 s53, s53, 8192
    s_and_b32 s53, s53, 0x7fff
    s_add_u32 s58, s58, 131072
    s_nop 15
    s_nop 15
    s_nop 7
    buffer_load_dwordx4 v[48:51], v10, s[32:35], s55 offen offset:0 sc1
    buffer_load_dwordx4 v[52:55], v10, s[32:35], s55 offen offset:1024 sc1
    s_branch L_chain_loop_w2_38
L_chain_last_39:
    s_waitcnt vmcnt(0)
    ds_read_b128 v[40:43], v10 offset:4096
    ds_read_b128 v[44:47], v10 offset:5120
    ds_read_b128 v[48:51], v10 offset:6144
    ds_read_b128 v[52:55], v10 offset:7168
    v_mov_b64 v[120:121], 0
    v_mov_b64 v[122:123], 0
    v_mov_b64 v[124:125], 0
    v_mov_b64 v[126:127], 0
    s_waitcnt lgkmcnt(7)
    v_smfmac_f32_16x16x64_bf16 v[112:115], v[24:27], a[64:71], v0
    v_smfmac_f32_16x16x64_bf16 v[116:119], v[24:27], a[72:79], v0
    v_smfmac_f32_16x16x64_bf16 v[120:123], v[24:27], a[192:199], v0
    v_smfmac_f32_16x16x64_bf16 v[124:127], v[24:27], a[200:207], v0
    s_waitcnt lgkmcnt(6)
    v_smfmac_f32_16x16x64_bf16 v[112:115], v[28:31], a[80:87], v0
    v_smfmac_f32_16x16x64_bf16 v[116:119], v[28:31], a[88:95], v0
    v_smfmac_f32_16x16x64_bf16 v[120:123], v[28:31], a[208:215], v0
    v_smfmac_f32_16x16x64_bf16 v[124:127], v[28:31], a[216:223], v0
    s_waitcnt lgkmcnt(5)
    v_smfmac_f32_16x16x64_bf16 v[112:115], v[32:35], a[96:103], v0
    v_smfmac_f32_16x16x64_bf16 v[116:119], v[32:35], a[104:111], v0
    v_smfmac_f32_16x16x64_bf16 v[120:123], v[32:35], a[224:231], v0
    v_smfmac_f32_16x16x64_bf16 v[124:127], v[32:35], a[232:239], v0
    s_waitcnt lgkmcnt(4)
    v_smfmac_f32_16x16x64_bf16 v[112:115], v[36:39], a[112:119], v0
    v_smfmac_f32_16x16x64_bf16 v[116:119], v[36:39], a[120:127], v0
    v_smfmac_f32_16x16x64_bf16 v[120:123], v[36:39], a[240:247], v0
    v_smfmac_f32_16x16x64_bf16 v[124:127], v[36:39], a[248:255], v0
    s_waitcnt lgkmcnt(3)
    v_smfmac_f32_16x16x64_bf16 v[112:115], v[40:43], a[128:135], v0
    v_smfmac_f32_16x16x64_bf16 v[116:119], v[40:43], a[136:143], v0
    v_smfmac_f32_16x16x64_bf16 v[120:123], v[40:43], v[128:135], v0
    v_smfmac_f32_16x16x64_bf16 v[124:127], v[40:43], v[136:143], v0
    s_waitcnt lgkmcnt(2)
    v_smfmac_f32_16x16x64_bf16 v[112:115], v[44:47], a[144:151], v0
    v_smfmac_f32_16x16x64_bf16 v[116:119], v[44:47], a[152:159], v0
    v_smfmac_f32_16x16x64_bf16 v[120:123], v[44:47], v[144:151], v0
    v_smfmac_f32_16x16x64_bf16 v[124:127], v[44:47], v[152:159], v0
    s_waitcnt lgkmcnt(1)
    v_smfmac_f32_16x16x64_bf16 v[112:115], v[48:51], a[160:167], v0
    v_smfmac_f32_16x16x64_bf16 v[116:119], v[48:51], a[168:175], v0
    v_smfmac_f32_16x16x64_bf16 v[120:123], v[48:51], v[160:167], v0
    v_smfmac_f32_16x16x64_bf16 v[124:127], v[48:51], v[168:175], v0
    s_waitcnt lgkmcnt(0)
    v_smfmac_f32_16x16x64_bf16 v[112:115], v[52:55], a[176:183], v0
    v_smfmac_f32_16x16x64_bf16 v[116:119], v[52:55], a[184:191], v0
    v_smfmac_f32_16x16x64_bf16 v[120:123], v[52:55], v[176:183], v0
    v_smfmac_f32_16x16x64_bf16 v[124:127], v[52:55], v[184:191], v0
    v_add_f32 v112, v112, v114
    v_add_f32 v113, v113, v115
    v_cvt_pk_bf16_f32 v21, v112, v113
    v_add_f32 v116, v116, v118
    v_add_f32 v117, v117, v119
    v_cvt_pk_bf16_f32 v23, v116, v117
    v_add_f32 v120, v120, v122
    v_add_f32 v121, v121, v123
    v_cvt_pk_bf16_f32 v20, v120, v121
    v_add_f32 v124, v124, v126
    v_add_f32 v125, v125, v127
    v_cvt_pk_bf16_f32 v22, v124, v125
    buffer_store_dwordx4 v[20:23], v10, s[32:35], s58 offen offset:2048 sc1
    s_waitcnt vmcnt(0)
    s_barrier
    s_endpgm
L_pexact_41:
    s_add_u32 s59, s59, 1
    s_cmp_gt_u32 s59, 262144
    s_cbranch_scc1 L_chain_abort_1
    s_waitcnt vmcnt(0)
    v_cmp_eq_u32 vcc, s45, v48
    v_cmp_eq_u32 s[100:101], s45, v49
    s_nop 0
    s_or_b64 vcc, vcc, s[100:101]
    v_cmp_eq_u32 s[100:101], s45, v50
    s_nop 0
    s_or_b64 vcc, vcc, s[100:101]
    v_cmp_eq_u32 s[100:101], s45, v51
    s_nop 0
    s_or_b64 vcc, vcc, s[100:101]
    v_cmp_eq_u32 s[100:101], s45, v52
    s_nop 0
    s_or_b64 vcc, vcc, s[100:101]
    v_cmp_eq_u32 s[100:101], s45, v53
    s_nop 0
    s_or_b64 vcc, vcc, s[100:101]
    v_cmp_eq_u32 s[100:101], s45, v54
    s_nop 0
    s_or_b64 vcc, vcc, s[100:101]
    v_cmp_eq_u32 s[100:101], s45, v55
    s_nop 0
    s_or_b64 vcc, vcc, s[100:101]
    ds_write_b128 v10, v[48:51] offset:4096
    ds_write_b128 v10, v[52:55] offset:5120
    s_and_b64 exec, exec, vcc
    s_cbranch_scc0 L_pout_42
    buffer_load_dwordx4 v[48:51], v10, s[32:35], s55 offen offset:0 sc1
    buffer_load_dwordx4 v[52:55], v10, s[32:35], s55 offen offset:1024 sc1
    s_branch L_pexact_41
L_pexact_45:
    s_add_u32 s59, s59, 1
    s_cmp_gt_u32 s59, 262144
    s_cbranch_scc1 L_chain_abort_1
    s_waitcnt vmcnt(0)
    v_cmp_eq_u32 vcc, s45, v24
    v_cmp_eq_u32 s[100:101], s45, v25
    s_nop 0
    s_or_b64 vcc, vcc, s[100:101]
    v_cmp_eq_u32 s[100:101], s45, v26
    s_nop 0
    s_or_b64 vcc, vcc, s[100:101]
    v_cmp_eq_u32 s[100:101], s45, v27
    s_nop 0
    s_or_b64 vcc, vcc, s[100:101]
    v_cmp_eq_u32 s[100:101], s45, v28
    s_nop 0
    s_or_b64 vcc, vcc, s[100:101]
    v_cmp_eq_u32 s[100:101], s45, v29
    s_nop 0
    s_or_b64 vcc, vcc, s[100:101]
    v_cmp_eq_u32 s[100:101], s45, v30
    s_nop 0
    s_or_b64 vcc, vcc, s[100:101]
    v_cmp_eq_u32 s[100:101], s45, v31
    s_nop 0
    s_or_b64 vcc, vcc, s[100:101]
    s_and_b64 exec, exec, vcc
    s_cbranch_scc0 L_pout_46
    buffer_load_dwordx4 v[24:27], v2, s[32:35], s43 offen offset:0 sc1
    buffer_load_dwordx4 v[28:31], v2, s[32:35], s43 offen offset:1024 sc1
    s_branch L_pexact_45
L_cl_0_3_11:
    buffer_load_dwordx4 v[48:51], v10, s[32:35], s55 offen offset:2048 sc1
    buffer_load_dwordx4 v[52:55], v10, s[32:35], s55 offen offset:3072 sc1
L_chain_loop_w3_48:
    s_mov_b32 s60, 0
L_poll_50:
    buffer_load_dwordx4 v[48:51], v10, s[32:35], s55 offen offset:2048 sc1
    buffer_load_dwordx4 v[52:55], v10, s[32:35], s55 offen offset:3072 sc1
    s_add_u32 s60, s60, 1
    s_cmp_gt_u32 s60, 64
    s_cbranch_scc1 L_pexact_51
    s_waitcnt vmcnt(2)
    v_max3_u32 v47, v48, v49, v50
    v_max3_u32 v47, v47, v51, v52
    ds_write_b128 v10, v[48:51] offset:6144
    v_max3_u32 v47, v47, v53, v54
    v_max_u32 v47, v47, v55
    ds_write_b128 v10, v[52:55] offset:7168
    v_cmp_le_u32 vcc, s45, v47
    s_nop 0
    s_and_b64 exec, exec, vcc
    s_cbranch_scc1 L_poll_50
L_pout_52:
    s_mov_b64 exec, -1
    s_waitcnt lgkmcnt(0)
    s_barrier
    ds_read_b128 v[24:27], v10 offset:0
    ds_read_b128 v[28:31], v10 offset:1024
    ds_read_b128 v[32:35], v10 offset:2048
    ds_read_b128 v[36:39], v10 offset:3072
    s_cmp_eq_u32 s42, 63
    s_cbranch_scc1 L_chain_last_49
    s_waitcnt lgkmcnt(3)
    v_smfmac_f32_16x16x64_bf16 v[104:107], v[24:27], v[12:19], v0
    v_smfmac_f32_16x16x64_bf16 v[108:111], v[24:27], v[120:127], v0
    ds_read_b128 v[12:15], v10 offset:22528
    s_waitcnt lgkmcnt(3)
    v_smfmac_f32_16x16x64_bf16 v[104:107], v[28:31], v[72:79], v0
    ds_read_b128 v[16:19], v10 offset:23552
    v_smfmac_f32_16x16x64_bf16 v[108:111], v[28:31], v[80:87], v0
    ds_read_b128 v[72:75], v10 offset:8192
    s_waitcnt lgkmcnt(4)
    v_smfmac_f32_16x16x64_bf16 v[104:107], v[32:35], v[88:95], v0
    ds_read_b128 v[76:79], v10 offset:9216
    v_smfmac_f32_16x16x64_bf16 v[108:111], v[32:35], v[96:103], v0
    ds_read_b128 v[80:83], v10 offset:10240
    s_waitcnt lgkmcnt(5)
    v_smfmac_f32_16x16x64_bf16 v[104:107], v[36:39], v[56:63], v0
    ds_read_b128 v[84:87], v10 offset:11264
    v_smfmac_f32_16x16x64_bf16 v[108:111], v[36:39], v[64:71], v0
    ds_read_b128 v[88:91], v10 offset:12288
    v_smfmac_f32_16x16x64_bf16 v[112:115], v[24:27], a[64:71], v0
    ds_read_b128 v[92:95], v10 offset:13312
    v_smfmac_f32_16x16x64_bf16 v[116:119], v[24:27], a[72:79], v0
    ds_read_b128 v[96:99], v10 offset:14336
    v_smfmac_f32_16x16x64_bf16 v[112:115], v[28:31], a[80:87], v0
    ds_read_b128 v[100:103], v10 offset:15360
    v_smfmac_f32_16x16x64_bf16 v[116:119], v[28:31], a[88:95], v0
    s_waitcnt vmcnt(0)
    ds_read_b128 v[40:43], v10 offset:4096
    v_smfmac_f32_16x16x64_bf16 v[112:115], v[32:35], a[96:103], v0
    s_waitcnt vmcnt(0)
    s_mov_b32 m0, 145408
    ds_read_b128 v[44:47], v10 offset:5120
    v_smfmac_f32_16x16x64_bf16 v[116:119], v[32:35], a[104:111], v0
    s_waitcnt lgkmcnt(2)
    s_barrier
    v_smfmac_f32_16x16x64_bf16 v[112:115], v[36:39], a[112:119], v0
    ds_read_b128 v[48:51], v10 offset:6144
    v_mov_b64 v[120:121], 0
    v_smfmac_f32_16x16x64_bf16 v[116:119], v[36:39], a[120:127], v0
    ds_read_b128 v[52:55], v10 offset:7168
    v_mov_b64 v[122:123], 0
    s_waitcnt lgkmcnt(3)
    v_smfmac_f32_16x16x64_bf16 v[104:107], v[40:43], a[0:7], v0
    v_mov_b64 v[124:125], 0
    v_smfmac_f32_16x16x64_bf16 v[108:111], v[40:43], a[8:15], v0
    buffer_load_dwordx4 v10, s[32:35], s56 offen sc1 lds
    v_mov_b64 v[126:127], 0
    v_smfmac_f32_16x16x64_bf16 v[112:115], v[40:43], a[128:135], v0
    v_smfmac_f32_16x16x64_bf16 v[116:119], v[40:43], a[136:143], v0
    s_waitcnt lgkmcnt(2)
    v_smfmac_f32_16x16x64_bf16 v[104:107], v[44:47], a[16:23], v0
    v_mov_b32 v56, s45
    v_smfmac_f32_16x16x64_bf16 v[108:111], v[44:47], a[24:31], v0
    buffer_load_dwordx4 v10, s[32:35], s56 offen offset:1024 sc1 lds
    s_mov_b32 m0, 153600
    v_mov_b32 v57, s45
    v_smfmac_f32_16x16x64_bf16 v[112:115], v[44:47], a[144:151], v0
    v_mov_b64 v[58:59], v[56:57]
    v_smfmac_f32_16x16x64_bf16 v[116:119], v[44:47], a[152:159], v0
    s_waitcnt lgkmcnt(1)
    v_smfmac_f32_16x16x64_bf16 v[104:107], v[48:51], a[32:39], v0
    v_smfmac_f32_16x16x64_bf16 v[108:111], v[48:51], a[40:47], v0
    buffer_load_dwordx4 v10, s[32:35], s69 offen sc1 lds
    s_waitcnt lgkmcnt(0)
    v_smfmac_f32_16x16x64_bf16 v[104:107], v[52:55], a[48:55], v0
    v_smfmac_f32_16x16x64_bf16 v[108:111], v[52:55], a[56:63], v0
    v_smfmac_f32_16x16x64_bf16 v[112:115], v[48:51], a[160:167], v0
    v_smfmac_f32_16x16x64_bf16 v[116:119], v[48:51], a[168:175], v0
    buffer_load_dwordx4 v10, s[32:35], s69 offen offset:1024 sc1 lds
    v_add_f32 v104, v104, v106
    v_smfmac_f32_16x16x64_bf16 v[112:115], v[52:55], a[176:183], v0
    v_add_f32 v105, v105, v107
    v_smfmac_f32_16x16x64_bf16 v[116:119], v[52:55], a[184:191], v0
    v_add_f32 v108, v108, v110
    v_smfmac_f32_16x16x64_bf16 v[120:123], v[24:27], a[192:199], v0
    v_add_f32 v109, v109, v111
    v_smfmac_f32_16x16x64_bf16 v[124:127], v[24:27], a[200:207], v0
    v_cvt_pk_bf16_f32 v104, v104, v105
    v_add_f32 v112, v112, v114
    v_add_f32 v113, v113, v115
    v_cvt_pk_bf16_f32 v21, v112, v113
    ds_write2_b32 v4, v21, v104 offset0:0 offset1:1
    v_pk_add_f32 v[116:117], v[116:117], v[118:119]
    v_cvt_pk_bf16_f32 v108, v108, v109
    v_cvt_pk_bf16_f32 v23, v116, v117
    ds_write2_b32 v4, v23, v108 offset0:128 offset1:129
    v_smfmac_f32_16x16x64_bf16 v[120:123], v[28:31], a[208:215], v0
    v_smfmac_f32_16x16x64_bf16 v[124:127], v[28:31], a[216:223], v0
    buffer_store_dwordx4 v[56:59], v2, s[32:35], s57 offen offset:1024
    v_smfmac_f32_16x16x64_bf16 v[120:123], v[32:35], a[224:231], v0
    v_smfmac_f32_16x16x64_bf16 v[124:127], v[32:35], a[232:239], v0
    buffer_store_dwordx4 v[56:59], v2, s[32:35], s57 offen offset:0
    s_waitcnt lgkmcnt(0)
    s_barrier
    ds_read_b64_tr_b16 v[56:57], v5 offset:0
    ds_read_b64_tr_b16 v[58:59], v5 offset:256
    v_smfmac_f32_16x16x64_bf16 v[120:123], v[36:39], a[240:247], v0
    ds_read_b64_tr_b16 v[60:61], v5 offset:1024
    ds_read_b64_tr_b16 v[62:63], v5 offset:1280
    v_smfmac_f32_16x16x64_bf16 v[124:127], v[36:39], a[248:255], v0
    ds_read_b64_tr_b16 v[64:65], v5 offset:2048
    ds_read_b64_tr_b16 v[66:67], v5 offset:2304
    v_smfmac_f32_16x16x64_bf16 v[120:123], v[40:43], v[128:135], v0
    ds_read_b64_tr_b16 v[68:69], v5 offset:3072
    ds_read_b64_tr_b16 v[70:71], v5 offset:3328
    v_smfmac_f32_16x16x64_bf16 v[124:127], v[40:43], v[136:143], v0
    s_waitcnt lgkmcnt(6)
    v_mfma_f32_16x16x32_bf16 v[112:115], v[56:59], v[56:59], 0
    ds_read_b128 v[24:27], v9 offset:0
    v_mfma_f32_16x16x32_bf16 v[104:107], v[72:75], v[56:59], 0
    ds_read_b128 v[28:31], v9 offset:1024
    v_mfma_f32_16x16x32_bf16 v[108:111], v[88:91], v[56:59], 0
    s_waitcnt lgkmcnt(6)
    v_mfma_f32_16x16x32_bf16 v[112:115], v[60:63], v[60:63], v[112:115]
    ds_read_b128 v[32:35], v9 offset:8192
    v_mfma_f32_16x16x32_bf16 v[104:107], v[76:79], v[60:63], v[104:107]
    ds_read_b128 v[36:39], v9 offset:9216
    v_mfma_f32_16x16x32_bf16 v[108:111], v[92:95], v[60:63], v[108:111]
    s_waitcnt lgkmcnt(6)
    v_mfma_f32_16x16x32_bf16 v[112:115], v[64:67], v[64:67], v[112:115]
    ds_read_b128 v[72:75], v9 offset:16384
    v_mfma_f32_16x16x32_bf16 v[104:107], v[80:83], v[64:67], v[104:107]
    ds_read_b128 v[76:79], v9 offset:17408
    v_mfma_f32_16x16x32_bf16 v[108:111], v[96:99], v[64:67], v[108:111]
    s_waitcnt lgkmcnt(6)
    v_mfma_f32_16x16x32_bf16 v[112:115], v[68:71], v[68:71], v[112:115]
    ds_read_b128 v[88:91], v9 offset:24576
    v_mfma_f32_16x16x32_bf16 v[104:107], v[84:87], v[68:71], v[104:107]
    ds_read_b128 v[92:95], v9 offset:25600
    v_mfma_f32_16x16x32_bf16 v[108:111], v[100:103], v[68:71], v[108:111]
    v_smfmac_f32_16x16x64_bf16 v[120:123], v[44:47], v[144:151], v0
    v_mov_b32 v84, 0x3f803f80
    v_smfmac_f32_16x16x64_bf16 v[124:127], v[44:47], v[152:159], v0
    v_max3_f32 v116, v112, v113, v104
    v_max3_f32 v117, v105, v106, v107
    v_max3_f32 v116, v116, v108, v109
    v_max3_f32 v117, v117, v110, v111
    v_max_f32 v116, v116, v117
    v_max_f32 v117, v116, v117
    v_smfmac_f32_16x16x64_bf16 v[120:123], v[48:51], v[160:167], v0
    v_permlane32_swap_b32 v116, v117
    v_max_f32 v116, v116, v117
    v_max_f32 v117, v116, v117
    v_smfmac_f32_16x16x64_bf16 v[124:127], v[48:51], v[168:175], v0
    v_permlane16_swap_b32 v116, v117
    v_smfmac_f32_16x16x64_bf16 v[120:123], v[52:55], v[176:183], v0
    v_max_f32 v116, v116, v117
    v_smfmac_f32_16x16x64_bf16 v[124:127], v[52:55], v[184:191], v0
    v_mul_f32 v116, s44, v116
    v_mov_b32 v85, 0x3f803f80
    v_pk_fma_f32 v[104:105], v[104:105], s[66:67], v[116:117] op_sel_hi:[1,1,0] neg_lo:[0,0,1] neg_hi:[0,0,1]
    v_pk_fma_f32 v[106:107], v[106:107], s[66:67], v[116:117] op_sel_hi:[1,1,0] neg_lo:[0,0,1] neg_hi:[0,0,1]
    v_exp_f32 v104, v104
    v_exp_f32 v105, v105
    v_pk_fma_f32 v[108:109], v[108:109], s[66:67], v[116:117] op_sel_hi:[1,1,0] neg_lo:[0,0,1] neg_hi:[0,0,1]
    v_exp_f32 v106, v106
    v_exp_f32 v107, v107
    v_pk_fma_f32 v[110:111], v[110:111], s[66:67], v[116:117] op_sel_hi:[1,1,0] neg_lo:[0,0,1] neg_hi:[0,0,1]
    v_cvt_pk_bf16_f32 v60, v104, v105
    v_exp_f32 v108, v108
    v_exp_f32 v109, v109
    v_cvt_pk_bf16_f32 v61, v106, v107
    v_pk_fma_f32 v[112:113], v[112:113], s[66:67], v[116:117] op_sel_hi:[1,1,0] neg_lo:[0,0,1] neg_hi:[0,0,1]
    v_exp_f32 v110, v110
    v_exp_f32 v111, v111
    v_cvt_pk_bf16_f32 v62, v108, v109
    v_exp_f32 v112, v112
    v_cvt_pk_bf16_f32 v63, v110, v111
    v_exp_f32 v113, v113
    v_mov_b64 v[86:87], v[84:85]
    v_mfma_f32_16x16x32_bf16 v[96:99], v[12:15], v[60:63], 0
    v_cvt_pk_bf16_f32 v56, v112, v113
    v_mov_b32 v57, 0
    v_mfma_f32_16x16x32_bf16 v[80:83], v[84:87], v[60:63], 0
    v_add_f32 v120, v120, v122
    v_add_f32 v121, v121, v123
    v_mfma_f32_16x16x32_bf16 v[100:103], v[16:19], v[60:63], 0
    v_cvt_pk_bf16_f32 v20, v120, v121
    v_add_f32 v124, v124, v126
    v_add_f32 v125, v125, v127
    v_mfma_f32_16x16x16_bf16 v[96:99], v[20:21], v[56:57], v[96:99]
    v_cvt_pk_bf16_f32 v22, v124, v125
    v_mfma_f32_16x16x16_bf16 v[80:83], v[84:85], v[56:57], v[80:83]
    s_nop 0
    v_mfma_f32_16x16x16_bf16 v[100:103], v[22:23], v[56:57], v[100:103]
    ds_read_b128 v[40:43], v9 offset:32768
    ds_read_b128 v[44:47], v9 offset:33792
    s_nop 3
    v_rcp_f32 v118, v80
    s_mov_b64 exec, s[70:71]
    v_pk_mul_f32 v[96:97], v[96:97], v[118:119] op_sel_hi:[1,0]
    v_cvt_pk_bf16_f32 v96, v96, v97
    v_pk_mul_f32 v[98:99], v[98:99], v[118:119] op_sel_hi:[1,0]
    v_cvt_pk_bf16_f32 v97, v98, v99
    v_pk_mul_f32 v[100:101], v[100:101], v[118:119] op_sel_hi:[1,0]
    v_cvt_pk_bf16_f32 v98, v100, v101
    v_pk_mul_f32 v[102:103], v[102:103], v[118:119] op_sel_hi:[1,0]
    v_cvt_pk_bf16_f32 v99, v102, v103
    ds_write2_b64 v6, v[96:97], v[98:99] offset0:0 offset1:4
    s_mov_b64 exec, -1
    buffer_store_dwordx4 v[20:23], v10, s[32:35], s58 offen offset:3072 sc1
    v_mov_b64 v[104:105], 0
    v_mov_b64 v[106:107], 0
    v_mov_b64 v[108:109], 0
    v_mov_b64 v[110:111], 0
    v_mov_b64 v[112:113], 0
    v_mov_b64 v[114:115], 0
    v_mov_b64 v[116:117], 0
    v_mov_b64 v[118:119], 0
    s_waitcnt lgkmcnt(0)
    s_barrier
    ds_read_b128 v[56:59], v7 offset:0
    ds_read_b128 v[60:63], v7 offset:64
    ds_read_b128 v[64:67], v7 offset:128
    ds_read_b128 v[68:71], v7 offset:192
    s_add_u32 s54, s52, 131072
    s_add_u32 s55, s54, 4096
    s_cmp_lt_u32 s42, 62
    s_cselect_b32 s60, 262144, 0
    s_add_u32 s56, s56, s60
    s_add_u32 s69, s69, s60
    s_mov_b32 s57, s43
    s_waitcnt lgkmcnt(3)
    v_smfmac_f32_16x16x64_bf16 v[104:107], v[56:59], v[192:199], v0
    v_mov_b32 v20, 0x3f80
    v_smfmac_f32_16x16x64_bf16 v[108:111], v[56:59], v[224:231], v0
    v_mov_b32 v21, 0x3f800000
    s_waitcnt lgkmcnt(2)
    v_smfmac_f32_16x16x64_bf16 v[104:107], v[60:63], v[200:207], v0
    ds_read_b128 v[48:51], v9 offset:40960
    v_cndmask_b32 v20, v20, v21, s[46:47]
    v_smfmac_f32_16x16x64_bf16 v[108:111], v[60:63], v[232:239], v0
    ds_read_b128 v[52:55], v9 offset:41984
    v_cndmask_b32 v80, 0, v20, s[92:93]
    s_waitcnt lgkmcnt(3)
    v_smfmac_f32_16x16x64_bf16 v[104:107], v[64:67], v[208:215], v0
    ds_read_b128 v[12:15], v9 offset:49152
    v_cndmask_b32 v81, 0, v20, s[94:95]
    v_smfmac_f32_16x16x64_bf16 v[108:111], v[64:67], v[240:247], v0
    ds_read_b128 v[16:19], v9 offset:50176
    v_cndmask_b32 v82, 0, v20, s[96:97]
    s_waitcnt lgkmcnt(4)
    v_smfmac_f32_16x16x64_bf16 v[104:107], v[68:71], v[216:223], v0
    ds_read_b128 v[120:123], v9 offset:57344
    v_cndmask_b32 v83, 0, v20, s[98:99]
    v_smfmac_f32_16x16x64_bf16 v[108:111], v[68:71], v[248:255], v0
    ds_read_b128 v[124:127], v9 offset:58368
    v_smfmac_f32_16x16x64_bf16 v[112:115], v[56:59], v[24:31], v0
    v_smfmac_f32_16x16x64_bf16 v[112:115], v[60:63], v[32:39], v0
    v_cvt_pk_bf16_f32 v96, v104, v105
    v_smfmac_f32_16x16x64_bf16 v[112:115], v[64:67], v[72:79], v0
    v_cvt_pk_bf16_f32 v97, v106, v107
    v_smfmac_f32_16x16x64_bf16 v[112:115], v[68:71], v[88:95], v0
    buffer_store_dwordx2 v[96:97], v1, s[32:35], s48 offen
    v_cvt_pk_bf16_f32 v98, v108, v109
    v_smfmac_f32_16x16x64_bf16 v[116:119], v[56:59], v[40:47], v0
    v_cvt_pk_bf16_f32 v99, v110, v111
    s_waitcnt lgkmcnt(4)
    v_smfmac_f32_16x16x64_bf16 v[116:119], v[60:63], v[48:55], v0
    buffer_store_dwordx2 v[98:99], v1, s[32:35], s49 offen
    s_waitcnt lgkmcnt(2)
    v_smfmac_f32_16x16x64_bf16 v[116:119], v[64:67], v[12:19], v0
    v_cvt_pk_bf16_f32 v100, v112, v113
    s_waitcnt lgkmcnt(0)
    v_smfmac_f32_16x16x64_bf16 v[116:119], v[68:71], v[120:127], v0
    v_cvt_pk_bf16_f32 v101, v114, v115
    buffer_store_dwordx2 v[100:101], v1, s[32:35], s50 offen
    s_nop 5
    v_cvt_pk_bf16_f32 v102, v116, v117
    v_cvt_pk_bf16_f32 v103, v118, v119
    buffer_store_dwordx2 v[102:103], v1, s[32:35], s51 offen
    v_mov_b64 v[104:105], 0
    v_mov_b64 v[106:107], 0
    v_mov_b64 v[108:109], 0
    v_mov_b64 v[110:111], 0
    v_mov_b64 v[112:113], 0
    v_mov_b64 v[114:115], 0
    v_mov_b64 v[116:117], 0
    v_mov_b64 v[118:119], 0
    s_xor_b32 s48, s48, 0x40000
    s_xor_b32 s49, s49, 0x40000
    s_xor_b32 s50, s50, 0x40000
    s_xor_b32 s51, s51, 0x40000
    v_mov_b32 v46, s45
    ds_read_b128 v[56:59], v8 offset:49152
    ds_read_b128 v[60:63], v8 offset:50176
    ds_read_b128 v[64:67], v8 offset:57344
    ds_read_b128 v[68:71], v8 offset:58368
    ds_read_b128 v[72:75], v8 offset:16384
    ds_read_b128 v[76:79], v8 offset:17408
    ds_read_b128 v[88:91], v8 offset:32768
    ds_read_b128 v[92:95], v8 offset:33792
    ds_read_b128 v[12:15], v8 offset:0
    ds_read_b128 v[16:19], v8 offset:1024
    ds_read_b128 v[120:123], v8 offset:8192
    ds_read_b128 v[124:127], v8 offset:9216
    ds_read_b128 v[96:99], v8 offset:40960
    buffer_load_dwordx4 v[24:27], v2, s[32:35], s43 offen offset:0 sc1
    buffer_load_dwordx4 v[28:31], v2, s[32:35], s43 offen offset:1024 sc1
    ds_read_b128 v[100:103], v8 offset:41984
    s_nop 15
    s_mov_b32 s60, 0
L_poll_54:
    buffer_load_dwordx4 v[24:27], v2, s[32:35], s43 offen offset:0 sc1
    buffer_load_dwordx4 v[28:31], v2, s[32:35], s43 offen offset:1024 sc1
    s_add_u32 s60, s60, 1
    s_cmp_gt_u32 s60, 64
    s_cbranch_scc1 L_pexact_55
    s_waitcnt vmcnt(2)
    v_max3_u32 v47, v24, v25, v26
    v_max3_u32 v47, v47, v27, v28
    v_max3_u32 v47, v47, v29, v30
    v_max_u32 v47, v47, v31
    v_cmp_le_u32 vcc, s45, v47
    s_nop 0
    s_and_b64 exec, exec, vcc
    s_cbranch_scc1 L_poll_54
L_pout_56:
    s_mov_b64 exec, -1
    v_mfma_f32_16x16x32_bf16 v[84:87], v[80:83], v[24:27], 0
    v_mfma_f32_16x16x32_bf16 v[84:87], v[80:83], v[28:31], v[84:87]
    s_nop 7
    v_add_f32_dpp v84, v84, v84 row_ror:8 row_mask:0xf bank_mask:0xf
    v_add_f32_dpp v85, v85, v85 row_ror:8 row_mask:0xf bank_mask:0xf
    s_nop 0
    v_add_f32_dpp v84, v84, v84 row_ror:4 row_mask:0xf bank_mask:0xf
    v_add_f32_dpp v85, v85, v85 row_ror:4 row_mask:0xf bank_mask:0xf
    v_cvt_pk_bf16_f32 v44, v84, v85
    buffer_store_dword v44, v3, s[32:35], s52 offen
    buffer_store_dword v46, v3, s[32:35], s53 offen
    ds_read_b128 v[80:83], v8 offset:24576
    ds_read_b128 v[84:87], v8 offset:25600
    s_add_u32 s42, s42, 1
    s_xor_b32 s43, s43, 0x40000
    s_add_u32 s52, s52, 8192
    s_and_b32 s52, s52, 0x7fff
    s_add_u32 s53, s53, 8192
    s_and_b32 s53, s53, 0x7fff
    s_add_u32 s58, s58, 131072
    s_nop 15
    s_nop 13
    buffer_load_dwordx4 v[48:51], v10, s[32:35], s55 offen offset:2048 sc1
    buffer_load_dwordx4 v[52:55], v10, s[32:35], s55 offen offset:3072 sc1
    s_branch L_chain_loop_w3_48
L_chain_last_49:
    s_waitcnt vmcnt(0)
    ds_read_b128 v[40:43], v10 offset:4096
    ds_read_b128 v[44:47], v10 offset:5120
    ds_read_b128 v[48:51], v10 offset:6144
    ds_read_b128 v[52:55], v10 offset:7168
    v_mov_b64 v[120:121], 0
    v_mov_b64 v[122:123], 0
    v_mov_b64 v[124:125], 0
    v_mov_b64 v[126:127], 0
    s_waitcnt lgkmcnt(7)
    v_smfmac_f32_16x16x64_bf16 v[112:115], v[24:27], a[64:71], v0
    v_smfmac_f32_16x16x64_bf16 v[116:119], v[24:27], a[72:79], v0
    v_smfmac_f32_16x16x64_bf16 v[120:123], v[24:27], a[192:199], v0
    v_smfmac_f32_16x16x64_bf16 v[124:127], v[24:27], a[200:207], v0
    s_waitcnt lgkmcnt(6)
    v_smfmac_f32_16x16x64_bf16 v[112:115], v[28:31], a[80:87], v0
    v_smfmac_f32_16x16x64_bf16 v[116:119], v[28:31], a[88:95], v0
    v_smfmac_f32_16x16x64_bf16 v[120:123], v[28:31], a[208:215], v0
    v_smfmac_f32_16x16x64_bf16 v[124:127], v[28:31], a[216:223], v0
    s_waitcnt lgkmcnt(5)
    v_smfmac_f32_16x16x64_bf16 v[112:115], v[32:35], a[96:103], v0
    v_smfmac_f32_16x16x64_bf16 v[116:119], v[32:35], a[104:111], v0
    v_smfmac_f32_16x16x64_bf16 v[120:123], v[32:35], a[224:231], v0
    v_smfmac_f32_16x16x64_bf16 v[124:127], v[32:35], a[232:239], v0
    s_waitcnt lgkmcnt(4)
    v_smfmac_f32_16x16x64_bf16 v[112:115], v[36:39], a[112:119], v0
    v_smfmac_f32_16x16x64_bf16 v[116:119], v[36:39], a[120:127], v0
    v_smfmac_f32_16x16x64_bf16 v[120:123], v[36:39], a[240:247], v0
    v_smfmac_f32_16x16x64_bf16 v[124:127], v[36:39], a[248:255], v0
    s_waitcnt lgkmcnt(3)
    v_smfmac_f32_16x16x64_bf16 v[112:115], v[40:43], a[128:135], v0
    v_smfmac_f32_16x16x64_bf16 v[116:119], v[40:43], a[136:143], v0
    v_smfmac_f32_16x16x64_bf16 v[120:123], v[40:43], v[128:135], v0
    v_smfmac_f32_16x16x64_bf16 v[124:127], v[40:43], v[136:143], v0
    s_waitcnt lgkmcnt(2)
    v_smfmac_f32_16x16x64_bf16 v[112:115], v[44:47], a[144:151], v0
    v_smfmac_f32_16x16x64_bf16 v[116:119], v[44:47], a[152:159], v0
    v_smfmac_f32_16x16x64_bf16 v[120:123], v[44:47], v[144:151], v0
    v_smfmac_f32_16x16x64_bf16 v[124:127], v[44:47], v[152:159], v0
    s_waitcnt lgkmcnt(1)
    v_smfmac_f32_16x16x64_bf16 v[112:115], v[48:51], a[160:167], v0
    v_smfmac_f32_16x16x64_bf16 v[116:119], v[48:51], a[168:175], v0
    v_smfmac_f32_16x16x64_bf16 v[120:123], v[48:51], v[160:167], v0
    v_smfmac_f32_16x16x64_bf16 v[124:127], v[48:51], v[168:175], v0
    s_waitcnt lgkmcnt(0)
    v_smfmac_f32_16x16x64_bf16 v[112:115], v[52:55], a[176:183], v0
    v_smfmac_f32_16x16x64_bf16 v[116:119], v[52:55], a[184:191], v0
    v_smfmac_f32_16x16x64_bf16 v[120:123], v[52:55], v[176:183], v0
    v_smfmac_f32_16x16x64_bf16 v[124:127], v[52:55], v[184:191], v0
    v_add_f32 v112, v112, v114
    v_add_f32 v113, v113, v115
    v_cvt_pk_bf16_f32 v21, v112, v113
    v_add_f32 v116, v116, v118
    v_add_f32 v117, v117, v119
    v_cvt_pk_bf16_f32 v23, v116, v117
    v_add_f32 v120, v120, v122
    v_add_f32 v121, v121, v123
    v_cvt_pk_bf16_f32 v20, v120, v121
    v_add_f32 v124, v124, v126
    v_add_f32 v125, v125, v127
    v_cvt_pk_bf16_f32 v22, v124, v125
    buffer_store_dwordx4 v[20:23], v10, s[32:35], s58 offen offset:3072 sc1
    s_waitcnt vmcnt(0)
    s_barrier
    s_endpgm
L_pexact_51:
    s_add_u32 s59, s59, 1
    s_cmp_gt_u32 s59, 262144
    s_cbranch_scc1 L_chain_abort_1
    s_waitcnt vmcnt(0)
    v_cmp_eq_u32 vcc, s45, v48
    v_cmp_eq_u32 s[100:101], s45, v49
    s_nop 0
    s_or_b64 vcc, vcc, s[100:101]
    v_cmp_eq_u32 s[100:101], s45, v50
    s_nop 0
    s_or_b64 vcc, vcc, s[100:101]
    v_cmp_eq_u32 s[100:101], s45, v51
    s_nop 0
    s_or_b64 vcc, vcc, s[100:101]
    v_cmp_eq_u32 s[100:101], s45, v52
    s_nop 0
    s_or_b64 vcc, vcc, s[100:101]
    v_cmp_eq_u32 s[100:101], s45, v53
    s_nop 0
    s_or_b64 vcc, vcc, s[100:101]
    v_cmp_eq_u32 s[100:101], s45, v54
    s_nop 0
    s_or_b64 vcc, vcc, s[100:101]
    v_cmp_eq_u32 s[100:101], s45, v55
    s_nop 0
    s_or_b64 vcc, vcc, s[100:101]
    ds_write_b128 v10, v[48:51] offset:6144
    ds_write_b128 v10, v[52:55] offset:7168
    s_and_b64 exec, exec, vcc
    s_cbranch_scc0 L_pout_52
    buffer_load_dwordx4 v[48:51], v10, s[32:35], s55 offen offset:2048 sc1
    buffer_load_dwordx4 v[52:55], v10, s[32:35], s55 offen offset:3072 sc1
    s_branch L_pexact_51
L_pexact_55:
    s_add_u32 s59, s59, 1
    s_cmp_gt_u32 s59, 262144
    s_cbranch_scc1 L_chain_abort_1
    s_waitcnt vmcnt(0)
    v_cmp_eq_u32 vcc, s45, v24
    v_cmp_eq_u32 s[100:101], s45, v25
    s_nop 0
    s_or_b64 vcc, vcc, s[100:101]
    v_cmp_eq_u32 s[100:101], s45, v26
    s_nop 0
    s_or_b64 vcc, vcc, s[100:101]
    v_cmp_eq_u32 s[100:101], s45, v27
    s_nop 0
    s_or_b64 vcc, vcc, s[100:101]
    v_cmp_eq_u32 s[100:101], s45, v28
    s_nop 0
    s_or_b64 vcc, vcc, s[100:101]
    v_cmp_eq_u32 s[100:101], s45, v29
    s_nop 0
    s_or_b64 vcc, vcc, s[100:101]
    v_cmp_eq_u32 s[100:101], s45, v30
    s_nop 0
    s_or_b64 vcc, vcc, s[100:101]
    v_cmp_eq_u32 s[100:101], s45, v31
    s_nop 0
    s_or_b64 vcc, vcc, s[100:101]
    s_and_b64 exec, exec, vcc
    s_cbranch_scc0 L_pout_56
    buffer_load_dwordx4 v[24:27], v2, s[32:35], s43 offen offset:0 sc1
    buffer_load_dwordx4 v[28:31], v2, s[32:35], s43 offen offset:1024 sc1
    s_branch L_pexact_55
L_chain_slow_5:
    s_cmp_eq_u32 s40, 1
    s_cbranch_scc1 L_cl_1_1_13
    s_cmp_eq_u32 s40, 2
    s_cbranch_scc1 L_cl_1_2_14
    s_cmp_eq_u32 s40, 3
    s_cbranch_scc1 L_cl_1_3_15
L_cl_1_0_12:
    buffer_load_dwordx4 v[48:51], v10, s[32:35], s54 offen offset:0 sc1
    buffer_load_dwordx4 v[52:55], v10, s[32:35], s54 offen offset:1024 sc1
L_chain_loop_w0_58:
    s_mov_b32 s60, 0
L_poll_60:
    buffer_load_dwordx4 v[48:51], v10, s[32:35], s54 offen offset:0 sc1
    buffer_load_dwordx4 v[52:55], v10, s[32:35], s54 offen offset:1024 sc1
    s_add_u32 s60, s60, 1
    s_cmp_gt_u32 s60, 64
    s_cbranch_scc1 L_pexact_61
    s_waitcnt vmcnt(2)
    v_max3_u32 v47, v48, v49, v50
    v_max3_u32 v47, v47, v51, v52
    ds_write_b128 v10, v[48:51] offset:0
    v_max3_u32 v47, v47, v53, v54
    v_max_u32 v47, v47, v55
    ds_write_b128 v10, v[52:55] offset:1024
    v_cmp_le_u32 vcc, s45, v47
    s_nop 0
    s_and_b64 exec, exec, vcc
    s_cbranch_scc1 L_poll_60
L_pout_62:
    s_mov_b64 exec, -1
    s_waitcnt lgkmcnt(0)
    s_barrier
    ds_read_b128 v[24:27], v10 offset:0
    ds_read_b128 v[28:31], v10 offset:1024
    ds_read_b128 v[32:35], v10 offset:2048
    ds_read_b128 v[36:39], v10 offset:3072
    s_cmp_eq_u32 s42, 63
    s_cbranch_scc1 L_chain_last_59
    s_waitcnt lgkmcnt(3)
    v_smfmac_f32_16x16x64_bf16 v[104:107], v[24:27], v[12:19], v0
    v_smfmac_f32_16x16x64_bf16 v[108:111], v[24:27], v[120:127], v0
    ds_read_b128 v[12:15], v10 offset:16384
    s_waitcnt lgkmcnt(3)
    v_smfmac_f32_16x16x64_bf16 v[104:107], v[28:31], v[72:79], v0
    ds_read_b128 v[16:19], v10 offset:17408
    v_smfmac_f32_16x16x64_bf16 v[108:111], v[28:31], v[80:87], v0
    ds_read_b128 v[72:75], v10 offset:8192
    v_mov_b32 v20, s42
    s_waitcnt lgkmcnt(4)
    v_smfmac_f32_16x16x64_bf16 v[104:107], v[32:35], v[88:95], v0
    ds_read_b128 v[76:79], v10 offset:9216
    v_smfmac_f32_16x16x64_bf16 v[108:111], v[32:35], v[96:103], v0
    ds_read_b128 v[80:83], v10 offset:10240
    s_waitcnt lgkmcnt(5)
    v_smfmac_f32_16x16x64_bf16 v[104:107], v[36:39], v[56:63], v0
    ds_read_b128 v[84:87], v10 offset:11264
    v_smfmac_f32_16x16x64_bf16 v[108:111], v[36:39], v[64:71], v0
    ds_read_b128 v[88:91], v10 offset:12288
    v_smfmac_f32_16x16x64_bf16 v[112:115], v[24:27], a[64:71], v0
    ds_read_b128 v[92:95], v10 offset:13312
    v_smfmac_f32_16x16x64_bf16 v[116:119], v[24:27], a[72:79], v0
    ds_read_b128 v[96:99], v10 offset:14336
    v_smfmac_f32_16x16x64_bf16 v[112:115], v[28:31], a[80:87], v0
    ds_read_b128 v[100:103], v10 offset:15360
    v_smfmac_f32_16x16x64_bf16 v[116:119], v[28:31], a[88:95], v0
    s_waitcnt vmcnt(0)
    ds_read_b128 v[40:43], v10 offset:4096
    v_smfmac_f32_16x16x64_bf16 v[112:115], v[32:35], a[96:103], v0
    s_waitcnt vmcnt(0)
    s_mov_b32 m0, 139264
    ds_read_b128 v[44:47], v10 offset:5120
    v_smfmac_f32_16x16x64_bf16 v[116:119], v[32:35], a[104:111], v0
    s_waitcnt lgkmcnt(2)
    s_barrier
    v_smfmac_f32_16x16x64_bf16 v[112:115], v[36:39], a[112:119], v0
    buffer_load_dwordx4 v10, s[32:35], s56 offen sc1 lds
    v_mov_b64 v[120:121], 0
    v_smfmac_f32_16x16x64_bf16 v[116:119], v[36:39], a[120:127], v0
    ds_read_b128 v[48:51], v10 offset:6144
    v_mov_b64 v[122:123], 0
    s_waitcnt lgkmcnt(2)
    v_smfmac_f32_16x16x64_bf16 v[104:107], v[40:43], a[0:7], v0
    ds_read_b128 v[52:55], v10 offset:7168
    v_mov_b64 v[124:125], 0
    v_smfmac_f32_16x16x64_bf16 v[108:111], v[40:43], a[8:15], v0
    v_mov_b64 v[126:127], 0
    v_smfmac_f32_16x16x64_bf16 v[112:115], v[40:43], a[128:135], v0
    buffer_load_dwordx4 v10, s[32:35], s56 offen offset:1024 sc1 lds
    s_mov_b32 m0, 147456
    v_smfmac_f32_16x16x64_bf16 v[116:119], v[40:43], a[136:143], v0
    s_waitcnt lgkmcnt(2)
    v_smfmac_f32_16x16x64_bf16 v[104:107], v[44:47], a[16:23], v0
    buffer_store_dword v20, off, s[32:35], s68 offset:384 sc1
    v_mov_b32 v56, s45
    v_smfmac_f32_16x16x64_bf16 v[108:111], v[44:47], a[24:31], v0
    buffer_load_dword v11, off, s[32:35], s68 sc1
    v_mov_b32 v57, s45
    v_smfmac_f32_16x16x64_bf16 v[112:115], v[44:47], a[144:151], v0
    buffer_load_dwordx4 v10, s[32:35], s69 offen sc1 lds
    v_mov_b64 v[58:59], v[56:57]
    v_smfmac_f32_16x16x64_bf16 v[116:119], v[44:47], a[152:159], v0
    s_waitcnt lgkmcnt(1)
    v_smfmac_f32_16x16x64_bf16 v[104:107], v[48:51], a[32:39], v0
    v_smfmac_f32_16x16x64_bf16 v[108:111], v[48:51], a[40:47], v0
    s_waitcnt lgkmcnt(0)
    v_smfmac_f32_16x16x64_bf16 v[104:107], v[52:55], a[48:55], v0
    buffer_load_dwordx4 v10, s[32:35], s69 offen offset:1024 sc1 lds
    v_smfmac_f32_16x16x64_bf16 v[108:111], v[52:55], a[56:63], v0
    v_smfmac_f32_16x16x64_bf16 v[112:115], v[48:51], a[160:167], v0
    v_smfmac_f32_16x16x64_bf16 v[116:119], v[48:51], a[168:175], v0
    v_add_f32 v104, v104, v106
    v_smfmac_f32_16x16x64_bf16 v[112:115], v[52:55], a[176:183], v0
    v_add_f32 v105, v105, v107
    v_smfmac_f32_16x16x64_bf16 v[116:119], v[52:55], a[184:191], v0
    v_add_f32 v108, v108, v110
    v_smfmac_f32_16x16x64_bf16 v[120:123], v[24:27], a[192:199], v0
    v_add_f32 v109, v109, v111
    v_smfmac_f32_16x16x64_bf16 v[124:127], v[24:27], a[200:207], v0
    v_cvt_pk_bf16_f32 v104, v104, v105
    v_add_f32 v112, v112, v114
    v_add_f32 v113, v113, v115
    v_cvt_pk_bf16_f32 v21, v112, v113
    ds_write2_b32 v4, v21, v104 offset0:0 offset1:1
    v_pk_add_f32 v[116:117], v[116:117], v[118:119]
    v_cvt_pk_bf16_f32 v108, v108, v109
    v_cvt_pk_bf16_f32 v23, v116, v117
    ds_write2_b32 v4, v23, v108 offset0:128 offset1:129
    v_smfmac_f32_16x16x64_bf16 v[120:123], v[28:31], a[208:215], v0
    buffer_store_dwordx4 v[56:59], v2, s[32:35], s57 offen offset:0 sc1
    v_smfmac_f32_16x16x64_bf16 v[124:127], v[28:31], a[216:223], v0
    v_smfmac_f32_16x16x64_bf16 v[120:123], v[32:35], a[224:231], v0
    buffer_store_dwordx4 v[56:59], v2, s[32:35], s57 offen offset:1024 sc1
    v_smfmac_f32_16x16x64_bf16 v[124:127], v[32:35], a[232:239], v0
    s_waitcnt lgkmcnt(0)
    s_barrier
    ds_read_b64_tr_b16 v[56:57], v5 offset:0
    ds_read_b64_tr_b16 v[58:59], v5 offset:256
    v_smfmac_f32_16x16x64_bf16 v[120:123], v[36:39], a[240:247], v0
    ds_read_b64_tr_b16 v[60:61], v5 offset:1024
    ds_read_b64_tr_b16 v[62:63], v5 offset:1280
    v_smfmac_f32_16x16x64_bf16 v[124:127], v[36:39], a[248:255], v0
    ds_read_b64_tr_b16 v[64:65], v5 offset:2048
    ds_read_b64_tr_b16 v[66:67], v5 offset:2304
    v_smfmac_f32_16x16x64_bf16 v[120:123], v[40:43], v[128:135], v0
    ds_read_b64_tr_b16 v[68:69], v5 offset:3072
    ds_read_b64_tr_b16 v[70:71], v5 offset:3328
    v_smfmac_f32_16x16x64_bf16 v[124:127], v[40:43], v[136:143], v0
    s_waitcnt lgkmcnt(6)
    v_mfma_f32_16x16x32_bf16 v[112:115], v[56:59], v[56:59], 0
    ds_read_b128 v[24:27], v9 offset:0
    v_mfma_f32_16x16x32_bf16 v[104:107], v[72:75], v[56:59], 0
    ds_read_b128 v[28:31], v9 offset:1024
    v_mfma_f32_16x16x32_bf16 v[108:111], v[88:91], v[56:59], 0
    s_waitcnt lgkmcnt(6)
    v_mfma_f32_16x16x32_bf16 v[112:115], v[60:63], v[60:63], v[112:115]
    ds_read_b128 v[32:35], v9 offset:8192
    v_mfma_f32_16x16x32_bf16 v[104:107], v[76:79], v[60:63], v[104:107]
    ds_read_b128 v[36:39], v9 offset:9216
    v_mfma_f32_16x16x32_bf16 v[108:111], v[92:95], v[60:63], v[108:111]
    s_waitcnt lgkmcnt(6)
    v_mfma_f32_16x16x32_bf16 v[112:115], v[64:67], v[64:67], v[112:115]
    ds_read_b128 v[72:75], v9 offset:16384
    v_mfma_f32_16x16x32_bf16 v[104:107], v[80:83], v[64:67], v[104:107]
    ds_read_b128 v[76:79], v9 offset:17408
    v_mfma_f32_16x16x32_bf16 v[108:111], v[96:99], v[64:67], v[108:111]
    s_waitcnt lgkmcnt(6)
    v_mfma_f32_16x16x32_bf16 v[112:115], v[68:71], v[68:71], v[112:115]
    ds_read_b128 v[88:91], v9 offset:24576
    v_mfma_f32_16x16x32_bf16 v[104:107], v[84:87], v[68:71], v[104:107]
    ds_read_b128 v[92:95], v9 offset:25600
    v_mfma_f32_16x16x32_bf16 v[108:111], v[100:103], v[68:71], v[108:111]
    v_smfmac_f32_16x16x64_bf16 v[120:123], v[44:47], v[144:151], v0
    v_mov_b32 v84, 0x3f803f80
    v_smfmac_f32_16x16x64_bf16 v[124:127], v[44:47], v[152:159], v0
    v_max3_f32 v116, v112, v113, v104
    v_max3_f32 v117, v105, v106, v107
    v_max3_f32 v116, v116, v108, v109
    v_max3_f32 v117, v117, v110, v111
    v_max_f32 v116, v116, v117
    v_max_f32 v117, v116, v117
    v_smfmac_f32_16x16x64_bf16 v[120:123], v[48:51], v[160:167], v0
    v_permlane32_swap_b32 v116, v117
    v_max_f32 v116, v116, v117
    v_max_f32 v117, v116, v117
    v_smfmac_f32_16x16x64_bf16 v[124:127], v[48:51], v[168:175], v0
    v_permlane16_swap_b32 v116, v117
    v_smfmac_f32_16x16x64_bf16 v[120:123], v[52:55], v[176:183], v0
    v_max_f32 v116, v116, v117
    v_smfmac_f32_16x16x64_bf16 v[124:127], v[52:55], v[184:191], v0
    v_mul_f32 v116, s44, v116
    v_mov_b32 v85, 0x3f803f80
    v_pk_fma_f32 v[104:105], v[104:105], s[66:67], v[116:117] op_sel_hi:[1,1,0] neg_lo:[0,0,1] neg_hi:[0,0,1]
    v_pk_fma_f32 v[106:107], v[106:107], s[66:67], v[116:117] op_sel_hi:[1,1,0] neg_lo:[0,0,1] neg_hi:[0,0,1]
    v_exp_f32 v104, v104
    v_exp_f32 v105, v105
    v_pk_fma_f32 v[108:109], v[108:109], s[66:67], v[116:117] op_sel_hi:[1,1,0] neg_lo:[0,0,1] neg_hi:[0,0,1]
    v_exp_f32 v106, v106
    v_exp_f32 v107, v107
    v_pk_fma_f32 v[110:111], v[110:111], s[66:67], v[116:117] op_sel_hi:[1,1,0] neg_lo:[0,0,1] neg_hi:[0,0,1]
    v_cvt_pk_bf16_f32 v60, v104, v105
    v_exp_f32 v108, v108
    v_exp_f32 v109, v109
    v_cvt_pk_bf16_f32 v61, v106, v107
    v_pk_fma_f32 v[112:113], v[112:113], s[66:67], v[116:117] op_sel_hi:[1,1,0] neg_lo:[0,0,1] neg_hi:[0,0,1]
    v_exp_f32 v110, v110
    v_exp_f32 v111, v111
    v_cvt_pk_bf16_f32 v62, v108, v109
    v_exp_f32 v112, v112
    v_cvt_pk_bf16_f32 v63, v110, v111
    v_exp_f32 v113, v113
    v_mov_b64 v[86:87], v[84:85]
    v_mfma_f32_16x16x32_bf16 v[96:99], v[12:15], v[60:63], 0
    v_cvt_pk_bf16_f32 v56, v112, v113
    v_mov_b32 v57, 0
    v_mfma_f32_16x16x32_bf16 v[80:83], v[84:87], v[60:63], 0
    v_add_f32 v120, v120, v122
    v_add_f32 v121, v121, v123
    v_mfma_f32_16x16x32_bf16 v[100:103], v[16:19], v[60:63], 0
    v_cvt_pk_bf16_f32 v20, v120, v121
    v_add_f32 v124, v124, v126
    v_add_f32 v125, v125, v127
    v_mfma_f32_16x16x16_bf16 v[96:99], v[20:21], v[56:57], v[96:99]
    v_cvt_pk_bf16_f32 v22, v124, v125
    v_mfma_f32_16x16x16_bf16 v[80:83], v[84:85], v[56:57], v[80:83]
    s_nop 0
    v_mfma_f32_16x16x16_bf16 v[100:103], v[22:23], v[56:57], v[100:103]
    ds_read_b128 v[40:43], v9 offset:32768
    ds_read_b128 v[44:47], v9 offset:33792
    buffer_store_dwordx4 v[20:23], v10, s[32:35], s58 offen offset:0 sc1
    s_nop 2
    v_rcp_f32 v118, v80
    s_mov_b64 exec, s[70:71]
    v_pk_mul_f32 v[96:97], v[96:97], v[118:119] op_sel_hi:[1,0]
    v_cvt_pk_bf16_f32 v96, v96, v97
    v_pk_mul_f32 v[98:99], v[98:99], v[118:119] op_sel_hi:[1,0]
    v_cvt_pk_bf16_f32 v97, v98, v99
    v_pk_mul_f32 v[100:101], v[100:101], v[118:119] op_sel_hi:[1,0]
    v_cvt_pk_bf16_f32 v98, v100, v101
    v_pk_mul_f32 v[102:103], v[102:103], v[118:119] op_sel_hi:[1,0]
    v_cvt_pk_bf16_f32 v99, v102, v103
    ds_write2_b64 v6, v[96:97], v[98:99] offset0:0 offset1:4
    s_mov_b64 exec, -1
    v_mov_b64 v[104:105], 0
    v_mov_b64 v[106:107], 0
    v_mov_b64 v[108:109], 0
    v_mov_b64 v[110:111], 0
    v_mov_b64 v[112:113], 0
    v_mov_b64 v[114:115], 0
    v_mov_b64 v[116:117], 0
    v_mov_b64 v[118:119], 0
    s_waitcnt lgkmcnt(0)
    s_barrier
    ds_read_b128 v[56:59], v7 offset:0
    ds_read_b128 v[60:63], v7 offset:64
    ds_read_b128 v[64:67], v7 offset:128
    ds_read_b128 v[68:71], v7 offset:192
    s_add_u32 s54, s52, 131072
    s_add_u32 s55, s54, 4096
    s_cmp_lt_u32 s42, 62
    s_cselect_b32 s60, 262144, 0
    s_add_u32 s56, s56, s60
    s_add_u32 s69, s69, s60
    s_mov_b32 s57, s43
    s_waitcnt lgkmcnt(3)
    v_smfmac_f32_16x16x64_bf16 v[104:107], v[56:59], v[192:199], v0
    v_mov_b32 v20, 0x3f80
    v_smfmac_f32_16x16x64_bf16 v[108:111], v[56:59], v[224:231], v0
    v_mov_b32 v21, 0x3f800000
    s_waitcnt lgkmcnt(2)
    v_smfmac_f32_16x16x64_bf16 v[104:107], v[60:63], v[200:207], v0
    ds_read_b128 v[48:51], v9 offset:40960
    v_cndmask_b32 v20, v20, v21, s[46:47]
    v_smfmac_f32_16x16x64_bf16 v[108:111], v[60:63], v[232:239], v0
    ds_read_b128 v[52:55], v9 offset:41984
    v_cndmask_b32 v80, 0, v20, s[92:93]
    s_waitcnt lgkmcnt(3)
    v_smfmac_f32_16x16x64_bf16 v[104:107], v[64:67], v[208:215], v0
    ds_read_b128 v[12:15], v9 offset:49152
    v_cndmask_b32 v81, 0, v20, s[94:95]
    v_smfmac_f32_16x16x64_bf16 v[108:111], v[64:67], v[240:247], v0
    ds_read_b128 v[16:19], v9 offset:50176
    v_cndmask_b32 v82, 0, v20, s[96:97]
    s_waitcnt lgkmcnt(4)
    v_smfmac_f32_16x16x64_bf16 v[104:107], v[68:71], v[216:223], v0
    ds_read_b128 v[120:123], v9 offset:57344
    v_cndmask_b32 v83, 0, v20, s[98:99]
    v_smfmac_f32_16x16x64_bf16 v[108:111], v[68:71], v[248:255], v0
    ds_read_b128 v[124:127], v9 offset:58368
    v_smfmac_f32_16x16x64_bf16 v[112:115], v[56:59], v[24:31], v0
    v_smfmac_f32_16x16x64_bf16 v[112:115], v[60:63], v[32:39], v0
    v_cvt_pk_bf16_f32 v96, v104, v105
    v_smfmac_f32_16x16x64_bf16 v[112:115], v[64:67], v[72:79], v0
    v_cvt_pk_bf16_f32 v97, v106, v107
    v_smfmac_f32_16x16x64_bf16 v[112:115], v[68:71], v[88:95], v0
    buffer_store_dwordx2 v[96:97], v1, s[32:35], s48 offen sc1
    v_cvt_pk_bf16_f32 v98, v108, v109
    v_smfmac_f32_16x16x64_bf16 v[116:119], v[56:59], v[40:47], v0
    v_cvt_pk_bf16_f32 v99, v110, v111
    s_waitcnt lgkmcnt(4)
    v_smfmac_f32_16x16x64_bf16 v[116:119], v[60:63], v[48:55], v0
    buffer_store_dwordx2 v[98:99], v1, s[32:35], s49 offen sc1
    s_waitcnt lgkmcnt(2)
    v_smfmac_f32_16x16x64_bf16 v[116:119], v[64:67], v[12:19], v0
    v_cvt_pk_bf16_f32 v100, v112, v113
    s_waitcnt lgkmcnt(0)
    v_smfmac_f32_16x16x64_bf16 v[116:119], v[68:71], v[120:127], v0
    v_cvt_pk_bf16_f32 v101, v114, v115
    buffer_store_dwordx2 v[100:101], v1, s[32:35], s50 offen sc1
    s_nop 5
    v_cvt_pk_bf16_f32 v102, v116, v117
    v_cvt_pk_bf16_f32 v103, v118, v119
    buffer_store_dwordx2 v[102:103], v1, s[32:35], s51 offen sc1
    v_mov_b64 v[104:105], 0
    v_mov_b64 v[106:107], 0
    v_mov_b64 v[108:109], 0
    v_mov_b64 v[110:111], 0
    v_mov_b64 v[112:113], 0
    v_mov_b64 v[114:115], 0
    v_mov_b64 v[116:117], 0
    v_mov_b64 v[118:119], 0
    s_xor_b32 s48, s48, 0x40000
    s_xor_b32 s49, s49, 0x40000
    s_xor_b32 s50, s50, 0x40000
    s_xor_b32 s51, s51, 0x40000
    v_mov_b32 v46, s45
    ds_read_b128 v[56:59], v8 offset:49152
    ds_read_b128 v[60:63], v8 offset:50176
    ds_read_b128 v[64:67], v8 offset:57344
    ds_read_b128 v[68:71], v8 offset:58368
    ds_read_b128 v[72:75], v8 offset:16384
    ds_read_b128 v[76:79], v8 offset:17408
    ds_read_b128 v[88:91], v8 offset:32768
    ds_read_b128 v[92:95], v8 offset:33792
    ds_read_b128 v[12:15], v8 offset:0
    ds_read_b128 v[16:19], v8 offset:1024
    buffer_load_dwordx4 v[24:27], v2, s[32:35], s43 offen offset:0 sc1
    buffer_load_dwordx4 v[28:31], v2, s[32:35], s43 offen offset:1024 sc1
    ds_read_b128 v[120:123], v8 offset:8192
    ds_read_b128 v[124:127], v8 offset:9216
    ds_read_b128 v[96:99], v8 offset:40960
    ds_read_b128 v[100:103], v8 offset:41984
    s_nop 3
    s_mov_b32 s60, 0
L_poll_64:
    buffer_load_dwordx4 v[24:27], v2, s[32:35], s43 offen offset:0 sc1
    buffer_load_dwordx4 v[28:31], v2, s[32:35], s43 offen offset:1024 sc1
    s_add_u32 s60, s60, 1
    s_cmp_gt_u32 s60, 64
    s_cbranch_scc1 L_pexact_65
    s_waitcnt vmcnt(2)
    v_max3_u32 v47, v24, v25, v26
    v_max3_u32 v47, v47, v27, v28
    v_max3_u32 v47, v47, v29, v30
    v_max_u32 v47, v47, v31
    v_cmp_le_u32 vcc, s45, v47
    s_nop 0
    s_and_b64 exec, exec, vcc
    s_cbranch_scc1 L_poll_64
L_pout_66:
    s_mov_b64 exec, -1
    v_mfma_f32_16x16x32_bf16 v[84:87], v[80:83], v[24:27], 0
    v_mfma_f32_16x16x32_bf16 v[84:87], v[80:83], v[28:31], v[84:87]
    s_nop 7
    v_add_f32_dpp v84, v84, v84 row_ror:8 row_mask:0xf bank_mask:0xf
    v_add_f32_dpp v85, v85, v85 row_ror:8 row_mask:0xf bank_mask:0xf
    s_nop 0
    v_add_f32_dpp v84, v84, v84 row_ror:4 row_mask:0xf bank_mask:0xf
    v_add_f32_dpp v85, v85, v85 row_ror:4 row_mask:0xf bank_mask:0xf
    v_cvt_pk_bf16_f32 v44, v84, v85
    buffer_store_dword v44, v3, s[32:35], s52 offen sc1
    buffer_store_dword v46, v3, s[32:35], s53 offen sc1
    ds_read_b128 v[80:83], v8 offset:24576
    ds_read_b128 v[84:87], v8 offset:25600
    s_add_u32 s62, s42, 3
    s_min_u32 s62, s62, 64
    v_cmp_gt_u32 vcc, s62, v11
    s_cbranch_vccnz L_avslow_68
L_avok_69:
    s_add_u32 s42, s42, 1
    s_xor_b32 s43, s43, 0x40000
    s_add_u32 s52, s52, 8192
    s_and_b32 s52, s52, 0x7fff
    s_add_u32 s53, s53, 8192
    s_and_b32 s53, s53, 0x7fff
    s_add_u32 s58, s58, 131072
    s_nop 15
    s_nop 15
    s_nop 15
    s_nop 1
    buffer_load_dwordx4 v[48:51], v10, s[32:35], s54 offen offset:0 sc1
    buffer_load_dwordx4 v[52:55], v10, s[32:35], s54 offen offset:1024 sc1
    s_branch L_chain_loop_w0_58
L_chain_last_59:
    v_mov_b32 v20, 63
    buffer_store_dword v20, off, s[32:35], s68 offset:384 sc1
    s_waitcnt vmcnt(1)
    ds_read_b128 v[40:43], v10 offset:4096
    ds_read_b128 v[44:47], v10 offset:5120
    ds_read_b128 v[48:51], v10 offset:6144
    ds_read_b128 v[52:55], v10 offset:7168
    v_mov_b64 v[120:121], 0
    v_mov_b64 v[122:123], 0
    v_mov_b64 v[124:125], 0
    v_mov_b64 v[126:127], 0
    s_waitcnt lgkmcnt(7)
    v_smfmac_f32_16x16x64_bf16 v[112:115], v[24:27], a[64:71], v0
    v_smfmac_f32_16x16x64_bf16 v[116:119], v[24:27], a[72:79], v0
    v_smfmac_f32_16x16x64_bf16 v[120:123], v[24:27], a[192:199], v0
    v_smfmac_f32_16x16x64_bf16 v[124:127], v[24:27], a[200:207], v0
    s_waitcnt lgkmcnt(6)
    v_smfmac_f32_16x16x64_bf16 v[112:115], v[28:31], a[80:87], v0
    v_smfmac_f32_16x16x64_bf16 v[116:119], v[28:31], a[88:95], v0
    v_smfmac_f32_16x16x64_bf16 v[120:123], v[28:31], a[208:215], v0
    v_smfmac_f32_16x16x64_bf16 v[124:127], v[28:31], a[216:223], v0
    s_waitcnt lgkmcnt(5)
    v_smfmac_f32_16x16x64_bf16 v[112:115], v[32:35], a[96:103], v0
    v_smfmac_f32_16x16x64_bf16 v[116:119], v[32:35], a[104:111], v0
    v_smfmac_f32_16x16x64_bf16 v[120:123], v[32:35], a[224:231], v0
    v_smfmac_f32_16x16x64_bf16 v[124:127], v[32:35], a[232:239], v0
    s_waitcnt lgkmcnt(4)
    v_smfmac_f32_16x16x64_bf16 v[112:115], v[36:39], a[112:119], v0
    v_smfmac_f32_16x16x64_bf16 v[116:119], v[36:39], a[120:127], v0
    v_smfmac_f32_16x16x64_bf16 v[120:123], v[36:39], a[240:247], v0
    v_smfmac_f32_16x16x64_bf16 v[124:127], v[36:39], a[248:255], v0
    s_waitcnt lgkmcnt(3)
    v_smfmac_f32_16x16x64_bf16 v[112:115], v[40:43], a[128:135], v0
    v_smfmac_f32_16x16x64_bf16 v[116:119], v[40:43], a[136:143], v0
    v_smfmac_f32_16x16x64_bf16 v[120:123], v[40:43], v[128:135], v0
    v_smfmac_f32_16x16x64_bf16 v[124:127], v[40:43], v[136:143], v0
    s_waitcnt lgkmcnt(2)
    v_smfmac_f32_16x16x64_bf16 v[112:115], v[44:47], a[144:151], v0
    v_smfmac_f32_16x16x64_bf16 v[116:119], v[44:47], a[152:159], v0
    v_smfmac_f32_16x16x64_bf16 v[120:123], v[44:47], v[144:151], v0
    v_smfmac_f32_16x16x64_bf16 v[124:127], v[44:47], v[152:159], v0
    s_waitcnt lgkmcnt(1)
    v_smfmac_f32_16x16x64_bf16 v[112:115], v[48:51], a[160:167], v0
    v_smfmac_f32_16x16x64_bf16 v[116:119], v[48:51], a[168:175], v0
    v_smfmac_f32_16x16x64_bf16 v[120:123], v[48:51], v[160:167], v0
    v_smfmac_f32_16x16x64_bf16 v[124:127], v[48:51], v[168:175], v0
    s_waitcnt lgkmcnt(0)
    v_smfmac_f32_16x16x64_bf16 v[112:115], v[52:55], a[176:183], v0
    v_smfmac_f32_16x16x64_bf16 v[116:119], v[52:55], a[184:191], v0
    v_smfmac_f32_16x16x64_bf16 v[120:123], v[52:55], v[176:183], v0
    v_smfmac_f32_16x16x64_bf16 v[124:127], v[52:55], v[184:191], v0
    v_add_f32 v112, v112, v114
    v_add_f32 v113, v113, v115
    v_cvt_pk_bf16_f32 v21, v112, v113
    v_add_f32 v116, v116, v118
    v_add_f32 v117, v117, v119
    v_cvt_pk_bf16_f32 v23, v116, v117
    v_add_f32 v120, v120, v122
    v_add_f32 v121, v121, v123
    v_cvt_pk_bf16_f32 v20, v120, v121
    v_add_f32 v124, v124, v126
    v_add_f32 v125, v125, v127
    v_cvt_pk_bf16_f32 v22, v124, v125
    buffer_store_dwordx4 v[20:23], v10, s[32:35], s58 offen offset:0 sc1
    s_waitcnt vmcnt(0)
    s_barrier
    v_mov_b32 v80, 64
    buffer_store_dword v80, off, s[32:35], s68 offset:384 sc1
    s_waitcnt vmcnt(0)
    s_endpgm
L_pexact_61:
    s_add_u32 s59, s59, 1
    s_cmp_gt_u32 s59, 262144
    s_cbranch_scc1 L_chain_abort_1
    s_waitcnt vmcnt(0)
    v_cmp_eq_u32 vcc, s45, v48
    v_cmp_eq_u32 s[100:101], s45, v49
    s_nop 0
    s_or_b64 vcc, vcc, s[100:101]
    v_cmp_eq_u32 s[100:101], s45, v50
    s_nop 0
    s_or_b64 vcc, vcc, s[100:101]
    v_cmp_eq_u32 s[100:101], s45, v51
    s_nop 0
    s_or_b64 vcc, vcc, s[100:101]
    v_cmp_eq_u32 s[100:101], s45, v52
    s_nop 0
    s_or_b64 vcc, vcc, s[100:101]
    v_cmp_eq_u32 s[100:101], s45, v53
    s_nop 0
    s_or_b64 vcc, vcc, s[100:101]
    v_cmp_eq_u32 s[100:101], s45, v54
    s_nop 0
    s_or_b64 vcc, vcc, s[100:101]
    v_cmp_eq_u32 s[100:101], s45, v55
    s_nop 0
    s_or_b64 vcc, vcc, s[100:101]
    ds_write_b128 v10, v[48:51] offset:0
    ds_write_b128 v10, v[52:55] offset:1024
    s_and_b64 exec, exec, vcc
    s_cbranch_scc0 L_pout_62
    buffer_load_dwordx4 v[48:51], v10, s[32:35], s54 offen offset:0 sc1
    buffer_load_dwordx4 v[52:55], v10, s[32:35], s54 offen offset:1024 sc1
    s_branch L_pexact_61
L_pexact_65:
    s_add_u32 s59, s59, 1
    s_cmp_gt_u32 s59, 262144
    s_cbranch_scc1 L_chain_abort_1
    s_waitcnt vmcnt(0)
    v_cmp_eq_u32 vcc, s45, v24
    v_cmp_eq_u32 s[100:101], s45, v25
    s_nop 0
    s_or_b64 vcc, vcc, s[100:101]
    v_cmp_eq_u32 s[100:101], s45, v26
    s_nop 0
    s_or_b64 vcc, vcc, s[100:101]
    v_cmp_eq_u32 s[100:101], s45, v27
    s_nop 0
    s_or_b64 vcc, vcc, s[100:101]
    v_cmp_eq_u32 s[100:101], s45, v28
    s_nop 0
    s_or_b64 vcc, vcc, s[100:101]
    v_cmp_eq_u32 s[100:101], s45, v29
    s_nop 0
    s_or_b64 vcc, vcc, s[100:101]
    v_cmp_eq_u32 s[100:101], s45, v30
    s_nop 0
    s_or_b64 vcc, vcc, s[100:101]
    v_cmp_eq_u32 s[100:101], s45, v31
    s_nop 0
    s_or_b64 vcc, vcc, s[100:101]
    s_and_b64 exec, exec, vcc
    s_cbranch_scc0 L_pout_66
    buffer_load_dwordx4 v[24:27], v2, s[32:35], s43 offen offset:0 sc1
    buffer_load_dwordx4 v[28:31], v2, s[32:35], s43 offen offset:1024 sc1
    s_branch L_pexact_65
L_avslow_68:
    s_add_u32 s59, s59, 1
    s_cmp_gt_u32 s59, 262144
    s_cbranch_scc1 L_chain_abort_1
    s_sleep 4
    buffer_load_dword v11, off, s[32:35], s68 sc1
    s_waitcnt vmcnt(0)
    v_cmp_gt_u32 vcc, s62, v11
    s_cbranch_vccnz L_avslow_68
    s_branch L_avok_69
L_cl_1_1_13:
    buffer_load_dwordx4 v[48:51], v10, s[32:35], s54 offen offset:2048 sc1
    buffer_load_dwordx4 v[52:55], v10, s[32:35], s54 offen offset:3072 sc1
L_chain_loop_w1_70:
    s_mov_b32 s60, 0
L_poll_72:
    buffer_load_dwordx4 v[48:51], v10, s[32:35], s54 offen offset:2048 sc1
    buffer_load_dwordx4 v[52:55], v10, s[32:35], s54 offen offset:3072 sc1
    s_add_u32 s60, s60, 1
    s_cmp_gt_u32 s60, 64
    s_cbranch_scc1 L_pexact_73
    s_waitcnt vmcnt(2)
    v_max3_u32 v47, v48, v49, v50
    v_max3_u32 v47, v47, v51, v52
    ds_write_b128 v10, v[48:51] offset:2048
    v_max3_u32 v47, v47, v53, v54
    v_max_u32 v47, v47, v55
    ds_write_b128 v10, v[52:55] offset:3072
    v_cmp_le_u32 vcc, s45, v47
    s_nop 0
    s_and_b64 exec, exec, vcc
    s_cbranch_scc1 L_poll_72
L_pout_74:
    s_mov_b64 exec, -1
    s_waitcnt lgkmcnt(0)
    s_barrier
    ds_read_b128 v[24:27], v10 offset:0
    ds_read_b128 v[28:31], v10 offset:1024
    ds_read_b128 v[32:35], v10 offset:2048
    ds_read_b128 v[36:39], v10 offset:3072
    s_cmp_eq_u32 s42, 63
    s_cbranch_scc1 L_chain_last_71
    s_waitcnt lgkmcnt(3)
    v_smfmac_f32_16x16x64_bf16 v[104:107], v[24:27], v[12:19], v0
    v_smfmac_f32_16x16x64_bf16 v[108:111], v[24:27], v[120:127], v0
    ds_read_b128 v[12:15], v10 offset:18432
    s_waitcnt lgkmcnt(3)
    v_smfmac_f32_16x16x64_bf16 v[104:107], v[28:31], v[72:79], v0
    ds_read_b128 v[16:19], v10 offset:19456
    v_smfmac_f32_16x16x64_bf16 v[108:111], v[28:31], v[80:87], v0
    ds_read_b128 v[72:75], v10 offset:8192
    s_waitcnt lgkmcnt(4)
    v_smfmac_f32_16x16x64_bf16 v[104:107], v[32:35], v[88:95], v0
    ds_read_b128 v[76:79], v10 offset:9216
    v_smfmac_f32_16x16x64_bf16 v[108:111], v[32:35], v[96:103], v0
    ds_read_b128 v[80:83], v10 offset:10240
    s_waitcnt lgkmcnt(5)
    v_smfmac_f32_16x16x64_bf16 v[104:107], v[36:39], v[56:63], v0
    ds_read_b128 v[84:87], v10 offset:11264
    v_smfmac_f32_16x16x64_bf16 v[108:111], v[36:39], v[64:71], v0
    ds_read_b128 v[88:91], v10 offset:12288
    v_smfmac_f32_16x16x64_bf16 v[112:115], v[24:27], a[64:71], v0
    ds_read_b128 v[92:95], v10 offset:13312
    v_smfmac_f32_16x16x64_bf16 v[116:119], v[24:27], a[72:79], v0
    ds_read_b128 v[96:99], v10 offset:14336
    v_smfmac_f32_16x16x64_bf16 v[112:115], v[28:31], a[80:87], v0
    ds_read_b128 v[100:103], v10 offset:15360
    v_smfmac_f32_16x16x64_bf16 v[116:119], v[28:31], a[88:95], v0
    s_waitcnt vmcnt(0)
    ds_read_b128 v[40:43], v10 offset:4096
    v_smfmac_f32_16x16x64_bf16 v[112:115], v[32:35], a[96:103], v0
    s_waitcnt vmcnt(0)
    s_mov_b32 m0, 141312
    ds_read_b128 v[44:47], v10 offset:5120
    v_smfmac_f32_16x16x64_bf16 v[116:119], v[32:35], a[104:111], v0
    s_waitcnt lgkmcnt(2)
    s_barrier
    v_smfmac_f32_16x16x64_bf16 v[112:115], v[36:39], a[112:119], v0
    ds_read_b128 v[48:51], v10 offset:6144
    v_mov_b64 v[120:121], 0
    v_smfmac_f32_16x16x64_bf16 v[116:119], v[36:39], a[120:127], v0
    buffer_load_dwordx4 v10, s[32:35], s56 offen sc1 lds
    v_mov_b64 v[122:123], 0
    s_waitcnt lgkmcnt(2)
    v_smfmac_f32_16x16x64_bf16 v[104:107], v[40:43], a[0:7], v0
    ds_read_b128 v[52:55], v10 offset:7168
    v_mov_b64 v[124:125], 0
    v_smfmac_f32_16x16x64_bf16 v[108:111], v[40:43], a[8:15], v0
    v_mov_b64 v[126:127], 0
    v_smfmac_f32_16x16x64_bf16 v[112:115], v[40:43], a[128:135], v0
    v_smfmac_f32_16x16x64_bf16 v[116:119], v[40:43], a[136:143], v0
    buffer_load_dwordx4 v10, s[32:35], s56 offen offset:1024 sc1 lds
    s_mov_b32 m0, 149504
    s_waitcnt lgkmcnt(2)
    v_smfmac_f32_16x16x64_bf16 v[104:107], v[44:47], a[16:23], v0
    v_mov_b32 v56, s45
    v_smfmac_f32_16x16x64_bf16 v[108:111], v[44:47], a[24:31], v0
    v_mov_b32 v57, s45
    v_smfmac_f32_16x16x64_bf16 v[112:115], v[44:47], a[144:151], v0
    v_mov_b64 v[58:59], v[56:57]
    v_smfmac_f32_16x16x64_bf16 v[116:119], v[44:47], a[152:159], v0
    buffer_load_dwordx4 v10, s[32:35], s69 offen sc1 lds
    s_waitcnt lgkmcnt(1)
    v_smfmac_f32_16x16x64_bf16 v[104:107], v[48:51], a[32:39], v0
    v_smfmac_f32_16x16x64_bf16 v[108:111], v[48:51], a[40:47], v0
    s_waitcnt lgkmcnt(0)
    v_smfmac_f32_16x16x64_bf16 v[104:107], v[52:55], a[48:55], v0
    v_smfmac_f32_16x16x64_bf16 v[108:111], v[52:55], a[56:63], v0
    buffer_load_dwordx4 v10, s[32:35], s69 offen offset:1024 sc1 lds
    v_smfmac_f32_16x16x64_bf16 v[112:115], v[48:51], a[160:167], v0
    v_smfmac_f32_16x16x64_bf16 v[116:119], v[48:51], a[168:175], v0
    v_add_f32 v104, v104, v106
    v_smfmac_f32_16x16x64_bf16 v[112:115], v[52:55], a[176:183], v0
    v_add_f32 v105, v105, v107
    v_smfmac_f32_16x16x64_bf16 v[116:119], v[52:55], a[184:191], v0
    v_add_f32 v108, v108, v110
    v_smfmac_f32_16x16x64_bf16 v[120:123], v[24:27], a[192:199], v0
    v_add_f32 v109, v109, v111
    v_smfmac_f32_16x16x64_bf16 v[124:127], v[24:27], a[200:207], v0
    v_cvt_pk_bf16_f32 v104, v104, v105
    v_add_f32 v112, v112, v114
    v_add_f32 v113, v113, v115
    v_cvt_pk_bf16_f32 v21, v112, v113
    ds_write2_b32 v4, v21, v104 offset0:0 offset1:1
    v_pk_add_f32 v[116:117], v[116:117], v[118:119]
    v_cvt_pk_bf16_f32 v108, v108, v109
    v_cvt_pk_bf16_f32 v23, v116, v117
    ds_write2_b32 v4, v23, v108 offset0:128 offset1:129
    v_smfmac_f32_16x16x64_bf16 v[120:123], v[28:31], a[208:215], v0
    v_smfmac_f32_16x16x64_bf16 v[124:127], v[28:31], a[216:223], v0
    buffer_store_dwordx4 v[56:59], v2, s[32:35], s57 offen offset:0 sc1
    v_smfmac_f32_16x16x64_bf16 v[120:123], v[32:35], a[224:231], v0
    v_smfmac_f32_16x16x64_bf16 v[124:127], v[32:35], a[232:239], v0
    buffer_store_dwordx4 v[56:59], v2, s[32:35], s57 offen offset:1024 sc1
    s_waitcnt lgkmcnt(0)
    s_barrier
    ds_read_b64_tr_b16 v[56:57], v5 offset:0
    ds_read_b64_tr_b16 v[58:59], v5 offset:256
    v_smfmac_f32_16x16x64_bf16 v[120:123], v[36:39], a[240:247], v0
    ds_read_b64_tr_b16 v[60:61], v5 offset:1024
    ds_read_b64_tr_b16 v[62:63], v5 offset:1280
    v_smfmac_f32_16x16x64_bf16 v[124:127], v[36:39], a[248:255], v0
    ds_read_b64_tr_b16 v[64:65], v5 offset:2048
    ds_read_b64_tr_b16 v[66:67], v5 offset:2304
    v_smfmac_f32_16x16x64_bf16 v[120:123], v[40:43], v[128:135], v0
    ds_read_b64_tr_b16 v[68:69], v5 offset:3072
    ds_read_b64_tr_b16 v[70:71], v5 offset:3328
    v_smfmac_f32_16x16x64_bf16 v[124:127], v[40:43], v[136:143], v0
    s_waitcnt lgkmcnt(6)
    v_mfma_f32_16x16x32_bf16 v[112:115], v[56:59], v[56:59], 0
    ds_read_b128 v[24:27], v9 offset:0
    v_mfma_f32_16x16x32_bf16 v[104:107], v[72:75], v[56:59], 0
    ds_read_b128 v[28:31], v9 offset:1024
    v_mfma_f32_16x16x32_bf16 v[108:111], v[88:91], v[56:59], 0
    s_waitcnt lgkmcnt(6)
    v_mfma_f32_16x16x32_bf16 v[112:115], v[60:63], v[60:63], v[112:115]
    ds_read_b128 v[32:35], v9 offset:8192
    v_mfma_f32_16x16x32_bf16 v[104:107], v[76:79], v[60:63], v[104:107]
    ds_read_b128 v[36:39], v9 offset:9216
    v_mfma_f32_16x16x32_bf16 v[108:111], v[92:95], v[60:63], v[108:111]
    s_waitcnt lgkmcnt(6)
    v_mfma_f32_16x16x32_bf16 v[112:115], v[64:67], v[64:67], v[112:115]
    ds_read_b128 v[72:75], v9 offset:16384
    v_mfma_f32_16x16x32_bf16 v[104:107], v[80:83], v[64:67], v[104:107]
    ds_read_b128 v[76:79], v9 offset:17408
    v_mfma_f32_16x16x32_bf16 v[108:111], v[96:99], v[64:67], v[108:111]
    s_waitcnt lgkmcnt(6)
    v_mfma_f32_16x16x32_bf16 v[112:115], v[68:71], v[68:71], v[112:115]
    ds_read_b128 v[88:91], v9 offset:24576
    v_mfma_f32_16x16x32_bf16 v[104:107], v[84:87], v[68:71], v[104:107]
    ds_read_b128 v[92:95], v9 offset:25600
    v_mfma_f32_16x16x32_bf16 v[108:111], v[100:103], v[68:71], v[108:111]
    v_smfmac_f32_16x16x64_bf16 v[120:123], v[44:47], v[144:151], v0
    v_mov_b32 v84, 0x3f803f80
    v_smfmac_f32_16x16x64_bf16 v[124:127], v[44:47], v[152:159], v0
    v_max3_f32 v116, v112, v113, v104
    v_max3_f32 v117, v105, v106, v107
    v_max3_f32 v116, v116, v108, v109
    v_max3_f32 v117, v117, v110, v111
    v_max_f32 v116, v116, v117
    v_max_f32 v117, v116, v117
    v_smfmac_f32_16x16x64_bf16 v[120:123], v[48:51], v[160:167], v0
    v_permlane32_swap_b32 v116, v117
    v_max_f32 v116, v116, v117
    v_max_f32 v117, v116, v117
    v_smfmac_f32_16x16x64_bf16 v[124:127], v[48:51], v[168:175], v0
    v_permlane16_swap_b32 v116, v117
    v_smfmac_f32_16x16x64_bf16 v[120:123], v[52:55], v[176:183], v0
    v_max_f32 v116, v116, v117
    v_smfmac_f32_16x16x64_bf16 v[124:127], v[52:55], v[184:191], v0
    v_mul_f32 v116, s44, v116
    v_mov_b32 v85, 0x3f803f80
    v_pk_fma_f32 v[104:105], v[104:105], s[66:67], v[116:117] op_sel_hi:[1,1,0] neg_lo:[0,0,1] neg_hi:[0,0,1]
    v_pk_fma_f32 v[106:107], v[106:107], s[66:67], v[116:117] op_sel_hi:[1,1,0] neg_lo:[0,0,1] neg_hi:[0,0,1]
    v_exp_f32 v104, v104
    v_exp_f32 v105, v105
    v_pk_fma_f32 v[108:109], v[108:109], s[66:67], v[116:117] op_sel_hi:[1,1,0] neg_lo:[0,0,1] neg_hi:[0,0,1]
    v_exp_f32 v106, v106
    v_exp_f32 v107, v107
    v_pk_fma_f32 v[110:111], v[110:111], s[66:67], v[116:117] op_sel_hi:[1,1,0] neg_lo:[0,0,1] neg_hi:[0,0,1]
    v_cvt_pk_bf16_f32 v60, v104, v105
    v_exp_f32 v108, v108
    v_exp_f32 v109, v109
    v_cvt_pk_bf16_f32 v61, v106, v107
    v_pk_fma_f32 v[112:113], v[112:113], s[66:67], v[116:117] op_sel_hi:[1,1,0] neg_lo:[0,0,1] neg_hi:[0,0,1]
    v_exp_f32 v110, v110
    v_exp_f32 v111, v111
    v_cvt_pk_bf16_f32 v62, v108, v109
    v_exp_f32 v112, v112
    v_cvt_pk_bf16_f32 v63, v110, v111
    v_exp_f32 v113, v113
    v_mov_b64 v[86:87], v[84:85]
    v_mfma_f32_16x16x32_bf16 v[96:99], v[12:15], v[60:63], 0
    v_cvt_pk_bf16_f32 v56, v112, v113
    v_mov_b32 v57, 0
    v_mfma_f32_16x16x32_bf16 v[80:83], v[84:87], v[60:63], 0
    v_add_f32 v120, v120, v122
    v_add_f32 v121, v121, v123
    v_mfma_f32_16x16x32_bf16 v[100:103], v[16:19], v[60:63], 0
    v_cvt_pk_bf16_f32 v20, v120, v121
    v_add_f32 v124, v124, v126
    v_add_f32 v125, v125, v127
    v_mfma_f32_16x16x16_bf16 v[96:99], v[20:21], v[56:57], v[96:99]
    v_cvt_pk_bf16_f32 v22, v124, v125
    v_mfma_f32_16x16x16_bf16 v[80:83], v[84:85], v[56:57], v[80:83]
    s_nop 0
    v_mfma_f32_16x16x16_bf16 v[100:103], v[22:23], v[56:57], v[100:103]
    ds_read_b128 v[40:43], v9 offset:32768
    ds_read_b128 v[44:47], v9 offset:33792
    buffer_store_dwordx4 v[20:23], v10, s[32:35], s58 offen offset:1024 sc1
    s_nop 2
    v_rcp_f32 v118, v80
    s_mov_b64 exec, s[70:71]
    v_pk_mul_f32 v[96:97], v[96:97], v[118:119] op_sel_hi:[1,0]
    v_cvt_pk_bf16_f32 v96, v96, v97
    v_pk_mul_f32 v[98:99], v[98:99], v[118:119] op_sel_hi:[1,0]
    v_cvt_pk_bf16_f32 v97, v98, v99
    v_pk_mul_f32 v[100:101], v[100:101], v[118:119] op_sel_hi:[1,0]
    v_cvt_pk_bf16_f32 v98, v100, v101
    v_pk_mul_f32 v[102:103], v[102:103], v[118:119] op_sel_hi:[1,0]
    v_cvt_pk_bf16_f32 v99, v102, v103
    ds_write2_b64 v6, v[96:97], v[98:99] offset0:0 offset1:4
    s_mov_b64 exec, -1
    v_mov_b64 v[104:105], 0
    v_mov_b64 v[106:107], 0
    v_mov_b64 v[108:109], 0
    v_mov_b64 v[110:111], 0
    v_mov_b64 v[112:113], 0
    v_mov_b64 v[114:115], 0
    v_mov_b64 v[116:117], 0
    v_mov_b64 v[118:119], 0
    s_waitcnt lgkmcnt(0)
    s_barrier
    ds_read_b128 v[56:59], v7 offset:0
    ds_read_b128 v[60:63], v7 offset:64
    ds_read_b128 v[64:67], v7 offset:128
    ds_read_b128 v[68:71], v7 offset:192
    s_add_u32 s54, s52, 131072
    s_add_u32 s55, s54, 4096
    s_cmp_lt_u32 s42, 62
    s_cselect_b32 s60, 262144, 0
    s_add_u32 s56, s56, s60
    s_add_u32 s69, s69, s60
    s_mov_b32 s57, s43
    s_waitcnt lgkmcnt(3)
    v_smfmac_f32_16x16x64_bf16 v[104:107], v[56:59], v[192:199], v0
    v_mov_b32 v20, 0x3f80
    v_smfmac_f32_16x16x64_bf16 v[108:111], v[56:59], v[224:231], v0
    v_mov_b32 v21, 0x3f800000
    s_waitcnt lgkmcnt(2)
    v_smfmac_f32_16x16x64_bf16 v[104:107], v[60:63], v[200:207], v0
    ds_read_b128 v[48:51], v9 offset:40960
    v_cndmask_b32 v20, v20, v21, s[46:47]
    v_smfmac_f32_16x16x64_bf16 v[108:111], v[60:63], v[232:239], v0
    ds_read_b128 v[52:55], v9 offset:41984
    v_cndmask_b32 v80, 0, v20, s[92:93]
    s_waitcnt lgkmcnt(3)
    v_smfmac_f32_16x16x64_bf16 v[104:107], v[64:67], v[208:215], v0
    ds_read_b128 v[12:15], v9 offset:49152
    v_cndmask_b32 v81, 0, v20, s[94:95]
    v_smfmac_f32_16x16x64_bf16 v[108:111], v[64:67], v[240:247], v0
    ds_read_b128 v[16:19], v9 offset:50176
    v_cndmask_b32 v82, 0, v20, s[96:97]
    s_waitcnt lgkmcnt(4)
    v_smfmac_f32_16x16x64_bf16 v[104:107], v[68:71], v[216:223], v0
    ds_read_b128 v[120:123], v9 offset:57344
    v_cndmask_b32 v83, 0, v20, s[98:99]
    v_smfmac_f32_16x16x64_bf16 v[108:111], v[68:71], v[248:255], v0
    ds_read_b128 v[124:127], v9 offset:58368
    v_smfmac_f32_16x16x64_bf16 v[112:115], v[56:59], v[24:31], v0
    v_smfmac_f32_16x16x64_bf16 v[112:115], v[60:63], v[32:39], v0
    v_cvt_pk_bf16_f32 v96, v104, v105
    v_smfmac_f32_16x16x64_bf16 v[112:115], v[64:67], v[72:79], v0
    v_cvt_pk_bf16_f32 v97, v106, v107
    v_smfmac_f32_16x16x64_bf16 v[112:115], v[68:71], v[88:95], v0
    buffer_store_dwordx2 v[96:97], v1, s[32:35], s48 offen sc1
    v_cvt_pk_bf16_f32 v98, v108, v109
    v_smfmac_f32_16x16x64_bf16 v[116:119], v[56:59], v[40:47], v0
    v_cvt_pk_bf16_f32 v99, v110, v111
    s_waitcnt lgkmcnt(4)
    v_smfmac_f32_16x16x64_bf16 v[116:119], v[60:63], v[48:55], v0
    buffer_store_dwordx2 v[98:99], v1, s[32:35], s49 offen sc1
    s_waitcnt lgkmcnt(2)
    v_smfmac_f32_16x16x64_bf16 v[116:119], v[64:67], v[12:19], v0
    v_cvt_pk_bf16_f32 v100, v112, v113
    s_waitcnt lgkmcnt(0)
    v_smfmac_f32_16x16x64_bf16 v[116:119], v[68:71], v[120:127], v0
    v_cvt_pk_bf16_f32 v101, v114, v115
    buffer_store_dwordx2 v[100:101], v1, s[32:35], s50 offen sc1
    s_nop 5
    v_cvt_pk_bf16_f32 v102, v116, v117
    v_cvt_pk_bf16_f32 v103, v118, v119
    buffer_store_dwordx2 v[102:103], v1, s[32:35], s51 offen sc1
    v_mov_b64 v[104:105], 0
    v_mov_b64 v[106:107], 0
    v_mov_b64 v[108:109], 0
    v_mov_b64 v[110:111], 0
    v_mov_b64 v[112:113], 0
    v_mov_b64 v[114:115], 0
    v_mov_b64 v[116:117], 0
    v_mov_b64 v[118:119], 0
    s_xor_b32 s48, s48, 0x40000
    s_xor_b32 s49, s49, 0x40000
    s_xor_b32 s50, s50, 0x40000
    s_xor_b32 s51, s51, 0x40000
    v_mov_b32 v46, s45
    ds_read_b128 v[56:59], v8 offset:49152
    ds_read_b128 v[60:63], v8 offset:50176
    ds_read_b128 v[64:67], v8 offset:57344
    ds_read_b128 v[68:71], v8 offset:58368
    ds_read_b128 v[72:75], v8 offset:16384
    ds_read_b128 v[76:79], v8 offset:17408
    ds_read_b128 v[88:91], v8 offset:32768
    ds_read_b128 v[92:95], v8 offset:33792
    ds_read_b128 v[12:15], v8 offset:0
    ds_read_b128 v[16:19], v8 offset:1024
    ds_read_b128 v[120:123], v8 offset:8192
    buffer_load_dwordx4 v[24:27], v2, s[32:35], s43 offen offset:0 sc1
    buffer_load_dwordx4 v[28:31], v2, s[32:35], s43 offen offset:1024 sc1
    ds_read_b128 v[124:127], v8 offset:9216
    ds_read_b128 v[96:99], v8 offset:40960
    ds_read_b128 v[100:103], v8 offset:41984
    s_nop 7
    s_mov_b32 s60, 0
L_poll_76:
    buffer_load_dwordx4 v[24:27], v2, s[32:35], s43 offen offset:0 sc1
    buffer_load_dwordx4 v[28:31], v2, s[32:35], s43 offen offset:1024 sc1
    s_add_u32 s60, s60, 1
    s_cmp_gt_u32 s60, 64
    s_cbranch_scc1 L_pexact_77
    s_waitcnt vmcnt(2)
    v_max3_u32 v47, v24, v25, v26
    v_max3_u32 v47, v47, v27, v28
    v_max3_u32 v47, v47, v29, v30
    v_max_u32 v47, v47, v31
    v_cmp_le_u32 vcc, s45, v47
    s_nop 0
    s_and_b64 exec, exec, vcc
    s_cbranch_scc1 L_poll_76
L_pout_78:
    s_mov_b64 exec, -1
    v_mfma_f32_16x16x32_bf16 v[84:87], v[80:83], v[24:27], 0
    v_mfma_f32_16x16x32_bf16 v[84:87], v[80:83], v[28:31], v[84:87]
    s_nop 7
    v_add_f32_dpp v84, v84, v84 row_ror:8 row_mask:0xf bank_mask:0xf
    v_add_f32_dpp v85, v85, v85 row_ror:8 row_mask:0xf bank_mask:0xf
    s_nop 0
    v_add_f32_dpp v84, v84, v84 row_ror:4 row_mask:0xf bank_mask:0xf
    v_add_f32_dpp v85, v85, v85 row_ror:4 row_mask:0xf bank_mask:0xf
    v_cvt_pk_bf16_f32 v44, v84, v85
    buffer_store_dword v44, v3, s[32:35], s52 offen sc1
    buffer_store_dword v46, v3, s[32:35], s53 offen sc1
    ds_read_b128 v[80:83], v8 offset:24576
    ds_read_b128 v[84:87], v8 offset:25600
    s_add_u32 s42, s42, 1
    s_xor_b32 s43, s43, 0x40000
    s_add_u32 s52, s52, 8192
    s_and_b32 s52, s52, 0x7fff
    s_add_u32 s53, s53, 8192
    s_and_b32 s53, s53, 0x7fff
    s_add_u32 s58, s58, 131072
    s_nop 15
    s_nop 15
    s_nop 12
    buffer_load_dwordx4 v[48:51], v10, s[32:35], s54 offen offset:2048 sc1
    buffer_load_dwordx4 v[52:55], v10, s[32:35], s54 offen offset:3072 sc1
    s_branch L_chain_loop_w1_70
L_chain_last_71:
    s_waitcnt vmcnt(0)
    ds_read_b128 v[40:43], v10 offset:4096
    ds_read_b128 v[44:47], v10 offset:5120
    ds_read_b128 v[48:51], v10 offset:6144
    ds_read_b128 v[52:55], v10 offset:7168
    v_mov_b64 v[120:121], 0
    v_mov_b64 v[122:123], 0
    v_mov_b64 v[124:125], 0
    v_mov_b64 v[126:127], 0
    s_waitcnt lgkmcnt(7)
    v_smfmac_f32_16x16x64_bf16 v[112:115], v[24:27], a[64:71], v0
    v_smfmac_f32_16x16x64_bf16 v[116:119], v[24:27], a[72:79], v0
    v_smfmac_f32_16x16x64_bf16 v[120:123], v[24:27], a[192:199], v0
    v_smfmac_f32_16x16x64_bf16 v[124:127], v[24:27], a[200:207], v0
    s_waitcnt lgkmcnt(6)
    v_smfmac_f32_16x16x64_bf16 v[112:115], v[28:31], a[80:87], v0
    v_smfmac_f32_16x16x64_bf16 v[116:119], v[28:31], a[88:95], v0
    v_smfmac_f32_16x16x64_bf16 v[120:123], v[28:31], a[208:215], v0
    v_smfmac_f32_16x16x64_bf16 v[124:127], v[28:31], a[216:223], v0
    s_waitcnt lgkmcnt(5)
    v_smfmac_f32_16x16x64_bf16 v[112:115], v[32:35], a[96:103], v0
    v_smfmac_f32_16x16x64_bf16 v[116:119], v[32:35], a[104:111], v0
    v_smfmac_f32_16x16x64_bf16 v[120:123], v[32:35], a[224:231], v0
    v_smfmac_f32_16x16x64_bf16 v[124:127], v[32:35], a[232:239], v0
    s_waitcnt lgkmcnt(4)
    v_smfmac_f32_16x16x64_bf16 v[112:115], v[36:39], a[112:119], v0
    v_smfmac_f32_16x16x64_bf16 v[116:119], v[36:39], a[120:127], v0
    v_smfmac_f32_16x16x64_bf16 v[120:123], v[36:39], a[240:247], v0
    v_smfmac_f32_16x16x64_bf16 v[124:127], v[36:39], a[248:255], v0
    s_waitcnt lgkmcnt(3)
    v_smfmac_f32_16x16x64_bf16 v[112:115], v[40:43], a[128:135], v0
    v_smfmac_f32_16x16x64_bf16 v[116:119], v[40:43], a[136:143], v0
    v_smfmac_f32_16x16x64_bf16 v[120:123], v[40:43], v[128:135], v0
    v_smfmac_f32_16x16x64_bf16 v[124:127], v[40:43], v[136:143], v0
    s_waitcnt lgkmcnt(2)
    v_smfmac_f32_16x16x64_bf16 v[112:115], v[44:47], a[144:151], v0
    v_smfmac_f32_16x16x64_bf16 v[116:119], v[44:47], a[152:159], v0
    v_smfmac_f32_16x16x64_bf16 v[120:123], v[44:47], v[144:151], v0
    v_smfmac_f32_16x16x64_bf16 v[124:127], v[44:47], v[152:159], v0
    s_waitcnt lgkmcnt(1)
    v_smfmac_f32_16x16x64_bf16 v[112:115], v[48:51], a[160:167], v0
    v_smfmac_f32_16x16x64_bf16 v[116:119], v[48:51], a[168:175], v0
    v_smfmac_f32_16x16x64_bf16 v[120:123], v[48:51], v[160:167], v0
    v_smfmac_f32_16x16x64_bf16 v[124:127], v[48:51], v[168:175], v0
    s_waitcnt lgkmcnt(0)
    v_smfmac_f32_16x16x64_bf16 v[112:115], v[52:55], a[176:183], v0
    v_smfmac_f32_16x16x64_bf16 v[116:119], v[52:55], a[184:191], v0
    v_smfmac_f32_16x16x64_bf16 v[120:123], v[52:55], v[176:183], v0
    v_smfmac_f32_16x16x64_bf16 v[124:127], v[52:55], v[184:191], v0
    v_add_f32 v112, v112, v114
    v_add_f32 v113, v113, v115
    v_cvt_pk_bf16_f32 v21, v112, v113
    v_add_f32 v116, v116, v118
    v_add_f32 v117, v117, v119
    v_cvt_pk_bf16_f32 v23, v116, v117
    v_add_f32 v120, v120, v122
    v_add_f32 v121, v121, v123
    v_cvt_pk_bf16_f32 v20, v120, v121
    v_add_f32 v124, v124, v126
    v_add_f32 v125, v125, v127
    v_cvt_pk_bf16_f32 v22, v124, v125
    buffer_store_dwordx4 v[20:23], v10, s[32:35], s58 offen offset:1024 sc1
    s_waitcnt vmcnt(0)
    s_barrier
    s_endpgm
L_pexact_73:
    s_add_u32 s59, s59, 1
    s_cmp_gt_u32 s59, 262144
    s_cbranch_scc1 L_chain_abort_1
    s_waitcnt vmcnt(0)
    v_cmp_eq_u32 vcc, s45, v48
    v_cmp_eq_u32 s[100:101], s45, v49
    s_nop 0
    s_or_b64 vcc, vcc, s[100:101]
    v_cmp_eq_u32 s[100:101], s45, v50
    s_nop 0
    s_or_b64 vcc, vcc, s[100:101]
    v_cmp_eq_u32 s[100:101], s45, v51
    s_nop 0
    s_or_b64 vcc, vcc, s[100:101]
    v_cmp_eq_u32 s[100:101], s45, v52
    s_nop 0
    s_or_b64 vcc, vcc, s[100:101]
    v_cmp_eq_u32 s[100:101], s45, v53
    s_nop 0
    s_or_b64 vcc, vcc, s[100:101]
    v_cmp_eq_u32 s[100:101], s45, v54
    s_nop 0
    s_or_b64 vcc, vcc, s[100:101]
    v_cmp_eq_u32 s[100:101], s45, v55
    s_nop 0
    s_or_b64 vcc, vcc, s[100:101]
    ds_write_b128 v10, v[48:51] offset:2048
    ds_write_b128 v10, v[52:55] offset:3072
    s_and_b64 exec, exec, vcc
    s_cbranch_scc0 L_pout_74
    buffer_load_dwordx4 v[48:51], v10, s[32:35], s54 offen offset:2048 sc1
    buffer_load_dwordx4 v[52:55], v10, s[32:35], s54 offen offset:3072 sc1
    s_branch L_pexact_73
L_pexact_77:
    s_add_u32 s59, s59, 1
    s_cmp_gt_u32 s59, 262144
    s_cbranch_scc1 L_chain_abort_1
    s_waitcnt vmcnt(0)
    v_cmp_eq_u32 vcc, s45, v24
    v_cmp_eq_u32 s[100:101], s45, v25
    s_nop 0
    s_or_b64 vcc, vcc, s[100:101]
    v_cmp_eq_u32 s[100:101], s45, v26
    s_nop 0
    s_or_b64 vcc, vcc, s[100:101]
    v_cmp_eq_u32 s[100:101], s45, v27
    s_nop 0
    s_or_b64 vcc, vcc, s[100:101]
    v_cmp_eq_u32 s[100:101], s45, v28
    s_nop 0
    s_or_b64 vcc, vcc, s[100:101]
    v_cmp_eq_u32 s[100:101], s45, v29
    s_nop 0
    s_or_b64 vcc, vcc, s[100:101]
    v_cmp_eq_u32 s[100:101], s45, v30
    s_nop 0
    s_or_b64 vcc, vcc, s[100:101]
    v_cmp_eq_u32 s[100:101], s45, v31
    s_nop 0
    s_or_b64 vcc, vcc, s[100:101]
    s_and_b64 exec, exec, vcc
    s_cbranch_scc0 L_pout_78
    buffer_load_dwordx4 v[24:27], v2, s[32:35], s43 offen offset:0 sc1
    buffer_load_dwordx4 v[28:31], v2, s[32:35], s43 offen offset:1024 sc1
    s_branch L_pexact_77
L_cl_1_2_14:
    buffer_load_dwordx4 v[48:51], v10, s[32:35], s55 offen offset:0 sc1
    buffer_load_dwordx4 v[52:55], v10, s[32:35], s55 offen offset:1024 sc1
L_chain_loop_w2_80:
    s_mov_b32 s60, 0
L_poll_82:
    buffer_load_dwordx4 v[48:51], v10, s[32:35], s55 offen offset:0 sc1
    buffer_load_dwordx4 v[52:55], v10, s[32:35], s55 offen offset:1024 sc1
    s_add_u32 s60, s60, 1
    s_cmp_gt_u32 s60, 64
    s_cbranch_scc1 L_pexact_83
    s_waitcnt vmcnt(2)
    v_max3_u32 v47, v48, v49, v50
    v_max3_u32 v47, v47, v51, v52
    ds_write_b128 v10, v[48:51] offset:4096
    v_max3_u32 v47, v47, v53, v54
    v_max_u32 v47, v47, v55
    ds_write_b128 v10, v[52:55] offset:5120
    v_cmp_le_u32 vcc, s45, v47
    s_nop 0
    s_and_b64 exec, exec, vcc
    s_cbranch_scc1 L_poll_82
L_pout_84:
    s_mov_b64 exec, -1
    s_waitcnt lgkmcnt(0)
    s_barrier
    ds_read_b128 v[24:27], v10 offset:0
    ds_read_b128 v[28:31], v10 offset:1024
    ds_read_b128 v[32:35], v10 offset:2048
    ds_read_b128 v[36:39], v10 offset:3072
    s_cmp_eq_u32 s42, 63
    s_cbranch_scc1 L_chain_last_81
    s_waitcnt lgkmcnt(3)
    v_smfmac_f32_16x16x64_bf16 v[104:107], v[24:27], v[12:19], v0
    v_smfmac_f32_16x16x64_bf16 v[108:111], v[24:27], v[120:127], v0
    ds_read_b128 v[12:15], v10 offset:20480
    s_waitcnt lgkmcnt(3)
    v_smfmac_f32_16x16x64_bf16 v[104:107], v[28:31], v[72:79], v0
    ds_read_b128 v[16:19], v10 offset:21504
    v_smfmac_f32_16x16x64_bf16 v[108:111], v[28:31], v[80:87], v0
    ds_read_b128 v[72:75], v10 offset:8192
    s_waitcnt lgkmcnt(4)
    v_smfmac_f32_16x16x64_bf16 v[104:107], v[32:35], v[88:95], v0
    ds_read_b128 v[76:79], v10 offset:9216
    v_smfmac_f32_16x16x64_bf16 v[108:111], v[32:35], v[96:103], v0
    ds_read_b128 v[80:83], v10 offset:10240
    s_waitcnt lgkmcnt(5)
    v_smfmac_f32_16x16x64_bf16 v[104:107], v[36:39], v[56:63], v0
    ds_read_b128 v[84:87], v10 offset:11264
    v_smfmac_f32_16x16x64_bf16 v[108:111], v[36:39], v[64:71], v0
    ds_read_b128 v[88:91], v10 offset:12288
    v_smfmac_f32_16x16x64_bf16 v[112:115], v[24:27], a[64:71], v0
    ds_read_b128 v[92:95], v10 offset:13312
    v_smfmac_f32_16x16x64_bf16 v[116:119], v[24:27], a[72:79], v0
    ds_read_b128 v[96:99], v10 offset:14336
    v_smfmac_f32_16x16x64_bf16 v[112:115], v[28:31], a[80:87], v0
    ds_read_b128 v[100:103], v10 offset:15360
    v_smfmac_f32_16x16x64_bf16 v[116:119], v[28:31], a[88:95], v0
    s_waitcnt vmcnt(0)
    ds_read_b128 v[40:43], v10 offset:4096
    v_smfmac_f32_16x16x64_bf16 v[112:115], v[32:35], a[96:103], v0
    s_waitcnt vmcnt(0)
    s_mov_b32 m0, 143360
    ds_read_b128 v[44:47], v10 offset:5120
    v_smfmac_f32_16x16x64_bf16 v[116:119], v[32:35], a[104:111], v0
    s_waitcnt lgkmcnt(2)
    s_barrier
    v_smfmac_f32_16x16x64_bf16 v[112:115], v[36:39], a[112:119], v0
    ds_read_b128 v[48:51], v10 offset:6144
    v_mov_b64 v[120:121], 0
    v_smfmac_f32_16x16x64_bf16 v[116:119], v[36:39], a[120:127], v0
    ds_read_b128 v[52:55], v10 offset:7168
    v_mov_b64 v[122:123], 0
    s_waitcnt lgkmcnt(3)
    v_smfmac_f32_16x16x64_bf16 v[104:107], v[40:43], a[0:7], v0
    buffer_load_dwordx4 v10, s[32:35], s56 offen sc1 lds
    v_mov_b64 v[124:125], 0
    v_smfmac_f32_16x16x64_bf16 v[108:111], v[40:43], a[8:15], v0
    v_mov_b64 v[126:127], 0
    v_smfmac_f32_16x16x64_bf16 v[112:115], v[40:43], a[128:135], v0
    v_smfmac_f32_16x16x64_bf16 v[116:119], v[40:43], a[136:143], v0
    s_waitcnt lgkmcnt(2)
    v_smfmac_f32_16x16x64_bf16 v[104:107], v[44:47], a[16:23], v0
    buffer_load_dwordx4 v10, s[32:35], s56 offen offset:1024 sc1 lds
    s_mov_b32 m0, 151552
    v_mov_b32 v56, s45
    v_smfmac_f32_16x16x64_bf16 v[108:111], v[44:47], a[24:31], v0
    v_mov_b32 v57, s45
    v_smfmac_f32_16x16x64_bf16 v[112:115], v[44:47], a[144:151], v0
    v_mov_b64 v[58:59], v[56:57]
    v_smfmac_f32_16x16x64_bf16 v[116:119], v[44:47], a[152:159], v0
    s_waitcnt lgkmcnt(1)
    v_smfmac_f32_16x16x64_bf16 v[104:107], v[48:51], a[32:39], v0
    buffer_load_dwordx4 v10, s[32:35], s69 offen sc1 lds
    v_smfmac_f32_16x16x64_bf16 v[108:111], v[48:51], a[40:47], v0
    s_waitcnt lgkmcnt(0)
    v_smfmac_f32_16x16x64_bf16 v[104:107], v[52:55], a[48:55], v0
    v_smfmac_f32_16x16x64_bf16 v[108:111], v[52:55], a[56:63], v0
    v_smfmac_f32_16x16x64_bf16 v[112:115], v[48:51], a[160:167], v0
    buffer_load_dwordx4 v10, s[32:35], s69 offen offset:1024 sc1 lds
    v_smfmac_f32_16x16x64_bf16 v[116:119], v[48:51], a[168:175], v0
    v_add_f32 v104, v104, v106
    v_smfmac_f32_16x16x64_bf16 v[112:115], v[52:55], a[176:183], v0
    v_add_f32 v105, v105, v107
    v_smfmac_f32_16x16x64_bf16 v[116:119], v[52:55], a[184:191], v0
    v_add_f32 v108, v108, v110
    v_smfmac_f32_16x16x64_bf16 v[120:123], v[24:27], a[192:199], v0
    v_add_f32 v109, v109, v111
    v_smfmac_f32_16x16x64_bf16 v[124:127], v[24:27], a[200:207], v0
    v_cvt_pk_bf16_f32 v104, v104, v105
    v_add_f32 v112, v112, v114
    v_add_f32 v113, v113, v115
    v_cvt_pk_bf16_f32 v21, v112, v113
    ds_write2_b32 v4, v21, v104 offset0:0 offset1:1
    v_pk_add_f32 v[116:117], v[116:117], v[118:119]
    v_cvt_pk_bf16_f32 v108, v108, v109
    v_cvt_pk_bf16_f32 v23, v116, v117
    ds_write2_b32 v4, v23, v108 offset0:128 offset1:129
    v_smfmac_f32_16x16x64_bf16 v[120:123], v[28:31], a[208:215], v0
    buffer_store_dwordx4 v[56:59], v2, s[32:35], s57 offen offset:1024 sc1
    v_smfmac_f32_16x16x64_bf16 v[124:127], v[28:31], a[216:223], v0
    v_smfmac_f32_16x16x64_bf16 v[120:123], v[32:35], a[224:231], v0
    buffer_store_dwordx4 v[56:59], v2, s[32:35], s57 offen offset:0 sc1
    v_smfmac_f32_16x16x64_bf16 v[124:127], v[32:35], a[232:239], v0
    s_waitcnt lgkmcnt(0)
    s_barrier
    ds_read_b64_tr_b16 v[56:57], v5 offset:0
    ds_read_b64_tr_b16 v[58:59], v5 offset:256
    v_smfmac_f32_16x16x64_bf16 v[120:123], v[36:39], a[240:247], v0
    ds_read_b64_tr_b16 v[60:61], v5 offset:1024
    ds_read_b64_tr_b16 v[62:63], v5 offset:1280
    v_smfmac_f32_16x16x64_bf16 v[124:127], v[36:39], a[248:255], v0
    ds_read_b64_tr_b16 v[64:65], v5 offset:2048
    ds_read_b64_tr_b16 v[66:67], v5 offset:2304
    v_smfmac_f32_16x16x64_bf16 v[120:123], v[40:43], v[128:135], v0
    ds_read_b64_tr_b16 v[68:69], v5 offset:3072
    ds_read_b64_tr_b16 v[70:71], v5 offset:3328
    v_smfmac_f32_16x16x64_bf16 v[124:127], v[40:43], v[136:143], v0
    s_waitcnt lgkmcnt(6)
    v_mfma_f32_16x16x32_bf16 v[112:115], v[56:59], v[56:59], 0
    ds_read_b128 v[24:27], v9 offset:0
    v_mfma_f32_16x16x32_bf16 v[104:107], v[72:75], v[56:59], 0
    ds_read_b128 v[28:31], v9 offset:1024
    v_mfma_f32_16x16x32_bf16 v[108:111], v[88:91], v[56:59], 0
    s_waitcnt lgkmcnt(6)
    v_mfma_f32_16x16x32_bf16 v[112:115], v[60:63], v[60:63], v[112:115]
    ds_read_b128 v[32:35], v9 offset:8192
    v_mfma_f32_16x16x32_bf16 v[104:107], v[76:79], v[60:63], v[104:107]
    ds_read_b128 v[36:39], v9 offset:9216
    v_mfma_f32_16x16x32_bf16 v[108:111], v[92:95], v[60:63], v[108:111]
    s_waitcnt lgkmcnt(6)
    v_mfma_f32_16x16x32_bf16 v[112:115], v[64:67], v[64:67], v[112:115]
    ds_read_b128 v[72:75], v9 offset:16384
    v_mfma_f32_16x16x32_bf16 v[104:107], v[80:83], v[64:67], v[104:107]
    ds_read_b128 v[76:79], v9 offset:17408
    v_mfma_f32_16x16x32_bf16 v[108:111], v[96:99], v[64:67], v[108:111]
    s_waitcnt lgkmcnt(6)
    v_mfma_f32_16x16x32_bf16 v[112:115], v[68:71], v[68:71], v[112:115]
    ds_read_b128 v[88:91], v9 offset:24576
    v_mfma_f32_16x16x32_bf16 v[104:107], v[84:87], v[68:71], v[104:107]
    ds_read_b128 v[92:95], v9 offset:25600
    v_mfma_f32_16x16x32_bf16 v[108:111], v[100:103], v[68:71], v[108:111]
    v_smfmac_f32_16x16x64_bf16 v[120:123], v[44:47], v[144:151], v0
    v_mov_b32 v84, 0x3f803f80
    v_smfmac_f32_16x16x64_bf16 v[124:127], v[44:47], v[152:159], v0
    v_max3_f32 v116, v112, v113, v104
    v_max3_f32 v117, v105, v106, v107
    v_max3_f32 v116, v116, v108, v109
    v_max3_f32 v117, v117, v110, v111
    v_max_f32 v116, v116, v117
    v_max_f32 v117, v116, v117
    v_smfmac_f32_16x16x64_bf16 v[120:123], v[48:51], v[160:167], v0
    v_permlane32_swap_b32 v116, v117
    v_max_f32 v116, v116, v117
    v_max_f32 v117, v116, v117
    v_smfmac_f32_16x16x64_bf16 v[124:127], v[48:51], v[168:175], v0
    v_permlane16_swap_b32 v116, v117
    v_smfmac_f32_16x16x64_bf16 v[120:123], v[52:55], v[176:183], v0
    v_max_f32 v116, v116, v117
    v_smfmac_f32_16x16x64_bf16 v[124:127], v[52:55], v[184:191], v0
    v_mul_f32 v116, s44, v116
    v_mov_b32 v85, 0x3f803f80
    v_pk_fma_f32 v[104:105], v[104:105], s[66:67], v[116:117] op_sel_hi:[1,1,0] neg_lo:[0,0,1] neg_hi:[0,0,1]
    v_pk_fma_f32 v[106:107], v[106:107], s[66:67], v[116:117] op_sel_hi:[1,1,0] neg_lo:[0,0,1] neg_hi:[0,0,1]
    v_exp_f32 v104, v104
    v_exp_f32 v105, v105
    v_pk_fma_f32 v[108:109], v[108:109], s[66:67], v[116:117] op_sel_hi:[1,1,0] neg_lo:[0,0,1] neg_hi:[0,0,1]
    v_exp_f32 v106, v106
    v_exp_f32 v107, v107
    v_pk_fma_f32 v[110:111], v[110:111], s[66:67], v[116:117] op_sel_hi:[1,1,0] neg_lo:[0,0,1] neg_hi:[0,0,1]
    v_cvt_pk_bf16_f32 v60, v104, v105
    v_exp_f32 v108, v108
    v_exp_f32 v109, v109
    v_cvt_pk_bf16_f32 v61, v106, v107
    v_pk_fma_f32 v[112:113], v[112:113], s[66:67], v[116:117] op_sel_hi:[1,1,0] neg_lo:[0,0,1] neg_hi:[0,0,1]
    v_exp_f32 v110, v110
    v_exp_f32 v111, v111
    v_cvt_pk_bf16_f32 v62, v108, v109
    v_exp_f32 v112, v112
    v_cvt_pk_bf16_f32 v63, v110, v111
    v_exp_f32 v113, v113
    v_mov_b64 v[86:87], v[84:85]
    v_mfma_f32_16x16x32_bf16 v[96:99], v[12:15], v[60:63], 0
    v_cvt_pk_bf16_f32 v56, v112, v113
    v_mov_b32 v57, 0
    v_mfma_f32_16x16x32_bf16 v[80:83], v[84:87], v[60:63], 0
    v_add_f32 v120, v120, v122
    v_add_f32 v121, v121, v123
    v_mfma_f32_16x16x32_bf16 v[100:103], v[16:19], v[60:63], 0
    v_cvt_pk_bf16_f32 v20, v120, v121
    v_add_f32 v124, v124, v126
    v_add_f32 v125, v125, v127
    v_mfma_f32_16x16x16_bf16 v[96:99], v[20:21], v[56:57], v[96:99]
    v_cvt_pk_bf16_f32 v22, v124, v125
    v_mfma_f32_16x16x16_bf16 v[80:83], v[84:85], v[56:57], v[80:83]
    s_nop 0
    v_mfma_f32_16x16x16_bf16 v[100:103], v[22:23], v[56:57], v[100:103]
    ds_read_b128 v[40:43], v9 offset:32768
    ds_read_b128 v[44:47], v9 offset:33792
    s_nop 3
    v_rcp_f32 v118, v80
    s_mov_b64 exec, s[70:71]
    v_pk_mul_f32 v[96:97], v[96:97], v[118:119] op_sel_hi:[1,0]
    v_cvt_pk_bf16_f32 v96, v96, v97
    v_pk_mul_f32 v[98:99], v[98:99], v[118:119] op_sel_hi:[1,0]
    v_cvt_pk_bf16_f32 v97, v98, v99
    v_pk_mul_f32 v[100:101], v[100:101], v[118:119] op_sel_hi:[1,0]
    v_cvt_pk_bf16_f32 v98, v100, v101
    v_pk_mul_f32 v[102:103], v[102:103], v[118:119] op_sel_hi:[1,0]
    v_cvt_pk_bf16_f32 v99, v102, v103
    ds_write2_b64 v6, v[96:97], v[98:99] offset0:0 offset1:4
    s_mov_b64 exec, -1
    buffer_store_dwordx4 v[20:23], v10, s[32:35], s58 offen offset:2048 sc1
    v_mov_b64 v[104:105], 0
    v_mov_b64 v[106:107], 0
    v_mov_b64 v[108:109], 0
    v_mov_b64 v[110:111], 0
    v_mov_b64 v[112:113], 0
    v_mov_b64 v[114:115], 0
    v_mov_b64 v[116:117], 0
    v_mov_b64 v[118:119], 0
    s_waitcnt lgkmcnt(0)
    s_barrier
    ds_read_b128 v[56:59], v7 offset:0
    ds_read_b128 v[60:63], v7 offset:64
    ds_read_b128 v[64:67], v7 offset:128
    ds_read_b128 v[68:71], v7 offset:192
    s_add_u32 s54, s52, 131072
    s_add_u32 s55, s54, 4096
    s_cmp_lt_u32 s42, 62
    s_cselect_b32 s60, 262144, 0
    s_add_u32 s56, s56, s60
    s_add_u32 s69, s69, s60
    s_mov_b32 s57, s43
    s_waitcnt lgkmcnt(3)
    v_smfmac_f32_16x16x64_bf16 v[104:107], v[56:59], v[192:199], v0
    v_mov_b32 v20, 0x3f80
    v_smfmac_f32_16x16x64_bf16 v[108:111], v[56:59], v[224:231], v0
    v_mov_b32 v21, 0x3f800000
    s_waitcnt lgkmcnt(2)
    v_smfmac_f32_16x16x64_bf16 v[104:107], v[60:63], v[200:207], v0
    ds_read_b128 v[48:51], v9 offset:40960
    v_cndmask_b32 v20, v20, v21, s[46:47]
    v_smfmac_f32_16x16x64_bf16 v[108:111], v[60:63], v[232:239], v0
    ds_read_b128 v[52:55], v9 offset:41984
    v_cndmask_b32 v80, 0, v20, s[92:93]
    s_waitcnt lgkmcnt(3)
    v_smfmac_f32_16x16x64_bf16 v[104:107], v[64:67], v[208:215], v0
    ds_read_b128 v[12:15], v9 offset:49152
    v_cndmask_b32 v81, 0, v20, s[94:95]
    v_smfmac_f32_16x16x64_bf16 v[108:111], v[64:67], v[240:247], v0
    ds_read_b128 v[16:19], v9 offset:50176
    v_cndmask_b32 v82, 0, v20, s[96:97]
    s_waitcnt lgkmcnt(4)
    v_smfmac_f32_16x16x64_bf16 v[104:107], v[68:71], v[216:223], v0
    ds_read_b128 v[120:123], v9 offset:57344
    v_cndmask_b32 v83, 0, v20, s[98:99]
    v_smfmac_f32_16x16x64_bf16 v[108:111], v[68:71], v[248:255], v0
    ds_read_b128 v[124:127], v9 offset:58368
    v_smfmac_f32_16x16x64_bf16 v[112:115], v[56:59], v[24:31], v0
    v_smfmac_f32_16x16x64_bf16 v[112:115], v[60:63], v[32:39], v0
    v_cvt_pk_bf16_f32 v96, v104, v105
    v_smfmac_f32_16x16x64_bf16 v[112:115], v[64:67], v[72:79], v0
    v_cvt_pk_bf16_f32 v97, v106, v107
    v_smfmac_f32_16x16x64_bf16 v[112:115], v[68:71], v[88:95], v0
    buffer_store_dwordx2 v[96:97], v1, s[32:35], s48 offen sc1
    v_cvt_pk_bf16_f32 v98, v108, v109
    v_smfmac_f32_16x16x64_bf16 v[116:119], v[56:59], v[40:47], v0
    v_cvt_pk_bf16_f32 v99, v110, v111
    s_waitcnt lgkmcnt(4)
    v_smfmac_f32_16x16x64_bf16 v[116:119], v[60:63], v[48:55], v0
    buffer_store_dwordx2 v[98:99], v1, s[32:35], s49 offen sc1
    s_waitcnt lgkmcnt(2)
    v_smfmac_f32_16x16x64_bf16 v[116:119], v[64:67], v[12:19], v0
    v_cvt_pk_bf16_f32 v100, v112, v113
    s_waitcnt lgkmcnt(0)
    v_smfmac_f32_16x16x64_bf16 v[116:119], v[68:71], v[120:127], v0
    v_cvt_pk_bf16_f32 v101, v114, v115
    buffer_store_dwordx2 v[100:101], v1, s[32:35], s50 offen sc1
    s_nop 5
    v_cvt_pk_bf16_f32 v102, v116, v117
    v_cvt_pk_bf16_f32 v103, v118, v119
    buffer_store_dwordx2 v[102:103], v1, s[32:35], s51 offen sc1
    v_mov_b64 v[104:105], 0
    v_mov_b64 v[106:107], 0
    v_mov_b64 v[108:109], 0
    v_mov_b64 v[110:111], 0
    v_mov_b64 v[112:113], 0
    v_mov_b64 v[114:115], 0
    v_mov_b64 v[116:117], 0
    v_mov_b64 v[118:119], 0
    s_xor_b32 s48, s48, 0x40000
    s_xor_b32 s49, s49, 0x40000
    s_xor_b32 s50, s50, 0x40000
    s_xor_b32 s51, s51, 0x40000
    v_mov_b32 v46, s45
    ds_read_b128 v[56:59], v8 offset:49152
    ds_read_b128 v[60:63], v8 offset:50176
    ds_read_b128 v[64:67], v8 offset:57344
    ds_read_b128 v[68:71], v8 offset:58368
    ds_read_b128 v[72:75], v8 offset:16384
    ds_read_b128 v[76:79], v8 offset:17408
    ds_read_b128 v[88:91], v8 offset:32768
    ds_read_b128 v[92:95], v8 offset:33792
    ds_read_b128 v[12:15], v8 offset:0
    ds_read_b128 v[16:19], v8 offset:1024
    ds_read_b128 v[120:123], v8 offset:8192
    ds_read_b128 v[124:127], v8 offset:9216
    buffer_load_dwordx4 v[24:27], v2, s[32:35], s43 offen offset:0 sc1
    buffer_load_dwordx4 v[28:31], v2, s[32:35], s43 offen offset:1024 sc1
    ds_read_b128 v[96:99], v8 offset:40960
    ds_read_b128 v[100:103], v8 offset:41984
    s_nop 11
    s_mov_b32 s60, 0
L_poll_86:
    buffer_load_dwordx4 v[24:27], v2, s[32:35], s43 offen offset:0 sc1
    buffer_load_dwordx4 v[28:31], v2, s[32:35], s43 offen offset:1024 sc1
    s_add_u32 s60, s60, 1
    s_cmp_gt_u32 s60, 64
    s_cbranch_scc1 L_pexact_87
    s_waitcnt vmcnt(2)
    v_max3_u32 v47, v24, v25, v26
    v_max3_u32 v47, v47, v27, v28
    v_max3_u32 v47, v47, v29, v30
    v_max_u32 v47, v47, v31
    v_cmp_le_u32 vcc, s45, v47
    s_nop 0
    s_and_b64 exec, exec, vcc
    s_cbranch_scc1 L_poll_86
L_pout_88:
    s_mov_b64 exec, -1
    v_mfma_f32_16x16x32_bf16 v[84:87], v[80:83], v[24:27], 0
    v_mfma_f32_16x16x32_bf16 v[84:87], v[80:83], v[28:31], v[84:87]
    s_nop 7
    v_add_f32_dpp v84, v84, v84 row_ror:8 row_mask:0xf bank_mask:0xf
    v_add_f32_dpp v85, v85, v85 row_ror:8 row_mask:0xf bank_mask:0xf
    s_nop 0
    v_add_f32_dpp v84, v84, v84 row_ror:4 row_mask:0xf bank_mask:0xf
    v_add_f32_dpp v85, v85, v85 row_ror:4 row_mask:0xf bank_mask:0xf
    v_cvt_pk_bf16_f32 v44, v84, v85
    buffer_store_dword v44, v3, s[32:35], s52 offen sc1
    buffer_store_dword v46, v3, s[32:35], s53 offen sc1
    ds_read_b128 v[80:83], v8 offset:24576
    ds_read_b128 v[84:87], v8 offset:25600
    s_add_u32 s42, s42, 1
    s_xor_b32 s43, s43, 0x40000
    s_add_u32 s52, s52, 8192
    s_and_b32 s52, s52, 0x7fff
    s_add_u32 s53, s53, 8192
    s_and_b32 s53, s53, 0x7fff
    s_add_u32 s58, s58, 131072
    s_nop 15
    s_nop 15
    s_nop 7
    buffer_load_dwordx4 v[48:51], v10, s[32:35], s55 offen offset:0 sc1
    buffer_load_dwordx4 v[52:55], v10, s[32:35], s55 offen offset:1024 sc1
    s_branch L_chain_loop_w2_80
L_chain_last_81:
    s_waitcnt vmcnt(0)
    ds_read_b128 v[40:43], v10 offset:4096
    ds_read_b128 v[44:47], v10 offset:5120
    ds_read_b128 v[48:51], v10 offset:6144
    ds_read_b128 v[52:55], v10 offset:7168
    v_mov_b64 v[120:121], 0
    v_mov_b64 v[122:123], 0
    v_mov_b64 v[124:125], 0
    v_mov_b64 v[126:127], 0
    s_waitcnt lgkmcnt(7)
    v_smfmac_f32_16x16x64_bf16 v[112:115], v[24:27], a[64:71], v0
    v_smfmac_f32_16x16x64_bf16 v[116:119], v[24:27], a[72:79], v0
    v_smfmac_f32_16x16x64_bf16 v[120:123], v[24:27], a[192:199], v0
    v_smfmac_f32_16x16x64_bf16 v[124:127], v[24:27], a[200:207], v0
    s_waitcnt lgkmcnt(6)
    v_smfmac_f32_16x16x64_bf16 v[112:115], v[28:31], a[80:87], v0
    v_smfmac_f32_16x16x64_bf16 v[116:119], v[28:31], a[88:95], v0
    v_smfmac_f32_16x16x64_bf16 v[120:123], v[28:31], a[208:215], v0
    v_smfmac_f32_16x16x64_bf16 v[124:127], v[28:31], a[216:223], v0
    s_waitcnt lgkmcnt(5)
    v_smfmac_f32_16x16x64_bf16 v[112:115], v[32:35], a[96:103], v0
    v_smfmac_f32_16x16x64_bf16 v[116:119], v[32:35], a[104:111], v0
    v_smfmac_f32_16x16x64_bf16 v[120:123], v[32:35], a[224:231], v0
    v_smfmac_f32_16x16x64_bf16 v[124:127], v[32:35], a[232:239], v0
    s_waitcnt lgkmcnt(4)
    v_smfmac_f32_16x16x64_bf16 v[112:115], v[36:39], a[112:119], v0
    v_smfmac_f32_16x16x64_bf16 v[116:119], v[36:39], a[120:127], v0
    v_smfmac_f32_16x16x64_bf16 v[120:123], v[36:39], a[240:247], v0
    v_smfmac_f32_16x16x64_bf16 v[124:127], v[36:39], a[248:255], v0
    s_waitcnt lgkmcnt(3)
    v_smfmac_f32_16x16x64_bf16 v[112:115], v[40:43], a[128:135], v0
    v_smfmac_f32_16x16x64_bf16 v[116:119], v[40:43], a[136:143], v0
    v_smfmac_f32_16x16x64_bf16 v[120:123], v[40:43], v[128:135], v0
    v_smfmac_f32_16x16x64_bf16 v[124:127], v[40:43], v[136:143], v0
    s_waitcnt lgkmcnt(2)
    v_smfmac_f32_16x16x64_bf16 v[112:115], v[44:47], a[144:151], v0
    v_smfmac_f32_16x16x64_bf16 v[116:119], v[44:47], a[152:159], v0
    v_smfmac_f32_16x16x64_bf16 v[120:123], v[44:47], v[144:151], v0
    v_smfmac_f32_16x16x64_bf16 v[124:127], v[44:47], v[152:159], v0
    s_waitcnt lgkmcnt(1)
    v_smfmac_f32_16x16x64_bf16 v[112:115], v[48:51], a[160:167], v0
    v_smfmac_f32_16x16x64_bf16 v[116:119], v[48:51], a[168:175], v0
    v_smfmac_f32_16x16x64_bf16 v[120:123], v[48:51], v[160:167], v0
    v_smfmac_f32_16x16x64_bf16 v[124:127], v[48:51], v[168:175], v0
    s_waitcnt lgkmcnt(0)
    v_smfmac_f32_16x16x64_bf16 v[112:115], v[52:55], a[176:183], v0
    v_smfmac_f32_16x16x64_bf16 v[116:119], v[52:55], a[184:191], v0
    v_smfmac_f32_16x16x64_bf16 v[120:123], v[52:55], v[176:183], v0
    v_smfmac_f32_16x16x64_bf16 v[124:127], v[52:55], v[184:191], v0
    v_add_f32 v112, v112, v114
    v_add_f32 v113, v113, v115
    v_cvt_pk_bf16_f32 v21, v112, v113
    v_add_f32 v116, v116, v118
    v_add_f32 v117, v117, v119
    v_cvt_pk_bf16_f32 v23, v116, v117
    v_add_f32 v120, v120, v122
    v_add_f32 v121, v121, v123
    v_cvt_pk_bf16_f32 v20, v120, v121
    v_add_f32 v124, v124, v126
    v_add_f32 v125, v125, v127
    v_cvt_pk_bf16_f32 v22, v124, v125
    buffer_store_dwordx4 v[20:23], v10, s[32:35], s58 offen offset:2048 sc1
    s_waitcnt vmcnt(0)
    s_barrier
    s_endpgm
L_pexact_83:
    s_add_u32 s59, s59, 1
    s_cmp_gt_u32 s59, 262144
    s_cbranch_scc1 L_chain_abort_1
    s_waitcnt vmcnt(0)
    v_cmp_eq_u32 vcc, s45, v48
    v_cmp_eq_u32 s[100:101], s45, v49
    s_nop 0
    s_or_b64 vcc, vcc, s[100:101]
    v_cmp_eq_u32 s[100:101], s45, v50
    s_nop 0
    s_or_b64 vcc, vcc, s[100:101]
    v_cmp_eq_u32 s[100:101], s45, v51
    s_nop 0
    s_or_b64 vcc, vcc, s[100:101]
    v_cmp_eq_u32 s[100:101], s45, v52
    s_nop 0
    s_or_b64 vcc, vcc, s[100:101]
    v_cmp_eq_u32 s[100:101], s45, v53
    s_nop 0
    s_or_b64 vcc, vcc, s[100:101]
    v_cmp_eq_u32 s[100:101], s45, v54
    s_nop 0
    s_or_b64 vcc, vcc, s[100:101]
    v_cmp_eq_u32 s[100:101], s45, v55
    s_nop 0
    s_or_b64 vcc, vcc, s[100:101]
    ds_write_b128 v10, v[48:51] offset:4096
    ds_write_b128 v10, v[52:55] offset:5120
    s_and_b64 exec, exec, vcc
    s_cbranch_scc0 L_pout_84
    buffer_load_dwordx4 v[48:51], v10, s[32:35], s55 offen offset:0 sc1
    buffer_load_dwordx4 v[52:55], v10, s[32:35], s55 offen offset:1024 sc1
    s_branch L_pexact_83
L_pexact_87:
    s_add_u32 s59, s59, 1
    s_cmp_gt_u32 s59, 262144
    s_cbranch_scc1 L_chain_abort_1
    s_waitcnt vmcnt(0)
    v_cmp_eq_u32 vcc, s45, v24
    v_cmp_eq_u32 s[100:101], s45, v25
    s_nop 0
    s_or_b64 vcc, vcc, s[100:101]
    v_cmp_eq_u32 s[100:101], s45, v26
    s_nop 0
    s_or_b64 vcc, vcc, s[100:101]
    v_cmp_eq_u32 s[100:101], s45, v27
    s_nop 0
    s_or_b64 vcc, vcc, s[100:101]
    v_cmp_eq_u32 s[100:101], s45, v28
    s_nop 0
    s_or_b64 vcc, vcc, s[100:101]
    v_cmp_eq_u32 s[100:101], s45, v29
    s_nop 0
    s_or_b64 vcc, vcc, s[100:101]
    v_cmp_eq_u32 s[100:101], s45, v30
    s_nop 0
    s_or_b64 vcc, vcc, s[100:101]
    v_cmp_eq_u32 s[100:101], s45, v31
    s_nop 0
    s_or_b64 vcc, vcc, s[100:101]
    s_and_b64 exec, exec, vcc
    s_cbranch_scc0 L_pout_88
    buffer_load_dwordx4 v[24:27], v2, s[32:35], s43 offen offset:0 sc1
    buffer_load_dwordx4 v[28:31], v2, s[32:35], s43 offen offset:1024 sc1
    s_branch L_pexact_87
L_cl_1_3_15:
    buffer_load_dwordx4 v[48:51], v10, s[32:35], s55 offen offset:2048 sc1
    buffer_load_dwordx4 v[52:55], v10, s[32:35], s55 offen offset:3072 sc1
L_chain_loop_w3_90:
    s_mov_b32 s60, 0
L_poll_92:
    buffer_load_dwordx4 v[48:51], v10, s[32:35], s55 offen offset:2048 sc1
    buffer_load_dwordx4 v[52:55], v10, s[32:35], s55 offen offset:3072 sc1
    s_add_u32 s60, s60, 1
    s_cmp_gt_u32 s60, 64
    s_cbranch_scc1 L_pexact_93
    s_waitcnt vmcnt(2)
    v_max3_u32 v47, v48, v49, v50
    v_max3_u32 v47, v47, v51, v52
    ds_write_b128 v10, v[48:51] offset:6144
    v_max3_u32 v47, v47, v53, v54
    v_max_u32 v47, v47, v55
    ds_write_b128 v10, v[52:55] offset:7168
    v_cmp_le_u32 vcc, s45, v47
    s_nop 0
    s_and_b64 exec, exec, vcc
    s_cbranch_scc1 L_poll_92
L_pout_94:
    s_mov_b64 exec, -1
    s_waitcnt lgkmcnt(0)
    s_barrier
    ds_read_b128 v[24:27], v10 offset:0
    ds_read_b128 v[28:31], v10 offset:1024
    ds_read_b128 v[32:35], v10 offset:2048
    ds_read_b128 v[36:39], v10 offset:3072
    s_cmp_eq_u32 s42, 63
    s_cbranch_scc1 L_chain_last_91
    s_waitcnt lgkmcnt(3)
    v_smfmac_f32_16x16x64_bf16 v[104:107], v[24:27], v[12:19], v0
    v_smfmac_f32_16x16x64_bf16 v[108:111], v[24:27], v[120:127], v0
    ds_read_b128 v[12:15], v10 offset:22528
    s_waitcnt lgkmcnt(3)
    v_smfmac_f32_16x16x64_bf16 v[104:107], v[28:31], v[72:79], v0
    ds_read_b128 v[16:19], v10 offset:23552
    v_smfmac_f32_16x16x64_bf16 v[108:111], v[28:31], v[80:87], v0
    ds_read_b128 v[72:75], v10 offset:8192
    s_waitcnt lgkmcnt(4)
    v_smfmac_f32_16x16x64_bf16 v[104:107], v[32:35], v[88:95], v0
    ds_read_b128 v[76:79], v10 offset:9216
    v_smfmac_f32_16x16x64_bf16 v[108:111], v[32:35], v[96:103], v0
    ds_read_b128 v[80:83], v10 offset:10240
    s_waitcnt lgkmcnt(5)
    v_smfmac_f32_16x16x64_bf16 v[104:107], v[36:39], v[56:63], v0
    ds_read_b128 v[84:87], v10 offset:11264
    v_smfmac_f32_16x16x64_bf16 v[108:111], v[36:39], v[64:71], v0
    ds_read_b128 v[88:91], v10 offset:12288
    v_smfmac_f32_16x16x64_bf16 v[112:115], v[24:27], a[64:71], v0
    ds_read_b128 v[92:95], v10 offset:13312
    v_smfmac_f32_16x16x64_bf16 v[116:119], v[24:27], a[72:79], v0
    ds_read_b128 v[96:99], v10 offset:14336
    v_smfmac_f32_16x16x64_bf16 v[112:115], v[28:31], a[80:87], v0
    ds_read_b128 v[100:103], v10 offset:15360
    v_smfmac_f32_16x16x64_bf16 v[116:119], v[28:31], a[88:95], v0
    s_waitcnt vmcnt(0)
    ds_read_b128 v[40:43], v10 offset:4096
    v_smfmac_f32_16x16x64_bf16 v[112:115], v[32:35], a[96:103], v0
    s_waitcnt vmcnt(0)
    s_mov_b32 m0, 145408
    ds_read_b128 v[44:47], v10 offset:5120
    v_smfmac_f32_16x16x64_bf16 v[116:119], v[32:35], a[104:111], v0
    s_waitcnt lgkmcnt(2)
    s_barrier
    v_smfmac_f32_16x16x64_bf16 v[112:115], v[36:39], a[112:119], v0
    ds_read_b128 v[48:51], v10 offset:6144
    v_mov_b64 v[120:121], 0
    v_smfmac_f32_16x16x64_bf16 v[116:119], v[36:39], a[120:127], v0
    ds_read_b128 v[52:55], v10 offset:7168
    v_mov_b64 v[122:123], 0
    s_waitcnt lgkmcnt(3)
    v_smfmac_f32_16x16x64_bf16 v[104:107], v[40:43], a[0:7], v0
    v_mov_b64 v[124:125], 0
    v_smfmac_f32_16x16x64_bf16 v[108:111], v[40:43], a[8:15], v0
    buffer_load_dwordx4 v10, s[32:35], s56 offen sc1 lds
    v_mov_b64 v[126:127], 0
    v_smfmac_f32_16x16x64_bf16 v[112:115], v[40:43], a[128:135], v0
    v_smfmac_f32_16x16x64_bf16 v[116:119], v[40:43], a[136:143], v0
    s_waitcnt lgkmcnt(2)
    v_smfmac_f32_16x16x64_bf16 v[104:107], v[44:47], a[16:23], v0
    v_mov_b32 v56, s45
    v_smfmac_f32_16x16x64_bf16 v[108:111], v[44:47], a[24:31], v0
    buffer_load_dwordx4 v10, s[32:35], s56 offen offset:1024 sc1 lds
    s_mov_b32 m0, 153600
    v_mov_b32 v57, s45
    v_smfmac_f32_16x16x64_bf16 v[112:115], v[44:47], a[144:151], v0
    v_mov_b64 v[58:59], v[56:57]
    v_smfmac_f32_16x16x64_bf16 v[116:119], v[44:47], a[152:159], v0
    s_waitcnt lgkmcnt(1)
    v_smfmac_f32_16x16x64_bf16 v[104:107], v[48:51], a[32:39], v0
    v_smfmac_f32_16x16x64_bf16 v[108:111], v[48:51], a[40:47], v0
    buffer_load_dwordx4 v10, s[32:35], s69 offen sc1 lds
    s_waitcnt lgkmcnt(0)
    v_smfmac_f32_16x16x64_bf16 v[104:107], v[52:55], a[48:55], v0
    v_smfmac_f32_16x16x64_bf16 v[108:111], v[52:55], a[56:63], v0
    v_smfmac_f32_16x16x64_bf16 v[112:115], v[48:51], a[160:167], v0
    v_smfmac_f32_16x16x64_bf16 v[116:119], v[48:51], a[168:175], v0
    buffer_load_dwordx4 v10, s[32:35], s69 offen offset:1024 sc1 lds
    v_add_f32 v104, v104, v106
    v_smfmac_f32_16x16x64_bf16 v[112:115], v[52:55], a[176:183], v0
    v_add_f32 v105, v105, v107
    v_smfmac_f32_16x16x64_bf16 v[116:119], v[52:55], a[184:191], v0
    v_add_f32 v108, v108, v110
    v_smfmac_f32_16x16x64_bf16 v[120:123], v[24:27], a[192:199], v0
    v_add_f32 v109, v109, v111
    v_smfmac_f32_16x16x64_bf16 v[124:127], v[24:27], a[200:207], v0
    v_cvt_pk_bf16_f32 v104, v104, v105
    v_add_f32 v112, v112, v114
    v_add_f32 v113, v113, v115
    v_cvt_pk_bf16_f32 v21, v112, v113
    ds_write2_b32 v4, v21, v104 offset0:0 offset1:1
    v_pk_add_f32 v[116:117], v[116:117], v[118:119]
    v_cvt_pk_bf16_f32 v108, v108, v109
    v_cvt_pk_bf16_f32 v23, v116, v117
    ds_write2_b32 v4, v23, v108 offset0:128 offset1:129
    v_smfmac_f32_16x16x64_bf16 v[120:123], v[28:31], a[208:215], v0
    v_smfmac_f32_16x16x64_bf16 v[124:127], v[28:31], a[216:223], v0
    buffer_store_dwordx4 v[56:59], v2, s[32:35], s57 offen offset:1024 sc1
    v_smfmac_f32_16x16x64_bf16 v[120:123], v[32:35], a[224:231], v0
    v_smfmac_f32_16x16x64_bf16 v[124:127], v[32:35], a[232:239], v0
    buffer_store_dwordx4 v[56:59], v2, s[32:35], s57 offen offset:0 sc1
    s_waitcnt lgkmcnt(0)
    s_barrier
    ds_read_b64_tr_b16 v[56:57], v5 offset:0
    ds_read_b64_tr_b16 v[58:59], v5 offset:256
    v_smfmac_f32_16x16x64_bf16 v[120:123], v[36:39], a[240:247], v0
    ds_read_b64_tr_b16 v[60:61], v5 offset:1024
    ds_read_b64_tr_b16 v[62:63], v5 offset:1280
    v_smfmac_f32_16x16x64_bf16 v[124:127], v[36:39], a[248:255], v0
    ds_read_b64_tr_b16 v[64:65], v5 offset:2048
    ds_read_b64_tr_b16 v[66:67], v5 offset:2304
    v_smfmac_f32_16x16x64_bf16 v[120:123], v[40:43], v[128:135], v0
    ds_read_b64_tr_b16 v[68:69], v5 offset:3072
    ds_read_b64_tr_b16 v[70:71], v5 offset:3328
    v_smfmac_f32_16x16x64_bf16 v[124:127], v[40:43], v[136:143], v0
    s_waitcnt lgkmcnt(6)
    v_mfma_f32_16x16x32_bf16 v[112:115], v[56:59], v[56:59], 0
    ds_read_b128 v[24:27], v9 offset:0
    v_mfma_f32_16x16x32_bf16 v[104:107], v[72:75], v[56:59], 0
    ds_read_b128 v[28:31], v9 offset:1024
    v_mfma_f32_16x16x32_bf16 v[108:111], v[88:91], v[56:59], 0
    s_waitcnt lgkmcnt(6)
    v_mfma_f32_16x16x32_bf16 v[112:115], v[60:63], v[60:63], v[112:115]
    ds_read_b128 v[32:35], v9 offset:8192
    v_mfma_f32_16x16x32_bf16 v[104:107], v[76:79], v[60:63], v[104:107]
    ds_read_b128 v[36:39], v9 offset:9216
    v_mfma_f32_16x16x32_bf16 v[108:111], v[92:95], v[60:63], v[108:111]
    s_waitcnt lgkmcnt(6)
    v_mfma_f32_16x16x32_bf16 v[112:115], v[64:67], v[64:67], v[112:115]
    ds_read_b128 v[72:75], v9 offset:16384
    v_mfma_f32_16x16x32_bf16 v[104:107], v[80:83], v[64:67], v[104:107]
    ds_read_b128 v[76:79], v9 offset:17408
    v_mfma_f32_16x16x32_bf16 v[108:111], v[96:99], v[64:67], v[108:111]
    s_waitcnt lgkmcnt(6)
    v_mfma_f32_16x16x32_bf16 v[112:115], v[68:71], v[68:71], v[112:115]
    ds_read_b128 v[88:91], v9 offset:24576
    v_mfma_f32_16x16x32_bf16 v[104:107], v[84:87], v[68:71], v[104:107]
    ds_read_b128 v[92:95], v9 offset:25600
    v_mfma_f32_16x16x32_bf16 v[108:111], v[100:103], v[68:71], v[108:111]
    v_smfmac_f32_16x16x64_bf16 v[120:123], v[44:47], v[144:151], v0
    v_mov_b32 v84, 0x3f803f80
    v_smfmac_f32_16x16x64_bf16 v[124:127], v[44:47], v[152:159], v0
    v_max3_f32 v116, v112, v113, v104
    v_max3_f32 v117, v105, v106, v107
    v_max3_f32 v116, v116, v108, v109
    v_max3_f32 v117, v117, v110, v111
    v_max_f32 v116, v116, v117
    v_max_f32 v117, v116, v117
    v_smfmac_f32_16x16x64_bf16 v[120:123], v[48:51], v[160:167], v0
    v_permlane32_swap_b32 v116, v117
    v_max_f32 v116, v116, v117
    v_max_f32 v117, v116, v117
    v_smfmac_f32_16x16x64_bf16 v[124:127], v[48:51], v[168:175], v0
    v_permlane16_swap_b32 v116, v117
    v_smfmac_f32_16x16x64_bf16 v[120:123], v[52:55], v[176:183], v0
    v_max_f32 v116, v116, v117
    v_smfmac_f32_16x16x64_bf16 v[124:127], v[52:55], v[184:191], v0
    v_mul_f32 v116, s44, v116
    v_mov_b32 v85, 0x3f803f80
    v_pk_fma_f32 v[104:105], v[104:105], s[66:67], v[116:117] op_sel_hi:[1,1,0] neg_lo:[0,0,1] neg_hi:[0,0,1]
    v_pk_fma_f32 v[106:107], v[106:107], s[66:67], v[116:117] op_sel_hi:[1,1,0] neg_lo:[0,0,1] neg_hi:[0,0,1]
    v_exp_f32 v104, v104
    v_exp_f32 v105, v105
    v_pk_fma_f32 v[108:109], v[108:109], s[66:67], v[116:117] op_sel_hi:[1,1,0] neg_lo:[0,0,1] neg_hi:[0,0,1]
    v_exp_f32 v106, v106
    v_exp_f32 v107, v107
    v_pk_fma_f32 v[110:111], v[110:111], s[66:67], v[116:117] op_sel_hi:[1,1,0] neg_lo:[0,0,1] neg_hi:[0,0,1]
    v_cvt_pk_bf16_f32 v60, v104, v105
    v_exp_f32 v108, v108
    v_exp_f32 v109, v109
    v_cvt_pk_bf16_f32 v61, v106, v107
    v_pk_fma_f32 v[112:113], v[112:113], s[66:67], v[116:117] op_sel_hi:[1,1,0] neg_lo:[0,0,1] neg_hi:[0,0,1]
    v_exp_f32 v110, v110
    v_exp_f32 v111, v111
    v_cvt_pk_bf16_f32 v62, v108, v109
    v_exp_f32 v112, v112
    v_cvt_pk_bf16_f32 v63, v110, v111
    v_exp_f32 v113, v113
    v_mov_b64 v[86:87], v[84:85]
    v_mfma_f32_16x16x32_bf16 v[96:99], v[12:15], v[60:63], 0
    v_cvt_pk_bf16_f32 v56, v112, v113
    v_mov_b32 v57, 0
    v_mfma_f32_16x16x32_bf16 v[80:83], v[84:87], v[60:63], 0
    v_add_f32 v120, v120, v122
    v_add_f32 v121, v121, v123
    v_mfma_f32_16x16x32_bf16 v[100:103], v[16:19], v[60:63], 0
    v_cvt_pk_bf16_f32 v20, v120, v121
    v_add_f32 v124, v124, v126
    v_add_f32 v125, v125, v127
    v_mfma_f32_16x16x16_bf16 v[96:99], v[20:21], v[56:57], v[96:99]
    v_cvt_pk_bf16_f32 v22, v124, v125
    v_mfma_f32_16x16x16_bf16 v[80:83], v[84:85], v[56:57], v[80:83]
    s_nop 0
    v_mfma_f32_16x16x16_bf16 v[100:103], v[22:23], v[56:57], v[100:103]
    ds_read_b128 v[40:43], v9 offset:32768
    ds_read_b128 v[44:47], v9 offset:33792
    s_nop 3
    v_rcp_f32 v118, v80
    s_mov_b64 exec, s[70:71]
    v_pk_mul_f32 v[96:97], v[96:97], v[118:119] op_sel_hi:[1,0]
    v_cvt_pk_bf16_f32 v96, v96, v97
    v_pk_mul_f32 v[98:99], v[98:99], v[118:119] op_sel_hi:[1,0]
    v_cvt_pk_bf16_f32 v97, v98, v99
    v_pk_mul_f32 v[100:101], v[100:101], v[118:119] op_sel_hi:[1,0]
    v_cvt_pk_bf16_f32 v98, v100, v101
    v_pk_mul_f32 v[102:103], v[102:103], v[118:119] op_sel_hi:[1,0]
    v_cvt_pk_bf16_f32 v99, v102, v103
    ds_write2_b64 v6, v[96:97], v[98:99] offset0:0 offset1:4
    s_mov_b64 exec, -1
    buffer_store_dwordx4 v[20:23], v10, s[32:35], s58 offen offset:3072 sc1
    v_mov_b64 v[104:105], 0
    v_mov_b64 v[106:107], 0
    v_mov_b64 v[108:109], 0
    v_mov_b64 v[110:111], 0
    v_mov_b64 v[112:113], 0
    v_mov_b64 v[114:115], 0
    v_mov_b64 v[116:117], 0
    v_mov_b64 v[118:119], 0
    s_waitcnt lgkmcnt(0)
    s_barrier
    ds_read_b128 v[56:59], v7 offset:0
    ds_read_b128 v[60:63], v7 offset:64
    ds_read_b128 v[64:67], v7 offset:128
    ds_read_b128 v[68:71], v7 offset:192
    s_add_u32 s54, s52, 131072
    s_add_u32 s55, s54, 4096
    s_cmp_lt_u32 s42, 62
    s_cselect_b32 s60, 262144, 0
    s_add_u32 s56, s56, s60
    s_add_u32 s69, s69, s60
    s_mov_b32 s57, s43
    s_waitcnt lgkmcnt(3)
    v_smfmac_f32_16x16x64_bf16 v[104:107], v[56:59], v[192:199], v0
    v_mov_b32 v20, 0x3f80
    v_smfmac_f32_16x16x64_bf16 v[108:111], v[56:59], v[224:231], v0
    v_mov_b32 v21, 0x3f800000
    s_waitcnt lgkmcnt(2)
    v_smfmac_f32_16x16x64_bf16 v[104:107], v[60:63], v[200:207], v0
    ds_read_b128 v[48:51], v9 offset:40960
    v_cndmask_b32 v20, v20, v21, s[46:47]
    v_smfmac_f32_16x16x64_bf16 v[108:111], v[60:63], v[232:239], v0
    ds_read_b128 v[52:55], v9 offset:41984
    v_cndmask_b32 v80, 0, v20, s[92:93]
    s_waitcnt lgkmcnt(3)
    v_smfmac_f32_16x16x64_bf16 v[104:107], v[64:67], v[208:215], v0
    ds_read_b128 v[12:15], v9 offset:49152
    v_cndmask_b32 v81, 0, v20, s[94:95]
    v_smfmac_f32_16x16x64_bf16 v[108:111], v[64:67], v[240:247], v0
    ds_read_b128 v[16:19], v9 offset:50176
    v_cndmask_b32 v82, 0, v20, s[96:97]
    s_waitcnt lgkmcnt(4)
    v_smfmac_f32_16x16x64_bf16 v[104:107], v[68:71], v[216:223], v0
    ds_read_b128 v[120:123], v9 offset:57344
    v_cndmask_b32 v83, 0, v20, s[98:99]
    v_smfmac_f32_16x16x64_bf16 v[108:111], v[68:71], v[248:255], v0
    ds_read_b128 v[124:127], v9 offset:58368
    v_smfmac_f32_16x16x64_bf16 v[112:115], v[56:59], v[24:31], v0
    v_smfmac_f32_16x16x64_bf16 v[112:115], v[60:63], v[32:39], v0
    v_cvt_pk_bf16_f32 v96, v104, v105
    v_smfmac_f32_16x16x64_bf16 v[112:115], v[64:67], v[72:79], v0
    v_cvt_pk_bf16_f32 v97, v106, v107
    v_smfmac_f32_16x16x64_bf16 v[112:115], v[68:71], v[88:95], v0
    buffer_store_dwordx2 v[96:97], v1, s[32:35], s48 offen sc1
    v_cvt_pk_bf16_f32 v98, v108, v109
    v_smfmac_f32_16x16x64_bf16 v[116:119], v[56:59], v[40:47], v0
    v_cvt_pk_bf16_f32 v99, v110, v111
    s_waitcnt lgkmcnt(4)
    v_smfmac_f32_16x16x64_bf16 v[116:119], v[60:63], v[48:55], v0
    buffer_store_dwordx2 v[98:99], v1, s[32:35], s49 offen sc1
    s_waitcnt lgkmcnt(2)
    v_smfmac_f32_16x16x64_bf16 v[116:119], v[64:67], v[12:19], v0
    v_cvt_pk_bf16_f32 v100, v112, v113
    s_waitcnt lgkmcnt(0)
    v_smfmac_f32_16x16x64_bf16 v[116:119], v[68:71], v[120:127], v0
    v_cvt_pk_bf16_f32 v101, v114, v115
    buffer_store_dwordx2 v[100:101], v1, s[32:35], s50 offen sc1
    s_nop 5
    v_cvt_pk_bf16_f32 v102, v116, v117
    v_cvt_pk_bf16_f32 v103, v118, v119
    buffer_store_dwordx2 v[102:103], v1, s[32:35], s51 offen sc1
    v_mov_b64 v[104:105], 0
    v_mov_b64 v[106:107], 0
    v_mov_b64 v[108:109], 0
    v_mov_b64 v[110:111], 0
    v_mov_b64 v[112:113], 0
    v_mov_b64 v[114:115], 0
    v_mov_b64 v[116:117], 0
    v_mov_b64 v[118:119], 0
    s_xor_b32 s48, s48, 0x40000
    s_xor_b32 s49, s49, 0x40000
    s_xor_b32 s50, s50, 0x40000
    s_xor_b32 s51, s51, 0x40000
    v_mov_b32 v46, s45
    ds_read_b128 v[56:59], v8 offset:49152
    ds_read_b128 v[60:63], v8 offset:50176
    ds_read_b128 v[64:67], v8 offset:57344
    ds_read_b128 v[68:71], v8 offset:58368
    ds_read_b128 v[72:75], v8 offset:16384
    ds_read_b128 v[76:79], v8 offset:17408
    ds_read_b128 v[88:91], v8 offset:32768
    ds_read_b128 v[92:95], v8 offset:33792
    ds_read_b128 v[12:15], v8 offset:0
    ds_read_b128 v[16:19], v8 offset:1024
    ds_read_b128 v[120:123], v8 offset:8192
    ds_read_b128 v[124:127], v8 offset:9216
    ds_read_b128 v[96:99], v8 offset:40960
    buffer_load_dwordx4 v[24:27], v2, s[32:35], s43 offen offset:0 sc1
    buffer_load_dwordx4 v[28:31], v2, s[32:35], s43 offen offset:1024 sc1
    ds_read_b128 v[100:103], v8 offset:41984
    s_nop 15
    s_mov_b32 s60, 0
L_poll_96:
    buffer_load_dwordx4 v[24:27], v2, s[32:35], s43 offen offset:0 sc1
    buffer_load_dwordx4 v[28:31], v2, s[32:35], s43 offen offset:1024 sc1
    s_add_u32 s60, s60, 1
    s_cmp_gt_u32 s60, 64
    s_cbranch_scc1 L_pexact_97
    s_waitcnt vmcnt(2)
    v_max3_u32 v47, v24, v25, v26
    v_max3_u32 v47, v47, v27, v28
    v_max3_u32 v47, v47, v29, v30
    v_max_u32 v47, v47, v31
    v_cmp_le_u32 vcc, s45, v47
    s_nop 0
    s_and_b64 exec, exec, vcc
    s_cbranch_scc1 L_poll_96
L_pout_98:
    s_mov_b64 exec, -1
    v_mfma_f32_16x16x32_bf16 v[84:87], v[80:83], v[24:27], 0
    v_mfma_f32_16x16x32_bf16 v[84:87], v[80:83], v[28:31], v[84:87]
    s_nop 7
    v_add_f32_dpp v84, v84, v84 row_ror:8 row_mask:0xf bank_mask:0xf
    v_add_f32_dpp v85, v85, v85 row_ror:8 row_mask:0xf bank_mask:0xf
    s_nop 0
    v_add_f32_dpp v84, v84, v84 row_ror:4 row_mask:0xf bank_mask:0xf
    v_add_f32_dpp v85, v85, v85 row_ror:4 row_mask:0xf bank_mask:0xf
    v_cvt_pk_bf16_f32 v44, v84, v85
    buffer_store_dword v44, v3, s[32:35], s52 offen sc1
    buffer_store_dword v46, v3, s[32:35], s53 offen sc1
    ds_read_b128 v[80:83], v8 offset:24576
    ds_read_b128 v[84:87], v8 offset:25600
    s_add_u32 s42, s42, 1
    s_xor_b32 s43, s43, 0x40000
    s_add_u32 s52, s52, 8192
    s_and_b32 s52, s52, 0x7fff
    s_add_u32 s53, s53, 8192
    s_and_b32 s53, s53, 0x7fff
    s_add_u32 s58, s58, 131072
    s_nop 15
    s_nop 13
    buffer_load_dwordx4 v[48:51], v10, s[32:35], s55 offen offset:2048 sc1
    buffer_load_dwordx4 v[52:55], v10, s[32:35], s55 offen offset:3072 sc1
    s_branch L_chain_loop_w3_90
L_chain_last_91:
    s_waitcnt vmcnt(0)
    ds_read_b128 v[40:43], v10 offset:4096
    ds_read_b128 v[44:47], v10 offset:5120
    ds_read_b128 v[48:51], v10 offset:6144
    ds_read_b128 v[52:55], v10 offset:7168
    v_mov_b64 v[120:121], 0
    v_mov_b64 v[122:123], 0
    v_mov_b64 v[124:125], 0
    v_mov_b64 v[126:127], 0
    s_waitcnt lgkmcnt(7)
    v_smfmac_f32_16x16x64_bf16 v[112:115], v[24:27], a[64:71], v0
    v_smfmac_f32_16x16x64_bf16 v[116:119], v[24:27], a[72:79], v0
    v_smfmac_f32_16x16x64_bf16 v[120:123], v[24:27], a[192:199], v0
    v_smfmac_f32_16x16x64_bf16 v[124:127], v[24:27], a[200:207], v0
    s_waitcnt lgkmcnt(6)
    v_smfmac_f32_16x16x64_bf16 v[112:115], v[28:31], a[80:87], v0
    v_smfmac_f32_16x16x64_bf16 v[116:119], v[28:31], a[88:95], v0
    v_smfmac_f32_16x16x64_bf16 v[120:123], v[28:31], a[208:215], v0
    v_smfmac_f32_16x16x64_bf16 v[124:127], v[28:31], a[216:223], v0
    s_waitcnt lgkmcnt(5)
    v_smfmac_f32_16x16x64_bf16 v[112:115], v[32:35], a[96:103], v0
    v_smfmac_f32_16x16x64_bf16 v[116:119], v[32:35], a[104:111], v0
    v_smfmac_f32_16x16x64_bf16 v[120:123], v[32:35], a[224:231], v0
    v_smfmac_f32_16x16x64_bf16 v[124:127], v[32:35], a[232:239], v0
    s_waitcnt lgkmcnt(4)
    v_smfmac_f32_16x16x64_bf16 v[112:115], v[36:39], a[112:119], v0
    v_smfmac_f32_16x16x64_bf16 v[116:119], v[36:39], a[120:127], v0
    v_smfmac_f32_16x16x64_bf16 v[120:123], v[36:39], a[240:247], v0
    v_smfmac_f32_16x16x64_bf16 v[124:127], v[36:39], a[248:255], v0
    s_waitcnt lgkmcnt(3)
    v_smfmac_f32_16x16x64_bf16 v[112:115], v[40:43], a[128:135], v0
    v_smfmac_f32_16x16x64_bf16 v[116:119], v[40:43], a[136:143], v0
    v_smfmac_f32_16x16x64_bf16 v[120:123], v[40:43], v[128:135], v0
    v_smfmac_f32_16x16x64_bf16 v[124:127], v[40:43], v[136:143], v0
    s_waitcnt lgkmcnt(2)
    v_smfmac_f32_16x16x64_bf16 v[112:115], v[44:47], a[144:151], v0
    v_smfmac_f32_16x16x64_bf16 v[116:119], v[44:47], a[152:159], v0
    v_smfmac_f32_16x16x64_bf16 v[120:123], v[44:47], v[144:151], v0
    v_smfmac_f32_16x16x64_bf16 v[124:127], v[44:47], v[152:159], v0
    s_waitcnt lgkmcnt(1)
    v_smfmac_f32_16x16x64_bf16 v[112:115], v[48:51], a[160:167], v0
    v_smfmac_f32_16x16x64_bf16 v[116:119], v[48:51], a[168:175], v0
    v_smfmac_f32_16x16x64_bf16 v[120:123], v[48:51], v[160:167], v0
    v_smfmac_f32_16x16x64_bf16 v[124:127], v[48:51], v[168:175], v0
    s_waitcnt lgkmcnt(0)
    v_smfmac_f32_16x16x64_bf16 v[112:115], v[52:55], a[176:183], v0
    v_smfmac_f32_16x16x64_bf16 v[116:119], v[52:55], a[184:191], v0
    v_smfmac_f32_16x16x64_bf16 v[120:123], v[52:55], v[176:183], v0
    v_smfmac_f32_16x16x64_bf16 v[124:127], v[52:55], v[184:191], v0
    v_add_f32 v112, v112, v114
    v_add_f32 v113, v113, v115
    v_cvt_pk_bf16_f32 v21, v112, v113
    v_add_f32 v116, v116, v118
    v_add_f32 v117, v117, v119
    v_cvt_pk_bf16_f32 v23, v116, v117
    v_add_f32 v120, v120, v122
    v_add_f32 v121, v121, v123
    v_cvt_pk_bf16_f32 v20, v120, v121
    v_add_f32 v124, v124, v126
    v_add_f32 v125, v125, v127
    v_cvt_pk_bf16_f32 v22, v124, v125
    buffer_store_dwordx4 v[20:23], v10, s[32:35], s58 offen offset:3072 sc1
    s_waitcnt vmcnt(0)
    s_barrier
    s_endpgm
L_pexact_93:
    s_add_u32 s59, s59, 1
    s_cmp_gt_u32 s59, 262144
    s_cbranch_scc1 L_chain_abort_1
    s_waitcnt vmcnt(0)
    v_cmp_eq_u32 vcc, s45, v48
    v_cmp_eq_u32 s[100:101], s45, v49
    s_nop 0
    s_or_b64 vcc, vcc, s[100:101]
    v_cmp_eq_u32 s[100:101], s45, v50
    s_nop 0
    s_or_b64 vcc, vcc, s[100:101]
    v_cmp_eq_u32 s[100:101], s45, v51
    s_nop 0
    s_or_b64 vcc, vcc, s[100:101]
    v_cmp_eq_u32 s[100:101], s45, v52
    s_nop 0
    s_or_b64 vcc, vcc, s[100:101]
    v_cmp_eq_u32 s[100:101], s45, v53
    s_nop 0
    s_or_b64 vcc, vcc, s[100:101]
    v_cmp_eq_u32 s[100:101], s45, v54
    s_nop 0
    s_or_b64 vcc, vcc, s[100:101]
    v_cmp_eq_u32 s[100:101], s45, v55
    s_nop 0
    s_or_b64 vcc, vcc, s[100:101]
    ds_write_b128 v10, v[48:51] offset:6144
    ds_write_b128 v10, v[52:55] offset:7168
    s_and_b64 exec, exec, vcc
    s_cbranch_scc0 L_pout_94
    buffer_load_dwordx4 v[48:51], v10, s[32:35], s55 offen offset:2048 sc1
    buffer_load_dwordx4 v[52:55], v10, s[32:35], s55 offen offset:3072 sc1
    s_branch L_pexact_93
L_pexact_97:
    s_add_u32 s59, s59, 1
    s_cmp_gt_u32 s59, 262144
    s_cbranch_scc1 L_chain_abort_1
    s_waitcnt vmcnt(0)
    v_cmp_eq_u32 vcc, s45, v24
    v_cmp_eq_u32 s[100:101], s45, v25
    s_nop 0
    s_or_b64 vcc, vcc, s[100:101]
    v_cmp_eq_u32 s[100:101], s45, v26
    s_nop 0
    s_or_b64 vcc, vcc, s[100:101]
    v_cmp_eq_u32 s[100:101], s45, v27
    s_nop 0
    s_or_b64 vcc, vcc, s[100:101]
    v_cmp_eq_u32 s[100:101], s45, v28
    s_nop 0
    s_or_b64 vcc, vcc, s[100:101]
    v_cmp_eq_u32 s[100:101], s45, v29
    s_nop 0
    s_or_b64 vcc, vcc, s[100:101]
    v_cmp_eq_u32 s[100:101], s45, v30
    s_nop 0
    s_or_b64 vcc, vcc, s[100:101]
    v_cmp_eq_u32 s[100:101], s45, v31
    s_nop 0
    s_or_b64 vcc, vcc, s[100:101]
    s_and_b64 exec, exec, vcc
    s_cbranch_scc0 L_pout_98
    buffer_load_dwordx4 v[24:27], v2, s[32:35], s43 offen offset:0 sc1
    buffer_load_dwordx4 v[28:31], v2, s[32:35], s43 offen offset:1024 sc1
    s_branch L_pexact_97
L_chain_abort_1:
    s_mov_b64 exec, 1
    s_waitcnt vmcnt(0)
    v_mov_b32 v30, 0xdead
    v_mov_b32 v31, 258048
    buffer_store_dword v30, v31, s[32:35], 0 offen sc1
    s_waitcnt vmcnt(0)
    s_endpgm
L_worker:
    s_mov_b32 s44, 0
    s_lshr_b32 s45, s2, 3
    s_mul_i32 s45, s45, 7
    s_add_u32 s45, s45, s3
    s_sub_u32 s41, s45, 1
    v_and_b32 v1, 63, v0
    v_lshlrev_b32 v2, 4, v1
    v_bfe_u32 v4, v1, 0, 1
    v_bfe_u32 v5, v1, 1, 1
    v_bfe_u32 v6, v1, 2, 1
    v_bfe_u32 v7, v1, 3, 1
    v_bfe_u32 v8, v1, 4, 1
    v_bfe_u32 v9, v1, 5, 1
    s_cmp_ge_u32 s41, 48
    s_cbranch_scc1 L_notqkv_101
    s_cmp_ge_u32 s41, 32
    s_cbranch_scc1 L_isq_102
    s_mov_b32 s42, s41
    s_mov_b32 s45, 0x0
    s_lshr_b32 s46, s42, 0
    s_and_b32 s46, s46, 0x1f
    s_mul_i32 s46, s46, 0x100
    s_add_u32 s45, s45, s46
    s_lshr_b32 s46, s40, 0
    s_and_b32 s46, s46, 0x3
    s_mul_i32 s46, s46, 0x8000
    s_add_u32 s45, s45, s46
    v_mov_b32 v10, s45
    s_mov_b32 s46, 0x10
    v_mad_u32_u24 v10, v4, s46, v10
    s_mov_b32 s46, 0x20
    v_mad_u32_u24 v10, v5, s46, v10
    s_mov_b32 s46, 0x40
    v_mad_u32_u24 v10, v6, s46, v10
    s_mov_b32 s46, 0x80
    v_mad_u32_u24 v10, v7, s46, v10
    s_mov_b32 s46, 0x2000
    v_mad_u32_u24 v10, v8, s46, v10
    s_mov_b32 s46, 0x4000
    v_mad_u32_u24 v10, v9, s46, v10
    s_mov_b32 s50, s10
    s_mov_b32 s51, s11
    s_lshl_b32 s47, s40, 10
    s_add_u32 s47, s47, 0
    s_mov_b32 m0, s47
    s_nop 0
    global_load_lds_dwordx4 v10, s[50:51]
    s_add_u32 s50, s50, 131072
    s_addc_u32 s51, s51, 0
    s_add_u32 s47, s47, 4096
    s_mov_b32 m0, s47
    s_nop 0
    global_load_lds_dwordx4 v10, s[50:51]
    s_add_u32 s50, s50, 131072
    s_addc_u32 s51, s51, 0
    s_add_u32 s47, s47, 4096
    s_mov_b32 m0, s47
    s_nop 0
    global_load_lds_dwordx4 v10, s[50:51]
    s_add_u32 s50, s50, 131072
    s_addc_u32 s51, s51, 0
    s_add_u32 s47, s47, 4096
    s_mov_b32 m0, s47
    s_nop 0
    global_load_lds_dwordx4 v10, s[50:51]
    s_add_u32 s50, s50, 131072
    s_addc_u32 s51, s51, 0
    s_add_u32 s47, s47, 4096
    s_mov_b32 m0, s47
    s_nop 0
    global_load_lds_dwordx4 v10, s[50:51]
    s_add_u32 s50, s50, 131072
    s_addc_u32 s51, s51, 0
    s_add_u32 s47, s47, 4096
    s_mov_b32 m0, s47
    s_nop 0
    global_load_lds_dwordx4 v10, s[50:51]
    s_add_u32 s50, s50, 131072
    s_addc_u32 s51, s51, 0
    s_add_u32 s47, s47, 4096
    s_mov_b32 m0, s47
    s_nop 0
    global_load_lds_dwordx4 v10, s[50:51]
    s_add_u32 s50, s50, 131072
    s_addc_u32 s51, s51, 0
    s_add_u32 s47, s47, 4096
    s_mov_b32 m0, s47
    s_nop 0
    global_load_lds_dwordx4 v10, s[50:51]
    s_add_u32 s50, s50, 131072
    s_addc_u32 s51, s51, 0
    s_add_u32 s47, s47, 4096
    s_mov_b32 m0, s47
    s_nop 0
    global_load_lds_dwordx4 v10, s[50:51]
    s_add_u32 s50, s50, 131072
    s_addc_u32 s51, s51, 0
    s_add_u32 s47, s47, 4096
    s_mov_b32 m0, s47
    s_nop 0
    global_load_lds_dwordx4 v10, s[50:51]
    s_add_u32 s50, s50, 131072
    s_addc_u32 s51, s51, 0
    s_add_u32 s47, s47, 4096
    s_mov_b32 m0, s47
    s_nop 0
    global_load_lds_dwordx4 v10, s[50:51]
    s_add_u32 s50, s50, 131072
    s_addc_u32 s51, s51, 0
    s_add_u32 s47, s47, 4096
    s_mov_b32 m0, s47
    s_nop 0
    global_load_lds_dwordx4 v10, s[50:51]
    s_add_u32 s50, s50, 131072
    s_addc_u32 s51, s51, 0
    s_add_u32 s47, s47, 4096
    s_mov_b32 m0, s47
    s_nop 0
    global_load_lds_dwordx4 v10, s[50:51]
    s_add_u32 s50, s50, 131072
    s_addc_u32 s51, s51, 0
    s_add_u32 s47, s47, 4096
    s_mov_b32 m0, s47
    s_nop 0
    global_load_lds_dwordx4 v10, s[50:51]
    s_add_u32 s50, s50, 131072
    s_addc_u32 s51, s51, 0
    s_add_u32 s47, s47, 4096
    s_mov_b32 m0, s47
    s_nop 0
    global_load_lds_dwordx4 v10, s[50:51]
    s_add_u32 s50, s50, 131072
    s_addc_u32 s51, s51, 0
    s_add_u32 s47, s47, 4096
    s_mov_b32 m0, s47
    s_nop 0
    global_load_lds_dwordx4 v10, s[50:51]
    s_add_u32 s50, s50, 131072
    s_addc_u32 s51, s51, 0
    s_add_u32 s47, s47, 4096
    s_mov_b32 m0, s47
    s_nop 0
    global_load_lds_dwordx4 v10, s[50:51]
    s_add_u32 s50, s50, 131072
    s_addc_u32 s51, s51, 0
    s_add_u32 s47, s47, 4096
    s_mov_b32 m0, s47
    s_nop 0
    global_load_lds_dwordx4 v10, s[50:51]
    s_add_u32 s50, s50, 131072
    s_addc_u32 s51, s51, 0
    s_add_u32 s47, s47, 4096
    s_mov_b32 m0, s47
    s_nop 0
    global_load_lds_dwordx4 v10, s[50:51]
    s_add_u32 s50, s50, 131072
    s_addc_u32 s51, s51, 0
    s_add_u32 s47, s47, 4096
    s_mov_b32 m0, s47
    s_nop 0
    global_load_lds_dwordx4 v10, s[50:51]
    s_add_u32 s50, s50, 131072
    s_addc_u32 s51, s51, 0
    s_add_u32 s47, s47, 4096
    s_mov_b32 m0, s47
    s_nop 0
    global_load_lds_dwordx4 v10, s[50:51]
    s_add_u32 s50, s50, 131072
    s_addc_u32 s51, s51, 0
    s_add_u32 s47, s47, 4096
    s_mov_b32 m0, s47
    s_nop 0
    global_load_lds_dwordx4 v10, s[50:51]
    s_add_u32 s50, s50, 131072
    s_addc_u32 s51, s51, 0
    s_add_u32 s47, s47, 4096
    s_mov_b32 m0, s47
    s_nop 0
    global_load_lds_dwordx4 v10, s[50:51]
    s_add_u32 s50, s50, 131072
    s_addc_u32 s51, s51, 0
    s_add_u32 s47, s47, 4096
    s_mov_b32 m0, s47
    s_nop 0
    global_load_lds_dwordx4 v10, s[50:51]
    s_add_u32 s50, s50, 131072
    s_addc_u32 s51, s51, 0
    s_add_u32 s47, s47, 4096
    s_mov_b32 m0, s47
    s_nop 0
    global_load_lds_dwordx4 v10, s[50:51]
    s_add_u32 s50, s50, 131072
    s_addc_u32 s51, s51, 0
    s_add_u32 s47, s47, 4096
    s_mov_b32 m0, s47
    s_nop 0
    global_load_lds_dwordx4 v10, s[50:51]
    s_add_u32 s50, s50, 131072
    s_addc_u32 s51, s51, 0
    s_add_u32 s47, s47, 4096
    s_mov_b32 m0, s47
    s_nop 0
    global_load_lds_dwordx4 v10, s[50:51]
    s_add_u32 s50, s50, 131072
    s_addc_u32 s51, s51, 0
    s_add_u32 s47, s47, 4096
    s_mov_b32 m0, s47
    s_nop 0
    global_load_lds_dwordx4 v10, s[50:51]
    s_add_u32 s50, s50, 131072
    s_addc_u32 s51, s51, 0
    s_add_u32 s47, s47, 4096
    s_mov_b32 m0, s47
    s_nop 0
    global_load_lds_dwordx4 v10, s[50:51]
    s_add_u32 s50, s50, 131072
    s_addc_u32 s51, s51, 0
    s_add_u32 s47, s47, 4096
    s_mov_b32 m0, s47
    s_nop 0
    global_load_lds_dwordx4 v10, s[50:51]
    s_add_u32 s50, s50, 131072
    s_addc_u32 s51, s51, 0
    s_add_u32 s47, s47, 4096
    s_mov_b32 m0, s47
    s_nop 0
    global_load_lds_dwordx4 v10, s[50:51]
    s_add_u32 s50, s50, 131072
    s_addc_u32 s51, s51, 0
    s_add_u32 s47, s47, 4096
    s_mov_b32 m0, s47
    s_nop 0
    global_load_lds_dwordx4 v10, s[50:51]
    s_add_u32 s50, s50, 131072
    s_addc_u32 s51, s51, 0
    s_add_u32 s47, s47, 4096
    s_waitcnt vmcnt(0)
    s_barrier
    s_mov_b32 s45, 0x0
    s_lshr_b32 s46, s40, 0
    s_and_b32 s46, s46, 0x3
    s_mul_i32 s46, s46, 0x40
    s_add_u32 s45, s45, s46
    v_mov_b32 v10, s45
    s_mov_b32 s46, 0x8
    v_mad_u32_u24 v10, v4, s46, v10
    s_mov_b32 s46, 0x10
    v_mad_u32_u24 v10, v5, s46, v10
    s_mov_b32 s46, 0x100
    v_mad_u32_u24 v10, v6, s46, v10
    s_mov_b32 s46, 0x200
    v_mad_u32_u24 v10, v7, s46, v10
    s_mov_b32 s46, 0x20
    v_mad_u32_u24 v10, v8, s46, v10
    s_mov_b32 s46, 0x800
    v_mad_u32_u24 v10, v9, s46, v10
    v_add_u32 v11, 0, v10
    ds_read_b64_tr_b16 a[0:1], v11 offset:0
    ds_read_b64_tr_b16 a[2:3], v11 offset:1024
    ds_read_b64_tr_b16 a[4:5], v11 offset:4096
    ds_read_b64_tr_b16 a[6:7], v11 offset:5120
    ds_read_b64_tr_b16 a[8:9], v11 offset:8192
    ds_read_b64_tr_b16 a[10:11], v11 offset:9216
    ds_read_b64_tr_b16 a[12:13], v11 offset:12288
    ds_read_b64_tr_b16 a[14:15], v11 offset:13312
    s_waitcnt lgkmcnt(0)
    ds_read_b64_tr_b16 a[16:17], v11 offset:16384
    ds_read_b64_tr_b16 a[18:19], v11 offset:17408
    ds_read_b64_tr_b16 a[20:21], v11 offset:20480
    ds_read_b64_tr_b16 a[22:23], v11 offset:21504
    ds_read_b64_tr_b16 a[24:25], v11 offset:24576
    ds_read_b64_tr_b16 a[26:27], v11 offset:25600
    ds_read_b64_tr_b16 a[28:29], v11 offset:28672
    ds_read_b64_tr_b16 a[30:31], v11 offset:29696
    s_waitcnt lgkmcnt(0)
    v_add_u32 v11, 32768, v10
    ds_read_b64_tr_b16 a[32:33], v11 offset:0
    ds_read_b64_tr_b16 a[34:35], v11 offset:1024
    ds_read_b64_tr_b16 a[36:37], v11 offset:4096
    ds_read_b64_tr_b16 a[38:39], v11 offset:5120
    ds_read_b64_tr_b16 a[40:41], v11 offset:8192
    ds_read_b64_tr_b16 a[42:43], v11 offset:9216
    ds_read_b64_tr_b16 a[44:45], v11 offset:12288
    ds_read_b64_tr_b16 a[46:47], v11 offset:13312
    s_waitcnt lgkmcnt(0)
    ds_read_b64_tr_b16 a[48:49], v11 offset:16384
    ds_read_b64_tr_b16 a[50:51], v11 offset:17408
    ds_read_b64_tr_b16 a[52:53], v11 offset:20480
    ds_read_b64_tr_b16 a[54:55], v11 offset:21504
    ds_read_b64_tr_b16 a[56:57], v11 offset:24576
    ds_read_b64_tr_b16 a[58:59], v11 offset:25600
    ds_read_b64_tr_b16 a[60:61], v11 offset:28672
    ds_read_b64_tr_b16 a[62:63], v11 offset:29696
    s_waitcnt lgkmcnt(0)
    v_add_u32 v11, 65536, v10
    ds_read_b64_tr_b16 a[64:65], v11 offset:0
    ds_read_b64_tr_b16 a[66:67], v11 offset:1024
    ds_read_b64_tr_b16 a[68:69], v11 offset:4096
    ds_read_b64_tr_b16 a[70:71], v11 offset:5120
    ds_read_b64_tr_b16 a[72:73], v11 offset:8192
    ds_read_b64_tr_b16 a[74:75], v11 offset:9216
    ds_read_b64_tr_b16 a[76:77], v11 offset:12288
    ds_read_b64_tr_b16 a[78:79], v11 offset:13312
    s_waitcnt lgkmcnt(0)
    ds_read_b64_tr_b16 a[80:81], v11 offset:16384
    ds_read_b64_tr_b16 a[82:83], v11 offset:17408
    ds_read_b64_tr_b16 a[84:85], v11 offset:20480
    ds_read_b64_tr_b16 a[86:87], v11 offset:21504
    ds_read_b64_tr_b16 a[88:89], v11 offset:24576
    ds_read_b64_tr_b16 a[90:91], v11 offset:25600
    ds_read_b64_tr_b16 a[92:93], v11 offset:28672
    ds_read_b64_tr_b16 a[94:95], v11 offset:29696
    s_waitcnt lgkmcnt(0)
    v_add_u32 v11, 98304, v10
    ds_read_b64_tr_b16 a[96:97], v11 offset:0
    ds_read_b64_tr_b16 a[98:99], v11 offset:1024
    ds_read_b64_tr_b16 a[100:101], v11 offset:4096
    ds_read_b64_tr_b16 a[102:103], v11 offset:5120
    ds_read_b64_tr_b16 a[104:105], v11 offset:8192
    ds_read_b64_tr_b16 a[106:107], v11 offset:9216
    ds_read_b64_tr_b16 a[108:109], v11 offset:12288
    ds_read_b64_tr_b16 a[110:111], v11 offset:13312
    s_waitcnt lgkmcnt(0)
    ds_read_b64_tr_b16 a[112:113], v11 offset:16384
    ds_read_b64_tr_b16 a[114:115], v11 offset:17408
    ds_read_b64_tr_b16 a[116:117], v11 offset:20480
    ds_read_b64_tr_b16 a[118:119], v11 offset:21504
    ds_read_b64_tr_b16 a[120:121], v11 offset:24576
    ds_read_b64_tr_b16 a[122:123], v11 offset:25600
    ds_read_b64_tr_b16 a[124:125], v11 offset:28672
    ds_read_b64_tr_b16 a[126:127], v11 offset:29696
    s_waitcnt lgkmcnt(0)
    s_waitcnt lgkmcnt(0)
    s_barrier
    s_mov_b32 s45, 0x0
    s_lshr_b32 s46, s42, 0
    s_and_b32 s46, s46, 0x1f
    s_mul_i32 s46, s46, 0x100
    s_add_u32 s45, s45, s46
    s_lshr_b32 s46, s40, 0
    s_and_b32 s46, s46, 0x3
    s_mul_i32 s46, s46, 0x8000
    s_add_u32 s45, s45, s46
    v_mov_b32 v10, s45
    s_mov_b32 s46, 0x10
    v_mad_u32_u24 v10, v4, s46, v10
    s_mov_b32 s46, 0x20
    v_mad_u32_u24 v10, v5, s46, v10
    s_mov_b32 s46, 0x40
    v_mad_u32_u24 v10, v6, s46, v10
    s_mov_b32 s46, 0x80
    v_mad_u32_u24 v10, v7, s46, v10
    s_mov_b32 s46, 0x2000
    v_mad_u32_u24 v10, v8, s46, v10
    s_mov_b32 s46, 0x4000
    v_mad_u32_u24 v10, v9, s46, v10
    s_mov_b32 s50, s12
    s_mov_b32 s51, s13
    s_lshl_b32 s47, s40, 10
    s_add_u32 s47, s47, 0
    s_mov_b32 m0, s47
    s_nop 0
    global_load_lds_dwordx4 v10, s[50:51]
    s_add_u32 s50, s50, 131072
    s_addc_u32 s51, s51, 0
    s_add_u32 s47, s47, 4096
    s_mov_b32 m0, s47
    s_nop 0
    global_load_lds_dwordx4 v10, s[50:51]
    s_add_u32 s50, s50, 131072
    s_addc_u32 s51, s51, 0
    s_add_u32 s47, s47, 4096
    s_mov_b32 m0, s47
    s_nop 0
    global_load_lds_dwordx4 v10, s[50:51]
    s_add_u32 s50, s50, 131072
    s_addc_u32 s51, s51, 0
    s_add_u32 s47, s47, 4096
    s_mov_b32 m0, s47
    s_nop 0
    global_load_lds_dwordx4 v10, s[50:51]
    s_add_u32 s50, s50, 131072
    s_addc_u32 s51, s51, 0
    s_add_u32 s47, s47, 4096
    s_mov_b32 m0, s47
    s_nop 0
    global_load_lds_dwordx4 v10, s[50:51]
    s_add_u32 s50, s50, 131072
    s_addc_u32 s51, s51, 0
    s_add_u32 s47, s47, 4096
    s_mov_b32 m0, s47
    s_nop 0
    global_load_lds_dwordx4 v10, s[50:51]
    s_add_u32 s50, s50, 131072
    s_addc_u32 s51, s51, 0
    s_add_u32 s47, s47, 4096
    s_mov_b32 m0, s47
    s_nop 0
    global_load_lds_dwordx4 v10, s[50:51]
    s_add_u32 s50, s50, 131072
    s_addc_u32 s51, s51, 0
    s_add_u32 s47, s47, 4096
    s_mov_b32 m0, s47
    s_nop 0
    global_load_lds_dwordx4 v10, s[50:51]
    s_add_u32 s50, s50, 131072
    s_addc_u32 s51, s51, 0
    s_add_u32 s47, s47, 4096
    s_mov_b32 m0, s47
    s_nop 0
    global_load_lds_dwordx4 v10, s[50:51]
    s_add_u32 s50, s50, 131072
    s_addc_u32 s51, s51, 0
    s_add_u32 s47, s47, 4096
    s_mov_b32 m0, s47
    s_nop 0
    global_load_lds_dwordx4 v10, s[50:51]
    s_add_u32 s50, s50, 131072
    s_addc_u32 s51, s51, 0
    s_add_u32 s47, s47, 4096
    s_mov_b32 m0, s47
    s_nop 0
    global_load_lds_dwordx4 v10, s[50:51]
    s_add_u32 s50, s50, 131072
    s_addc_u32 s51, s51, 0
    s_add_u32 s47, s47, 4096
    s_mov_b32 m0, s47
    s_nop 0
    global_load_lds_dwordx4 v10, s[50:51]
    s_add_u32 s50, s50, 131072
    s_addc_u32 s51, s51, 0
    s_add_u32 s47, s47, 4096
    s_mov_b32 m0, s47
    s_nop 0
    global_load_lds_dwordx4 v10, s[50:51]
    s_add_u32 s50, s50, 131072
    s_addc_u32 s51, s51, 0
    s_add_u32 s47, s47, 4096
    s_mov_b32 m0, s47
    s_nop 0
    global_load_lds_dwordx4 v10, s[50:51]
    s_add_u32 s50, s50, 131072
    s_addc_u32 s51, s51, 0
    s_add_u32 s47, s47, 4096
    s_mov_b32 m0, s47
    s_nop 0
    global_load_lds_dwordx4 v10, s[50:51]
    s_add_u32 s50, s50, 131072
    s_addc_u32 s51, s51, 0
    s_add_u32 s47, s47, 4096
    s_mov_b32 m0, s47
    s_nop 0
    global_load_lds_dwordx4 v10, s[50:51]
    s_add_u32 s50, s50, 131072
    s_addc_u32 s51, s51, 0
    s_add_u32 s47, s47, 4096
    s_mov_b32 m0, s47
    s_nop 0
    global_load_lds_dwordx4 v10, s[50:51]
    s_add_u32 s50, s50, 131072
    s_addc_u32 s51, s51, 0
    s_add_u32 s47, s47, 4096
    s_mov_b32 m0, s47
    s_nop 0
    global_load_lds_dwordx4 v10, s[50:51]
    s_add_u32 s50, s50, 131072
    s_addc_u32 s51, s51, 0
    s_add_u32 s47, s47, 4096
    s_mov_b32 m0, s47
    s_nop 0
    global_load_lds_dwordx4 v10, s[50:51]
    s_add_u32 s50, s50, 131072
    s_addc_u32 s51, s51, 0
    s_add_u32 s47, s47, 4096
    s_mov_b32 m0, s47
    s_nop 0
    global_load_lds_dwordx4 v10, s[50:51]
    s_add_u32 s50, s50, 131072
    s_addc_u32 s51, s51, 0
    s_add_u32 s47, s47, 4096
    s_mov_b32 m0, s47
    s_nop 0
    global_load_lds_dwordx4 v10, s[50:51]
    s_add_u32 s50, s50, 131072
    s_addc_u32 s51, s51, 0
    s_add_u32 s47, s47, 4096
    s_mov_b32 m0, s47
    s_nop 0
    global_load_lds_dwordx4 v10, s[50:51]
    s_add_u32 s50, s50, 131072
    s_addc_u32 s51, s51, 0
    s_add_u32 s47, s47, 4096
    s_mov_b32 m0, s47
    s_nop 0
    global_load_lds_dwordx4 v10, s[50:51]
    s_add_u32 s50, s50, 131072
    s_addc_u32 s51, s51, 0
    s_add_u32 s47, s47, 4096
    s_mov_b32 m0, s47
    s_nop 0
    global_load_lds_dwordx4 v10, s[50:51]
    s_add_u32 s50, s50, 131072
    s_addc_u32 s51, s51, 0
    s_add_u32 s47, s47, 4096
    s_mov_b32 m0, s47
    s_nop 0
    global_load_lds_dwordx4 v10, s[50:51]
    s_add_u32 s50, s50, 131072
    s_addc_u32 s51, s51, 0
    s_add_u32 s47, s47, 4096
    s_mov_b32 m0, s47
    s_nop 0
    global_load_lds_dwordx4 v10, s[50:51]
    s_add_u32 s50, s50, 131072
    s_addc_u32 s51, s51, 0
    s_add_u32 s47, s47, 4096
    s_mov_b32 m0, s47
    s_nop 0
    global_load_lds_dwordx4 v10, s[50:51]
    s_add_u32 s50, s50, 131072
    s_addc_u32 s51, s51, 0
    s_add_u32 s47, s47, 4096
    s_mov_b32 m0, s47
    s_nop 0
    global_load_lds_dwordx4 v10, s[50:51]
    s_add_u32 s50, s50, 131072
    s_addc_u32 s51, s51, 0
    s_add_u32 s47, s47, 4096
    s_mov_b32 m0, s47
    s_nop 0
    global_load_lds_dwordx4 v10, s[50:51]
    s_add_u32 s50, s50, 131072
    s_addc_u32 s51, s51, 0
    s_add_u32 s47, s47, 4096
    s_mov_b32 m0, s47
    s_nop 0
    global_load_lds_dwordx4 v10, s[50:51]
    s_add_u32 s50, s50, 131072
    s_addc_u32 s51, s51, 0
    s_add_u32 s47, s47, 4096
    s_mov_b32 m0, s47
    s_nop 0
    global_load_lds_dwordx4 v10, s[50:51]
    s_add_u32 s50, s50, 131072
    s_addc_u32 s51, s51, 0
    s_add_u32 s47, s47, 4096
    s_mov_b32 m0, s47
    s_nop 0
    global_load_lds_dwordx4 v10, s[50:51]
    s_add_u32 s50, s50, 131072
    s_addc_u32 s51, s51, 0
    s_add_u32 s47, s47, 4096
    s_waitcnt vmcnt(0)
    s_barrier
    s_mov_b32 s45, 0x0
    s_lshr_b32 s46, s40, 0
    s_and_b32 s46, s46, 0x3
    s_mul_i32 s46, s46, 0x40
    s_add_u32 s45, s45, s46
    v_mov_b32 v10, s45
    s_mov_b32 s46, 0x8
    v_mad_u32_u24 v10, v4, s46, v10
    s_mov_b32 s46, 0x10
    v_mad_u32_u24 v10, v5, s46, v10
    s_mov_b32 s46, 0x100
    v_mad_u32_u24 v10, v6, s46, v10
    s_mov_b32 s46, 0x200
    v_mad_u32_u24 v10, v7, s46, v10
    s_mov_b32 s46, 0x20
    v_mad_u32_u24 v10, v8, s46, v10
    s_mov_b32 s46, 0x800
    v_mad_u32_u24 v10, v9, s46, v10
    v_add_u32 v11, 0, v10
    ds_read_b64_tr_b16 a[128:129], v11 offset:0
    ds_read_b64_tr_b16 a[130:131], v11 offset:1024
    ds_read_b64_tr_b16 a[132:133], v11 offset:4096
    ds_read_b64_tr_b16 a[134:135], v11 offset:5120
    ds_read_b64_tr_b16 a[136:137], v11 offset:8192
    ds_read_b64_tr_b16 a[138:139], v11 offset:9216
    ds_read_b64_tr_b16 a[140:141], v11 offset:12288
    ds_read_b64_tr_b16 a[142:143], v11 offset:13312
    s_waitcnt lgkmcnt(0)
    ds_read_b64_tr_b16 a[144:145], v11 offset:16384
    ds_read_b64_tr_b16 a[146:147], v11 offset:17408
    ds_read_b64_tr_b16 a[148:149], v11 offset:20480
    ds_read_b64_tr_b16 a[150:151], v11 offset:21504
    ds_read_b64_tr_b16 a[152:153], v11 offset:24576
    ds_read_b64_tr_b16 a[154:155], v11 offset:25600
    ds_read_b64_tr_b16 a[156:157], v11 offset:28672
    ds_read_b64_tr_b16 a[158:159], v11 offset:29696
    s_waitcnt lgkmcnt(0)
    v_add_u32 v11, 32768, v10
    ds_read_b64_tr_b16 a[160:161], v11 offset:0
    ds_read_b64_tr_b16 a[162:163], v11 offset:1024
    ds_read_b64_tr_b16 a[164:165], v11 offset:4096
    ds_read_b64_tr_b16 a[166:167], v11 offset:5120
    ds_read_b64_tr_b16 a[168:169], v11 offset:8192
    ds_read_b64_tr_b16 a[170:171], v11 offset:9216
    ds_read_b64_tr_b16 a[172:173], v11 offset:12288
    ds_read_b64_tr_b16 a[174:175], v11 offset:13312
    s_waitcnt lgkmcnt(0)
    ds_read_b64_tr_b16 a[176:177], v11 offset:16384
    ds_read_b64_tr_b16 a[178:179], v11 offset:17408
    ds_read_b64_tr_b16 a[180:181], v11 offset:20480
    ds_read_b64_tr_b16 a[182:183], v11 offset:21504
    ds_read_b64_tr_b16 a[184:185], v11 offset:24576
    ds_read_b64_tr_b16 a[186:187], v11 offset:25600
    ds_read_b64_tr_b16 a[188:189], v11 offset:28672
    ds_read_b64_tr_b16 a[190:191], v11 offset:29696
    s_waitcnt lgkmcnt(0)
    v_add_u32 v11, 65536, v10
    ds_read_b64_tr_b16 a[192:193], v11 offset:0
    ds_read_b64_tr_b16 a[194:195], v11 offset:1024
    ds_read_b64_tr_b16 a[196:197], v11 offset:4096
    ds_read_b64_tr_b16 a[198:199], v11 offset:5120
    ds_read_b64_tr_b16 a[200:201], v11 offset:8192
    ds_read_b64_tr_b16 a[202:203], v11 offset:9216
    ds_read_b64_tr_b16 a[204:205], v11 offset:12288
    ds_read_b64_tr_b16 a[206:207], v11 offset:13312
    s_waitcnt lgkmcnt(0)
    ds_read_b64_tr_b16 a[208:209], v11 offset:16384
    ds_read_b64_tr_b16 a[210:211], v11 offset:17408
    ds_read_b64_tr_b16 a[212:213], v11 offset:20480
    ds_read_b64_tr_b16 a[214:215], v11 offset:21504
    ds_read_b64_tr_b16 a[216:217], v11 offset:24576
    ds_read_b64_tr_b16 a[218:219], v11 offset:25600
    ds_read_b64_tr_b16 a[220:221], v11 offset:28672
    ds_read_b64_tr_b16 a[222:223], v11 offset:29696
    s_waitcnt lgkmcnt(0)
    v_add_u32 v11, 98304, v10
    ds_read_b64_tr_b16 a[224:225], v11 offset:0
    ds_read_b64_tr_b16 a[226:227], v11 offset:1024
    ds_read_b64_tr_b16 a[228:229], v11 offset:4096
    ds_read_b64_tr_b16 a[230:231], v11 offset:5120
    ds_read_b64_tr_b16 a[232:233], v11 offset:8192
    ds_read_b64_tr_b16 a[234:235], v11 offset:9216
    ds_read_b64_tr_b16 a[236:237], v11 offset:12288
    ds_read_b64_tr_b16 a[238:239], v11 offset:13312
    s_waitcnt lgkmcnt(0)
    ds_read_b64_tr_b16 a[240:241], v11 offset:16384
    ds_read_b64_tr_b16 a[242:243], v11 offset:17408
    ds_read_b64_tr_b16 a[244:245], v11 offset:20480
    ds_read_b64_tr_b16 a[246:247], v11 offset:21504
    ds_read_b64_tr_b16 a[248:249], v11 offset:24576
    ds_read_b64_tr_b16 a[250:251], v11 offset:25600
    ds_read_b64_tr_b16 a[252:253], v11 offset:28672
    ds_read_b64_tr_b16 a[254:255], v11 offset:29696
    s_waitcnt lgkmcnt(0)
    s_waitcnt lgkmcnt(0)
    s_barrier
    s_cmp_lg_u32 s40, 0
    s_cbranch_scc1 L_nopoll_104
    v_mov_b32 v12, 64
    s_mov_b64 exec, 1
L_iw_105:
    buffer_load_dword v13, v12, s[36:39], 0 offen sc1
    s_waitcnt vmcnt(0)
    v_cmp_gt_u32 vcc, 96, v13
    s_cbranch_vccz L_iwok_106
    s_add_u32 s44, s44, 1
    s_cmp_gt_u32 s44, 1048576
    s_cbranch_scc1 L_w_abort_100
    s_sleep 4
    s_branch L_iw_105
L_iwok_106:
    s_mov_b64 exec, -1
L_nopoll_104:
    s_barrier
    v_lshlrev_b32 v12, 6, v1
    s_cmp_ge_u32 s40, 2
    s_cbranch_scc1 L_hw_107
    s_lshl_b32 s48, s40, 12
    s_add_u32 s48, s48, 425984
    s_mov_b32 exec_lo, 0xffffffff
    s_mov_b32 exec_hi, 0xffffffff
L_wf_108:
    buffer_load_dword v13, v12, s[32:35], s48 offen sc1
    s_waitcnt vmcnt(0)
    v_cmp_gt_u32 vcc, 1, v13
    s_nop 0
    s_and_b32 vcc_lo, vcc_lo, 0xffffffff
    s_and_b32 vcc_hi, vcc_hi, 0xffffffff
    s_cmp_eq_u64 vcc, 0
    s_cbranch_scc1 L_wfok_109
    s_add_u32 s44, s44, 1
    s_cmp_gt_u32 s44, 1048576
    s_cbranch_scc1 L_w_abort_100
    s_sleep 1
    s_branch L_wf_108
L_wfok_109:
    s_mov_b64 exec, -1
L_wfskip_110:
L_hw_107:
    s_barrier
    s_mov_b32 s52, 2097152
    s_mov_b32 s53, 0
    s_lshl_b32 s45, s42, 9
    s_add_u32 s54, s45, 393216
    s_mov_b32 s45, 0x2800000
    s_lshr_b32 s46, s40, 0
    s_and_b32 s46, s46, 0x3
    s_mul_i32 s46, s46, 0x400
    s_add_u32 s45, s45, s46
    s_lshr_b32 s46, s42, 0
    s_and_b32 s46, s46, 0x1f
    s_mul_i32 s46, s46, 0x2000
    s_add_u32 s45, s45, s46
    v_mov_b32 v3, s45
    s_mov_b32 s46, 0x10
    v_mad_u32_u24 v3, v4, s46, v3
    s_mov_b32 s46, 0x20
    v_mad_u32_u24 v3, v5, s46, v3
    s_mov_b32 s46, 0x40
    v_mad_u32_u24 v3, v6, s46, v3
    s_mov_b32 s46, 0x1000
    v_mad_u32_u24 v3, v7, s46, v3
    s_mov_b32 s46, 0x80
    v_mad_u32_u24 v3, v8, s46, v3
    s_mov_b32 s46, 0x100
    v_mad_u32_u24 v3, v9, s46, v3
    s_mov_b32 s45, 0x3800000
    s_lshr_b32 s46, s40, 0
    s_and_b32 s46, s46, 0x3
    s_mul_i32 s46, s46, 0x800
    s_add_u32 s45, s45, s46
    s_lshr_b32 s46, s42, 0
    s_and_b32 s46, s46, 0x1f
    s_mul_i32 s46, s46, 0x2000
    s_add_u32 s45, s45, s46
    v_mov_b32 v14, s45
    s_mov_b32 s46, 0x10
    v_mad_u32_u24 v14, v4, s46, v14
    s_mov_b32 s46, 0x20
    v_mad_u32_u24 v14, v5, s46, v14
    s_mov_b32 s46, 0x40
    v_mad_u32_u24 v14, v6, s46, v14
    s_mov_b32 s46, 0x80
    v_mad_u32_u24 v14, v7, s46, v14
    s_mov_b32 s46, 0x400
    v_mad_u32_u24 v14, v8, s46, v14
    s_mov_b32 s46, 0x100
    v_mad_u32_u24 v14, v9, s46, v14
    s_mov_b32 s43, 0
    s_mov_b32 s56, 0
    s_lshl_b32 s45, s40, 13
    s_add_u32 s46, s52, s45
    s_add_u32 s45, s45, s56
    s_add_u32 m0, s45, 0
    s_add_u32 s47, s46, 0
    buffer_load_dwordx4 v2, s[32:35], s47 offen offset:0 sc1 lds
    buffer_load_dwordx4 v2, s[32:35], s47 offen offset:1024 sc1 lds
    buffer_load_dwordx4 v2, s[32:35], s47 offen offset:2048 sc1 lds
    buffer_load_dwordx4 v2, s[32:35], s47 offen offset:3072 sc1 lds
    s_add_u32 m0, s45, 4096
    s_add_u32 s47, s46, 4096
    buffer_load_dwordx4 v2, s[32:35], s47 offen offset:0 sc1 lds
    buffer_load_dwordx4 v2, s[32:35], s47 offen offset:1024 sc1 lds
    buffer_load_dwordx4 v2, s[32:35], s47 offen offset:2048 sc1 lds
    buffer_load_dwordx4 v2, s[32:35], s47 offen offset:3072 sc1 lds
    v_mov_b32 v15, v2
    s_waitcnt vmcnt(0)
L_kv_111:
    s_waitcnt vmcnt(4)
    s_barrier
    s_xor_b32 s56, s56, 0x8000
    s_cmp_lt_u32 s43, 63
    s_cselect_b32 s45, 32768, 0
    s_add_u32 s52, s52, s45
    ds_read_b128 v[48:51], v15 offset:0
    ds_read_b128 v[52:55], v15 offset:1024
    ds_read_b128 v[56:59], v15 offset:2048
    ds_read_b128 v[60:63], v15 offset:3072
    ds_read_b128 v[64:67], v15 offset:4096
    ds_read_b128 v[68:71], v15 offset:5120
    ds_read_b128 v[72:75], v15 offset:6144
    ds_read_b128 v[76:79], v15 offset:7168
    s_lshl_b32 s45, s40, 13
    s_add_u32 s46, s52, s45
    s_add_u32 s45, s45, s56
    s_add_u32 m0, s45, 0
    s_add_u32 s47, s46, 0
    buffer_load_dwordx4 v2, s[32:35], s47 offen offset:0 sc1 lds
    buffer_load_dwordx4 v2, s[32:35], s47 offen offset:1024 sc1 lds
    buffer_load_dwordx4 v2, s[32:35], s47 offen offset:2048 sc1 lds
    buffer_load_dwordx4 v2, s[32:35], s47 offen offset:3072 sc1 lds
    s_add_u32 m0, s45, 4096
    s_add_u32 s47, s46, 4096
    buffer_load_dwordx4 v2, s[32:35], s47 offen offset:0 sc1 lds
    buffer_load_dwordx4 v2, s[32:35], s47 offen offset:1024 sc1 lds
    buffer_load_dwordx4 v2, s[32:35], s47 offen offset:2048 sc1 lds
    buffer_load_dwordx4 v2, s[32:35], s47 offen offset:3072 sc1 lds
    s_waitcnt lgkmcnt(7)
    v_mfma_f32_32x32x16_bf16 v[32:47], a[0:3], v[48:51], 0
    v_mfma_f32_32x32x16_bf16 v[80:95], v[48:51], a[128:131], 0
    ds_read_b128 v[48:51], v15 offset:8192
    s_waitcnt lgkmcnt(7)
    v_mfma_f32_32x32x16_bf16 v[32:47], a[4:7], v[52:55], v[32:47]
    v_mfma_f32_32x32x16_bf16 v[80:95], v[52:55], a[132:135], v[80:95]
    ds_read_b128 v[52:55], v15 offset:9216
    s_waitcnt lgkmcnt(7)
    v_mfma_f32_32x32x16_bf16 v[32:47], a[8:11], v[56:59], v[32:47]
    v_mfma_f32_32x32x16_bf16 v[80:95], v[56:59], a[136:139], v[80:95]
    ds_read_b128 v[56:59], v15 offset:10240
    s_waitcnt lgkmcnt(7)
    v_mfma_f32_32x32x16_bf16 v[32:47], a[12:15], v[60:63], v[32:47]
    v_mfma_f32_32x32x16_bf16 v[80:95], v[60:63], a[140:143], v[80:95]
    ds_read_b128 v[60:63], v15 offset:11264
    s_waitcnt lgkmcnt(7)
    v_mfma_f32_32x32x16_bf16 v[32:47], a[16:19], v[64:67], v[32:47]
    v_mfma_f32_32x32x16_bf16 v[80:95], v[64:67], a[144:147], v[80:95]
    ds_read_b128 v[64:67], v15 offset:12288
    s_waitcnt lgkmcnt(7)
    v_mfma_f32_32x32x16_bf16 v[32:47], a[20:23], v[68:71], v[32:47]
    v_mfma_f32_32x32x16_bf16 v[80:95], v[68:71], a[148:151], v[80:95]
    ds_read_b128 v[68:71], v15 offset:13312
    s_waitcnt lgkmcnt(7)
    v_mfma_f32_32x32x16_bf16 v[32:47], a[24:27], v[72:75], v[32:47]
    v_mfma_f32_32x32x16_bf16 v[80:95], v[72:75], a[152:155], v[80:95]
    ds_read_b128 v[72:75], v15 offset:14336
    s_waitcnt lgkmcnt(7)
    v_mfma_f32_32x32x16_bf16 v[32:47], a[28:31], v[76:79], v[32:47]
    v_mfma_f32_32x32x16_bf16 v[80:95], v[76:79], a[156:159], v[80:95]
    ds_read_b128 v[76:79], v15 offset:15360
    s_waitcnt lgkmcnt(7)
    v_mfma_f32_32x32x16_bf16 v[32:47], a[32:35], v[48:51], v[32:47]
    v_mfma_f32_32x32x16_bf16 v[80:95], v[48:51], a[160:163], v[80:95]
    ds_read_b128 v[48:51], v15 offset:16384
    s_waitcnt lgkmcnt(7)
    v_mfma_f32_32x32x16_bf16 v[32:47], a[36:39], v[52:55], v[32:47]
    v_mfma_f32_32x32x16_bf16 v[80:95], v[52:55], a[164:167], v[80:95]
    ds_read_b128 v[52:55], v15 offset:17408
    s_waitcnt lgkmcnt(7)
    v_mfma_f32_32x32x16_bf16 v[32:47], a[40:43], v[56:59], v[32:47]
    v_mfma_f32_32x32x16_bf16 v[80:95], v[56:59], a[168:171], v[80:95]
    ds_read_b128 v[56:59], v15 offset:18432
    s_waitcnt lgkmcnt(7)
    v_mfma_f32_32x32x16_bf16 v[32:47], a[44:47], v[60:63], v[32:47]
    v_mfma_f32_32x32x16_bf16 v[80:95], v[60:63], a[172:175], v[80:95]
    ds_read_b128 v[60:63], v15 offset:19456
    s_waitcnt lgkmcnt(7)
    v_mfma_f32_32x32x16_bf16 v[32:47], a[48:51], v[64:67], v[32:47]
    v_mfma_f32_32x32x16_bf16 v[80:95], v[64:67], a[176:179], v[80:95]
    ds_read_b128 v[64:67], v15 offset:20480
    s_waitcnt vmcnt(8)
    s_barrier
    s_cmp_lg_u32 s40, 3
    s_cbranch_scc1 L_nosig_112
    v_mov_b32 v13, s43
    v_mov_b32 v12, 0
    s_mov_b64 exec, 1
    buffer_store_dword v13, v12, s[32:35], s54 offen sc1
    s_mov_b64 exec, -1
L_nosig_112:
    s_waitcnt lgkmcnt(7)
    v_mfma_f32_32x32x16_bf16 v[32:47], a[52:55], v[68:71], v[32:47]
    v_mfma_f32_32x32x16_bf16 v[80:95], v[68:71], a[180:183], v[80:95]
    ds_read_b128 v[68:71], v15 offset:21504
    s_waitcnt lgkmcnt(7)
    v_mfma_f32_32x32x16_bf16 v[32:47], a[56:59], v[72:75], v[32:47]
    v_mfma_f32_32x32x16_bf16 v[80:95], v[72:75], a[184:187], v[80:95]
    ds_read_b128 v[72:75], v15 offset:22528
    s_waitcnt lgkmcnt(7)
    v_mfma_f32_32x32x16_bf16 v[32:47], a[60:63], v[76:79], v[32:47]
    v_mfma_f32_32x32x16_bf16 v[80:95], v[76:79], a[188:191], v[80:95]
    ds_read_b128 v[76:79], v15 offset:23552
    s_waitcnt lgkmcnt(7)
    v_mfma_f32_32x32x16_bf16 v[32:47], a[64:67], v[48:51], v[32:47]
    v_mfma_f32_32x32x16_bf16 v[80:95], v[48:51], a[192:195], v[80:95]
    ds_read_b128 v[48:51], v15 offset:24576
    s_waitcnt lgkmcnt(7)
    v_mfma_f32_32x32x16_bf16 v[32:47], a[68:71], v[52:55], v[32:47]
    v_mfma_f32_32x32x16_bf16 v[80:95], v[52:55], a[196:199], v[80:95]
    ds_read_b128 v[52:55], v15 offset:25600
    s_waitcnt lgkmcnt(7)
    v_mfma_f32_32x32x16_bf16 v[32:47], a[72:75], v[56:59], v[32:47]
    v_mfma_f32_32x32x16_bf16 v[80:95], v[56:59], a[200:203], v[80:95]
    ds_read_b128 v[56:59], v15 offset:26624
    s_waitcnt lgkmcnt(7)
    v_mfma_f32_32x32x16_bf16 v[32:47], a[76:79], v[60:63], v[32:47]
    v_mfma_f32_32x32x16_bf16 v[80:95], v[60:63], a[204:207], v[80:95]
    ds_read_b128 v[60:63], v15 offset:27648
    s_waitcnt lgkmcnt(7)
    v_mfma_f32_32x32x16_bf16 v[32:47], a[80:83], v[64:67], v[32:47]
    v_mfma_f32_32x32x16_bf16 v[80:95], v[64:67], a[208:211], v[80:95]
    ds_read_b128 v[64:67], v15 offset:28672
    s_waitcnt lgkmcnt(7)
    v_mfma_f32_32x32x16_bf16 v[32:47], a[84:87], v[68:71], v[32:47]
    v_mfma_f32_32x32x16_bf16 v[80:95], v[68:71], a[212:215], v[80:95]
    ds_read_b128 v[68:71], v15 offset:29696
    s_waitcnt lgkmcnt(7)
    v_mfma_f32_32x32x16_bf16 v[32:47], a[88:91], v[72:75], v[32:47]
    v_mfma_f32_32x32x16_bf16 v[80:95], v[72:75], a[216:219], v[80:95]
    ds_read_b128 v[72:75], v15 offset:30720
    s_waitcnt lgkmcnt(7)
    v_mfma_f32_32x32x16_bf16 v[32:47], a[92:95], v[76:79], v[32:47]
    v_mfma_f32_32x32x16_bf16 v[80:95], v[76:79], a[220:223], v[80:95]
    ds_read_b128 v[76:79], v15 offset:31744
    s_waitcnt lgkmcnt(7)
    v_mfma_f32_32x32x16_bf16 v[32:47], a[96:99], v[48:51], v[32:47]
    v_mfma_f32_32x32x16_bf16 v[80:95], v[48:51], a[224:227], v[80:95]
    s_waitcnt lgkmcnt(6)
    v_mfma_f32_32x32x16_bf16 v[32:47], a[100:103], v[52:55], v[32:47]
    v_mfma_f32_32x32x16_bf16 v[80:95], v[52:55], a[228:231], v[80:95]
    s_waitcnt lgkmcnt(5)
    v_mfma_f32_32x32x16_bf16 v[32:47], a[104:107], v[56:59], v[32:47]
    v_mfma_f32_32x32x16_bf16 v[80:95], v[56:59], a[232:235], v[80:95]
    s_waitcnt lgkmcnt(4)
    v_mfma_f32_32x32x16_bf16 v[32:47], a[108:111], v[60:63], v[32:47]
    v_mfma_f32_32x32x16_bf16 v[80:95], v[60:63], a[236:239], v[80:95]
    s_waitcnt lgkmcnt(3)
    v_mfma_f32_32x32x16_bf16 v[32:47], a[112:115], v[64:67], v[32:47]
    v_mfma_f32_32x32x16_bf16 v[80:95], v[64:67], a[240:243], v[80:95]
    s_waitcnt lgkmcnt(2)
    v_mfma_f32_32x32x16_bf16 v[32:47], a[116:119], v[68:71], v[32:47]
    v_mfma_f32_32x32x16_bf16 v[80:95], v[68:71], a[244:247], v[80:95]
    s_waitcnt lgkmcnt(1)
    v_mfma_f32_32x32x16_bf16 v[32:47], a[120:123], v[72:75], v[32:47]
    v_mfma_f32_32x32x16_bf16 v[80:95], v[72:75], a[248:251], v[80:95]
    s_waitcnt lgkmcnt(0)
    v_mfma_f32_32x32x16_bf16 v[32:47], a[124:127], v[76:79], v[32:47]
    v_mfma_f32_32x32x16_bf16 v[80:95], v[76:79], a[252:255], v[80:95]
    v_xor_b32 v15, 0x8000, v15
    s_nop 8
    v_cvt_pk_bf16_f32 v16, v32, v33
    v_cvt_pk_bf16_f32 v17, v34, v35
    v_cvt_pk_bf16_f32 v18, v36, v37
    v_cvt_pk_bf16_f32 v19, v38, v39
    v_cvt_pk_bf16_f32 v20, v40, v41
    v_cvt_pk_bf16_f32 v21, v42, v43
    v_cvt_pk_bf16_f32 v22, v44, v45
    v_cvt_pk_bf16_f32 v23, v46, v47
    buffer_store_dwordx4 v[16:19], v3, s[32:35], s53 offen sc1
    buffer_store_dwordx4 v[20:23], v3, s[32:35], s53 offen offset:512 sc1
    v_cvt_pk_bf16_f32 v24, v80, v81
    v_cvt_pk_bf16_f32 v25, v82, v83
    v_cvt_pk_bf16_f32 v26, v84, v85
    v_cvt_pk_bf16_f32 v27, v86, v87
    v_cvt_pk_bf16_f32 v28, v88, v89
    v_cvt_pk_bf16_f32 v29, v90, v91
    v_cvt_pk_bf16_f32 v30, v92, v93
    v_cvt_pk_bf16_f32 v31, v94, v95
    buffer_store_dwordx4 v[24:27], v14, s[32:35], s53 offen sc1
    buffer_store_dwordx4 v[28:31], v14, s[32:35], s53 offen offset:512 sc1
    s_add_u32 s53, s53, 262144
    s_add_u32 s43, s43, 1
    s_cmp_lt_u32 s43, 64
    s_cbranch_scc1 L_kv_111
    s_waitcnt vmcnt(0)
    s_barrier
    v_mov_b32 v13, s43
    v_mov_b32 v12, 0
    s_mov_b64 exec, 1
    buffer_store_dword v13, v12, s[32:35], s54 offen sc1
    s_mov_b64 exec, -1
    s_waitcnt vmcnt(0)
    s_endpgm
L_isq_102:
    s_sub_u32 s42, s41, 32
    s_mov_b32 s45, 0x0
    s_lshr_b32 s46, s42, 0
    s_and_b32 s46, s46, 0xf
    s_mul_i32 s46, s46, 0x200
    s_add_u32 s45, s45, s46
    s_lshr_b32 s46, s40, 0
    s_and_b32 s46, s46, 0x3
    s_mul_i32 s46, s46, 0x8000
    s_add_u32 s45, s45, s46
    v_mov_b32 v10, s45
    s_mov_b32 s46, 0x10
    v_mad_u32_u24 v10, v4, s46, v10
    s_mov_b32 s46, 0x20
    v_mad_u32_u24 v10, v5, s46, v10
    s_mov_b32 s46, 0x40
    v_mad_u32_u24 v10, v6, s46, v10
    s_mov_b32 s46, 0x80
    v_mad_u32_u24 v10, v7, s46, v10
    s_mov_b32 s46, 0x2000
    v_mad_u32_u24 v10, v8, s46, v10
    s_mov_b32 s46, 0x4000
    v_mad_u32_u24 v10, v9, s46, v10
    s_mov_b32 s50, s8
    s_mov_b32 s51, s9
    s_lshl_b32 s47, s40, 10
    s_add_u32 s47, s47, 0
    s_mov_b32 m0, s47
    s_nop 0
    global_load_lds_dwordx4 v10, s[50:51]
    s_add_u32 s50, s50, 131072
    s_addc_u32 s51, s51, 0
    s_add_u32 s47, s47, 4096
    s_mov_b32 m0, s47
    s_nop 0
    global_load_lds_dwordx4 v10, s[50:51]
    s_add_u32 s50, s50, 131072
    s_addc_u32 s51, s51, 0
    s_add_u32 s47, s47, 4096
    s_mov_b32 m0, s47
    s_nop 0
    global_load_lds_dwordx4 v10, s[50:51]
    s_add_u32 s50, s50, 131072
    s_addc_u32 s51, s51, 0
    s_add_u32 s47, s47, 4096
    s_mov_b32 m0, s47
    s_nop 0
    global_load_lds_dwordx4 v10, s[50:51]
    s_add_u32 s50, s50, 131072
    s_addc_u32 s51, s51, 0
    s_add_u32 s47, s47, 4096
    s_mov_b32 m0, s47
    s_nop 0
    global_load_lds_dwordx4 v10, s[50:51]
    s_add_u32 s50, s50, 131072
    s_addc_u32 s51, s51, 0
    s_add_u32 s47, s47, 4096
    s_mov_b32 m0, s47
    s_nop 0
    global_load_lds_dwordx4 v10, s[50:51]
    s_add_u32 s50, s50, 131072
    s_addc_u32 s51, s51, 0
    s_add_u32 s47, s47, 4096
    s_mov_b32 m0, s47
    s_nop 0
    global_load_lds_dwordx4 v10, s[50:51]
    s_add_u32 s50, s50, 131072
    s_addc_u32 s51, s51, 0
    s_add_u32 s47, s47, 4096
    s_mov_b32 m0, s47
    s_nop 0
    global_load_lds_dwordx4 v10, s[50:51]
    s_add_u32 s50, s50, 131072
    s_addc_u32 s51, s51, 0
    s_add_u32 s47, s47, 4096
    s_mov_b32 m0, s47
    s_nop 0
    global_load_lds_dwordx4 v10, s[50:51]
    s_add_u32 s50, s50, 131072
    s_addc_u32 s51, s51, 0
    s_add_u32 s47, s47, 4096
    s_mov_b32 m0, s47
    s_nop 0
    global_load_lds_dwordx4 v10, s[50:51]
    s_add_u32 s50, s50, 131072
    s_addc_u32 s51, s51, 0
    s_add_u32 s47, s47, 4096
    s_mov_b32 m0, s47
    s_nop 0
    global_load_lds_dwordx4 v10, s[50:51]
    s_add_u32 s50, s50, 131072
    s_addc_u32 s51, s51, 0
    s_add_u32 s47, s47, 4096
    s_mov_b32 m0, s47
    s_nop 0
    global_load_lds_dwordx4 v10, s[50:51]
    s_add_u32 s50, s50, 131072
    s_addc_u32 s51, s51, 0
    s_add_u32 s47, s47, 4096
    s_mov_b32 m0, s47
    s_nop 0
    global_load_lds_dwordx4 v10, s[50:51]
    s_add_u32 s50, s50, 131072
    s_addc_u32 s51, s51, 0
    s_add_u32 s47, s47, 4096
    s_mov_b32 m0, s47
    s_nop 0
    global_load_lds_dwordx4 v10, s[50:51]
    s_add_u32 s50, s50, 131072
    s_addc_u32 s51, s51, 0
    s_add_u32 s47, s47, 4096
    s_mov_b32 m0, s47
    s_nop 0
    global_load_lds_dwordx4 v10, s[50:51]
    s_add_u32 s50, s50, 131072
    s_addc_u32 s51, s51, 0
    s_add_u32 s47, s47, 4096
    s_mov_b32 m0, s47
    s_nop 0
    global_load_lds_dwordx4 v10, s[50:51]
    s_add_u32 s50, s50, 131072
    s_addc_u32 s51, s51, 0
    s_add_u32 s47, s47, 4096
    s_mov_b32 m0, s47
    s_nop 0
    global_load_lds_dwordx4 v10, s[50:51]
    s_add_u32 s50, s50, 131072
    s_addc_u32 s51, s51, 0
    s_add_u32 s47, s47, 4096
    s_mov_b32 m0, s47
    s_nop 0
    global_load_lds_dwordx4 v10, s[50:51]
    s_add_u32 s50, s50, 131072
    s_addc_u32 s51, s51, 0
    s_add_u32 s47, s47, 4096
    s_mov_b32 m0, s47
    s_nop 0
    global_load_lds_dwordx4 v10, s[50:51]
    s_add_u32 s50, s50, 131072
    s_addc_u32 s51, s51, 0
    s_add_u32 s47, s47, 4096
    s_mov_b32 m0, s47
    s_nop 0
    global_load_lds_dwordx4 v10, s[50:51]
    s_add_u32 s50, s50, 131072
    s_addc_u32 s51, s51, 0
    s_add_u32 s47, s47, 4096
    s_mov_b32 m0, s47
    s_nop 0
    global_load_lds_dwordx4 v10, s[50:51]
    s_add_u32 s50, s50, 131072
    s_addc_u32 s51, s51, 0
    s_add_u32 s47, s47, 4096
    s_mov_b32 m0, s47
    s_nop 0
    global_load_lds_dwordx4 v10, s[50:51]
    s_add_u32 s50, s50, 131072
    s_addc_u32 s51, s51, 0
    s_add_u32 s47, s47, 4096
    s_mov_b32 m0, s47
    s_nop 0
    global_load_lds_dwordx4 v10, s[50:51]
    s_add_u32 s50, s50, 131072
    s_addc_u32 s51, s51, 0
    s_add_u32 s47, s47, 4096
    s_mov_b32 m0, s47
    s_nop 0
    global_load_lds_dwordx4 v10, s[50:51]
    s_add_u32 s50, s50, 131072
    s_addc_u32 s51, s51, 0
    s_add_u32 s47, s47, 4096
    s_mov_b32 m0, s47
    s_nop 0
    global_load_lds_dwordx4 v10, s[50:51]
    s_add_u32 s50, s50, 131072
    s_addc_u32 s51, s51, 0
    s_add_u32 s47, s47, 4096
    s_mov_b32 m0, s47
    s_nop 0
    global_load_lds_dwordx4 v10, s[50:51]
    s_add_u32 s50, s50, 131072
    s_addc_u32 s51, s51, 0
    s_add_u32 s47, s47, 4096
    s_mov_b32 m0, s47
    s_nop 0
    global_load_lds_dwordx4 v10, s[50:51]
    s_add_u32 s50, s50, 131072
    s_addc_u32 s51, s51, 0
    s_add_u32 s47, s47, 4096
    s_mov_b32 m0, s47
    s_nop 0
    global_load_lds_dwordx4 v10, s[50:51]
    s_add_u32 s50, s50, 131072
    s_addc_u32 s51, s51, 0
    s_add_u32 s47, s47, 4096
    s_mov_b32 m0, s47
    s_nop 0
    global_load_lds_dwordx4 v10, s[50:51]
    s_add_u32 s50, s50, 131072
    s_addc_u32 s51, s51, 0
    s_add_u32 s47, s47, 4096
    s_mov_b32 m0, s47
    s_nop 0
    global_load_lds_dwordx4 v10, s[50:51]
    s_add_u32 s50, s50, 131072
    s_addc_u32 s51, s51, 0
    s_add_u32 s47, s47, 4096
    s_mov_b32 m0, s47
    s_nop 0
    global_load_lds_dwordx4 v10, s[50:51]
    s_add_u32 s50, s50, 131072
    s_addc_u32 s51, s51, 0
    s_add_u32 s47, s47, 4096
    s_mov_b32 m0, s47
    s_nop 0
    global_load_lds_dwordx4 v10, s[50:51]
    s_add_u32 s50, s50, 131072
    s_addc_u32 s51, s51, 0
    s_add_u32 s47, s47, 4096
    s_waitcnt vmcnt(0)
    s_barrier
    s_mov_b32 s45, 0x0
    s_lshr_b32 s46, s40, 0
    s_and_b32 s46, s46, 0x3
    s_mul_i32 s46, s46, 0x40
    s_add_u32 s45, s45, s46
    v_mov_b32 v10, s45
    s_mov_b32 s46, 0x8
    v_mad_u32_u24 v10, v4, s46, v10
    s_mov_b32 s46, 0x10
    v_mad_u32_u24 v10, v5, s46, v10
    s_mov_b32 s46, 0x100
    v_mad_u32_u24 v10, v6, s46, v10
    s_mov_b32 s46, 0x200
    v_mad_u32_u24 v10, v7, s46, v10
    s_mov_b32 s46, 0x20
    v_mad_u32_u24 v10, v8, s46, v10
    s_mov_b32 s46, 0x800
    v_mad_u32_u24 v10, v9, s46, v10
    v_add_u32 v11, 0, v10
    ds_read_b64_tr_b16 a[0:1], v11 offset:0
    ds_read_b64_tr_b16 a[2:3], v11 offset:1024
    ds_read_b64_tr_b16 a[4:5], v11 offset:4096
    ds_read_b64_tr_b16 a[6:7], v11 offset:5120
    ds_read_b64_tr_b16 a[8:9], v11 offset:8192
    ds_read_b64_tr_b16 a[10:11], v11 offset:9216
    ds_read_b64_tr_b16 a[12:13], v11 offset:12288
    ds_read_b64_tr_b16 a[14:15], v11 offset:13312
    s_waitcnt lgkmcnt(0)
    ds_read_b64_tr_b16 a[16:17], v11 offset:16384
    ds_read_b64_tr_b16 a[18:19], v11 offset:17408
    ds_read_b64_tr_b16 a[20:21], v11 offset:20480
    ds_read_b64_tr_b16 a[22:23], v11 offset:21504
    ds_read_b64_tr_b16 a[24:25], v11 offset:24576
    ds_read_b64_tr_b16 a[26:27], v11 offset:25600
    ds_read_b64_tr_b16 a[28:29], v11 offset:28672
    ds_read_b64_tr_b16 a[30:31], v11 offset:29696
    s_waitcnt lgkmcnt(0)
    v_add_u32 v11, 32768, v10
    ds_read_b64_tr_b16 a[32:33], v11 offset:0
    ds_read_b64_tr_b16 a[34:35], v11 offset:1024
    ds_read_b64_tr_b16 a[36:37], v11 offset:4096
    ds_read_b64_tr_b16 a[38:39], v11 offset:5120
    ds_read_b64_tr_b16 a[40:41], v11 offset:8192
    ds_read_b64_tr_b16 a[42:43], v11 offset:9216
    ds_read_b64_tr_b16 a[44:45], v11 offset:12288
    ds_read_b64_tr_b16 a[46:47], v11 offset:13312
    s_waitcnt lgkmcnt(0)
    ds_read_b64_tr_b16 a[48:49], v11 offset:16384
    ds_read_b64_tr_b16 a[50:51], v11 offset:17408
    ds_read_b64_tr_b16 a[52:53], v11 offset:20480
    ds_read_b64_tr_b16 a[54:55], v11 offset:21504
    ds_read_b64_tr_b16 a[56:57], v11 offset:24576
    ds_read_b64_tr_b16 a[58:59], v11 offset:25600
    ds_read_b64_tr_b16 a[60:61], v11 offset:28672
    ds_read_b64_tr_b16 a[62:63], v11 offset:29696
    s_waitcnt lgkmcnt(0)
    v_add_u32 v11, 65536, v10
    ds_read_b64_tr_b16 a[64:65], v11 offset:0
    ds_read_b64_tr_b16 a[66:67], v11 offset:1024
    ds_read_b64_tr_b16 a[68:69], v11 offset:4096
    ds_read_b64_tr_b16 a[70:71], v11 offset:5120
    ds_read_b64_tr_b16 a[72:73], v11 offset:8192
    ds_read_b64_tr_b16 a[74:75], v11 offset:9216
    ds_read_b64_tr_b16 a[76:77], v11 offset:12288
    ds_read_b64_tr_b16 a[78:79], v11 offset:13312
    s_waitcnt lgkmcnt(0)
    ds_read_b64_tr_b16 a[80:81], v11 offset:16384
    ds_read_b64_tr_b16 a[82:83], v11 offset:17408
    ds_read_b64_tr_b16 a[84:85], v11 offset:20480
    ds_read_b64_tr_b16 a[86:87], v11 offset:21504
    ds_read_b64_tr_b16 a[88:89], v11 offset:24576
    ds_read_b64_tr_b16 a[90:91], v11 offset:25600
    ds_read_b64_tr_b16 a[92:93], v11 offset:28672
    ds_read_b64_tr_b16 a[94:95], v11 offset:29696
    s_waitcnt lgkmcnt(0)
    v_add_u32 v11, 98304, v10
    ds_read_b64_tr_b16 a[96:97], v11 offset:0
    ds_read_b64_tr_b16 a[98:99], v11 offset:1024
    ds_read_b64_tr_b16 a[100:101], v11 offset:4096
    ds_read_b64_tr_b16 a[102:103], v11 offset:5120
    ds_read_b64_tr_b16 a[104:105], v11 offset:8192
    ds_read_b64_tr_b16 a[106:107], v11 offset:9216
    ds_read_b64_tr_b16 a[108:109], v11 offset:12288
    ds_read_b64_tr_b16 a[110:111], v11 offset:13312
    s_waitcnt lgkmcnt(0)
    ds_read_b64_tr_b16 a[112:113], v11 offset:16384
    ds_read_b64_tr_b16 a[114:115], v11 offset:17408
    ds_read_b64_tr_b16 a[116:117], v11 offset:20480
    ds_read_b64_tr_b16 a[118:119], v11 offset:21504
    ds_read_b64_tr_b16 a[120:121], v11 offset:24576
    ds_read_b64_tr_b16 a[122:123], v11 offset:25600
    ds_read_b64_tr_b16 a[124:125], v11 offset:28672
    ds_read_b64_tr_b16 a[126:127], v11 offset:29696
    s_waitcnt lgkmcnt(0)
    s_waitcnt lgkmcnt(0)
    s_barrier
    s_mov_b32 s45, 0x100
    s_lshr_b32 s46, s42, 0
    s_and_b32 s46, s46, 0xf
    s_mul_i32 s46, s46, 0x200
    s_add_u32 s45, s45, s46
    s_lshr_b32 s46, s40, 0
    s_and_b32 s46, s46, 0x3
    s_mul_i32 s46, s46, 0x8000
    s_add_u32 s45, s45, s46
    v_mov_b32 v10, s45
    s_mov_b32 s46, 0x10
    v_mad_u32_u24 v10, v4, s46, v10
    s_mov_b32 s46, 0x20
    v_mad_u32_u24 v10, v5, s46, v10
    s_mov_b32 s46, 0x40
    v_mad_u32_u24 v10, v6, s46, v10
    s_mov_b32 s46, 0x80
    v_mad_u32_u24 v10, v7, s46, v10
    s_mov_b32 s46, 0x2000
    v_mad_u32_u24 v10, v8, s46, v10
    s_mov_b32 s46, 0x4000
    v_mad_u32_u24 v10, v9, s46, v10
    s_mov_b32 s50, s8
    s_mov_b32 s51, s9
    s_lshl_b32 s47, s40, 10
    s_add_u32 s47, s47, 0
    s_mov_b32 m0, s47
    s_nop 0
    global_load_lds_dwordx4 v10, s[50:51]
    s_add_u32 s50, s50, 131072
    s_addc_u32 s51, s51, 0
    s_add_u32 s47, s47, 4096
    s_mov_b32 m0, s47
    s_nop 0
    global_load_lds_dwordx4 v10, s[50:51]
    s_add_u32 s50, s50, 131072
    s_addc_u32 s51, s51, 0
    s_add_u32 s47, s47, 4096
    s_mov_b32 m0, s47
    s_nop 0
    global_load_lds_dwordx4 v10, s[50:51]
    s_add_u32 s50, s50, 131072
    s_addc_u32 s51, s51, 0
    s_add_u32 s47, s47, 4096
    s_mov_b32 m0, s47
    s_nop 0
    global_load_lds_dwordx4 v10, s[50:51]
    s_add_u32 s50, s50, 131072
    s_addc_u32 s51, s51, 0
    s_add_u32 s47, s47, 4096
    s_mov_b32 m0, s47
    s_nop 0
    global_load_lds_dwordx4 v10, s[50:51]
    s_add_u32 s50, s50, 131072
    s_addc_u32 s51, s51, 0
    s_add_u32 s47, s47, 4096
    s_mov_b32 m0, s47
    s_nop 0
    global_load_lds_dwordx4 v10, s[50:51]
    s_add_u32 s50, s50, 131072
    s_addc_u32 s51, s51, 0
    s_add_u32 s47, s47, 4096
    s_mov_b32 m0, s47
    s_nop 0
    global_load_lds_dwordx4 v10, s[50:51]
    s_add_u32 s50, s50, 131072
    s_addc_u32 s51, s51, 0
    s_add_u32 s47, s47, 4096
    s_mov_b32 m0, s47
    s_nop 0
    global_load_lds_dwordx4 v10, s[50:51]
    s_add_u32 s50, s50, 131072
    s_addc_u32 s51, s51, 0
    s_add_u32 s47, s47, 4096
    s_mov_b32 m0, s47
    s_nop 0
    global_load_lds_dwordx4 v10, s[50:51]
    s_add_u32 s50, s50, 131072
    s_addc_u32 s51, s51, 0
    s_add_u32 s47, s47, 4096
    s_mov_b32 m0, s47
    s_nop 0
    global_load_lds_dwordx4 v10, s[50:51]
    s_add_u32 s50, s50, 131072
    s_addc_u32 s51, s51, 0
    s_add_u32 s47, s47, 4096
    s_mov_b32 m0, s47
    s_nop 0
    global_load_lds_dwordx4 v10, s[50:51]
    s_add_u32 s50, s50, 131072
    s_addc_u32 s51, s51, 0
    s_add_u32 s47, s47, 4096
    s_mov_b32 m0, s47
    s_nop 0
    global_load_lds_dwordx4 v10, s[50:51]
    s_add_u32 s50, s50, 131072
    s_addc_u32 s51, s51, 0
    s_add_u32 s47, s47, 4096
    s_mov_b32 m0, s47
    s_nop 0
    global_load_lds_dwordx4 v10, s[50:51]
    s_add_u32 s50, s50, 131072
    s_addc_u32 s51, s51, 0
    s_add_u32 s47, s47, 4096
    s_mov_b32 m0, s47
    s_nop 0
    global_load_lds_dwordx4 v10, s[50:51]
    s_add_u32 s50, s50, 131072
    s_addc_u32 s51, s51, 0
    s_add_u32 s47, s47, 4096
    s_mov_b32 m0, s47
    s_nop 0
    global_load_lds_dwordx4 v10, s[50:51]
    s_add_u32 s50, s50, 131072
    s_addc_u32 s51, s51, 0
    s_add_u32 s47, s47, 4096
    s_mov_b32 m0, s47
    s_nop 0
    global_load_lds_dwordx4 v10, s[50:51]
    s_add_u32 s50, s50, 131072
    s_addc_u32 s51, s51, 0
    s_add_u32 s47, s47, 4096
    s_mov_b32 m0, s47
    s_nop 0
    global_load_lds_dwordx4 v10, s[50:51]
    s_add_u32 s50, s50, 131072
    s_addc_u32 s51, s51, 0
    s_add_u32 s47, s47, 4096
    s_mov_b32 m0, s47
    s_nop 0
    global_load_lds_dwordx4 v10, s[50:51]
    s_add_u32 s50, s50, 131072
    s_addc_u32 s51, s51, 0
    s_add_u32 s47, s47, 4096
    s_mov_b32 m0, s47
    s_nop 0
    global_load_lds_dwordx4 v10, s[50:51]
    s_add_u32 s50, s50, 131072
    s_addc_u32 s51, s51, 0
    s_add_u32 s47, s47, 4096
    s_mov_b32 m0, s47
    s_nop 0
    global_load_lds_dwordx4 v10, s[50:51]
    s_add_u32 s50, s50, 131072
    s_addc_u32 s51, s51, 0
    s_add_u32 s47, s47, 4096
    s_mov_b32 m0, s47
    s_nop 0
    global_load_lds_dwordx4 v10, s[50:51]
    s_add_u32 s50, s50, 131072
    s_addc_u32 s51, s51, 0
    s_add_u32 s47, s47, 4096
    s_mov_b32 m0, s47
    s_nop 0
    global_load_lds_dwordx4 v10, s[50:51]
    s_add_u32 s50, s50, 131072
    s_addc_u32 s51, s51, 0
    s_add_u32 s47, s47, 4096
    s_mov_b32 m0, s47
    s_nop 0
    global_load_lds_dwordx4 v10, s[50:51]
    s_add_u32 s50, s50, 131072
    s_addc_u32 s51, s51, 0
    s_add_u32 s47, s47, 4096
    s_mov_b32 m0, s47
    s_nop 0
    global_load_lds_dwordx4 v10, s[50:51]
    s_add_u32 s50, s50, 131072
    s_addc_u32 s51, s51, 0
    s_add_u32 s47, s47, 4096
    s_mov_b32 m0, s47
    s_nop 0
    global_load_lds_dwordx4 v10, s[50:51]
    s_add_u32 s50, s50, 131072
    s_addc_u32 s51, s51, 0
    s_add_u32 s47, s47, 4096
    s_mov_b32 m0, s47
    s_nop 0
    global_load_lds_dwordx4 v10, s[50:51]
    s_add_u32 s50, s50, 131072
    s_addc_u32 s51, s51, 0
    s_add_u32 s47, s47, 4096
    s_mov_b32 m0, s47
    s_nop 0
    global_load_lds_dwordx4 v10, s[50:51]
    s_add_u32 s50, s50, 131072
    s_addc_u32 s51, s51, 0
    s_add_u32 s47, s47, 4096
    s_mov_b32 m0, s47
    s_nop 0
    global_load_lds_dwordx4 v10, s[50:51]
    s_add_u32 s50, s50, 131072
    s_addc_u32 s51, s51, 0
    s_add_u32 s47, s47, 4096
    s_mov_b32 m0, s47
    s_nop 0
    global_load_lds_dwordx4 v10, s[50:51]
    s_add_u32 s50, s50, 131072
    s_addc_u32 s51, s51, 0
    s_add_u32 s47, s47, 4096
    s_mov_b32 m0, s47
    s_nop 0
    global_load_lds_dwordx4 v10, s[50:51]
    s_add_u32 s50, s50, 131072
    s_addc_u32 s51, s51, 0
    s_add_u32 s47, s47, 4096
    s_mov_b32 m0, s47
    s_nop 0
    global_load_lds_dwordx4 v10, s[50:51]
    s_add_u32 s50, s50, 131072
    s_addc_u32 s51, s51, 0
    s_add_u32 s47, s47, 4096
    s_mov_b32 m0, s47
    s_nop 0
    global_load_lds_dwordx4 v10, s[50:51]
    s_add_u32 s50, s50, 131072
    s_addc_u32 s51, s51, 0
    s_add_u32 s47, s47, 4096
    s_waitcnt vmcnt(0)
    s_barrier
    s_mov_b32 s45, 0x0
    s_lshr_b32 s46, s40, 0
    s_and_b32 s46, s46, 0x3
    s_mul_i32 s46, s46, 0x40
    s_add_u32 s45, s45, s46
    v_mov_b32 v10, s45
    s_mov_b32 s46, 0x8
    v_mad_u32_u24 v10, v4, s46, v10
    s_mov_b32 s46, 0x10
    v_mad_u32_u24 v10, v5, s46, v10
    s_mov_b32 s46, 0x100
    v_mad_u32_u24 v10, v6, s46, v10
    s_mov_b32 s46, 0x200
    v_mad_u32_u24 v10, v7, s46, v10
    s_mov_b32 s46, 0x20
    v_mad_u32_u24 v10, v8, s46, v10
    s_mov_b32 s46, 0x800
    v_mad_u32_u24 v10, v9, s46, v10
    v_add_u32 v11, 0, v10
    ds_read_b64_tr_b16 a[128:129], v11 offset:0
    ds_read_b64_tr_b16 a[130:131], v11 offset:1024
    ds_read_b64_tr_b16 a[132:133], v11 offset:4096
    ds_read_b64_tr_b16 a[134:135], v11 offset:5120
    ds_read_b64_tr_b16 a[136:137], v11 offset:8192
    ds_read_b64_tr_b16 a[138:139], v11 offset:9216
    ds_read_b64_tr_b16 a[140:141], v11 offset:12288
    ds_read_b64_tr_b16 a[142:143], v11 offset:13312
    s_waitcnt lgkmcnt(0)
    ds_read_b64_tr_b16 a[144:145], v11 offset:16384
    ds_read_b64_tr_b16 a[146:147], v11 offset:17408
    ds_read_b64_tr_b16 a[148:149], v11 offset:20480
    ds_read_b64_tr_b16 a[150:151], v11 offset:21504
    ds_read_b64_tr_b16 a[152:153], v11 offset:24576
    ds_read_b64_tr_b16 a[154:155], v11 offset:25600
    ds_read_b64_tr_b16 a[156:157], v11 offset:28672
    ds_read_b64_tr_b16 a[158:159], v11 offset:29696
    s_waitcnt lgkmcnt(0)
    v_add_u32 v11, 32768, v10
    ds_read_b64_tr_b16 a[160:161], v11 offset:0
    ds_read_b64_tr_b16 a[162:163], v11 offset:1024
    ds_read_b64_tr_b16 a[164:165], v11 offset:4096
    ds_read_b64_tr_b16 a[166:167], v11 offset:5120
    ds_read_b64_tr_b16 a[168:169], v11 offset:8192
    ds_read_b64_tr_b16 a[170:171], v11 offset:9216
    ds_read_b64_tr_b16 a[172:173], v11 offset:12288
    ds_read_b64_tr_b16 a[174:175], v11 offset:13312
    s_waitcnt lgkmcnt(0)
    ds_read_b64_tr_b16 a[176:177], v11 offset:16384
    ds_read_b64_tr_b16 a[178:179], v11 offset:17408
    ds_read_b64_tr_b16 a[180:181], v11 offset:20480
    ds_read_b64_tr_b16 a[182:183], v11 offset:21504
    ds_read_b64_tr_b16 a[184:185], v11 offset:24576
    ds_read_b64_tr_b16 a[186:187], v11 offset:25600
    ds_read_b64_tr_b16 a[188:189], v11 offset:28672
    ds_read_b64_tr_b16 a[190:191], v11 offset:29696
    s_waitcnt lgkmcnt(0)
    v_add_u32 v11, 65536, v10
    ds_read_b64_tr_b16 a[192:193], v11 offset:0
    ds_read_b64_tr_b16 a[194:195], v11 offset:1024
    ds_read_b64_tr_b16 a[196:197], v11 offset:4096
    ds_read_b64_tr_b16 a[198:199], v11 offset:5120
    ds_read_b64_tr_b16 a[200:201], v11 offset:8192
    ds_read_b64_tr_b16 a[202:203], v11 offset:9216
    ds_read_b64_tr_b16 a[204:205], v11 offset:12288
    ds_read_b64_tr_b16 a[206:207], v11 offset:13312
    s_waitcnt lgkmcnt(0)
    ds_read_b64_tr_b16 a[208:209], v11 offset:16384
    ds_read_b64_tr_b16 a[210:211], v11 offset:17408
    ds_read_b64_tr_b16 a[212:213], v11 offset:20480
    ds_read_b64_tr_b16 a[214:215], v11 offset:21504
    ds_read_b64_tr_b16 a[216:217], v11 offset:24576
    ds_read_b64_tr_b16 a[218:219], v11 offset:25600
    ds_read_b64_tr_b16 a[220:221], v11 offset:28672
    ds_read_b64_tr_b16 a[222:223], v11 offset:29696
    s_waitcnt lgkmcnt(0)
    v_add_u32 v11, 98304, v10
    ds_read_b64_tr_b16 a[224:225], v11 offset:0
    ds_read_b64_tr_b16 a[226:227], v11 offset:1024
    ds_read_b64_tr_b16 a[228:229], v11 offset:4096
    ds_read_b64_tr_b16 a[230:231], v11 offset:5120
    ds_read_b64_tr_b16 a[232:233], v11 offset:8192
    ds_read_b64_tr_b16 a[234:235], v11 offset:9216
    ds_read_b64_tr_b16 a[236:237], v11 offset:12288
    ds_read_b64_tr_b16 a[238:239], v11 offset:13312
    s_waitcnt lgkmcnt(0)
    ds_read_b64_tr_b16 a[240:241], v11 offset:16384
    ds_read_b64_tr_b16 a[242:243], v11 offset:17408
    ds_read_b64_tr_b16 a[244:245], v11 offset:20480
    ds_read_b64_tr_b16 a[246:247], v11 offset:21504
    ds_read_b64_tr_b16 a[248:249], v11 offset:24576
    ds_read_b64_tr_b16 a[250:251], v11 offset:25600
    ds_read_b64_tr_b16 a[252:253], v11 offset:28672
    ds_read_b64_tr_b16 a[254:255], v11 offset:29696
    s_waitcnt lgkmcnt(0)
    s_waitcnt lgkmcnt(0)
    s_barrier
    s_cmp_lg_u32 s40, 0
    s_cbranch_scc1 L_nopoll_113
    v_mov_b32 v12, 64
    s_mov_b64 exec, 1
L_iw_114:
    buffer_load_dword v13, v12, s[36:39], 0 offen sc1
    s_waitcnt vmcnt(0)
    v_cmp_gt_u32 vcc, 96, v13
    s_cbranch_vccz L_iwok_115
    s_add_u32 s44, s44, 1
    s_cmp_gt_u32 s44, 1048576
    s_cbranch_scc1 L_w_abort_100
    s_sleep 4
    s_branch L_iw_114
L_iwok_115:
    s_mov_b64 exec, -1
L_nopoll_113:
    s_barrier
    v_lshlrev_b32 v12, 6, v1
    s_cmp_ge_u32 s40, 2
    s_cbranch_scc1 L_hw_116
    s_lshl_b32 s48, s40, 12
    s_add_u32 s48, s48, 425984
    s_mov_b32 exec_lo, 0xffffffff
    s_mov_b32 exec_hi, 0xffffffff
L_wf_117:
    buffer_load_dword v13, v12, s[32:35], s48 offen sc1
    s_waitcnt vmcnt(0)
    v_cmp_gt_u32 vcc, 1, v13
    s_nop 0
    s_and_b32 vcc_lo, vcc_lo, 0xffffffff
    s_and_b32 vcc_hi, vcc_hi, 0xffffffff
    s_cmp_eq_u64 vcc, 0
    s_cbranch_scc1 L_wfok_118
    s_add_u32 s44, s44, 1
    s_cmp_gt_u32 s44, 1048576
    s_cbranch_scc1 L_w_abort_100
    s_sleep 1
    s_branch L_wf_117
L_wfok_118:
    s_mov_b64 exec, -1
L_wfskip_119:
L_hw_116:
    s_barrier
    s_mov_b32 s52, 2097152
    s_mov_b32 s53, 0
    s_lshl_b32 s45, s42, 10
    s_add_u32 s54, s45, 393472
    s_add_u32 s58, s54, 512
    s_mov_b32 s45, 0x1800000
    s_lshr_b32 s46, s40, 0
    s_and_b32 s46, s46, 0x3
    s_mul_i32 s46, s46, 0x400
    s_add_u32 s45, s45, s46
    s_lshr_b32 s46, s42, 0
    s_and_b32 s46, s46, 0xf
    s_mul_i32 s46, s46, 0x4000
    s_add_u32 s45, s45, s46
    v_mov_b32 v3, s45
    s_mov_b32 s46, 0x10
    v_mad_u32_u24 v3, v4, s46, v3
    s_mov_b32 s46, 0x20
    v_mad_u32_u24 v3, v5, s46, v3
    s_mov_b32 s46, 0x40
    v_mad_u32_u24 v3, v6, s46, v3
    s_mov_b32 s46, 0x80
    v_mad_u32_u24 v3, v7, s46, v3
    s_mov_b32 s46, 0x1000
    v_mad_u32_u24 v3, v8, s46, v3
    s_mov_b32 s46, 0x100
    v_mad_u32_u24 v3, v9, s46, v3
    s_mov_b32 s45, 0x1802000
    s_lshr_b32 s46, s40, 0
    s_and_b32 s46, s46, 0x3
    s_mul_i32 s46, s46, 0x400
    s_add_u32 s45, s45, s46
    s_lshr_b32 s46, s42, 0
    s_and_b32 s46, s46, 0xf
    s_mul_i32 s46, s46, 0x4000
    s_add_u32 s45, s45, s46
    v_mov_b32 v14, s45
    s_mov_b32 s46, 0x10
    v_mad_u32_u24 v14, v4, s46, v14
    s_mov_b32 s46, 0x20
    v_mad_u32_u24 v14, v5, s46, v14
    s_mov_b32 s46, 0x40
    v_mad_u32_u24 v14, v6, s46, v14
    s_mov_b32 s46, 0x80
    v_mad_u32_u24 v14, v7, s46, v14
    s_mov_b32 s46, 0x1000
    v_mad_u32_u24 v14, v8, s46, v14
    s_mov_b32 s46, 0x100
    v_mad_u32_u24 v14, v9, s46, v14
    s_mov_b32 s43, 0
    s_mov_b32 s56, 0
    s_lshl_b32 s45, s40, 13
    s_add_u32 s46, s52, s45
    s_add_u32 s45, s45, s56
    s_add_u32 m0, s45, 0
    s_add_u32 s47, s46, 0
    buffer_load_dwordx4 v2, s[32:35], s47 offen offset:0 sc1 lds
    buffer_load_dwordx4 v2, s[32:35], s47 offen offset:1024 sc1 lds
    buffer_load_dwordx4 v2, s[32:35], s47 offen offset:2048 sc1 lds
    buffer_load_dwordx4 v2, s[32:35], s47 offen offset:3072 sc1 lds
    s_add_u32 m0, s45, 4096
    s_add_u32 s47, s46, 4096
    buffer_load_dwordx4 v2, s[32:35], s47 offen offset:0 sc1 lds
    buffer_load_dwordx4 v2, s[32:35], s47 offen offset:1024 sc1 lds
    buffer_load_dwordx4 v2, s[32:35], s47 offen offset:2048 sc1 lds
    buffer_load_dwordx4 v2, s[32:35], s47 offen offset:3072 sc1 lds
    v_mov_b32 v15, v2
    s_waitcnt vmcnt(0)
L_q_120:
    s_waitcnt vmcnt(4)
    s_barrier
    s_xor_b32 s56, s56, 0x8000
    s_cmp_lt_u32 s43, 63
    s_cselect_b32 s45, 32768, 0
    s_add_u32 s52, s52, s45
    ds_read_b128 v[48:51], v15 offset:0
    ds_read_b128 v[52:55], v15 offset:1024
    ds_read_b128 v[56:59], v15 offset:2048
    ds_read_b128 v[60:63], v15 offset:3072
    ds_read_b128 v[64:67], v15 offset:4096
    ds_read_b128 v[68:71], v15 offset:5120
    ds_read_b128 v[72:75], v15 offset:6144
    ds_read_b128 v[76:79], v15 offset:7168
    s_lshl_b32 s45, s40, 13
    s_add_u32 s46, s52, s45
    s_add_u32 s45, s45, s56
    s_add_u32 m0, s45, 0
    s_add_u32 s47, s46, 0
    buffer_load_dwordx4 v2, s[32:35], s47 offen offset:0 sc1 lds
    buffer_load_dwordx4 v2, s[32:35], s47 offen offset:1024 sc1 lds
    buffer_load_dwordx4 v2, s[32:35], s47 offen offset:2048 sc1 lds
    buffer_load_dwordx4 v2, s[32:35], s47 offen offset:3072 sc1 lds
    s_add_u32 m0, s45, 4096
    s_add_u32 s47, s46, 4096
    buffer_load_dwordx4 v2, s[32:35], s47 offen offset:0 sc1 lds
    buffer_load_dwordx4 v2, s[32:35], s47 offen offset:1024 sc1 lds
    buffer_load_dwordx4 v2, s[32:35], s47 offen offset:2048 sc1 lds
    buffer_load_dwordx4 v2, s[32:35], s47 offen offset:3072 sc1 lds
    s_waitcnt lgkmcnt(7)
    v_mfma_f32_32x32x16_bf16 v[32:47], a[0:3], v[48:51], 0
    v_mfma_f32_32x32x16_bf16 v[80:95], a[128:131], v[48:51], 0
    ds_read_b128 v[48:51], v15 offset:8192
    s_waitcnt lgkmcnt(7)
    v_mfma_f32_32x32x16_bf16 v[32:47], a[4:7], v[52:55], v[32:47]
    v_mfma_f32_32x32x16_bf16 v[80:95], a[132:135], v[52:55], v[80:95]
    ds_read_b128 v[52:55], v15 offset:9216
    s_waitcnt lgkmcnt(7)
    v_mfma_f32_32x32x16_bf16 v[32:47], a[8:11], v[56:59], v[32:47]
    v_mfma_f32_32x32x16_bf16 v[80:95], a[136:139], v[56:59], v[80:95]
    ds_read_b128 v[56:59], v15 offset:10240
    s_waitcnt lgkmcnt(7)
    v_mfma_f32_32x32x16_bf16 v[32:47], a[12:15], v[60:63], v[32:47]
    v_mfma_f32_32x32x16_bf16 v[80:95], a[140:143], v[60:63], v[80:95]
    ds_read_b128 v[60:63], v15 offset:11264
    s_waitcnt lgkmcnt(7)
    v_mfma_f32_32x32x16_bf16 v[32:47], a[16:19], v[64:67], v[32:47]
    v_mfma_f32_32x32x16_bf16 v[80:95], a[144:147], v[64:67], v[80:95]
    ds_read_b128 v[64:67], v15 offset:12288
    s_waitcnt lgkmcnt(7)
    v_mfma_f32_32x32x16_bf16 v[32:47], a[20:23], v[68:71], v[32:47]
    v_mfma_f32_32x32x16_bf16 v[80:95], a[148:151], v[68:71], v[80:95]
    ds_read_b128 v[68:71], v15 offset:13312
    s_waitcnt lgkmcnt(7)
    v_mfma_f32_32x32x16_bf16 v[32:47], a[24:27], v[72:75], v[32:47]
    v_mfma_f32_32x32x16_bf16 v[80:95], a[152:155], v[72:75], v[80:95]
    ds_read_b128 v[72:75], v15 offset:14336
    s_waitcnt lgkmcnt(7)
    v_mfma_f32_32x32x16_bf16 v[32:47], a[28:31], v[76:79], v[32:47]
    v_mfma_f32_32x32x16_bf16 v[80:95], a[156:159], v[76:79], v[80:95]
    ds_read_b128 v[76:79], v15 offset:15360
    s_waitcnt lgkmcnt(7)
    v_mfma_f32_32x32x16_bf16 v[32:47], a[32:35], v[48:51], v[32:47]
    v_mfma_f32_32x32x16_bf16 v[80:95], a[160:163], v[48:51], v[80:95]
    ds_read_b128 v[48:51], v15 offset:16384
    s_waitcnt lgkmcnt(7)
    v_mfma_f32_32x32x16_bf16 v[32:47], a[36:39], v[52:55], v[32:47]
    v_mfma_f32_32x32x16_bf16 v[80:95], a[164:167], v[52:55], v[80:95]
    ds_read_b128 v[52:55], v15 offset:17408
    s_waitcnt lgkmcnt(7)
    v_mfma_f32_32x32x16_bf16 v[32:47], a[40:43], v[56:59], v[32:47]
    v_mfma_f32_32x32x16_bf16 v[80:95], a[168:171], v[56:59], v[80:95]
    ds_read_b128 v[56:59], v15 offset:18432
    s_waitcnt lgkmcnt(7)
    v_mfma_f32_32x32x16_bf16 v[32:47], a[44:47], v[60:63], v[32:47]
    v_mfma_f32_32x32x16_bf16 v[80:95], a[172:175], v[60:63], v[80:95]
    ds_read_b128 v[60:63], v15 offset:19456
    s_waitcnt lgkmcnt(7)
    v_mfma_f32_32x32x16_bf16 v[32:47], a[48:51], v[64:67], v[32:47]
    v_mfma_f32_32x32x16_bf16 v[80:95], a[176:179], v[64:67], v[80:95]
    ds_read_b128 v[64:67], v15 offset:20480
    s_waitcnt vmcnt(8)
    s_barrier
    s_cmp_lg_u32 s40, 3
    s_cbranch_scc1 L_nosig_121
    v_mov_b32 v13, s43
    v_mov_b32 v12, 0
    s_mov_b64 exec, 1
    buffer_store_dword v13, v12, s[32:35], s54 offen sc1
    s_mov_b64 exec, -1
    v_mov_b32 v13, s43
    v_mov_b32 v12, 0
    s_mov_b64 exec, 1
    buffer_store_dword v13, v12, s[32:35], s58 offen sc1
    s_mov_b64 exec, -1
L_nosig_121:
    s_waitcnt lgkmcnt(7)
    v_mfma_f32_32x32x16_bf16 v[32:47], a[52:55], v[68:71], v[32:47]
    v_mfma_f32_32x32x16_bf16 v[80:95], a[180:183], v[68:71], v[80:95]
    ds_read_b128 v[68:71], v15 offset:21504
    s_waitcnt lgkmcnt(7)
    v_mfma_f32_32x32x16_bf16 v[32:47], a[56:59], v[72:75], v[32:47]
    v_mfma_f32_32x32x16_bf16 v[80:95], a[184:187], v[72:75], v[80:95]
    ds_read_b128 v[72:75], v15 offset:22528
    s_waitcnt lgkmcnt(7)
    v_mfma_f32_32x32x16_bf16 v[32:47], a[60:63], v[76:79], v[32:47]
    v_mfma_f32_32x32x16_bf16 v[80:95], a[188:191], v[76:79], v[80:95]
    ds_read_b128 v[76:79], v15 offset:23552
    s_waitcnt lgkmcnt(7)
    v_mfma_f32_32x32x16_bf16 v[32:47], a[64:67], v[48:51], v[32:47]
    v_mfma_f32_32x32x16_bf16 v[80:95], a[192:195], v[48:51], v[80:95]
    ds_read_b128 v[48:51], v15 offset:24576
    s_waitcnt lgkmcnt(7)
    v_mfma_f32_32x32x16_bf16 v[32:47], a[68:71], v[52:55], v[32:47]
    v_mfma_f32_32x32x16_bf16 v[80:95], a[196:199], v[52:55], v[80:95]
    ds_read_b128 v[52:55], v15 offset:25600
    s_waitcnt lgkmcnt(7)
    v_mfma_f32_32x32x16_bf16 v[32:47], a[72:75], v[56:59], v[32:47]
    v_mfma_f32_32x32x16_bf16 v[80:95], a[200:203], v[56:59], v[80:95]
    ds_read_b128 v[56:59], v15 offset:26624
    s_waitcnt lgkmcnt(7)
    v_mfma_f32_32x32x16_bf16 v[32:47], a[76:79], v[60:63], v[32:47]
    v_mfma_f32_32x32x16_bf16 v[80:95], a[204:207], v[60:63], v[80:95]
    ds_read_b128 v[60:63], v15 offset:27648
    s_waitcnt lgkmcnt(7)
    v_mfma_f32_32x32x16_bf16 v[32:47], a[80:83], v[64:67], v[32:47]
    v_mfma_f32_32x32x16_bf16 v[80:95], a[208:211], v[64:67], v[80:95]
    ds_read_b128 v[64:67], v15 offset:28672
    s_waitcnt lgkmcnt(7)
    v_mfma_f32_32x32x16_bf16 v[32:47], a[84:87], v[68:71], v[32:47]
    v_mfma_f32_32x32x16_bf16 v[80:95], a[212:215], v[68:71], v[80:95]
    ds_read_b128 v[68:71], v15 offset:29696
    s_waitcnt lgkmcnt(7)
    v_mfma_f32_32x32x16_bf16 v[32:47], a[88:91], v[72:75], v[32:47]
    v_mfma_f32_32x32x16_bf16 v[80:95], a[216:219], v[72:75], v[80:95]
    ds_read_b128 v[72:75], v15 offset:30720
    s_waitcnt lgkmcnt(7)
    v_mfma_f32_32x32x16_bf16 v[32:47], a[92:95], v[76:79], v[32:47]
    v_mfma_f32_32x32x16_bf16 v[80:95], a[220:223], v[76:79], v[80:95]
    ds_read_b128 v[76:79], v15 offset:31744
    s_waitcnt lgkmcnt(7)
    v_mfma_f32_32x32x16_bf16 v[32:47], a[96:99], v[48:51], v[32:47]
    v_mfma_f32_32x32x16_bf16 v[80:95], a[224:227], v[48:51], v[80:95]
    s_waitcnt lgkmcnt(6)
    v_mfma_f32_32x32x16_bf16 v[32:47], a[100:103], v[52:55], v[32:47]
    v_mfma_f32_32x32x16_bf16 v[80:95], a[228:231], v[52:55], v[80:95]
    s_waitcnt lgkmcnt(5)
    v_mfma_f32_32x32x16_bf16 v[32:47], a[104:107], v[56:59], v[32:47]
    v_mfma_f32_32x32x16_bf16 v[80:95], a[232:235], v[56:59], v[80:95]
    s_waitcnt lgkmcnt(4)
    v_mfma_f32_32x32x16_bf16 v[32:47], a[108:111], v[60:63], v[32:47]
    v_mfma_f32_32x32x16_bf16 v[80:95], a[236:239], v[60:63], v[80:95]
    s_waitcnt lgkmcnt(3)
    v_mfma_f32_32x32x16_bf16 v[32:47], a[112:115], v[64:67], v[32:47]
    v_mfma_f32_32x32x16_bf16 v[80:95], a[240:243], v[64:67], v[80:95]
    s_waitcnt lgkmcnt(2)
    v_mfma_f32_32x32x16_bf16 v[32:47], a[116:119], v[68:71], v[32:47]
    v_mfma_f32_32x32x16_bf16 v[80:95], a[244:247], v[68:71], v[80:95]
    s_waitcnt lgkmcnt(1)
    v_mfma_f32_32x32x16_bf16 v[32:47], a[120:123], v[72:75], v[32:47]
    v_mfma_f32_32x32x16_bf16 v[80:95], a[248:251], v[72:75], v[80:95]
    s_waitcnt lgkmcnt(0)
    v_mfma_f32_32x32x16_bf16 v[32:47], a[124:127], v[76:79], v[32:47]
    v_mfma_f32_32x32x16_bf16 v[80:95], a[252:255], v[76:79], v[80:95]
    v_xor_b32 v15, 0x8000, v15
    s_nop 8
    v_cvt_pk_bf16_f32 v16, v32, v33
    v_cvt_pk_bf16_f32 v17, v34, v35
    v_cvt_pk_bf16_f32 v18, v36, v37
    v_cvt_pk_bf16_f32 v19, v38, v39
    v_cvt_pk_bf16_f32 v20, v40, v41
    v_cvt_pk_bf16_f32 v21, v42, v43
    v_cvt_pk_bf16_f32 v22, v44, v45
    v_cvt_pk_bf16_f32 v23, v46, v47
    buffer_store_dwordx4 v[16:19], v3, s[32:35], s53 offen sc1
    buffer_store_dwordx4 v[20:23], v3, s[32:35], s53 offen offset:512 sc1
    v_cvt_pk_bf16_f32 v24, v80, v81
    v_cvt_pk_bf16_f32 v25, v82, v83
    v_cvt_pk_bf16_f32 v26, v84, v85
    v_cvt_pk_bf16_f32 v27, v86, v87
    v_cvt_pk_bf16_f32 v28, v88, v89
    v_cvt_pk_bf16_f32 v29, v90, v91
    v_cvt_pk_bf16_f32 v30, v92, v93
    v_cvt_pk_bf16_f32 v31, v94, v95
    buffer_store_dwordx4 v[24:27], v14, s[32:35], s53 offen sc1
    buffer_store_dwordx4 v[28:31], v14, s[32:35], s53 offen offset:512 sc1
    s_add_u32 s53, s53, 262144
    s_add_u32 s43, s43, 1
    s_cmp_lt_u32 s43, 64
    s_cbranch_scc1 L_q_120
    s_waitcnt vmcnt(0)
    s_barrier
    v_mov_b32 v13, s43
    v_mov_b32 v12, 0
    s_mov_b64 exec, 1
    buffer_store_dword v13, v12, s[32:35], s54 offen sc1
    s_mov_b64 exec, -1
    v_mov_b32 v13, s43
    v_mov_b32 v12, 0
    s_mov_b64 exec, 1
    buffer_store_dword v13, v12, s[32:35], s58 offen sc1
    s_mov_b64 exec, -1
    s_waitcnt vmcnt(0)
    s_endpgm
L_notqkv_101:
    s_cmp_lt_u32 s41, 96
    s_cbranch_scc1 L_noln_a_123
    s_sub_u32 s45, s41, 96
    s_lshl_b32 s45, s45, 14
    s_lshl_b32 s46, s40, 12
    s_add_u32 s45, s45, s46
    v_add_u32 v12, s45, v2
    global_load_dwordx4 v[64:67], v12, s[4:5] offset:0
    global_load_dwordx4 v[68:71], v12, s[4:5] offset:1024
    global_load_dwordx4 v[72:75], v12, s[4:5] offset:2048
    global_load_dwordx4 v[76:79], v12, s[4:5] offset:3072
L_noln_a_123:
    s_cmp_lt_u32 s41, 128
    s_cbranch_scc1 L_nomod_122
    s_sub_u32 s48, s41, 128
    v_lshrrev_b32 v12, 2, v0
    v_and_b32 v13, 3, v0
    s_movk_i32 s57, 6144
    v_mul_lo_u32 v14, v12, s57
    v_lshl_add_u32 v14, v13, 4, v14
    s_lshl_b32 s45, s48, 6
    v_add_u32 v14, s45, v14
    v_lshlrev_b32 v15, 1, v12
    global_load_dwordx4 v[128:131], v14, s[24:25]
    global_load_ushort v24, v15, s[22:23] offset:0
    v_add_u32 v14, 393216, v14
    global_load_dwordx4 v[132:135], v14, s[24:25]
    global_load_ushort v25, v15, s[22:23] offset:128
    v_add_u32 v14, 393216, v14
    global_load_dwordx4 v[136:139], v14, s[24:25]
    global_load_ushort v26, v15, s[22:23] offset:256
    v_add_u32 v14, 393216, v14
    global_load_dwordx4 v[140:143], v14, s[24:25]
    global_load_ushort v27, v15, s[22:23] offset:384
    v_add_u32 v14, 393216, v14
    global_load_dwordx4 v[144:147], v14, s[24:25]
    global_load_ushort v28, v15, s[22:23] offset:512
    v_add_u32 v14, 393216, v14
    global_load_dwordx4 v[148:151], v14, s[24:25]
    global_load_ushort v29, v15, s[22:23] offset:640
    v_add_u32 v14, 393216, v14
    global_load_dwordx4 v[152:155], v14, s[24:25]
    global_load_ushort v30, v15, s[22:23] offset:768
    v_add_u32 v14, 393216, v14
    global_load_dwordx4 v[156:159], v14, s[24:25]
    global_load_ushort v31, v15, s[22:23] offset:896
    s_cmp_ge_u32 s48, 64
    s_cbranch_scc1 L_noclr_124
    s_lshl_b32 s45, s48, 10
    s_add_u32 s45, s45, 393216
    v_lshlrev_b32 v36, 2, v0
    v_mov_b32 v37, 0
    buffer_store_dword v37, v36, s[32:35], s45 offen sc1
L_noclr_124:
    v_mov_b32 v40, 0
    v_mov_b32 v41, 0
    v_mov_b32 v42, 0
    v_mov_b32 v43, 0
    v_mov_b32 v44, 0
    v_mov_b32 v45, 0
    v_mov_b32 v46, 0
    v_mov_b32 v47, 0
    s_waitcnt vmcnt(14)
    v_lshlrev_b32 v24, 16, v24
    v_mul_f32 v38, 0xbfb8aa3b, v24
    v_exp_f32 v38, v38
    s_nop 0
    v_add_f32 v38, 1.0, v38
    v_rcp_f32 v38, v38
    s_nop 0
    v_mul_f32 v24, v24, v38
    v_cvt_pk_bf16_f32 v38, v24, v24
    v_lshlrev_b32 v24, 16, v38
    v_and_b32 v39, 0xffff0000, v38
    v_and_b32 v49, 0xffff0000, v128
    v_lshlrev_b32 v48, 16, v128
    v_and_b32 v51, 0xffff0000, v129
    v_lshlrev_b32 v50, 16, v129
    v_and_b32 v53, 0xffff0000, v130
    v_lshlrev_b32 v52, 16, v130
    v_and_b32 v55, 0xffff0000, v131
    v_lshlrev_b32 v54, 16, v131
    v_fmac_f32 v40, v24, v48
    v_fmac_f32 v41, v24, v49
    v_fmac_f32 v42, v24, v50
    v_fmac_f32 v43, v24, v51
    v_fmac_f32 v44, v24, v52
    v_fmac_f32 v45, v24, v53
    v_fmac_f32 v46, v24, v54
    v_fmac_f32 v47, v24, v55
    s_waitcnt vmcnt(12)
    v_lshlrev_b32 v25, 16, v25
    v_mul_f32 v38, 0xbfb8aa3b, v25
    v_exp_f32 v38, v38
    s_nop 0
    v_add_f32 v38, 1.0, v38
    v_rcp_f32 v38, v38
    s_nop 0
    v_mul_f32 v25, v25, v38
    v_cvt_pk_bf16_f32 v38, v25, v25
    v_lshlrev_b32 v25, 16, v38
    v_and_b32 v39, 0xffff0000, v38
    v_and_b32 v49, 0xffff0000, v132
    v_lshlrev_b32 v48, 16, v132
    v_and_b32 v51, 0xffff0000, v133
    v_lshlrev_b32 v50, 16, v133
    v_and_b32 v53, 0xffff0000, v134
    v_lshlrev_b32 v52, 16, v134
    v_and_b32 v55, 0xffff0000, v135
    v_lshlrev_b32 v54, 16, v135
    v_fmac_f32 v40, v25, v48
    v_fmac_f32 v41, v25, v49
    v_fmac_f32 v42, v25, v50
    v_fmac_f32 v43, v25, v51
    v_fmac_f32 v44, v25, v52
    v_fmac_f32 v45, v25, v53
    v_fmac_f32 v46, v25, v54
    v_fmac_f32 v47, v25, v55
    s_waitcnt vmcnt(10)
    v_lshlrev_b32 v26, 16, v26
    v_mul_f32 v38, 0xbfb8aa3b, v26
    v_exp_f32 v38, v38
    s_nop 0
    v_add_f32 v38, 1.0, v38
    v_rcp_f32 v38, v38
    s_nop 0
    v_mul_f32 v26, v26, v38
    v_cvt_pk_bf16_f32 v38, v26, v26
    v_lshlrev_b32 v26, 16, v38
    v_and_b32 v39, 0xffff0000, v38
    v_and_b32 v49, 0xffff0000, v136
    v_lshlrev_b32 v48, 16, v136
    v_and_b32 v51, 0xffff0000, v137
    v_lshlrev_b32 v50, 16, v137
    v_and_b32 v53, 0xffff0000, v138
    v_lshlrev_b32 v52, 16, v138
    v_and_b32 v55, 0xffff0000, v139
    v_lshlrev_b32 v54, 16, v139
    v_fmac_f32 v40, v26, v48
    v_fmac_f32 v41, v26, v49
    v_fmac_f32 v42, v26, v50
    v_fmac_f32 v43, v26, v51
    v_fmac_f32 v44, v26, v52
    v_fmac_f32 v45, v26, v53
    v_fmac_f32 v46, v26, v54
    v_fmac_f32 v47, v26, v55
    s_waitcnt vmcnt(8)
    v_lshlrev_b32 v27, 16, v27
    v_mul_f32 v38, 0xbfb8aa3b, v27
    v_exp_f32 v38, v38
    s_nop 0
    v_add_f32 v38, 1.0, v38
    v_rcp_f32 v38, v38
    s_nop 0
    v_mul_f32 v27, v27, v38
    v_cvt_pk_bf16_f32 v38, v27, v27
    v_lshlrev_b32 v27, 16, v38
    v_and_b32 v39, 0xffff0000, v38
    v_and_b32 v49, 0xffff0000, v140
    v_lshlrev_b32 v48, 16, v140
    v_and_b32 v51, 0xffff0000, v141
    v_lshlrev_b32 v50, 16, v141
    v_and_b32 v53, 0xffff0000, v142
    v_lshlrev_b32 v52, 16, v142
    v_and_b32 v55, 0xffff0000, v143
    v_lshlrev_b32 v54, 16, v143
    v_fmac_f32 v40, v27, v48
    v_fmac_f32 v41, v27, v49
    v_fmac_f32 v42, v27, v50
    v_fmac_f32 v43, v27, v51
    v_fmac_f32 v44, v27, v52
    v_fmac_f32 v45, v27, v53
    v_fmac_f32 v46, v27, v54
    v_fmac_f32 v47, v27, v55
    s_waitcnt vmcnt(6)
    v_lshlrev_b32 v28, 16, v28
    v_mul_f32 v38, 0xbfb8aa3b, v28
    v_exp_f32 v38, v38
    s_nop 0
    v_add_f32 v38, 1.0, v38
    v_rcp_f32 v38, v38
    s_nop 0
    v_mul_f32 v28, v28, v38
    v_cvt_pk_bf16_f32 v38, v28, v28
    v_lshlrev_b32 v28, 16, v38
    v_and_b32 v39, 0xffff0000, v38
    v_and_b32 v49, 0xffff0000, v144
    v_lshlrev_b32 v48, 16, v144
    v_and_b32 v51, 0xffff0000, v145
    v_lshlrev_b32 v50, 16, v145
    v_and_b32 v53, 0xffff0000, v146
    v_lshlrev_b32 v52, 16, v146
    v_and_b32 v55, 0xffff0000, v147
    v_lshlrev_b32 v54, 16, v147
    v_fmac_f32 v40, v28, v48
    v_fmac_f32 v41, v28, v49
    v_fmac_f32 v42, v28, v50
    v_fmac_f32 v43, v28, v51
    v_fmac_f32 v44, v28, v52
    v_fmac_f32 v45, v28, v53
    v_fmac_f32 v46, v28, v54
    v_fmac_f32 v47, v28, v55
    s_waitcnt vmcnt(4)
    v_lshlrev_b32 v29, 16, v29
    v_mul_f32 v38, 0xbfb8aa3b, v29
    v_exp_f32 v38, v38
    s_nop 0
    v_add_f32 v38, 1.0, v38
    v_rcp_f32 v38, v38
    s_nop 0
    v_mul_f32 v29, v29, v38
    v_cvt_pk_bf16_f32 v38, v29, v29
    v_lshlrev_b32 v29, 16, v38
    v_and_b32 v39, 0xffff0000, v38
    v_and_b32 v49, 0xffff0000, v148
    v_lshlrev_b32 v48, 16, v148
    v_and_b32 v51, 0xffff0000, v149
    v_lshlrev_b32 v50, 16, v149
    v_and_b32 v53, 0xffff0000, v150
    v_lshlrev_b32 v52, 16, v150
    v_and_b32 v55, 0xffff0000, v151
    v_lshlrev_b32 v54, 16, v151
    v_fmac_f32 v40, v29, v48
    v_fmac_f32 v41, v29, v49
    v_fmac_f32 v42, v29, v50
    v_fmac_f32 v43, v29, v51
    v_fmac_f32 v44, v29, v52
    v_fmac_f32 v45, v29, v53
    v_fmac_f32 v46, v29, v54
    v_fmac_f32 v47, v29, v55
    s_waitcnt vmcnt(2)
    v_lshlrev_b32 v30, 16, v30
    v_mul_f32 v38, 0xbfb8aa3b, v30
    v_exp_f32 v38, v38
    s_nop 0
    v_add_f32 v38, 1.0, v38
    v_rcp_f32 v38, v38
    s_nop 0
    v_mul_f32 v30, v30, v38
    v_cvt_pk_bf16_f32 v38, v30, v30
    v_lshlrev_b32 v30, 16, v38
    v_and_b32 v39, 0xffff0000, v38
    v_and_b32 v49, 0xffff0000, v152
    v_lshlrev_b32 v48, 16, v152
    v_and_b32 v51, 0xffff0000, v153
    v_lshlrev_b32 v50, 16, v153
    v_and_b32 v53, 0xffff0000, v154
    v_lshlrev_b32 v52, 16, v154
    v_and_b32 v55, 0xffff0000, v155
    v_lshlrev_b32 v54, 16, v155
    v_fmac_f32 v40, v30, v48
    v_fmac_f32 v41, v30, v49
    v_fmac_f32 v42, v30, v50
    v_fmac_f32 v43, v30, v51
    v_fmac_f32 v44, v30, v52
    v_fmac_f32 v45, v30, v53
    v_fmac_f32 v46, v30, v54
    v_fmac_f32 v47, v30, v55
    s_waitcnt vmcnt(0)
    v_lshlrev_b32 v31, 16, v31
    v_mul_f32 v38, 0xbfb8aa3b, v31
    v_exp_f32 v38, v38
    s_nop 0
    v_add_f32 v38, 1.0, v38
    v_rcp_f32 v38, v38
    s_nop 0
    v_mul_f32 v31, v31, v38
    v_cvt_pk_bf16_f32 v38, v31, v31
    v_lshlrev_b32 v31, 16, v38
    v_and_b32 v39, 0xffff0000, v38
    v_and_b32 v49, 0xffff0000, v156
    v_lshlrev_b32 v48, 16, v156
    v_and_b32 v51, 0xffff0000, v157
    v_lshlrev_b32 v50, 16, v157
    v_and_b32 v53, 0xffff0000, v158
    v_lshlrev_b32 v52, 16, v158
    v_and_b32 v55, 0xffff0000, v159
    v_lshlrev_b32 v54, 16, v159
    v_fmac_f32 v40, v31, v48
    v_fmac_f32 v41, v31, v49
    v_fmac_f32 v42, v31, v50
    v_fmac_f32 v43, v31, v51
    v_fmac_f32 v44, v31, v52
    v_fmac_f32 v45, v31, v53
    v_fmac_f32 v46, v31, v54
    v_fmac_f32 v47, v31, v55
    v_lshlrev_b32 v12, 5, v0
    v_add_u32 v12, 131072, v12
    ds_write_b128 v12, v[40:43]
    ds_write_b128 v12, v[44:47] offset:16
    s_waitcnt lgkmcnt(0)
    s_barrier
    v_lshrrev_b32 v12, 5, v0
    v_lshlrev_b32 v12, 10, v12
    v_and_b32 v13, 31, v0
    v_lshl_add_u32 v12, v13, 2, v12
    v_add_u32 v12, 131072, v12
    ds_read_b32 v16, v12 offset:0
    ds_read_b32 v17, v12 offset:128
    ds_read_b32 v18, v12 offset:256
    ds_read_b32 v19, v12 offset:384
    ds_read_b32 v20, v12 offset:512
    ds_read_b32 v21, v12 offset:640
    ds_read_b32 v22, v12 offset:768
    ds_read_b32 v23, v12 offset:896
    s_waitcnt lgkmcnt(6)
    v_add_f32 v16, v16, v17
    s_waitcnt lgkmcnt(5)
    v_add_f32 v16, v16, v18
    s_waitcnt lgkmcnt(4)
    v_add_f32 v16, v16, v19
    s_waitcnt lgkmcnt(3)
    v_add_f32 v16, v16, v20
    s_waitcnt lgkmcnt(2)
    v_add_f32 v16, v16, v21
    s_waitcnt lgkmcnt(1)
    v_add_f32 v16, v16, v22
    s_waitcnt lgkmcnt(0)
    v_add_f32 v16, v16, v23
    v_lshlrev_b32 v12, 2, v0
    v_add_u32 v12, 139264, v12
    ds_write_b32 v12, v16
    s_waitcnt vmcnt(0) lgkmcnt(0)
    s_barrier
    s_cmp_lg_u32 s40, 0
    s_cbranch_scc1 L_nomod_122
    v_lshlrev_b32 v12, 2, v13
    v_add_u32 v14, 139264, v12
    ds_read_b32 v16, v14 offset:0
    ds_read_b32 v17, v14 offset:128
    ds_read_b32 v18, v14 offset:256
    ds_read_b32 v19, v14 offset:384
    ds_read_b32 v20, v14 offset:512
    ds_read_b32 v21, v14 offset:640
    ds_read_b32 v22, v14 offset:768
    ds_read_b32 v23, v14 offset:896
    s_waitcnt lgkmcnt(6)
    v_add_f32 v16, v16, v17
    s_waitcnt lgkmcnt(5)
    v_add_f32 v16, v16, v18
    s_waitcnt lgkmcnt(4)
    v_add_f32 v16, v16, v19
    s_waitcnt lgkmcnt(3)
    v_add_f32 v16, v16, v20
    s_waitcnt lgkmcnt(2)
    v_add_f32 v16, v16, v21
    s_waitcnt lgkmcnt(1)
    v_add_f32 v16, v16, v22
    s_waitcnt lgkmcnt(0)
    v_add_f32 v16, v16, v23
    v_cvt_pk_bf16_f32 v18, v16, v16
    v_lshlrev_b32 v16, 16, v18
    v_and_b32 v17, 0xffff0000, v18
    s_lshl_b32 s45, s48, 7
    s_mov_b32 exec_hi, 0
    buffer_store_dword v16, v12, s[32:35], s45 offen sc1
    v_mov_b32 v12, 128
    v_mov_b32 v13, 1
    s_mov_b64 exec, 1
    s_waitcnt vmcnt(0)
    buffer_atomic_add v13, v12, s[36:39], 0 offen sc0
    s_waitcnt vmcnt(0)
    v_cmp_eq_u32 vcc, 95, v13
    s_cbranch_vccz L_notlast_126
    v_mov_b32 v12, 64
    v_mov_b32 v13, 96
    buffer_store_dword v13, v12, s[36:39], 0 offen sc1
L_notlast_126:
    s_mov_b64 exec, -1
L_nomod_122:
    s_cmp_lt_u32 s41, 96
    s_cbranch_scc1 L_noln_b_127
    s_waitcnt vmcnt(3)
    v_and_b32 v81, 0xffff0000, v64
    v_lshlrev_b32 v80, 16, v64
    v_and_b32 v83, 0xffff0000, v65
    v_lshlrev_b32 v82, 16, v65
    v_and_b32 v85, 0xffff0000, v66
    v_lshlrev_b32 v84, 16, v66
    v_and_b32 v87, 0xffff0000, v67
    v_lshlrev_b32 v86, 16, v67
    v_add_f32 v12, v80, v81
    v_add_f32 v12, v12, v82
    v_add_f32 v12, v12, v83
    v_add_f32 v12, v12, v84
    v_add_f32 v12, v12, v85
    v_add_f32 v12, v12, v86
    v_add_f32 v12, v12, v87
    s_nop 1
    v_add_f32_dpp v12, v12, v12 row_ror:8 row_mask:0xf bank_mask:0xf
    s_nop 1
    v_add_f32_dpp v12, v12, v12 row_ror:4 row_mask:0xf bank_mask:0xf
    s_nop 1
    v_add_f32_dpp v12, v12, v12 row_ror:2 row_mask:0xf bank_mask:0xf
    s_nop 1
    v_add_f32_dpp v12, v12, v12 row_ror:1 row_mask:0xf bank_mask:0xf
    v_mov_b32 v13, v12
    s_nop 1
    v_permlane16_swap_b32 v12, v13
    v_add_f32 v12, v12, v13
    v_mov_b32 v13, v12
    s_nop 1
    v_permlane32_swap_b32 v12, v13
    v_add_f32 v12, v12, v13
    v_mul_f32 v14, 0x3b000000, v12
    v_sub_f32 v13, v80, v14
    v_mul_f32 v15, v13, v13
    v_sub_f32 v13, v81, v14
    v_fmac_f32 v15, v13, v13
    v_sub_f32 v13, v82, v14
    v_fmac_f32 v15, v13, v13
    v_sub_f32 v13, v83, v14
    v_fmac_f32 v15, v13, v13
    v_sub_f32 v13, v84, v14
    v_fmac_f32 v15, v13, v13
    v_sub_f32 v13, v85, v14
    v_fmac_f32 v15, v13, v13
    v_sub_f32 v13, v86, v14
    v_fmac_f32 v15, v13, v13
    v_sub_f32 v13, v87, v14
    v_fmac_f32 v15, v13, v13
    s_nop 1
    v_add_f32_dpp v15, v15, v15 row_ror:8 row_mask:0xf bank_mask:0xf
    s_nop 1
    v_add_f32_dpp v15, v15, v15 row_ror:4 row_mask:0xf bank_mask:0xf
    s_nop 1
    v_add_f32_dpp v15, v15, v15 row_ror:2 row_mask:0xf bank_mask:0xf
    s_nop 1
    v_add_f32_dpp v15, v15, v15 row_ror:1 row_mask:0xf bank_mask:0xf
    v_mov_b32 v13, v15
    s_nop 1
    v_permlane16_swap_b32 v15, v13
    v_add_f32 v15, v15, v13
    v_mov_b32 v13, v15
    s_nop 1
    v_permlane32_swap_b32 v15, v13
    v_add_f32 v15, v15, v13
    v_mul_f32 v15, 0x3b000000, v15
    v_cvt_pk_bf16_f32 v13, v14, v15
    v_lshlrev_b32 v14, 16, v13
    v_and_b32 v15, 0xffff0000, v13
    v_add_f32 v15, 0x3727c5ac, v15
    v_cvt_pk_bf16_f32 v13, v15, v15
    v_lshlrev_b32 v15, 16, v13
    v_and_b32 v12, 0xffff0000, v13
    v_sqrt_f32 v15, v15
    s_nop 0
    v_cvt_pk_bf16_f32 v13, v15, v15
    v_lshlrev_b32 v15, 16, v13
    v_and_b32 v12, 0xffff0000, v13
    v_rcp_f32 v15, v15
    v_sub_f32 v80, v80, v14
    v_sub_f32 v81, v81, v14
    v_cvt_pk_bf16_f32 v13, v80, v81
    v_lshlrev_b32 v80, 16, v13
    v_and_b32 v81, 0xffff0000, v13
    v_mul_f32 v80, v80, v15
    v_mul_f32 v81, v81, v15
    v_cvt_pk_bf16_f32 v13, v80, v81
    v_lshlrev_b32 v80, 16, v13
    v_and_b32 v81, 0xffff0000, v13
    v_sub_f32 v82, v82, v14
    v_sub_f32 v83, v83, v14
    v_cvt_pk_bf16_f32 v13, v82, v83
    v_lshlrev_b32 v82, 16, v13
    v_and_b32 v83, 0xffff0000, v13
    v_mul_f32 v82, v82, v15
    v_mul_f32 v83, v83, v15
    v_cvt_pk_bf16_f32 v13, v82, v83
    v_lshlrev_b32 v82, 16, v13
    v_and_b32 v83, 0xffff0000, v13
    v_sub_f32 v84, v84, v14
    v_sub_f32 v85, v85, v14
    v_cvt_pk_bf16_f32 v13, v84, v85
    v_lshlrev_b32 v84, 16, v13
    v_and_b32 v85, 0xffff0000, v13
    v_mul_f32 v84, v84, v15
    v_mul_f32 v85, v85, v15
    v_cvt_pk_bf16_f32 v13, v84, v85
    v_lshlrev_b32 v84, 16, v13
    v_and_b32 v85, 0xffff0000, v13
    v_sub_f32 v86, v86, v14
    v_sub_f32 v87, v87, v14
    v_cvt_pk_bf16_f32 v13, v86, v87
    v_lshlrev_b32 v86, 16, v13
    v_and_b32 v87, 0xffff0000, v13
    v_mul_f32 v86, v86, v15
    v_mul_f32 v87, v87, v15
    v_cvt_pk_bf16_f32 v13, v86, v87
    v_lshlrev_b32 v86, 16, v13
    v_and_b32 v87, 0xffff0000, v13
    s_waitcnt vmcnt(2)
    v_and_b32 v89, 0xffff0000, v68
    v_lshlrev_b32 v88, 16, v68
    v_and_b32 v91, 0xffff0000, v69
    v_lshlrev_b32 v90, 16, v69
    v_and_b32 v93, 0xffff0000, v70
    v_lshlrev_b32 v92, 16, v70
    v_and_b32 v95, 0xffff0000, v71
    v_lshlrev_b32 v94, 16, v71
    v_add_f32 v12, v88, v89
    v_add_f32 v12, v12, v90
    v_add_f32 v12, v12, v91
    v_add_f32 v12, v12, v92
    v_add_f32 v12, v12, v93
    v_add_f32 v12, v12, v94
    v_add_f32 v12, v12, v95
    s_nop 1
    v_add_f32_dpp v12, v12, v12 row_ror:8 row_mask:0xf bank_mask:0xf
    s_nop 1
    v_add_f32_dpp v12, v12, v12 row_ror:4 row_mask:0xf bank_mask:0xf
    s_nop 1
    v_add_f32_dpp v12, v12, v12 row_ror:2 row_mask:0xf bank_mask:0xf
    s_nop 1
    v_add_f32_dpp v12, v12, v12 row_ror:1 row_mask:0xf bank_mask:0xf
    v_mov_b32 v13, v12
    s_nop 1
    v_permlane16_swap_b32 v12, v13
    v_add_f32 v12, v12, v13
    v_mov_b32 v13, v12
    s_nop 1
    v_permlane32_swap_b32 v12, v13
    v_add_f32 v12, v12, v13
    v_mul_f32 v14, 0x3b000000, v12
    v_sub_f32 v13, v88, v14
    v_mul_f32 v15, v13, v13
    v_sub_f32 v13, v89, v14
    v_fmac_f32 v15, v13, v13
    v_sub_f32 v13, v90, v14
    v_fmac_f32 v15, v13, v13
    v_sub_f32 v13, v91, v14
    v_fmac_f32 v15, v13, v13
    v_sub_f32 v13, v92, v14
    v_fmac_f32 v15, v13, v13
    v_sub_f32 v13, v93, v14
    v_fmac_f32 v15, v13, v13
    v_sub_f32 v13, v94, v14
    v_fmac_f32 v15, v13, v13
    v_sub_f32 v13, v95, v14
    v_fmac_f32 v15, v13, v13
    s_nop 1
    v_add_f32_dpp v15, v15, v15 row_ror:8 row_mask:0xf bank_mask:0xf
    s_nop 1
    v_add_f32_dpp v15, v15, v15 row_ror:4 row_mask:0xf bank_mask:0xf
    s_nop 1
    v_add_f32_dpp v15, v15, v15 row_ror:2 row_mask:0xf bank_mask:0xf
    s_nop 1
    v_add_f32_dpp v15, v15, v15 row_ror:1 row_mask:0xf bank_mask:0xf
    v_mov_b32 v13, v15
    s_nop 1
    v_permlane16_swap_b32 v15, v13
    v_add_f32 v15, v15, v13
    v_mov_b32 v13, v15
    s_nop 1
    v_permlane32_swap_b32 v15, v13
    v_add_f32 v15, v15, v13
    v_mul_f32 v15, 0x3b000000, v15
    v_cvt_pk_bf16_f32 v13, v14, v15
    v_lshlrev_b32 v14, 16, v13
    v_and_b32 v15, 0xffff0000, v13
    v_add_f32 v15, 0x3727c5ac, v15
    v_cvt_pk_bf16_f32 v13, v15, v15
    v_lshlrev_b32 v15, 16, v13
    v_and_b32 v12, 0xffff0000, v13
    v_sqrt_f32 v15, v15
    s_nop 0
    v_cvt_pk_bf16_f32 v13, v15, v15
    v_lshlrev_b32 v15, 16, v13
    v_and_b32 v12, 0xffff0000, v13
    v_rcp_f32 v15, v15
    v_sub_f32 v88, v88, v14
    v_sub_f32 v89, v89, v14
    v_cvt_pk_bf16_f32 v13, v88, v89
    v_lshlrev_b32 v88, 16, v13
    v_and_b32 v89, 0xffff0000, v13
    v_mul_f32 v88, v88, v15
    v_mul_f32 v89, v89, v15
    v_cvt_pk_bf16_f32 v13, v88, v89
    v_lshlrev_b32 v88, 16, v13
    v_and_b32 v89, 0xffff0000, v13
    v_sub_f32 v90, v90, v14
    v_sub_f32 v91, v91, v14
    v_cvt_pk_bf16_f32 v13, v90, v91
    v_lshlrev_b32 v90, 16, v13
    v_and_b32 v91, 0xffff0000, v13
    v_mul_f32 v90, v90, v15
    v_mul_f32 v91, v91, v15
    v_cvt_pk_bf16_f32 v13, v90, v91
    v_lshlrev_b32 v90, 16, v13
    v_and_b32 v91, 0xffff0000, v13
    v_sub_f32 v92, v92, v14
    v_sub_f32 v93, v93, v14
    v_cvt_pk_bf16_f32 v13, v92, v93
    v_lshlrev_b32 v92, 16, v13
    v_and_b32 v93, 0xffff0000, v13
    v_mul_f32 v92, v92, v15
    v_mul_f32 v93, v93, v15
    v_cvt_pk_bf16_f32 v13, v92, v93
    v_lshlrev_b32 v92, 16, v13
    v_and_b32 v93, 0xffff0000, v13
    v_sub_f32 v94, v94, v14
    v_sub_f32 v95, v95, v14
    v_cvt_pk_bf16_f32 v13, v94, v95
    v_lshlrev_b32 v94, 16, v13
    v_and_b32 v95, 0xffff0000, v13
    v_mul_f32 v94, v94, v15
    v_mul_f32 v95, v95, v15
    v_cvt_pk_bf16_f32 v13, v94, v95
    v_lshlrev_b32 v94, 16, v13
    v_and_b32 v95, 0xffff0000, v13
    s_waitcnt vmcnt(1)
    v_and_b32 v97, 0xffff0000, v72
    v_lshlrev_b32 v96, 16, v72
    v_and_b32 v99, 0xffff0000, v73
    v_lshlrev_b32 v98, 16, v73
    v_and_b32 v101, 0xffff0000, v74
    v_lshlrev_b32 v100, 16, v74
    v_and_b32 v103, 0xffff0000, v75
    v_lshlrev_b32 v102, 16, v75
    v_add_f32 v12, v96, v97
    v_add_f32 v12, v12, v98
    v_add_f32 v12, v12, v99
    v_add_f32 v12, v12, v100
    v_add_f32 v12, v12, v101
    v_add_f32 v12, v12, v102
    v_add_f32 v12, v12, v103
    s_nop 1
    v_add_f32_dpp v12, v12, v12 row_ror:8 row_mask:0xf bank_mask:0xf
    s_nop 1
    v_add_f32_dpp v12, v12, v12 row_ror:4 row_mask:0xf bank_mask:0xf
    s_nop 1
    v_add_f32_dpp v12, v12, v12 row_ror:2 row_mask:0xf bank_mask:0xf
    s_nop 1
    v_add_f32_dpp v12, v12, v12 row_ror:1 row_mask:0xf bank_mask:0xf
    v_mov_b32 v13, v12
    s_nop 1
    v_permlane16_swap_b32 v12, v13
    v_add_f32 v12, v12, v13
    v_mov_b32 v13, v12
    s_nop 1
    v_permlane32_swap_b32 v12, v13
    v_add_f32 v12, v12, v13
    v_mul_f32 v14, 0x3b000000, v12
    v_sub_f32 v13, v96, v14
    v_mul_f32 v15, v13, v13
    v_sub_f32 v13, v97, v14
    v_fmac_f32 v15, v13, v13
    v_sub_f32 v13, v98, v14
    v_fmac_f32 v15, v13, v13
    v_sub_f32 v13, v99, v14
    v_fmac_f32 v15, v13, v13
    v_sub_f32 v13, v100, v14
    v_fmac_f32 v15, v13, v13
    v_sub_f32 v13, v101, v14
    v_fmac_f32 v15, v13, v13
    v_sub_f32 v13, v102, v14
    v_fmac_f32 v15, v13, v13
    v_sub_f32 v13, v103, v14
    v_fmac_f32 v15, v13, v13
    s_nop 1
    v_add_f32_dpp v15, v15, v15 row_ror:8 row_mask:0xf bank_mask:0xf
    s_nop 1
    v_add_f32_dpp v15, v15, v15 row_ror:4 row_mask:0xf bank_mask:0xf
    s_nop 1
    v_add_f32_dpp v15, v15, v15 row_ror:2 row_mask:0xf bank_mask:0xf
    s_nop 1
    v_add_f32_dpp v15, v15, v15 row_ror:1 row_mask:0xf bank_mask:0xf
    v_mov_b32 v13, v15
    s_nop 1
    v_permlane16_swap_b32 v15, v13
    v_add_f32 v15, v15, v13
    v_mov_b32 v13, v15
    s_nop 1
    v_permlane32_swap_b32 v15, v13
    v_add_f32 v15, v15, v13
    v_mul_f32 v15, 0x3b000000, v15
    v_cvt_pk_bf16_f32 v13, v14, v15
    v_lshlrev_b32 v14, 16, v13
    v_and_b32 v15, 0xffff0000, v13
    v_add_f32 v15, 0x3727c5ac, v15
    v_cvt_pk_bf16_f32 v13, v15, v15
    v_lshlrev_b32 v15, 16, v13
    v_and_b32 v12, 0xffff0000, v13
    v_sqrt_f32 v15, v15
    s_nop 0
    v_cvt_pk_bf16_f32 v13, v15, v15
    v_lshlrev_b32 v15, 16, v13
    v_and_b32 v12, 0xffff0000, v13
    v_rcp_f32 v15, v15
    v_sub_f32 v96, v96, v14
    v_sub_f32 v97, v97, v14
    v_cvt_pk_bf16_f32 v13, v96, v97
    v_lshlrev_b32 v96, 16, v13
    v_and_b32 v97, 0xffff0000, v13
    v_mul_f32 v96, v96, v15
    v_mul_f32 v97, v97, v15
    v_cvt_pk_bf16_f32 v13, v96, v97
    v_lshlrev_b32 v96, 16, v13
    v_and_b32 v97, 0xffff0000, v13
    v_sub_f32 v98, v98, v14
    v_sub_f32 v99, v99, v14
    v_cvt_pk_bf16_f32 v13, v98, v99
    v_lshlrev_b32 v98, 16, v13
    v_and_b32 v99, 0xffff0000, v13
    v_mul_f32 v98, v98, v15
    v_mul_f32 v99, v99, v15
    v_cvt_pk_bf16_f32 v13, v98, v99
    v_lshlrev_b32 v98, 16, v13
    v_and_b32 v99, 0xffff0000, v13
    v_sub_f32 v100, v100, v14
    v_sub_f32 v101, v101, v14
    v_cvt_pk_bf16_f32 v13, v100, v101
    v_lshlrev_b32 v100, 16, v13
    v_and_b32 v101, 0xffff0000, v13
    v_mul_f32 v100, v100, v15
    v_mul_f32 v101, v101, v15
    v_cvt_pk_bf16_f32 v13, v100, v101
    v_lshlrev_b32 v100, 16, v13
    v_and_b32 v101, 0xffff0000, v13
    v_sub_f32 v102, v102, v14
    v_sub_f32 v103, v103, v14
    v_cvt_pk_bf16_f32 v13, v102, v103
    v_lshlrev_b32 v102, 16, v13
    v_and_b32 v103, 0xffff0000, v13
    v_mul_f32 v102, v102, v15
    v_mul_f32 v103, v103, v15
    v_cvt_pk_bf16_f32 v13, v102, v103
    v_lshlrev_b32 v102, 16, v13
    v_and_b32 v103, 0xffff0000, v13
    s_waitcnt vmcnt(0)
    v_and_b32 v105, 0xffff0000, v76
    v_lshlrev_b32 v104, 16, v76
    v_and_b32 v107, 0xffff0000, v77
    v_lshlrev_b32 v106, 16, v77
    v_and_b32 v109, 0xffff0000, v78
    v_lshlrev_b32 v108, 16, v78
    v_and_b32 v111, 0xffff0000, v79
    v_lshlrev_b32 v110, 16, v79
    v_add_f32 v12, v104, v105
    v_add_f32 v12, v12, v106
    v_add_f32 v12, v12, v107
    v_add_f32 v12, v12, v108
    v_add_f32 v12, v12, v109
    v_add_f32 v12, v12, v110
    v_add_f32 v12, v12, v111
    s_nop 1
    v_add_f32_dpp v12, v12, v12 row_ror:8 row_mask:0xf bank_mask:0xf
    s_nop 1
    v_add_f32_dpp v12, v12, v12 row_ror:4 row_mask:0xf bank_mask:0xf
    s_nop 1
    v_add_f32_dpp v12, v12, v12 row_ror:2 row_mask:0xf bank_mask:0xf
    s_nop 1
    v_add_f32_dpp v12, v12, v12 row_ror:1 row_mask:0xf bank_mask:0xf
    v_mov_b32 v13, v12
    s_nop 1
    v_permlane16_swap_b32 v12, v13
    v_add_f32 v12, v12, v13
    v_mov_b32 v13, v12
    s_nop 1
    v_permlane32_swap_b32 v12, v13
    v_add_f32 v12, v12, v13
    v_mul_f32 v14, 0x3b000000, v12
    v_sub_f32 v13, v104, v14
    v_mul_f32 v15, v13, v13
    v_sub_f32 v13, v105, v14
    v_fmac_f32 v15, v13, v13
    v_sub_f32 v13, v106, v14
    v_fmac_f32 v15, v13, v13
    v_sub_f32 v13, v107, v14
    v_fmac_f32 v15, v13, v13
    v_sub_f32 v13, v108, v14
    v_fmac_f32 v15, v13, v13
    v_sub_f32 v13, v109, v14
    v_fmac_f32 v15, v13, v13
    v_sub_f32 v13, v110, v14
    v_fmac_f32 v15, v13, v13
    v_sub_f32 v13, v111, v14
    v_fmac_f32 v15, v13, v13
    s_nop 1
    v_add_f32_dpp v15, v15, v15 row_ror:8 row_mask:0xf bank_mask:0xf
    s_nop 1
    v_add_f32_dpp v15, v15, v15 row_ror:4 row_mask:0xf bank_mask:0xf
    s_nop 1
    v_add_f32_dpp v15, v15, v15 row_ror:2 row_mask:0xf bank_mask:0xf
    s_nop 1
    v_add_f32_dpp v15, v15, v15 row_ror:1 row_mask:0xf bank_mask:0xf
    v_mov_b32 v13, v15
    s_nop 1
    v_permlane16_swap_b32 v15, v13
    v_add_f32 v15, v15, v13
    v_mov_b32 v13, v15
    s_nop 1
    v_permlane32_swap_b32 v15, v13
    v_add_f32 v15, v15, v13
    v_mul_f32 v15, 0x3b000000, v15
    v_cvt_pk_bf16_f32 v13, v14, v15
    v_lshlrev_b32 v14, 16, v13
    v_and_b32 v15, 0xffff0000, v13
    v_add_f32 v15, 0x3727c5ac, v15
    v_cvt_pk_bf16_f32 v13, v15, v15
    v_lshlrev_b32 v15, 16, v13
    v_and_b32 v12, 0xffff0000, v13
    v_sqrt_f32 v15, v15
    s_nop 0
    v_cvt_pk_bf16_f32 v13, v15, v15
    v_lshlrev_b32 v15, 16, v13
    v_and_b32 v12, 0xffff0000, v13
    v_rcp_f32 v15, v15
    v_sub_f32 v104, v104, v14
    v_sub_f32 v105, v105, v14
    v_cvt_pk_bf16_f32 v13, v104, v105
    v_lshlrev_b32 v104, 16, v13
    v_and_b32 v105, 0xffff0000, v13
    v_mul_f32 v104, v104, v15
    v_mul_f32 v105, v105, v15
    v_cvt_pk_bf16_f32 v13, v104, v105
    v_lshlrev_b32 v104, 16, v13
    v_and_b32 v105, 0xffff0000, v13
    v_sub_f32 v106, v106, v14
    v_sub_f32 v107, v107, v14
    v_cvt_pk_bf16_f32 v13, v106, v107
    v_lshlrev_b32 v106, 16, v13
    v_and_b32 v107, 0xffff0000, v13
    v_mul_f32 v106, v106, v15
    v_mul_f32 v107, v107, v15
    v_cvt_pk_bf16_f32 v13, v106, v107
    v_lshlrev_b32 v106, 16, v13
    v_and_b32 v107, 0xffff0000, v13
    v_sub_f32 v108, v108, v14
    v_sub_f32 v109, v109, v14
    v_cvt_pk_bf16_f32 v13, v108, v109
    v_lshlrev_b32 v108, 16, v13
    v_and_b32 v109, 0xffff0000, v13
    v_mul_f32 v108, v108, v15
    v_mul_f32 v109, v109, v15
    v_cvt_pk_bf16_f32 v13, v108, v109
    v_lshlrev_b32 v108, 16, v13
    v_and_b32 v109, 0xffff0000, v13
    v_sub_f32 v110, v110, v14
    v_sub_f32 v111, v111, v14
    v_cvt_pk_bf16_f32 v13, v110, v111
    v_lshlrev_b32 v110, 16, v13
    v_and_b32 v111, 0xffff0000, v13
    v_mul_f32 v110, v110, v15
    v_mul_f32 v111, v111, v15
    v_cvt_pk_bf16_f32 v13, v110, v111
    v_lshlrev_b32 v110, 16, v13
    v_and_b32 v111, 0xffff0000, v13
L_noln_b_127:
    v_lshlrev_b32 v12, 2, v1
    s_cmp_lg_u32 s40, 0
    s_cbranch_scc1 L_nopoll_128
    v_mov_b32 v12, 64
    s_mov_b64 exec, 1
L_iw_129:
    buffer_load_dword v13, v12, s[36:39], 0 offen sc1
    s_waitcnt vmcnt(0)
    v_cmp_gt_u32 vcc, 96, v13
    s_cbranch_vccz L_iwok_130
    s_add_u32 s44, s44, 1
    s_cmp_gt_u32 s44, 1048576
    s_cbranch_scc1 L_w_abort_100
    s_sleep 4
    s_branch L_iw_129
L_iwok_130:
    s_mov_b64 exec, -1
L_nopoll_128:
    s_barrier
    s_cmp_lt_u32 s41, 96
    s_cbranch_scc1 L_noln_c_131
    v_lshlrev_b32 v12, 5, v1
    buffer_load_dwordx4 v[16:19], v12, s[32:35], 0 offen sc1
    buffer_load_dwordx4 v[20:23], v12, s[32:35], 0 offen offset:16 sc1
    buffer_load_dwordx4 v[24:27], v12, s[32:35], 0 offen offset:2048 sc1
    buffer_load_dwordx4 v[28:31], v12, s[32:35], 0 offen offset:2064 sc1
    s_waitcnt vmcnt(1)
    v_add_f32 v24, 1.0, v24
    v_add_f32 v25, 1.0, v25
    v_cvt_pk_bf16_f32 v13, v24, v25
    v_lshlrev_b32 v24, 16, v13
    v_and_b32 v25, 0xffff0000, v13
    v_add_f32 v26, 1.0, v26
    v_add_f32 v27, 1.0, v27
    v_cvt_pk_bf16_f32 v13, v26, v27
    v_lshlrev_b32 v26, 16, v13
    v_and_b32 v27, 0xffff0000, v13
    s_waitcnt vmcnt(0)
    v_add_f32 v28, 1.0, v28
    v_add_f32 v29, 1.0, v29
    v_cvt_pk_bf16_f32 v13, v28, v29
    v_lshlrev_b32 v28, 16, v13
    v_and_b32 v29, 0xffff0000, v13
    v_add_f32 v30, 1.0, v30
    v_add_f32 v31, 1.0, v31
    v_cvt_pk_bf16_f32 v13, v30, v31
    v_lshlrev_b32 v30, 16, v13
    v_and_b32 v31, 0xffff0000, v13
    v_lshlrev_b32 v14, 8, v1
    s_lshl_b32 s45, s40, 6
    s_add_u32 s45, s45, 147456
    v_add_u32 v14, s45, v14
    v_mul_f32 v80, v80, v24
    v_mul_f32 v81, v81, v25
    v_cvt_pk_bf16_f32 v13, v80, v81
    v_lshlrev_b32 v80, 16, v13
    v_and_b32 v81, 0xffff0000, v13
    v_add_f32 v80, v80, v16
    v_add_f32 v81, v81, v17
    v_cvt_pk_bf16_f32 v32, v80, v81
    v_mul_f32 v82, v82, v26
    v_mul_f32 v83, v83, v27
    v_cvt_pk_bf16_f32 v13, v82, v83
    v_lshlrev_b32 v82, 16, v13
    v_and_b32 v83, 0xffff0000, v13
    v_add_f32 v82, v82, v18
    v_add_f32 v83, v83, v19
    v_cvt_pk_bf16_f32 v33, v82, v83
    v_mul_f32 v84, v84, v28
    v_mul_f32 v85, v85, v29
    v_cvt_pk_bf16_f32 v13, v84, v85
    v_lshlrev_b32 v84, 16, v13
    v_and_b32 v85, 0xffff0000, v13
    v_add_f32 v84, v84, v20
    v_add_f32 v85, v85, v21
    v_cvt_pk_bf16_f32 v34, v84, v85
    v_mul_f32 v86, v86, v30
    v_mul_f32 v87, v87, v31
    v_cvt_pk_bf16_f32 v13, v86, v87
    v_lshlrev_b32 v86, 16, v13
    v_and_b32 v87, 0xffff0000, v13
    v_add_f32 v86, v86, v22
    v_add_f32 v87, v87, v23
    v_cvt_pk_bf16_f32 v35, v86, v87
    ds_write_b128 v14, v[32:35] offset:0
    v_mul_f32 v88, v88, v24
    v_mul_f32 v89, v89, v25
    v_cvt_pk_bf16_f32 v13, v88, v89
    v_lshlrev_b32 v88, 16, v13
    v_and_b32 v89, 0xffff0000, v13
    v_add_f32 v88, v88, v16
    v_add_f32 v89, v89, v17
    v_cvt_pk_bf16_f32 v36, v88, v89
    v_mul_f32 v90, v90, v26
    v_mul_f32 v91, v91, v27
    v_cvt_pk_bf16_f32 v13, v90, v91
    v_lshlrev_b32 v90, 16, v13
    v_and_b32 v91, 0xffff0000, v13
    v_add_f32 v90, v90, v18
    v_add_f32 v91, v91, v19
    v_cvt_pk_bf16_f32 v37, v90, v91
    v_mul_f32 v92, v92, v28
    v_mul_f32 v93, v93, v29
    v_cvt_pk_bf16_f32 v13, v92, v93
    v_lshlrev_b32 v92, 16, v13
    v_and_b32 v93, 0xffff0000, v13
    v_add_f32 v92, v92, v20
    v_add_f32 v93, v93, v21
    v_cvt_pk_bf16_f32 v38, v92, v93
    v_mul_f32 v94, v94, v30
    v_mul_f32 v95, v95, v31
    v_cvt_pk_bf16_f32 v13, v94, v95
    v_lshlrev_b32 v94, 16, v13
    v_and_b32 v95, 0xffff0000, v13
    v_add_f32 v94, v94, v22
    v_add_f32 v95, v95, v23
    v_cvt_pk_bf16_f32 v39, v94, v95
    ds_write_b128 v14, v[36:39] offset:16
    v_mul_f32 v96, v96, v24
    v_mul_f32 v97, v97, v25
    v_cvt_pk_bf16_f32 v13, v96, v97
    v_lshlrev_b32 v96, 16, v13
    v_and_b32 v97, 0xffff0000, v13
    v_add_f32 v96, v96, v16
    v_add_f32 v97, v97, v17
    v_cvt_pk_bf16_f32 v40, v96, v97
    v_mul_f32 v98, v98, v26
    v_mul_f32 v99, v99, v27
    v_cvt_pk_bf16_f32 v13, v98, v99
    v_lshlrev_b32 v98, 16, v13
    v_and_b32 v99, 0xffff0000, v13
    v_add_f32 v98, v98, v18
    v_add_f32 v99, v99, v19
    v_cvt_pk_bf16_f32 v41, v98, v99
    v_mul_f32 v100, v100, v28
    v_mul_f32 v101, v101, v29
    v_cvt_pk_bf16_f32 v13, v100, v101
    v_lshlrev_b32 v100, 16, v13
    v_and_b32 v101, 0xffff0000, v13
    v_add_f32 v100, v100, v20
    v_add_f32 v101, v101, v21
    v_cvt_pk_bf16_f32 v42, v100, v101
    v_mul_f32 v102, v102, v30
    v_mul_f32 v103, v103, v31
    v_cvt_pk_bf16_f32 v13, v102, v103
    v_lshlrev_b32 v102, 16, v13
    v_and_b32 v103, 0xffff0000, v13
    v_add_f32 v102, v102, v22
    v_add_f32 v103, v103, v23
    v_cvt_pk_bf16_f32 v43, v102, v103
    ds_write_b128 v14, v[40:43] offset:32
    v_mul_f32 v104, v104, v24
    v_mul_f32 v105, v105, v25
    v_cvt_pk_bf16_f32 v13, v104, v105
    v_lshlrev_b32 v104, 16, v13
    v_and_b32 v105, 0xffff0000, v13
    v_add_f32 v104, v104, v16
    v_add_f32 v105, v105, v17
    v_cvt_pk_bf16_f32 v44, v104, v105
    v_mul_f32 v106, v106, v26
    v_mul_f32 v107, v107, v27
    v_cvt_pk_bf16_f32 v13, v106, v107
    v_lshlrev_b32 v106, 16, v13
    v_and_b32 v107, 0xffff0000, v13
    v_add_f32 v106, v106, v18
    v_add_f32 v107, v107, v19
    v_cvt_pk_bf16_f32 v45, v106, v107
    v_mul_f32 v108, v108, v28
    v_mul_f32 v109, v109, v29
    v_cvt_pk_bf16_f32 v13, v108, v109
    v_lshlrev_b32 v108, 16, v13
    v_and_b32 v109, 0xffff0000, v13
    v_add_f32 v108, v108, v20
    v_add_f32 v109, v109, v21
    v_cvt_pk_bf16_f32 v46, v108, v109
    v_mul_f32 v110, v110, v30
    v_mul_f32 v111, v111, v31
    v_cvt_pk_bf16_f32 v13, v110, v111
    v_lshlrev_b32 v110, 16, v13
    v_and_b32 v111, 0xffff0000, v13
    v_add_f32 v110, v110, v22
    v_add_f32 v111, v111, v23
    v_cvt_pk_bf16_f32 v47, v110, v111
    ds_write_b128 v14, v[44:47] offset:48
    s_waitcnt lgkmcnt(0)
    s_barrier
    s_lshl_b32 s45, s40, 12
    s_add_u32 s45, s45, 147456
    v_add_u32 v14, s45, v2
    ds_read_b128 v[32:35], v14 offset:0
    ds_read_b128 v[36:39], v14 offset:1024
    ds_read_b128 v[40:43], v14 offset:2048
    ds_read_b128 v[44:47], v14 offset:3072
    s_sub_u32 s48, s41, 96
    s_mov_b32 s45, 0x200000
    s_lshr_b32 s46, s48, 1
    s_and_b32 s46, s46, 0x3f
    s_mul_i32 s46, s46, 0x8000
    s_add_u32 s45, s45, s46
    s_lshr_b32 s46, s48, 0
    s_and_b32 s46, s46, 0x1
    s_mul_i32 s46, s46, 0x100
    s_add_u32 s45, s45, s46
    s_lshr_b32 s46, s40, 0
    s_and_b32 s46, s46, 0x3
    s_mul_i32 s46, s46, 0x2000
    s_add_u32 s45, s45, s46
    v_mov_b32 v15, s45
    s_mov_b32 s46, 0x10
    v_mad_u32_u24 v15, v4, s46, v15
    s_mov_b32 s46, 0x20
    v_mad_u32_u24 v15, v5, s46, v15
    s_mov_b32 s46, 0x40
    v_mad_u32_u24 v15, v6, s46, v15
    s_mov_b32 s46, 0x80
    v_mad_u32_u24 v15, v7, s46, v15
    s_mov_b32 s46, 0x200
    v_mad_u32_u24 v15, v8, s46, v15
    s_mov_b32 s46, 0x400
    v_mad_u32_u24 v15, v9, s46, v15
    s_mov_b32 s45, 0
    s_waitcnt lgkmcnt(3)
    buffer_store_dwordx4 v[32:35], v15, s[32:35], s45 offen sc1
    s_mov_b32 s45, 2048
    s_waitcnt lgkmcnt(2)
    buffer_store_dwordx4 v[36:39], v15, s[32:35], s45 offen sc1
    s_mov_b32 s45, 4096
    s_waitcnt lgkmcnt(1)
    buffer_store_dwordx4 v[40:43], v15, s[32:35], s45 offen sc1
    s_mov_b32 s45, 6144
    s_waitcnt lgkmcnt(0)
    buffer_store_dwordx4 v[44:47], v15, s[32:35], s45 offen sc1
    s_waitcnt vmcnt(0)
    s_barrier
    s_cmp_lg_u32 s40, 0
    s_cbranch_scc1 L_hfl_132
    s_lshl_b32 s45, s48, 6
    s_add_u32 s45, s45, 425984
    v_mov_b32 v13, 1
    v_mov_b32 v12, 0
    s_mov_b64 exec, 1
    buffer_store_dword v13, v12, s[32:35], s45 offen sc1
    s_mov_b64 exec, -1
L_hfl_132:
L_noln_c_131:
    s_cmp_ge_u32 s41, 112
    s_cbranch_scc1 L_role_133
    s_sub_u32 s42, s41, 48
    s_lshr_b32 s97, s42, 4
    s_mov_b32 s45, 0x0
    s_lshr_b32 s46, s42, 1
    s_and_b32 s46, s46, 0x7
    s_mul_i32 s46, s46, 0x80000
    s_add_u32 s45, s45, s46
    s_lshr_b32 s46, s42, 0
    s_and_b32 s46, s46, 0x1
    s_mul_i32 s46, s46, 0x200
    s_add_u32 s45, s45, s46
    s_lshr_b32 s46, s40, 0
    s_and_b32 s46, s46, 0x3
    s_mul_i32 s46, s46, 0x1000
    s_add_u32 s45, s45, s46
    v_mov_b32 v10, s45
    s_mov_b32 s46, 0x10
    v_mad_u32_u24 v10, v4, s46, v10
    s_mov_b32 s46, 0x20
    v_mad_u32_u24 v10, v5, s46, v10
    s_mov_b32 s46, 0x40
    v_mad_u32_u24 v10, v6, s46, v10
    s_mov_b32 s46, 0x80
    v_mad_u32_u24 v10, v7, s46, v10
    s_mov_b32 s46, 0x400
    v_mad_u32_u24 v10, v8, s46, v10
    s_mov_b32 s46, 0x800
    v_mad_u32_u24 v10, v9, s46, v10
    s_mov_b32 s50, s14
    s_mov_b32 s51, s15
    s_lshl_b32 s47, s40, 10
    s_add_u32 s47, s47, 0
    s_mov_b32 m0, s47
    s_nop 0
    global_load_lds_dwordx4 v10, s[50:51]
    s_add_u32 s50, s50, 16384
    s_addc_u32 s51, s51, 0
    s_add_u32 s47, s47, 4096
    s_mov_b32 m0, s47
    s_nop 0
    global_load_lds_dwordx4 v10, s[50:51]
    s_add_u32 s50, s50, 16384
    s_addc_u32 s51, s51, 0
    s_add_u32 s47, s47, 4096
    s_mov_b32 m0, s47
    s_nop 0
    global_load_lds_dwordx4 v10, s[50:51]
    s_add_u32 s50, s50, 16384
    s_addc_u32 s51, s51, 0
    s_add_u32 s47, s47, 4096
    s_mov_b32 m0, s47
    s_nop 0
    global_load_lds_dwordx4 v10, s[50:51]
    s_add_u32 s50, s50, 16384
    s_addc_u32 s51, s51, 0
    s_add_u32 s47, s47, 4096
    s_mov_b32 m0, s47
    s_nop 0
    global_load_lds_dwordx4 v10, s[50:51]
    s_add_u32 s50, s50, 16384
    s_addc_u32 s51, s51, 0
    s_add_u32 s47, s47, 4096
    s_mov_b32 m0, s47
    s_nop 0
    global_load_lds_dwordx4 v10, s[50:51]
    s_add_u32 s50, s50, 16384
    s_addc_u32 s51, s51, 0
    s_add_u32 s47, s47, 4096
    s_mov_b32 m0, s47
    s_nop 0
    global_load_lds_dwordx4 v10, s[50:51]
    s_add_u32 s50, s50, 16384
    s_addc_u32 s51, s51, 0
    s_add_u32 s47, s47, 4096
    s_mov_b32 m0, s47
    s_nop 0
    global_load_lds_dwordx4 v10, s[50:51]
    s_add_u32 s50, s50, 16384
    s_addc_u32 s51, s51, 0
    s_add_u32 s47, s47, 4096
    s_mov_b32 m0, s47
    s_nop 0
    global_load_lds_dwordx4 v10, s[50:51]
    s_add_u32 s50, s50, 16384
    s_addc_u32 s51, s51, 0
    s_add_u32 s47, s47, 4096
    s_mov_b32 m0, s47
    s_nop 0
    global_load_lds_dwordx4 v10, s[50:51]
    s_add_u32 s50, s50, 16384
    s_addc_u32 s51, s51, 0
    s_add_u32 s47, s47, 4096
    s_mov_b32 m0, s47
    s_nop 0
    global_load_lds_dwordx4 v10, s[50:51]
    s_add_u32 s50, s50, 16384
    s_addc_u32 s51, s51, 0
    s_add_u32 s47, s47, 4096
    s_mov_b32 m0, s47
    s_nop 0
    global_load_lds_dwordx4 v10, s[50:51]
    s_add_u32 s50, s50, 16384
    s_addc_u32 s51, s51, 0
    s_add_u32 s47, s47, 4096
    s_mov_b32 m0, s47
    s_nop 0
    global_load_lds_dwordx4 v10, s[50:51]
    s_add_u32 s50, s50, 16384
    s_addc_u32 s51, s51, 0
    s_add_u32 s47, s47, 4096
    s_mov_b32 m0, s47
    s_nop 0
    global_load_lds_dwordx4 v10, s[50:51]
    s_add_u32 s50, s50, 16384
    s_addc_u32 s51, s51, 0
    s_add_u32 s47, s47, 4096
    s_mov_b32 m0, s47
    s_nop 0
    global_load_lds_dwordx4 v10, s[50:51]
    s_add_u32 s50, s50, 16384
    s_addc_u32 s51, s51, 0
    s_add_u32 s47, s47, 4096
    s_mov_b32 m0, s47
    s_nop 0
    global_load_lds_dwordx4 v10, s[50:51]
    s_add_u32 s50, s50, 16384
    s_addc_u32 s51, s51, 0
    s_add_u32 s47, s47, 4096
    s_mov_b32 m0, s47
    s_nop 0
    global_load_lds_dwordx4 v10, s[50:51]
    s_add_u32 s50, s50, 16384
    s_addc_u32 s51, s51, 0
    s_add_u32 s47, s47, 4096
    s_mov_b32 m0, s47
    s_nop 0
    global_load_lds_dwordx4 v10, s[50:51]
    s_add_u32 s50, s50, 16384
    s_addc_u32 s51, s51, 0
    s_add_u32 s47, s47, 4096
    s_mov_b32 m0, s47
    s_nop 0
    global_load_lds_dwordx4 v10, s[50:51]
    s_add_u32 s50, s50, 16384
    s_addc_u32 s51, s51, 0
    s_add_u32 s47, s47, 4096
    s_mov_b32 m0, s47
    s_nop 0
    global_load_lds_dwordx4 v10, s[50:51]
    s_add_u32 s50, s50, 16384
    s_addc_u32 s51, s51, 0
    s_add_u32 s47, s47, 4096
    s_mov_b32 m0, s47
    s_nop 0
    global_load_lds_dwordx4 v10, s[50:51]
    s_add_u32 s50, s50, 16384
    s_addc_u32 s51, s51, 0
    s_add_u32 s47, s47, 4096
    s_mov_b32 m0, s47
    s_nop 0
    global_load_lds_dwordx4 v10, s[50:51]
    s_add_u32 s50, s50, 16384
    s_addc_u32 s51, s51, 0
    s_add_u32 s47, s47, 4096
    s_mov_b32 m0, s47
    s_nop 0
    global_load_lds_dwordx4 v10, s[50:51]
    s_add_u32 s50, s50, 16384
    s_addc_u32 s51, s51, 0
    s_add_u32 s47, s47, 4096
    s_mov_b32 m0, s47
    s_nop 0
    global_load_lds_dwordx4 v10, s[50:51]
    s_add_u32 s50, s50, 16384
    s_addc_u32 s51, s51, 0
    s_add_u32 s47, s47, 4096
    s_mov_b32 m0, s47
    s_nop 0
    global_load_lds_dwordx4 v10, s[50:51]
    s_add_u32 s50, s50, 16384
    s_addc_u32 s51, s51, 0
    s_add_u32 s47, s47, 4096
    s_mov_b32 m0, s47
    s_nop 0
    global_load_lds_dwordx4 v10, s[50:51]
    s_add_u32 s50, s50, 16384
    s_addc_u32 s51, s51, 0
    s_add_u32 s47, s47, 4096
    s_mov_b32 m0, s47
    s_nop 0
    global_load_lds_dwordx4 v10, s[50:51]
    s_add_u32 s50, s50, 16384
    s_addc_u32 s51, s51, 0
    s_add_u32 s47, s47, 4096
    s_mov_b32 m0, s47
    s_nop 0
    global_load_lds_dwordx4 v10, s[50:51]
    s_add_u32 s50, s50, 16384
    s_addc_u32 s51, s51, 0
    s_add_u32 s47, s47, 4096
    s_mov_b32 m0, s47
    s_nop 0
    global_load_lds_dwordx4 v10, s[50:51]
    s_add_u32 s50, s50, 16384
    s_addc_u32 s51, s51, 0
    s_add_u32 s47, s47, 4096
    s_mov_b32 m0, s47
    s_nop 0
    global_load_lds_dwordx4 v10, s[50:51]
    s_add_u32 s50, s50, 16384
    s_addc_u32 s51, s51, 0
    s_add_u32 s47, s47, 4096
    s_mov_b32 m0, s47
    s_nop 0
    global_load_lds_dwordx4 v10, s[50:51]
    s_add_u32 s50, s50, 16384
    s_addc_u32 s51, s51, 0
    s_add_u32 s47, s47, 4096
    s_mov_b32 m0, s47
    s_nop 0
    global_load_lds_dwordx4 v10, s[50:51]
    s_add_u32 s50, s50, 16384
    s_addc_u32 s51, s51, 0
    s_add_u32 s47, s47, 4096
    s_waitcnt vmcnt(0)
    s_barrier
    s_mov_b32 s45, 0x0
    s_lshr_b32 s46, s40, 0
    s_and_b32 s46, s46, 0x3
    s_mul_i32 s46, s46, 0x40
    s_add_u32 s45, s45, s46
    v_mov_b32 v10, s45
    s_mov_b32 s46, 0x8
    v_mad_u32_u24 v10, v4, s46, v10
    s_mov_b32 s46, 0x10
    v_mad_u32_u24 v10, v5, s46, v10
    s_mov_b32 s46, 0x100
    v_mad_u32_u24 v10, v6, s46, v10
    s_mov_b32 s46, 0x200
    v_mad_u32_u24 v10, v7, s46, v10
    s_mov_b32 s46, 0x20
    v_mad_u32_u24 v10, v8, s46, v10
    s_mov_b32 s46, 0x400
    v_mad_u32_u24 v10, v9, s46, v10
    v_add_u32 v11, 0, v10
    ds_read_b64_tr_b16 a[0:1], v11 offset:0
    ds_read_b64_tr_b16 a[2:3], v11 offset:4096
    ds_read_b64_tr_b16 a[4:5], v11 offset:2048
    ds_read_b64_tr_b16 a[6:7], v11 offset:6144
    ds_read_b64_tr_b16 a[8:9], v11 offset:8192
    ds_read_b64_tr_b16 a[10:11], v11 offset:12288
    ds_read_b64_tr_b16 a[12:13], v11 offset:10240
    ds_read_b64_tr_b16 a[14:15], v11 offset:14336
    s_waitcnt lgkmcnt(0)
    ds_read_b64_tr_b16 a[16:17], v11 offset:16384
    ds_read_b64_tr_b16 a[18:19], v11 offset:20480
    ds_read_b64_tr_b16 a[20:21], v11 offset:18432
    ds_read_b64_tr_b16 a[22:23], v11 offset:22528
    ds_read_b64_tr_b16 a[24:25], v11 offset:24576
    ds_read_b64_tr_b16 a[26:27], v11 offset:28672
    ds_read_b64_tr_b16 a[28:29], v11 offset:26624
    ds_read_b64_tr_b16 a[30:31], v11 offset:30720
    s_waitcnt lgkmcnt(0)
    v_add_u32 v11, 32768, v10
    ds_read_b64_tr_b16 a[32:33], v11 offset:0
    ds_read_b64_tr_b16 a[34:35], v11 offset:4096
    ds_read_b64_tr_b16 a[36:37], v11 offset:2048
    ds_read_b64_tr_b16 a[38:39], v11 offset:6144
    ds_read_b64_tr_b16 a[40:41], v11 offset:8192
    ds_read_b64_tr_b16 a[42:43], v11 offset:12288
    ds_read_b64_tr_b16 a[44:45], v11 offset:10240
    ds_read_b64_tr_b16 a[46:47], v11 offset:14336
    s_waitcnt lgkmcnt(0)
    ds_read_b64_tr_b16 a[48:49], v11 offset:16384
    ds_read_b64_tr_b16 a[50:51], v11 offset:20480
    ds_read_b64_tr_b16 a[52:53], v11 offset:18432
    ds_read_b64_tr_b16 a[54:55], v11 offset:22528
    ds_read_b64_tr_b16 a[56:57], v11 offset:24576
    ds_read_b64_tr_b16 a[58:59], v11 offset:28672
    ds_read_b64_tr_b16 a[60:61], v11 offset:26624
    ds_read_b64_tr_b16 a[62:63], v11 offset:30720
    s_waitcnt lgkmcnt(0)
    v_add_u32 v11, 65536, v10
    ds_read_b64_tr_b16 a[64:65], v11 offset:0
    ds_read_b64_tr_b16 a[66:67], v11 offset:4096
    ds_read_b64_tr_b16 a[68:69], v11 offset:2048
    ds_read_b64_tr_b16 a[70:71], v11 offset:6144
    ds_read_b64_tr_b16 a[72:73], v11 offset:8192
    ds_read_b64_tr_b16 a[74:75], v11 offset:12288
    ds_read_b64_tr_b16 a[76:77], v11 offset:10240
    ds_read_b64_tr_b16 a[78:79], v11 offset:14336
    s_waitcnt lgkmcnt(0)
    ds_read_b64_tr_b16 a[80:81], v11 offset:16384
    ds_read_b64_tr_b16 a[82:83], v11 offset:20480
    ds_read_b64_tr_b16 a[84:85], v11 offset:18432
    ds_read_b64_tr_b16 a[86:87], v11 offset:22528
    ds_read_b64_tr_b16 a[88:89], v11 offset:24576
    ds_read_b64_tr_b16 a[90:91], v11 offset:28672
    ds_read_b64_tr_b16 a[92:93], v11 offset:26624
    ds_read_b64_tr_b16 a[94:95], v11 offset:30720
    s_waitcnt lgkmcnt(0)
    v_add_u32 v11, 98304, v10
    ds_read_b64_tr_b16 a[96:97], v11 offset:0
    ds_read_b64_tr_b16 a[98:99], v11 offset:4096
    ds_read_b64_tr_b16 a[100:101], v11 offset:2048
    ds_read_b64_tr_b16 a[102:103], v11 offset:6144
    ds_read_b64_tr_b16 a[104:105], v11 offset:8192
    ds_read_b64_tr_b16 a[106:107], v11 offset:12288
    ds_read_b64_tr_b16 a[108:109], v11 offset:10240
    ds_read_b64_tr_b16 a[110:111], v11 offset:14336
    s_waitcnt lgkmcnt(0)
    ds_read_b64_tr_b16 a[112:113], v11 offset:16384
    ds_read_b64_tr_b16 a[114:115], v11 offset:20480
    ds_read_b64_tr_b16 a[116:117], v11 offset:18432
    ds_read_b64_tr_b16 a[118:119], v11 offset:22528
    ds_read_b64_tr_b16 a[120:121], v11 offset:24576
    ds_read_b64_tr_b16 a[122:123], v11 offset:28672
    ds_read_b64_tr_b16 a[124:125], v11 offset:26624
    ds_read_b64_tr_b16 a[126:127], v11 offset:30720
    s_waitcnt lgkmcnt(0)
    s_waitcnt lgkmcnt(0)
    s_barrier
    s_mov_b32 s45, 0x100
    s_lshr_b32 s46, s42, 1
    s_and_b32 s46, s46, 0x7
    s_mul_i32 s46, s46, 0x80000
    s_add_u32 s45, s45, s46
    s_lshr_b32 s46, s42, 0
    s_and_b32 s46, s46, 0x1
    s_mul_i32 s46, s46, 0x200
    s_add_u32 s45, s45, s46
    s_lshr_b32 s46, s40, 0
    s_and_b32 s46, s46, 0x3
    s_mul_i32 s46, s46, 0x1000
    s_add_u32 s45, s45, s46
    v_mov_b32 v10, s45
    s_mov_b32 s46, 0x10
    v_mad_u32_u24 v10, v4, s46, v10
    s_mov_b32 s46, 0x20
    v_mad_u32_u24 v10, v5, s46, v10
    s_mov_b32 s46, 0x40
    v_mad_u32_u24 v10, v6, s46, v10
    s_mov_b32 s46, 0x80
    v_mad_u32_u24 v10, v7, s46, v10
    s_mov_b32 s46, 0x400
    v_mad_u32_u24 v10, v8, s46, v10
    s_mov_b32 s46, 0x800
    v_mad_u32_u24 v10, v9, s46, v10
    s_mov_b32 s50, s14
    s_mov_b32 s51, s15
    s_lshl_b32 s47, s40, 10
    s_add_u32 s47, s47, 0
    s_mov_b32 m0, s47
    s_nop 0
    global_load_lds_dwordx4 v10, s[50:51]
    s_add_u32 s50, s50, 16384
    s_addc_u32 s51, s51, 0
    s_add_u32 s47, s47, 4096
    s_mov_b32 m0, s47
    s_nop 0
    global_load_lds_dwordx4 v10, s[50:51]
    s_add_u32 s50, s50, 16384
    s_addc_u32 s51, s51, 0
    s_add_u32 s47, s47, 4096
    s_mov_b32 m0, s47
    s_nop 0
    global_load_lds_dwordx4 v10, s[50:51]
    s_add_u32 s50, s50, 16384
    s_addc_u32 s51, s51, 0
    s_add_u32 s47, s47, 4096
    s_mov_b32 m0, s47
    s_nop 0
    global_load_lds_dwordx4 v10, s[50:51]
    s_add_u32 s50, s50, 16384
    s_addc_u32 s51, s51, 0
    s_add_u32 s47, s47, 4096
    s_mov_b32 m0, s47
    s_nop 0
    global_load_lds_dwordx4 v10, s[50:51]
    s_add_u32 s50, s50, 16384
    s_addc_u32 s51, s51, 0
    s_add_u32 s47, s47, 4096
    s_mov_b32 m0, s47
    s_nop 0
    global_load_lds_dwordx4 v10, s[50:51]
    s_add_u32 s50, s50, 16384
    s_addc_u32 s51, s51, 0
    s_add_u32 s47, s47, 4096
    s_mov_b32 m0, s47
    s_nop 0
    global_load_lds_dwordx4 v10, s[50:51]
    s_add_u32 s50, s50, 16384
    s_addc_u32 s51, s51, 0
    s_add_u32 s47, s47, 4096
    s_mov_b32 m0, s47
    s_nop 0
    global_load_lds_dwordx4 v10, s[50:51]
    s_add_u32 s50, s50, 16384
    s_addc_u32 s51, s51, 0
    s_add_u32 s47, s47, 4096
    s_mov_b32 m0, s47
    s_nop 0
    global_load_lds_dwordx4 v10, s[50:51]
    s_add_u32 s50, s50, 16384
    s_addc_u32 s51, s51, 0
    s_add_u32 s47, s47, 4096
    s_mov_b32 m0, s47
    s_nop 0
    global_load_lds_dwordx4 v10, s[50:51]
    s_add_u32 s50, s50, 16384
    s_addc_u32 s51, s51, 0
    s_add_u32 s47, s47, 4096
    s_mov_b32 m0, s47
    s_nop 0
    global_load_lds_dwordx4 v10, s[50:51]
    s_add_u32 s50, s50, 16384
    s_addc_u32 s51, s51, 0
    s_add_u32 s47, s47, 4096
    s_mov_b32 m0, s47
    s_nop 0
    global_load_lds_dwordx4 v10, s[50:51]
    s_add_u32 s50, s50, 16384
    s_addc_u32 s51, s51, 0
    s_add_u32 s47, s47, 4096
    s_mov_b32 m0, s47
    s_nop 0
    global_load_lds_dwordx4 v10, s[50:51]
    s_add_u32 s50, s50, 16384
    s_addc_u32 s51, s51, 0
    s_add_u32 s47, s47, 4096
    s_mov_b32 m0, s47
    s_nop 0
    global_load_lds_dwordx4 v10, s[50:51]
    s_add_u32 s50, s50, 16384
    s_addc_u32 s51, s51, 0
    s_add_u32 s47, s47, 4096
    s_mov_b32 m0, s47
    s_nop 0
    global_load_lds_dwordx4 v10, s[50:51]
    s_add_u32 s50, s50, 16384
    s_addc_u32 s51, s51, 0
    s_add_u32 s47, s47, 4096
    s_mov_b32 m0, s47
    s_nop 0
    global_load_lds_dwordx4 v10, s[50:51]
    s_add_u32 s50, s50, 16384
    s_addc_u32 s51, s51, 0
    s_add_u32 s47, s47, 4096
    s_mov_b32 m0, s47
    s_nop 0
    global_load_lds_dwordx4 v10, s[50:51]
    s_add_u32 s50, s50, 16384
    s_addc_u32 s51, s51, 0
    s_add_u32 s47, s47, 4096
    s_mov_b32 m0, s47
    s_nop 0
    global_load_lds_dwordx4 v10, s[50:51]
    s_add_u32 s50, s50, 16384
    s_addc_u32 s51, s51, 0
    s_add_u32 s47, s47, 4096
    s_mov_b32 m0, s47
    s_nop 0
    global_load_lds_dwordx4 v10, s[50:51]
    s_add_u32 s50, s50, 16384
    s_addc_u32 s51, s51, 0
    s_add_u32 s47, s47, 4096
    s_mov_b32 m0, s47
    s_nop 0
    global_load_lds_dwordx4 v10, s[50:51]
    s_add_u32 s50, s50, 16384
    s_addc_u32 s51, s51, 0
    s_add_u32 s47, s47, 4096
    s_mov_b32 m0, s47
    s_nop 0
    global_load_lds_dwordx4 v10, s[50:51]
    s_add_u32 s50, s50, 16384
    s_addc_u32 s51, s51, 0
    s_add_u32 s47, s47, 4096
    s_mov_b32 m0, s47
    s_nop 0
    global_load_lds_dwordx4 v10, s[50:51]
    s_add_u32 s50, s50, 16384
    s_addc_u32 s51, s51, 0
    s_add_u32 s47, s47, 4096
    s_mov_b32 m0, s47
    s_nop 0
    global_load_lds_dwordx4 v10, s[50:51]
    s_add_u32 s50, s50, 16384
    s_addc_u32 s51, s51, 0
    s_add_u32 s47, s47, 4096
    s_mov_b32 m0, s47
    s_nop 0
    global_load_lds_dwordx4 v10, s[50:51]
    s_add_u32 s50, s50, 16384
    s_addc_u32 s51, s51, 0
    s_add_u32 s47, s47, 4096
    s_mov_b32 m0, s47
    s_nop 0
    global_load_lds_dwordx4 v10, s[50:51]
    s_add_u32 s50, s50, 16384
    s_addc_u32 s51, s51, 0
    s_add_u32 s47, s47, 4096
    s_mov_b32 m0, s47
    s_nop 0
    global_load_lds_dwordx4 v10, s[50:51]
    s_add_u32 s50, s50, 16384
    s_addc_u32 s51, s51, 0
    s_add_u32 s47, s47, 4096
    s_mov_b32 m0, s47
    s_nop 0
    global_load_lds_dwordx4 v10, s[50:51]
    s_add_u32 s50, s50, 16384
    s_addc_u32 s51, s51, 0
    s_add_u32 s47, s47, 4096
    s_mov_b32 m0, s47
    s_nop 0
    global_load_lds_dwordx4 v10, s[50:51]
    s_add_u32 s50, s50, 16384
    s_addc_u32 s51, s51, 0
    s_add_u32 s47, s47, 4096
    s_mov_b32 m0, s47
    s_nop 0
    global_load_lds_dwordx4 v10, s[50:51]
    s_add_u32 s50, s50, 16384
    s_addc_u32 s51, s51, 0
    s_add_u32 s47, s47, 4096
    s_mov_b32 m0, s47
    s_nop 0
    global_load_lds_dwordx4 v10, s[50:51]
    s_add_u32 s50, s50, 16384
    s_addc_u32 s51, s51, 0
    s_add_u32 s47, s47, 4096
    s_mov_b32 m0, s47
    s_nop 0
    global_load_lds_dwordx4 v10, s[50:51]
    s_add_u32 s50, s50, 16384
    s_addc_u32 s51, s51, 0
    s_add_u32 s47, s47, 4096
    s_mov_b32 m0, s47
    s_nop 0
    global_load_lds_dwordx4 v10, s[50:51]
    s_add_u32 s50, s50, 16384
    s_addc_u32 s51, s51, 0
    s_add_u32 s47, s47, 4096
    s_waitcnt vmcnt(0)
    s_barrier
    s_mov_b32 s45, 0x0
    s_lshr_b32 s46, s40, 0
    s_and_b32 s46, s46, 0x3
    s_mul_i32 s46, s46, 0x40
    s_add_u32 s45, s45, s46
    v_mov_b32 v10, s45
    s_mov_b32 s46, 0x8
    v_mad_u32_u24 v10, v4, s46, v10
    s_mov_b32 s46, 0x10
    v_mad_u32_u24 v10, v5, s46, v10
    s_mov_b32 s46, 0x100
    v_mad_u32_u24 v10, v6, s46, v10
    s_mov_b32 s46, 0x200
    v_mad_u32_u24 v10, v7, s46, v10
    s_mov_b32 s46, 0x20
    v_mad_u32_u24 v10, v8, s46, v10
    s_mov_b32 s46, 0x400
    v_mad_u32_u24 v10, v9, s46, v10
    v_add_u32 v11, 0, v10
    ds_read_b64_tr_b16 a[128:129], v11 offset:0
    ds_read_b64_tr_b16 a[130:131], v11 offset:4096
    ds_read_b64_tr_b16 a[132:133], v11 offset:2048
    ds_read_b64_tr_b16 a[134:135], v11 offset:6144
    ds_read_b64_tr_b16 a[136:137], v11 offset:8192
    ds_read_b64_tr_b16 a[138:139], v11 offset:12288
    ds_read_b64_tr_b16 a[140:141], v11 offset:10240
    ds_read_b64_tr_b16 a[142:143], v11 offset:14336
    s_waitcnt lgkmcnt(0)
    ds_read_b64_tr_b16 a[144:145], v11 offset:16384
    ds_read_b64_tr_b16 a[146:147], v11 offset:20480
    ds_read_b64_tr_b16 a[148:149], v11 offset:18432
    ds_read_b64_tr_b16 a[150:151], v11 offset:22528
    ds_read_b64_tr_b16 a[152:153], v11 offset:24576
    ds_read_b64_tr_b16 a[154:155], v11 offset:28672
    ds_read_b64_tr_b16 a[156:157], v11 offset:26624
    ds_read_b64_tr_b16 a[158:159], v11 offset:30720
    s_waitcnt lgkmcnt(0)
    v_add_u32 v11, 32768, v10
    ds_read_b64_tr_b16 a[160:161], v11 offset:0
    ds_read_b64_tr_b16 a[162:163], v11 offset:4096
    ds_read_b64_tr_b16 a[164:165], v11 offset:2048
    ds_read_b64_tr_b16 a[166:167], v11 offset:6144
    ds_read_b64_tr_b16 a[168:169], v11 offset:8192
    ds_read_b64_tr_b16 a[170:171], v11 offset:12288
    ds_read_b64_tr_b16 a[172:173], v11 offset:10240
    ds_read_b64_tr_b16 a[174:175], v11 offset:14336
    s_waitcnt lgkmcnt(0)
    ds_read_b64_tr_b16 a[176:177], v11 offset:16384
    ds_read_b64_tr_b16 a[178:179], v11 offset:20480
    ds_read_b64_tr_b16 a[180:181], v11 offset:18432
    ds_read_b64_tr_b16 a[182:183], v11 offset:22528
    ds_read_b64_tr_b16 a[184:185], v11 offset:24576
    ds_read_b64_tr_b16 a[186:187], v11 offset:28672
    ds_read_b64_tr_b16 a[188:189], v11 offset:26624
    ds_read_b64_tr_b16 a[190:191], v11 offset:30720
    s_waitcnt lgkmcnt(0)
    v_add_u32 v11, 65536, v10
    ds_read_b64_tr_b16 a[192:193], v11 offset:0
    ds_read_b64_tr_b16 a[194:195], v11 offset:4096
    ds_read_b64_tr_b16 a[196:197], v11 offset:2048
    ds_read_b64_tr_b16 a[198:199], v11 offset:6144
    ds_read_b64_tr_b16 a[200:201], v11 offset:8192
    ds_read_b64_tr_b16 a[202:203], v11 offset:12288
    ds_read_b64_tr_b16 a[204:205], v11 offset:10240
    ds_read_b64_tr_b16 a[206:207], v11 offset:14336
    s_waitcnt lgkmcnt(0)
    ds_read_b64_tr_b16 a[208:209], v11 offset:16384
    ds_read_b64_tr_b16 a[210:211], v11 offset:20480
    ds_read_b64_tr_b16 a[212:213], v11 offset:18432
    ds_read_b64_tr_b16 a[214:215], v11 offset:22528
    ds_read_b64_tr_b16 a[216:217], v11 offset:24576
    ds_read_b64_tr_b16 a[218:219], v11 offset:28672
    ds_read_b64_tr_b16 a[220:221], v11 offset:26624
    ds_read_b64_tr_b16 a[222:223], v11 offset:30720
    s_waitcnt lgkmcnt(0)
    v_add_u32 v11, 98304, v10
    ds_read_b64_tr_b16 a[224:225], v11 offset:0
    ds_read_b64_tr_b16 a[226:227], v11 offset:4096
    ds_read_b64_tr_b16 a[228:229], v11 offset:2048
    ds_read_b64_tr_b16 a[230:231], v11 offset:6144
    ds_read_b64_tr_b16 a[232:233], v11 offset:8192
    ds_read_b64_tr_b16 a[234:235], v11 offset:12288
    ds_read_b64_tr_b16 a[236:237], v11 offset:10240
    ds_read_b64_tr_b16 a[238:239], v11 offset:14336
    s_waitcnt lgkmcnt(0)
    ds_read_b64_tr_b16 a[240:241], v11 offset:16384
    ds_read_b64_tr_b16 a[242:243], v11 offset:20480
    ds_read_b64_tr_b16 a[244:245], v11 offset:18432
    ds_read_b64_tr_b16 a[246:247], v11 offset:22528
    ds_read_b64_tr_b16 a[248:249], v11 offset:24576
    ds_read_b64_tr_b16 a[250:251], v11 offset:28672
    ds_read_b64_tr_b16 a[252:253], v11 offset:26624
    ds_read_b64_tr_b16 a[254:255], v11 offset:30720
    s_waitcnt lgkmcnt(0)
    s_waitcnt lgkmcnt(0)
    s_barrier
    s_lshl_b32 s45, s42, 7
    s_add_u32 s54, s45, 417792
    s_mov_b32 s53, 0
    s_mov_b32 s45, 0x5800000
    s_lshr_b32 s46, s42, 1
    s_and_b32 s46, s46, 0x1f
    s_mul_i32 s46, s46, 0x10000
    s_add_u32 s45, s45, s46
    s_lshr_b32 s46, s42, 0
    s_and_b32 s46, s46, 0x1
    s_mul_i32 s46, s46, 0x200
    s_add_u32 s45, s45, s46
    s_lshr_b32 s46, s40, 0
    s_and_b32 s46, s46, 0x3
    s_mul_i32 s46, s46, 0x40
    s_add_u32 s45, s45, s46
    v_mov_b32 v19, s45
    s_mov_b32 s46, 0x4
    v_mad_u32_u24 v19, v4, s46, v19
    s_mov_b32 s46, 0x8
    v_mad_u32_u24 v19, v5, s46, v19
    s_mov_b32 s46, 0x400
    v_mad_u32_u24 v19, v6, s46, v19
    s_mov_b32 s46, 0x10
    v_mad_u32_u24 v19, v7, s46, v19
    s_mov_b32 s46, 0x20
    v_mad_u32_u24 v19, v8, s46, v19
    s_mov_b32 s46, 0x2000
    v_mad_u32_u24 v19, v9, s46, v19
    s_and_b32 s62, s42, 0xe
    s_lshl_b32 s62, s62, 1
    s_add_u32 s62, s62, s40
    s_mov_b32 s64, 0xfff0ffff
    s_mov_b32 s65, 0x0
    s_mov_b32 s66, 0xffe0fffe
    s_mov_b32 s67, 0x0
    s_mov_b32 s68, 0xffc0fffc
    s_mov_b32 s69, 0x0
    s_mov_b32 s70, 0xff80fff8
    s_mov_b32 s71, 0x0
    s_mov_b32 s72, 0xf000ff00
    s_mov_b32 s73, 0x0
    s_mov_b32 s74, 0xe000fe00
    s_mov_b32 s75, 0x0
    s_mov_b32 s76, 0xc000fc00
    s_mov_b32 s77, 0x0
    s_mov_b32 s78, 0x8000f800
    s_mov_b32 s79, 0x0
    s_mov_b32 s80, 0xffffffff
    s_mov_b32 s81, 0xfff0ffff
    s_mov_b32 s82, 0xffffffff
    s_mov_b32 s83, 0xffe0fffe
    s_mov_b32 s84, 0xffffffff
    s_mov_b32 s85, 0xffc0fffc
    s_mov_b32 s86, 0xffffffff
    s_mov_b32 s87, 0xff80fff8
    s_mov_b32 s88, 0xffffffff
    s_mov_b32 s89, 0xf000ff00
    s_mov_b32 s90, 0xffffffff
    s_mov_b32 s91, 0xe000fe00
    s_mov_b32 s92, 0xffffffff
    s_mov_b32 s93, 0xc000fc00
    s_mov_b32 s94, 0xffffffff
    s_mov_b32 s95, 0x8000f800
    s_mov_b32 s57, 0x3db504f3
    s_mov_b32 s58, 0x3fb8aa3b
    s_lshl_b32 s45, s62, 9
    s_add_u32 s59, s45, 393216
    s_lshl_b32 s46, s97, 5
    s_add_u32 s46, s46, s62
    s_lshl_b32 s52, s46, 13
    s_lshl_b32 s60, s46, 12
    s_mov_b32 s49, 0
    s_mov_b32 s96, 0
    s_mov_b32 s45, 0x8000
    s_lshr_b32 s46, s40, 0
    s_and_b32 s46, s46, 0x3
    s_mul_i32 s46, s46, 0x1000
    s_add_u32 s45, s45, s46
    v_mov_b32 v3, s45
    s_mov_b32 s46, 0x20
    v_mad_u32_u24 v3, v4, s46, v3
    s_mov_b32 s46, 0x40
    v_mad_u32_u24 v3, v5, s46, v3
    s_mov_b32 s46, 0x80
    v_mad_u32_u24 v3, v6, s46, v3
    s_mov_b32 s46, 0x100
    v_mad_u32_u24 v3, v7, s46, v3
    s_mov_b32 s46, 0x8
    v_mad_u32_u24 v3, v8, s46, v3
    s_mov_b32 s46, 0x10
    v_mad_u32_u24 v3, v9, s46, v3
    s_mov_b32 s45, 0x8000
    s_lshr_b32 s46, s40, 0
    s_and_b32 s46, s46, 0x3
    s_mul_i32 s46, s46, 0x1000
    s_add_u32 s45, s45, s46
    v_mov_b32 v10, s45
    s_mov_b32 s46, 0x8
    v_mad_u32_u24 v10, v4, s46, v10
    s_mov_b32 s46, 0x10
    v_mad_u32_u24 v10, v5, s46, v10
    s_mov_b32 s46, 0x20
    v_mad_u32_u24 v10, v6, s46, v10
    s_mov_b32 s46, 0x40
    v_mad_u32_u24 v10, v7, s46, v10
    s_mov_b32 s46, 0x80
    v_mad_u32_u24 v10, v8, s46, v10
    s_mov_b32 s46, 0x200
    v_mad_u32_u24 v10, v9, s46, v10
    s_mov_b32 s45, 0x0
    s_lshr_b32 s46, s40, 0
    s_and_b32 s46, s46, 0x3
    s_mul_i32 s46, s46, 0x2000
    s_add_u32 s45, s45, s46
    v_mov_b32 v11, s45
    s_mov_b32 s46, 0x10
    v_mad_u32_u24 v11, v4, s46, v11
    s_mov_b32 s46, 0x20
    v_mad_u32_u24 v11, v5, s46, v11
    s_mov_b32 s46, 0x40
    v_mad_u32_u24 v11, v6, s46, v11
    s_mov_b32 s46, 0x80
    v_mad_u32_u24 v11, v7, s46, v11
    s_mov_b32 s46, 0x200
    v_mad_u32_u24 v11, v8, s46, v11
    s_mov_b32 s46, 0x400
    v_mad_u32_u24 v11, v9, s46, v11
    v_mov_b32 v14, 0xce6e6b28
    s_mov_b32 s43, s97
L_aw_134:
    s_add_u32 s61, s43, 1
    s_cmp_ge_u32 s49, s61
    s_cbranch_scc1 L_wfskip_138
    s_mov_b32 exec_lo, 0x10001
    s_mov_b32 exec_hi, 0x0
L_wf_136:
    buffer_load_dword v15, v2, s[32:35], s59 offen sc1
    s_waitcnt vmcnt(0)
    v_cmp_gt_u32 vcc, s61, v15
    s_nop 0
    s_and_b32 vcc_lo, vcc_lo, 0x10001
    s_and_b32 vcc_hi, vcc_hi, 0x0
    s_cmp_eq_u64 vcc, 0
    s_cbranch_scc1 L_wfok_137
    s_add_u32 s44, s44, 1
    s_cmp_gt_u32 s44, 1048576
    s_cbranch_scc1 L_w_abort_100
    s_sleep 1
    s_branch L_wf_136
L_wfok_137:
    s_mov_b32 s49, s61
    s_add_u32 s101, s49, 1
    v_cmp_gt_u32 vcc, s101, v15
    s_nop 0
    s_and_b32 vcc_lo, vcc_lo, 0x10001
    s_and_b32 vcc_hi, vcc_hi, 0x0
    s_cmp_eq_u64 vcc, 0
    s_cselect_b32 s49, s101, s49
    s_add_u32 s101, s49, 2
    v_cmp_gt_u32 vcc, s101, v15
    s_nop 0
    s_and_b32 vcc_lo, vcc_lo, 0x10001
    s_and_b32 vcc_hi, vcc_hi, 0x0
    s_cmp_eq_u64 vcc, 0
    s_cselect_b32 s49, s101, s49
    s_add_u32 s101, s49, 4
    v_cmp_gt_u32 vcc, s101, v15
    s_nop 0
    s_and_b32 vcc_lo, vcc_lo, 0x10001
    s_and_b32 vcc_hi, vcc_hi, 0x0
    s_cmp_eq_u64 vcc, 0
    s_cselect_b32 s49, s101, s49
    s_add_u32 s101, s49, 8
    v_cmp_gt_u32 vcc, s101, v15
    s_nop 0
    s_and_b32 vcc_lo, vcc_lo, 0x10001
    s_and_b32 vcc_hi, vcc_hi, 0x0
    s_cmp_eq_u64 vcc, 0
    s_cselect_b32 s49, s101, s49
    s_mov_b64 exec, -1
L_wfskip_138:
    s_add_u32 s45, s52, 25165824
    buffer_load_dwordx4 v[160:163], v2, s[32:35], s45 offen offset:0 sc1
    buffer_load_dwordx4 v[164:167], v2, s[32:35], s45 offen offset:1024 sc1
    buffer_load_dwordx4 v[168:171], v2, s[32:35], s45 offen offset:2048 sc1
    buffer_load_dwordx4 v[172:175], v2, s[32:35], s45 offen offset:3072 sc1
    s_add_u32 s45, s52, 25169920
    buffer_load_dwordx4 v[176:179], v2, s[32:35], s45 offen offset:0 sc1
    buffer_load_dwordx4 v[180:183], v2, s[32:35], s45 offen offset:1024 sc1
    buffer_load_dwordx4 v[184:187], v2, s[32:35], s45 offen offset:2048 sc1
    buffer_load_dwordx4 v[188:191], v2, s[32:35], s45 offen offset:3072 sc1
    s_add_u32 s45, s52, 41943040
    buffer_load_dwordx4 v[192:195], v2, s[32:35], s45 offen offset:0 sc1
    buffer_load_dwordx4 v[196:199], v2, s[32:35], s45 offen offset:1024 sc1
    buffer_load_dwordx4 v[200:203], v2, s[32:35], s45 offen offset:2048 sc1
    buffer_load_dwordx4 v[204:207], v2, s[32:35], s45 offen offset:3072 sc1
    s_add_u32 s45, s52, 41947136
    buffer_load_dwordx4 v[208:211], v2, s[32:35], s45 offen offset:0 sc1
    buffer_load_dwordx4 v[212:215], v2, s[32:35], s45 offen offset:1024 sc1
    buffer_load_dwordx4 v[216:219], v2, s[32:35], s45 offen offset:2048 sc1
    buffer_load_dwordx4 v[220:223], v2, s[32:35], s45 offen offset:3072 sc1
    s_add_u32 s45, s52, 58720256
    buffer_load_dwordx4 v[224:227], v2, s[32:35], s45 offen offset:0 sc1
    buffer_load_dwordx4 v[228:231], v2, s[32:35], s45 offen offset:1024 sc1
    buffer_load_dwordx4 v[232:235], v2, s[32:35], s45 offen offset:2048 sc1
    buffer_load_dwordx4 v[236:239], v2, s[32:35], s45 offen offset:3072 sc1
    s_add_u32 s45, s52, 58724352
    buffer_load_dwordx4 v[240:243], v2, s[32:35], s45 offen offset:0 sc1
    buffer_load_dwordx4 v[244:247], v2, s[32:35], s45 offen offset:1024 sc1
    buffer_load_dwordx4 v[248:251], v2, s[32:35], s45 offen offset:2048 sc1
    buffer_load_dwordx4 v[252:255], v2, s[32:35], s45 offen offset:3072 sc1
    s_add_u32 s52, s52, 1048576
    s_add_u32 s55, s43, 1
    buffer_load_dword v18, off, s[32:35], s59 offset:384 sc1
    s_waitcnt vmcnt(16)
    v_mfma_f32_16x16x32_bf16 v[112:115], v[192:195], v[160:163], 0
    s_waitcnt vmcnt(15)
    v_mfma_f32_16x16x32_bf16 v[112:115], v[196:199], v[164:167], v[112:115]
    s_waitcnt vmcnt(14)
    v_mfma_f32_16x16x32_bf16 v[112:115], v[200:203], v[168:171], v[112:115]
    s_waitcnt vmcnt(13)
    v_mfma_f32_16x16x32_bf16 v[112:115], v[204:207], v[172:175], v[112:115]
    s_waitcnt vmcnt(12)
    v_mfma_f32_16x16x32_bf16 v[116:119], v[208:211], v[160:163], 0
    s_waitcnt vmcnt(11)
    v_mfma_f32_16x16x32_bf16 v[116:119], v[212:215], v[164:167], v[116:119]
    s_waitcnt vmcnt(10)
    v_mfma_f32_16x16x32_bf16 v[116:119], v[216:219], v[168:171], v[116:119]
    s_waitcnt vmcnt(9)
    v_mfma_f32_16x16x32_bf16 v[116:119], v[220:223], v[172:175], v[116:119]
    v_mfma_f32_16x16x32_bf16 v[124:127], v[192:195], v[176:179], 0
    v_mfma_f32_16x16x32_bf16 v[124:127], v[196:199], v[180:183], v[124:127]
    v_mfma_f32_16x16x32_bf16 v[124:127], v[200:203], v[184:187], v[124:127]
    v_mfma_f32_16x16x32_bf16 v[124:127], v[204:207], v[188:191], v[124:127]
    v_mfma_f32_16x16x32_bf16 v[128:131], v[208:211], v[176:179], 0
    v_mfma_f32_16x16x32_bf16 v[128:131], v[212:215], v[180:183], v[128:131]
    v_mfma_f32_16x16x32_bf16 v[128:131], v[216:219], v[184:187], v[128:131]
    v_mfma_f32_16x16x32_bf16 v[128:131], v[220:223], v[188:191], v[128:131]
    v_cvt_pk_bf16_f32 v15, v112, v113
    v_lshlrev_b32 v112, 16, v15
    v_and_b32 v113, 0xffff0000, v15
    v_mul_f32 v112, s57, v112
    v_mul_f32 v113, s57, v113
    v_cvt_pk_bf16_f32 v15, v112, v113
    v_lshlrev_b32 v112, 16, v15
    v_and_b32 v113, 0xffff0000, v15
    v_cvt_pk_bf16_f32 v15, v114, v115
    v_lshlrev_b32 v114, 16, v15
    v_and_b32 v115, 0xffff0000, v15
    v_mul_f32 v114, s57, v114
    v_mul_f32 v115, s57, v115
    v_cvt_pk_bf16_f32 v15, v114, v115
    v_lshlrev_b32 v114, 16, v15
    v_and_b32 v115, 0xffff0000, v15
    v_cvt_pk_bf16_f32 v15, v116, v117
    v_lshlrev_b32 v116, 16, v15
    v_and_b32 v117, 0xffff0000, v15
    v_mul_f32 v116, s57, v116
    v_mul_f32 v117, s57, v117
    v_cvt_pk_bf16_f32 v15, v116, v117
    v_lshlrev_b32 v116, 16, v15
    v_and_b32 v117, 0xffff0000, v15
    v_cvt_pk_bf16_f32 v15, v118, v119
    v_lshlrev_b32 v118, 16, v15
    v_and_b32 v119, 0xffff0000, v15
    v_mul_f32 v118, s57, v118
    v_mul_f32 v119, s57, v119
    v_cvt_pk_bf16_f32 v15, v118, v119
    v_lshlrev_b32 v118, 16, v15
    v_and_b32 v119, 0xffff0000, v15
    v_cndmask_b32 v112, v14, v112, s[64:65]
    v_cndmask_b32 v113, v14, v113, s[66:67]
    v_cndmask_b32 v114, v14, v114, s[68:69]
    v_cndmask_b32 v115, v14, v115, s[70:71]
    v_cndmask_b32 v116, v14, v116, s[72:73]
    v_cndmask_b32 v117, v14, v117, s[74:75]
    v_cndmask_b32 v118, v14, v118, s[76:77]
    v_cndmask_b32 v119, v14, v119, s[78:79]
    v_max3_f32 v16, v112, v113, v114
    v_max3_f32 v16, v16, v115, v116
    v_max3_f32 v16, v16, v117, v118
    v_max_f32 v16, v16, v119
    v_cvt_pk_bf16_f32 v15, v124, v125
    v_lshlrev_b32 v124, 16, v15
    v_and_b32 v125, 0xffff0000, v15
    v_mul_f32 v124, s57, v124
    v_mul_f32 v125, s57, v125
    v_cvt_pk_bf16_f32 v15, v124, v125
    v_lshlrev_b32 v124, 16, v15
    v_and_b32 v125, 0xffff0000, v15
    v_cvt_pk_bf16_f32 v15, v126, v127
    v_lshlrev_b32 v126, 16, v15
    v_and_b32 v127, 0xffff0000, v15
    v_mul_f32 v126, s57, v126
    v_mul_f32 v127, s57, v127
    v_cvt_pk_bf16_f32 v15, v126, v127
    v_lshlrev_b32 v126, 16, v15
    v_and_b32 v127, 0xffff0000, v15
    v_cvt_pk_bf16_f32 v15, v128, v129
    v_lshlrev_b32 v128, 16, v15
    v_and_b32 v129, 0xffff0000, v15
    v_mul_f32 v128, s57, v128
    v_mul_f32 v129, s57, v129
    v_cvt_pk_bf16_f32 v15, v128, v129
    v_lshlrev_b32 v128, 16, v15
    v_and_b32 v129, 0xffff0000, v15
    v_cvt_pk_bf16_f32 v15, v130, v131
    v_lshlrev_b32 v130, 16, v15
    v_and_b32 v131, 0xffff0000, v15
    v_mul_f32 v130, s57, v130
    v_mul_f32 v131, s57, v131
    v_cvt_pk_bf16_f32 v15, v130, v131
    v_lshlrev_b32 v130, 16, v15
    v_and_b32 v131, 0xffff0000, v15
    v_cndmask_b32 v124, v14, v124, s[80:81]
    v_cndmask_b32 v125, v14, v125, s[82:83]
    v_cndmask_b32 v126, v14, v126, s[84:85]
    v_cndmask_b32 v127, v14, v127, s[86:87]
    v_cndmask_b32 v128, v14, v128, s[88:89]
    v_cndmask_b32 v129, v14, v129, s[90:91]
    v_cndmask_b32 v130, v14, v130, s[92:93]
    v_cndmask_b32 v131, v14, v131, s[94:95]
    v_max3_f32 v17, v124, v125, v126
    v_max3_f32 v17, v17, v127, v128
    v_max3_f32 v17, v17, v129, v130
    v_max_f32 v17, v17, v131
    s_waitcnt vmcnt(0)
    v_readfirstlane_b32 s101, v18
    s_nop 0
    s_max_u32 s96, s96, s101
    s_cmp_ge_u32 s96, s55
    s_cbranch_scc1 L_wfskip_141
    s_mov_b32 exec_lo, 0x1000000
    s_mov_b32 exec_hi, 0x0
L_wf_139:
    buffer_load_dword v15, v2, s[32:35], s59 offen sc1
    s_waitcnt vmcnt(0)
    v_cmp_gt_u32 vcc, s55, v15
    s_nop 0
    s_and_b32 vcc_lo, vcc_lo, 0x1000000
    s_and_b32 vcc_hi, vcc_hi, 0x0
    s_cmp_eq_u64 vcc, 0
    s_cbranch_scc1 L_wfok_140
    s_add_u32 s44, s44, 1
    s_cmp_gt_u32 s44, 1048576
    s_cbranch_scc1 L_w_abort_100
    s_branch L_wf_139
L_wfok_140:
    s_mov_b32 s96, s55
    s_add_u32 s101, s96, 1
    v_cmp_gt_u32 vcc, s101, v15
    s_nop 0
    s_and_b32 vcc_lo, vcc_lo, 0x1000000
    s_and_b32 vcc_hi, vcc_hi, 0x0
    s_cmp_eq_u64 vcc, 0
    s_cselect_b32 s96, s101, s96
    s_add_u32 s101, s96, 2
    v_cmp_gt_u32 vcc, s101, v15
    s_nop 0
    s_and_b32 vcc_lo, vcc_lo, 0x1000000
    s_and_b32 vcc_hi, vcc_hi, 0x0
    s_cmp_eq_u64 vcc, 0
    s_cselect_b32 s96, s101, s96
    s_add_u32 s101, s96, 4
    v_cmp_gt_u32 vcc, s101, v15
    s_nop 0
    s_and_b32 vcc_lo, vcc_lo, 0x1000000
    s_and_b32 vcc_hi, vcc_hi, 0x0
    s_cmp_eq_u64 vcc, 0
    s_cselect_b32 s96, s101, s96
    s_add_u32 s101, s96, 8
    v_cmp_gt_u32 vcc, s101, v15
    s_nop 0
    s_and_b32 vcc_lo, vcc_lo, 0x1000000
    s_and_b32 vcc_hi, vcc_hi, 0x0
    s_cmp_eq_u64 vcc, 0
    s_cselect_b32 s96, s101, s96
    s_mov_b64 exec, -1
L_wfskip_141:
    s_add_u32 s45, s60, 8388608
    buffer_load_dwordx4 v[80:83], v2, s[32:35], s45 offen offset:0 sc1
    buffer_load_dwordx4 v[84:87], v2, s[32:35], s45 offen offset:1024 sc1
    buffer_load_dwordx4 v[88:91], v2, s[32:35], s45 offen offset:2048 sc1
    buffer_load_dwordx4 v[92:95], v2, s[32:35], s45 offen offset:3072 sc1
    s_waitcnt vmcnt(3)
    ds_write_b32 v3, v81 offset:0
    ds_write_b32 v3, v83 offset:512
    s_waitcnt vmcnt(2)
    ds_write_b32 v3, v85 offset:1024
    ds_write_b32 v3, v87 offset:1536
    s_waitcnt vmcnt(1)
    ds_write_b32 v3, v89 offset:2048
    ds_write_b32 v3, v91 offset:2560
    s_waitcnt vmcnt(0)
    ds_write_b32 v3, v93 offset:3072
    ds_write_b32 v3, v95 offset:3584
    s_waitcnt lgkmcnt(0)
    ds_read_b64_tr_b16 v[96:97], v10 offset:0
    ds_read_b64_tr_b16 v[98:99], v10 offset:256
    ds_read_b64_tr_b16 v[100:101], v10 offset:1024
    ds_read_b64_tr_b16 v[102:103], v10 offset:1280
    ds_read_b64_tr_b16 v[104:105], v10 offset:2048
    ds_read_b64_tr_b16 v[106:107], v10 offset:2304
    ds_read_b64_tr_b16 v[108:109], v10 offset:3072
    ds_read_b64_tr_b16 v[110:111], v10 offset:3328
    s_waitcnt lgkmcnt(6)
    v_mfma_f32_16x16x32_bf16 v[120:123], v[96:99], v[160:163], 0
    v_mfma_f32_16x16x32_bf16 v[132:135], v[96:99], v[176:179], 0
    s_waitcnt lgkmcnt(4)
    v_mfma_f32_16x16x32_bf16 v[120:123], v[100:103], v[164:167], v[120:123]
    v_mfma_f32_16x16x32_bf16 v[132:135], v[100:103], v[180:183], v[132:135]
    s_waitcnt lgkmcnt(2)
    v_mfma_f32_16x16x32_bf16 v[120:123], v[104:107], v[168:171], v[120:123]
    v_mfma_f32_16x16x32_bf16 v[132:135], v[104:107], v[184:187], v[132:135]
    s_waitcnt lgkmcnt(0)
    v_mfma_f32_16x16x32_bf16 v[120:123], v[108:111], v[172:175], v[120:123]
    v_mfma_f32_16x16x32_bf16 v[132:135], v[108:111], v[188:191], v[132:135]
    s_nop 5
    v_cvt_pk_bf16_f32 v15, v120, v121
    v_lshlrev_b32 v120, 16, v15
    v_and_b32 v121, 0xffff0000, v15
    v_mul_f32 v120, s57, v120
    v_mul_f32 v121, s57, v121
    v_cvt_pk_bf16_f32 v15, v120, v121
    v_lshlrev_b32 v120, 16, v15
    v_and_b32 v121, 0xffff0000, v15
    v_max3_f32 v16, v16, v120, v121
    v_mov_b32 v13, v16
    s_nop 1
    v_permlane32_swap_b32 v16, v13
    v_max_f32 v16, v16, v13
    v_mov_b32 v13, v16
    s_nop 1
    v_permlane16_swap_b32 v16, v13
    v_max_f32 v16, v16, v13
    v_sub_f32 v112, v112, v16
    v_mul_f32 v112, s58, v112
    v_exp_f32 v112, v112
    v_sub_f32 v113, v113, v16
    v_mul_f32 v113, s58, v113
    v_exp_f32 v113, v113
    v_sub_f32 v114, v114, v16
    v_mul_f32 v114, s58, v114
    v_exp_f32 v114, v114
    v_sub_f32 v115, v115, v16
    v_mul_f32 v115, s58, v115
    v_exp_f32 v115, v115
    v_sub_f32 v116, v116, v16
    v_mul_f32 v116, s58, v116
    v_exp_f32 v116, v116
    v_sub_f32 v117, v117, v16
    v_mul_f32 v117, s58, v117
    v_exp_f32 v117, v117
    v_sub_f32 v118, v118, v16
    v_mul_f32 v118, s58, v118
    v_exp_f32 v118, v118
    v_sub_f32 v119, v119, v16
    v_mul_f32 v119, s58, v119
    v_exp_f32 v119, v119
    v_sub_f32 v120, v120, v16
    v_mul_f32 v120, s58, v120
    v_exp_f32 v120, v120
    v_sub_f32 v121, v121, v16
    v_mul_f32 v121, s58, v121
    v_exp_f32 v121, v121
    v_add_f32 v16, v112, v113
    v_add_f32 v16, v16, v114
    v_add_f32 v16, v16, v115
    v_add_f32 v16, v16, v116
    v_add_f32 v16, v16, v117
    v_add_f32 v16, v16, v118
    v_add_f32 v16, v16, v119
    v_add_f32 v16, v16, v120
    v_add_f32 v16, v16, v121
    v_mov_b32 v13, v16
    s_nop 1
    v_permlane32_swap_b32 v16, v13
    v_add_f32 v16, v16, v13
    v_mov_b32 v13, v16
    s_nop 1
    v_permlane16_swap_b32 v16, v13
    v_add_f32 v16, v16, v13
    v_rcp_f32 v16, v16
    s_nop 0
    v_mul_f32 v112, v112, v16
    v_mul_f32 v113, v113, v16
    v_mul_f32 v114, v114, v16
    v_mul_f32 v115, v115, v16
    v_mul_f32 v116, v116, v16
    v_mul_f32 v117, v117, v16
    v_mul_f32 v118, v118, v16
    v_mul_f32 v119, v119, v16
    v_mul_f32 v120, v120, v16
    v_mul_f32 v121, v121, v16
    v_cvt_pk_bf16_f32 v140, v112, v113
    v_cvt_pk_bf16_f32 v141, v114, v115
    v_cvt_pk_bf16_f32 v142, v116, v117
    v_cvt_pk_bf16_f32 v143, v118, v119
    v_cvt_pk_bf16_f32 v136, v120, v121
    v_mov_b32 v137, 0
    v_mfma_f32_16x16x32_bf16 v[48:51], v[224:227], v[140:143], 0
    v_mfma_f32_16x16x32_bf16 v[52:55], v[228:231], v[140:143], 0
    v_mfma_f32_16x16x32_bf16 v[56:59], v[232:235], v[140:143], 0
    v_mfma_f32_16x16x32_bf16 v[60:63], v[236:239], v[140:143], 0
    v_mfma_f32_16x16x32_bf16 v[64:67], v[240:243], v[140:143], 0
    v_mfma_f32_16x16x32_bf16 v[68:71], v[244:247], v[140:143], 0
    v_mfma_f32_16x16x32_bf16 v[72:75], v[248:251], v[140:143], 0
    v_mfma_f32_16x16x32_bf16 v[76:79], v[252:255], v[140:143], 0
    v_mfma_f32_16x16x16_bf16 v[48:51], v[80:81], v[136:137], v[48:51]
    v_mfma_f32_16x16x16_bf16 v[52:55], v[82:83], v[136:137], v[52:55]
    v_mfma_f32_16x16x16_bf16 v[56:59], v[84:85], v[136:137], v[56:59]
    v_mfma_f32_16x16x16_bf16 v[60:63], v[86:87], v[136:137], v[60:63]
    v_mfma_f32_16x16x16_bf16 v[64:67], v[88:89], v[136:137], v[64:67]
    v_mfma_f32_16x16x16_bf16 v[68:71], v[90:91], v[136:137], v[68:71]
    v_mfma_f32_16x16x16_bf16 v[72:75], v[92:93], v[136:137], v[72:75]
    v_mfma_f32_16x16x16_bf16 v[76:79], v[94:95], v[136:137], v[76:79]
    v_cvt_pk_bf16_f32 v15, v132, v133
    v_lshlrev_b32 v132, 16, v15
    v_and_b32 v133, 0xffff0000, v15
    v_mul_f32 v132, s57, v132
    v_mul_f32 v133, s57, v133
    v_cvt_pk_bf16_f32 v15, v132, v133
    v_lshlrev_b32 v132, 16, v15
    v_and_b32 v133, 0xffff0000, v15
    v_max3_f32 v17, v17, v132, v133
    v_mov_b32 v13, v17
    s_nop 1
    v_permlane32_swap_b32 v17, v13
    v_max_f32 v17, v17, v13
    v_mov_b32 v13, v17
    s_nop 1
    v_permlane16_swap_b32 v17, v13
    v_max_f32 v17, v17, v13
    v_sub_f32 v124, v124, v17
    v_mul_f32 v124, s58, v124
    v_exp_f32 v124, v124
    v_sub_f32 v125, v125, v17
    v_mul_f32 v125, s58, v125
    v_exp_f32 v125, v125
    v_sub_f32 v126, v126, v17
    v_mul_f32 v126, s58, v126
    v_exp_f32 v126, v126
    v_sub_f32 v127, v127, v17
    v_mul_f32 v127, s58, v127
    v_exp_f32 v127, v127
    v_sub_f32 v128, v128, v17
    v_mul_f32 v128, s58, v128
    v_exp_f32 v128, v128
    v_sub_f32 v129, v129, v17
    v_mul_f32 v129, s58, v129
    v_exp_f32 v129, v129
    v_sub_f32 v130, v130, v17
    v_mul_f32 v130, s58, v130
    v_exp_f32 v130, v130
    v_sub_f32 v131, v131, v17
    v_mul_f32 v131, s58, v131
    v_exp_f32 v131, v131
    v_sub_f32 v132, v132, v17
    v_mul_f32 v132, s58, v132
    v_exp_f32 v132, v132
    v_sub_f32 v133, v133, v17
    v_mul_f32 v133, s58, v133
    v_exp_f32 v133, v133
    v_add_f32 v17, v124, v125
    v_add_f32 v17, v17, v126
    v_add_f32 v17, v17, v127
    v_add_f32 v17, v17, v128
    v_add_f32 v17, v17, v129
    v_add_f32 v17, v17, v130
    v_add_f32 v17, v17, v131
    v_add_f32 v17, v17, v132
    v_add_f32 v17, v17, v133
    v_mov_b32 v13, v17
    s_nop 1
    v_permlane32_swap_b32 v17, v13
    v_add_f32 v17, v17, v13
    v_mov_b32 v13, v17
    s_nop 1
    v_permlane16_swap_b32 v17, v13
    v_add_f32 v17, v17, v13
    v_rcp_f32 v17, v17
    s_nop 0
    v_mul_f32 v124, v124, v17
    v_mul_f32 v125, v125, v17
    v_mul_f32 v126, v126, v17
    v_mul_f32 v127, v127, v17
    v_mul_f32 v128, v128, v17
    v_mul_f32 v129, v129, v17
    v_mul_f32 v130, v130, v17
    v_mul_f32 v131, v131, v17
    v_mul_f32 v132, v132, v17
    v_mul_f32 v133, v133, v17
    v_cvt_pk_bf16_f32 v148, v124, v125
    v_cvt_pk_bf16_f32 v149, v126, v127
    v_cvt_pk_bf16_f32 v150, v128, v129
    v_cvt_pk_bf16_f32 v151, v130, v131
    v_cvt_pk_bf16_f32 v144, v132, v133
    v_mov_b32 v145, 0
    v_cvt_pk_bf16_f32 v152, v48, v49
    v_cvt_pk_bf16_f32 v153, v50, v51
    v_cvt_pk_bf16_f32 v154, v52, v53
    v_cvt_pk_bf16_f32 v155, v54, v55
    ds_write_b128 v11, v[152:155] offset:0
    v_cvt_pk_bf16_f32 v156, v56, v57
    v_cvt_pk_bf16_f32 v157, v58, v59
    v_cvt_pk_bf16_f32 v158, v60, v61
    v_cvt_pk_bf16_f32 v159, v62, v63
    ds_write_b128 v11, v[156:159] offset:2048
    v_cvt_pk_bf16_f32 v152, v64, v65
    v_cvt_pk_bf16_f32 v153, v66, v67
    v_cvt_pk_bf16_f32 v154, v68, v69
    v_cvt_pk_bf16_f32 v155, v70, v71
    ds_write_b128 v11, v[152:155] offset:4096
    v_cvt_pk_bf16_f32 v156, v72, v73
    v_cvt_pk_bf16_f32 v157, v74, v75
    v_cvt_pk_bf16_f32 v158, v76, v77
    v_cvt_pk_bf16_f32 v159, v78, v79
    ds_write_b128 v11, v[156:159] offset:6144
    v_mfma_f32_16x16x32_bf16 v[48:51], v[224:227], v[148:151], 0
    v_mfma_f32_16x16x32_bf16 v[52:55], v[228:231], v[148:151], 0
    v_mfma_f32_16x16x32_bf16 v[56:59], v[232:235], v[148:151], 0
    v_mfma_f32_16x16x32_bf16 v[60:63], v[236:239], v[148:151], 0
    v_mfma_f32_16x16x32_bf16 v[64:67], v[240:243], v[148:151], 0
    v_mfma_f32_16x16x32_bf16 v[68:71], v[244:247], v[148:151], 0
    v_mfma_f32_16x16x32_bf16 v[72:75], v[248:251], v[148:151], 0
    v_mfma_f32_16x16x32_bf16 v[76:79], v[252:255], v[148:151], 0
    v_mfma_f32_16x16x16_bf16 v[48:51], v[80:81], v[144:145], v[48:51]
    v_mfma_f32_16x16x16_bf16 v[52:55], v[82:83], v[144:145], v[52:55]
    v_mfma_f32_16x16x16_bf16 v[56:59], v[84:85], v[144:145], v[56:59]
    v_mfma_f32_16x16x16_bf16 v[60:63], v[86:87], v[144:145], v[60:63]
    v_mfma_f32_16x16x16_bf16 v[64:67], v[88:89], v[144:145], v[64:67]
    v_mfma_f32_16x16x16_bf16 v[68:71], v[90:91], v[144:145], v[68:71]
    v_mfma_f32_16x16x16_bf16 v[72:75], v[92:93], v[144:145], v[72:75]
    v_mfma_f32_16x16x16_bf16 v[76:79], v[94:95], v[144:145], v[76:79]
    s_nop 0
    v_cvt_pk_bf16_f32 v152, v48, v49
    v_cvt_pk_bf16_f32 v153, v50, v51
    v_cvt_pk_bf16_f32 v154, v52, v53
    v_cvt_pk_bf16_f32 v155, v54, v55
    ds_write_b128 v11, v[152:155] offset:256
    v_cvt_pk_bf16_f32 v156, v56, v57
    v_cvt_pk_bf16_f32 v157, v58, v59
    v_cvt_pk_bf16_f32 v158, v60, v61
    v_cvt_pk_bf16_f32 v159, v62, v63
    ds_write_b128 v11, v[156:159] offset:2304
    v_cvt_pk_bf16_f32 v152, v64, v65
    v_cvt_pk_bf16_f32 v153, v66, v67
    v_cvt_pk_bf16_f32 v154, v68, v69
    v_cvt_pk_bf16_f32 v155, v70, v71
    ds_write_b128 v11, v[152:155] offset:4352
    v_cvt_pk_bf16_f32 v156, v72, v73
    v_cvt_pk_bf16_f32 v157, v74, v75
    v_cvt_pk_bf16_f32 v158, v76, v77
    v_cvt_pk_bf16_f32 v159, v78, v79
    ds_write_b128 v11, v[156:159] offset:6400
    s_waitcnt lgkmcnt(0)
    s_barrier
    ds_read_b128 v[48:51], v2 offset:0
    ds_read_b128 v[52:55], v2 offset:1024
    ds_read_b128 v[56:59], v2 offset:2048
    ds_read_b128 v[60:63], v2 offset:3072
    ds_read_b128 v[64:67], v2 offset:4096
    ds_read_b128 v[68:71], v2 offset:5120
    ds_read_b128 v[72:75], v2 offset:6144
    ds_read_b128 v[76:79], v2 offset:7168
    s_waitcnt lgkmcnt(7)
    v_mfma_f32_32x32x16_bf16 v[32:47], v[48:51], a[0:3], 0
    v_mfma_f32_32x32x16_bf16 v[80:95], v[48:51], a[128:131], 0
    ds_read_b128 v[48:51], v2 offset:8192
    s_waitcnt lgkmcnt(7)
    v_mfma_f32_32x32x16_bf16 v[32:47], v[52:55], a[4:7], v[32:47]
    v_mfma_f32_32x32x16_bf16 v[80:95], v[52:55], a[132:135], v[80:95]
    ds_read_b128 v[52:55], v2 offset:9216
    s_waitcnt lgkmcnt(7)
    v_mfma_f32_32x32x16_bf16 v[32:47], v[56:59], a[8:11], v[32:47]
    v_mfma_f32_32x32x16_bf16 v[80:95], v[56:59], a[136:139], v[80:95]
    ds_read_b128 v[56:59], v2 offset:10240
    s_waitcnt lgkmcnt(7)
    v_mfma_f32_32x32x16_bf16 v[32:47], v[60:63], a[12:15], v[32:47]
    v_mfma_f32_32x32x16_bf16 v[80:95], v[60:63], a[140:143], v[80:95]
    ds_read_b128 v[60:63], v2 offset:11264
    s_waitcnt lgkmcnt(7)
    v_mfma_f32_32x32x16_bf16 v[32:47], v[64:67], a[16:19], v[32:47]
    v_mfma_f32_32x32x16_bf16 v[80:95], v[64:67], a[144:147], v[80:95]
    ds_read_b128 v[64:67], v2 offset:12288
    s_waitcnt lgkmcnt(7)
    v_mfma_f32_32x32x16_bf16 v[32:47], v[68:71], a[20:23], v[32:47]
    v_mfma_f32_32x32x16_bf16 v[80:95], v[68:71], a[148:151], v[80:95]
    ds_read_b128 v[68:71], v2 offset:13312
    s_waitcnt lgkmcnt(7)
    v_mfma_f32_32x32x16_bf16 v[32:47], v[72:75], a[24:27], v[32:47]
    v_mfma_f32_32x32x16_bf16 v[80:95], v[72:75], a[152:155], v[80:95]
    ds_read_b128 v[72:75], v2 offset:14336
    s_waitcnt lgkmcnt(7)
    v_mfma_f32_32x32x16_bf16 v[32:47], v[76:79], a[28:31], v[32:47]
    v_mfma_f32_32x32x16_bf16 v[80:95], v[76:79], a[156:159], v[80:95]
    ds_read_b128 v[76:79], v2 offset:15360
    s_waitcnt lgkmcnt(7)
    v_mfma_f32_32x32x16_bf16 v[32:47], v[48:51], a[32:35], v[32:47]
    v_mfma_f32_32x32x16_bf16 v[80:95], v[48:51], a[160:163], v[80:95]
    ds_read_b128 v[48:51], v2 offset:16384
    s_waitcnt lgkmcnt(7)
    v_mfma_f32_32x32x16_bf16 v[32:47], v[52:55], a[36:39], v[32:47]
    v_mfma_f32_32x32x16_bf16 v[80:95], v[52:55], a[164:167], v[80:95]
    ds_read_b128 v[52:55], v2 offset:17408
    s_waitcnt lgkmcnt(7)
    v_mfma_f32_32x32x16_bf16 v[32:47], v[56:59], a[40:43], v[32:47]
    v_mfma_f32_32x32x16_bf16 v[80:95], v[56:59], a[168:171], v[80:95]
    ds_read_b128 v[56:59], v2 offset:18432
    s_waitcnt lgkmcnt(7)
    v_mfma_f32_32x32x16_bf16 v[32:47], v[60:63], a[44:47], v[32:47]
    v_mfma_f32_32x32x16_bf16 v[80:95], v[60:63], a[172:175], v[80:95]
    ds_read_b128 v[60:63], v2 offset:19456
    s_waitcnt lgkmcnt(7)
    v_mfma_f32_32x32x16_bf16 v[32:47], v[64:67], a[48:51], v[32:47]
    v_mfma_f32_32x32x16_bf16 v[80:95], v[64:67], a[176:179], v[80:95]
    ds_read_b128 v[64:67], v2 offset:20480
    s_waitcnt lgkmcnt(7)
    v_mfma_f32_32x32x16_bf16 v[32:47], v[68:71], a[52:55], v[32:47]
    v_mfma_f32_32x32x16_bf16 v[80:95], v[68:71], a[180:183], v[80:95]
    ds_read_b128 v[68:71], v2 offset:21504
    s_waitcnt lgkmcnt(7)
    v_mfma_f32_32x32x16_bf16 v[32:47], v[72:75], a[56:59], v[32:47]
    v_mfma_f32_32x32x16_bf16 v[80:95], v[72:75], a[184:187], v[80:95]
    ds_read_b128 v[72:75], v2 offset:22528
    s_waitcnt lgkmcnt(7)
    v_mfma_f32_32x32x16_bf16 v[32:47], v[76:79], a[60:63], v[32:47]
    v_mfma_f32_32x32x16_bf16 v[80:95], v[76:79], a[188:191], v[80:95]
    ds_read_b128 v[76:79], v2 offset:23552
    s_waitcnt lgkmcnt(7)
    v_mfma_f32_32x32x16_bf16 v[32:47], v[48:51], a[64:67], v[32:47]
    v_mfma_f32_32x32x16_bf16 v[80:95], v[48:51], a[192:195], v[80:95]
    ds_read_b128 v[48:51], v2 offset:24576
    s_waitcnt lgkmcnt(7)
    v_mfma_f32_32x32x16_bf16 v[32:47], v[52:55], a[68:71], v[32:47]
    v_mfma_f32_32x32x16_bf16 v[80:95], v[52:55], a[196:199], v[80:95]
    ds_read_b128 v[52:55], v2 offset:25600
    s_waitcnt lgkmcnt(7)
    v_mfma_f32_32x32x16_bf16 v[32:47], v[56:59], a[72:75], v[32:47]
    v_mfma_f32_32x32x16_bf16 v[80:95], v[56:59], a[200:203], v[80:95]
    ds_read_b128 v[56:59], v2 offset:26624
    s_waitcnt lgkmcnt(7)
    v_mfma_f32_32x32x16_bf16 v[32:47], v[60:63], a[76:79], v[32:47]
    v_mfma_f32_32x32x16_bf16 v[80:95], v[60:63], a[204:207], v[80:95]
    ds_read_b128 v[60:63], v2 offset:27648
    s_waitcnt lgkmcnt(7)
    v_mfma_f32_32x32x16_bf16 v[32:47], v[64:67], a[80:83], v[32:47]
    v_mfma_f32_32x32x16_bf16 v[80:95], v[64:67], a[208:211], v[80:95]
    ds_read_b128 v[64:67], v2 offset:28672
    s_waitcnt lgkmcnt(7)
    v_mfma_f32_32x32x16_bf16 v[32:47], v[68:71], a[84:87], v[32:47]
    v_mfma_f32_32x32x16_bf16 v[80:95], v[68:71], a[212:215], v[80:95]
    ds_read_b128 v[68:71], v2 offset:29696
    s_waitcnt lgkmcnt(7)
    v_mfma_f32_32x32x16_bf16 v[32:47], v[72:75], a[88:91], v[32:47]
    v_mfma_f32_32x32x16_bf16 v[80:95], v[72:75], a[216:219], v[80:95]
    ds_read_b128 v[72:75], v2 offset:30720
    s_waitcnt lgkmcnt(7)
    v_mfma_f32_32x32x16_bf16 v[32:47], v[76:79], a[92:95], v[32:47]
    v_mfma_f32_32x32x16_bf16 v[80:95], v[76:79], a[220:223], v[80:95]
    ds_read_b128 v[76:79], v2 offset:31744
    s_waitcnt lgkmcnt(7)
    v_mfma_f32_32x32x16_bf16 v[32:47], v[48:51], a[96:99], v[32:47]
    v_mfma_f32_32x32x16_bf16 v[80:95], v[48:51], a[224:227], v[80:95]
    s_waitcnt lgkmcnt(6)
    v_mfma_f32_32x32x16_bf16 v[32:47], v[52:55], a[100:103], v[32:47]
    v_mfma_f32_32x32x16_bf16 v[80:95], v[52:55], a[228:231], v[80:95]
    s_waitcnt lgkmcnt(5)
    v_mfma_f32_32x32x16_bf16 v[32:47], v[56:59], a[104:107], v[32:47]
    v_mfma_f32_32x32x16_bf16 v[80:95], v[56:59], a[232:235], v[80:95]
    s_waitcnt lgkmcnt(4)
    v_mfma_f32_32x32x16_bf16 v[32:47], v[60:63], a[108:111], v[32:47]
    v_mfma_f32_32x32x16_bf16 v[80:95], v[60:63], a[236:239], v[80:95]
    s_waitcnt lgkmcnt(3)
    v_mfma_f32_32x32x16_bf16 v[32:47], v[64:67], a[112:115], v[32:47]
    v_mfma_f32_32x32x16_bf16 v[80:95], v[64:67], a[240:243], v[80:95]
    s_waitcnt lgkmcnt(2)
    v_mfma_f32_32x32x16_bf16 v[32:47], v[68:71], a[116:119], v[32:47]
    v_mfma_f32_32x32x16_bf16 v[80:95], v[68:71], a[244:247], v[80:95]
    s_waitcnt lgkmcnt(1)
    v_mfma_f32_32x32x16_bf16 v[32:47], v[72:75], a[120:123], v[32:47]
    v_mfma_f32_32x32x16_bf16 v[80:95], v[72:75], a[248:251], v[80:95]
    s_waitcnt lgkmcnt(0)
    v_mfma_f32_32x32x16_bf16 v[32:47], v[76:79], a[124:127], v[32:47]
    v_mfma_f32_32x32x16_bf16 v[80:95], v[76:79], a[252:255], v[80:95]
    s_add_u32 s45, s53, 0
    s_nop 8
    buffer_store_dword v32, v19, s[32:35], s45 offen offset:0 sc1
    buffer_store_dword v33, v19, s[32:35], s45 offen offset:2048 sc1
    s_add_u32 s45, s53, 4096
    buffer_store_dword v34, v19, s[32:35], s45 offen offset:0 sc1
    buffer_store_dword v35, v19, s[32:35], s45 offen offset:2048 sc1
    s_add_u32 s45, s53, 16384
    buffer_store_dword v36, v19, s[32:35], s45 offen offset:0 sc1
    buffer_store_dword v37, v19, s[32:35], s45 offen offset:2048 sc1
    s_add_u32 s45, s53, 20480
    buffer_store_dword v38, v19, s[32:35], s45 offen offset:0 sc1
    buffer_store_dword v39, v19, s[32:35], s45 offen offset:2048 sc1
    s_add_u32 s45, s53, 32768
    buffer_store_dword v40, v19, s[32:35], s45 offen offset:0 sc1
    buffer_store_dword v41, v19, s[32:35], s45 offen offset:2048 sc1
    s_add_u32 s45, s53, 36864
    buffer_store_dword v42, v19, s[32:35], s45 offen offset:0 sc1
    buffer_store_dword v43, v19, s[32:35], s45 offen offset:2048 sc1
    s_add_u32 s45, s53, 49152
    buffer_store_dword v44, v19, s[32:35], s45 offen offset:0 sc1
    buffer_store_dword v45, v19, s[32:35], s45 offen offset:2048 sc1
    s_add_u32 s45, s53, 53248
    buffer_store_dword v46, v19, s[32:35], s45 offen offset:0 sc1
    buffer_store_dword v47, v19, s[32:35], s45 offen offset:2048 sc1
    s_add_u32 s45, s53, 256
    buffer_store_dword v80, v19, s[32:35], s45 offen offset:0 sc1
    buffer_store_dword v81, v19, s[32:35], s45 offen offset:2048 sc1
    s_add_u32 s45, s53, 4352
    buffer_store_dword v82, v19, s[32:35], s45 offen offset:0 sc1
    buffer_store_dword v83, v19, s[32:35], s45 offen offset:2048 sc1
    s_add_u32 s45, s53, 16640
    buffer_store_dword v84, v19, s[32:35], s45 offen offset:0 sc1
    buffer_store_dword v85, v19, s[32:35], s45 offen offset:2048 sc1
    s_add_u32 s45, s53, 20736
    buffer_store_dword v86, v19, s[32:35], s45 offen offset:0 sc1
    buffer_store_dword v87, v19, s[32:35], s45 offen offset:2048 sc1
    s_add_u32 s45, s53, 33024
    buffer_store_dword v88, v19, s[32:35], s45 offen offset:0 sc1
    buffer_store_dword v89, v19, s[32:35], s45 offen offset:2048 sc1
    s_add_u32 s45, s53, 37120
    buffer_store_dword v90, v19, s[32:35], s45 offen offset:0 sc1
    buffer_store_dword v91, v19, s[32:35], s45 offen offset:2048 sc1
    s_add_u32 s45, s53, 49408
    buffer_store_dword v92, v19, s[32:35], s45 offen offset:0 sc1
    buffer_store_dword v93, v19, s[32:35], s45 offen offset:2048 sc1
    s_add_u32 s45, s53, 53504
    buffer_store_dword v94, v19, s[32:35], s45 offen offset:0 sc1
    buffer_store_dword v95, v19, s[32:35], s45 offen offset:2048 sc1
    s_add_u32 s53, s53, 2097152
    s_waitcnt vmcnt(0)
    s_barrier
    s_cmp_lg_u32 s40, 3
    s_cbranch_scc1 L_nosig_142
    s_lshr_b32 s45, s43, 2
    s_add_u32 s45, s45, 1
    v_mov_b32 v13, s45
    v_mov_b32 v12, 0
    s_mov_b64 exec, 1
    buffer_store_dword v13, v12, s[32:35], s54 offen sc1
    s_mov_b64 exec, -1
L_nosig_142:
    s_add_u32 s60, s60, 524288
    s_add_u32 s43, s43, 4
    s_cmp_ge_u32 s43, 64
    s_cbranch_scc1 L_awx_135
    s_branch L_aw_134
L_awx_135:
    s_waitcnt vmcnt(0)
    s_endpgm
L_role_133:
    s_cmp_ge_u32 s41, 168
    s_cbranch_scc1 L_role_143
    s_sub_u32 s42, s41, 112
    s_cmp_ge_u32 s42, 28
    s_cselect_b32 s97, 1, 0
    s_mul_i32 s45, s97, 28
    s_sub_u32 s42, s42, s45
    s_mov_b32 s45, 0x0
    s_lshr_b32 s46, s42, 0
    s_and_b32 s46, s46, 0x1f
    s_mul_i32 s46, s46, 0x80
    s_add_u32 s45, s45, s46
    s_lshr_b32 s46, s40, 0
    s_and_b32 s46, s46, 0x3
    s_mul_i32 s46, s46, 0x7000
    s_add_u32 s45, s45, s46
    v_mov_b32 v10, s45
    s_mov_b32 s46, 0x10
    v_mad_u32_u24 v10, v4, s46, v10
    s_mov_b32 s46, 0x20
    v_mad_u32_u24 v10, v5, s46, v10
    s_mov_b32 s46, 0x40
    v_mad_u32_u24 v10, v6, s46, v10
    s_mov_b32 s46, 0xe00
    v_mad_u32_u24 v10, v7, s46, v10
    s_mov_b32 s46, 0x1c00
    v_mad_u32_u24 v10, v8, s46, v10
    s_mov_b32 s46, 0x3800
    v_mad_u32_u24 v10, v9, s46, v10
    s_mov_b32 s50, s16
    s_mov_b32 s51, s17
    s_lshl_b32 s47, s40, 10
    s_add_u32 s47, s47, 0
    s_mov_b32 m0, s47
    s_nop 0
    global_load_lds_dwordx4 v10, s[50:51]
    s_add_u32 s50, s50, 114688
    s_addc_u32 s51, s51, 0
    s_add_u32 s47, s47, 4096
    s_mov_b32 m0, s47
    s_nop 0
    global_load_lds_dwordx4 v10, s[50:51]
    s_add_u32 s50, s50, 114688
    s_addc_u32 s51, s51, 0
    s_add_u32 s47, s47, 4096
    s_mov_b32 m0, s47
    s_nop 0
    global_load_lds_dwordx4 v10, s[50:51]
    s_add_u32 s50, s50, 114688
    s_addc_u32 s51, s51, 0
    s_add_u32 s47, s47, 4096
    s_mov_b32 m0, s47
    s_nop 0
    global_load_lds_dwordx4 v10, s[50:51]
    s_add_u32 s50, s50, 114688
    s_addc_u32 s51, s51, 0
    s_add_u32 s47, s47, 4096
    s_mov_b32 m0, s47
    s_nop 0
    global_load_lds_dwordx4 v10, s[50:51]
    s_add_u32 s50, s50, 114688
    s_addc_u32 s51, s51, 0
    s_add_u32 s47, s47, 4096
    s_mov_b32 m0, s47
    s_nop 0
    global_load_lds_dwordx4 v10, s[50:51]
    s_add_u32 s50, s50, 114688
    s_addc_u32 s51, s51, 0
    s_add_u32 s47, s47, 4096
    s_mov_b32 m0, s47
    s_nop 0
    global_load_lds_dwordx4 v10, s[50:51]
    s_add_u32 s50, s50, 114688
    s_addc_u32 s51, s51, 0
    s_add_u32 s47, s47, 4096
    s_mov_b32 m0, s47
    s_nop 0
    global_load_lds_dwordx4 v10, s[50:51]
    s_add_u32 s50, s50, 114688
    s_addc_u32 s51, s51, 0
    s_add_u32 s47, s47, 4096
    s_mov_b32 m0, s47
    s_nop 0
    global_load_lds_dwordx4 v10, s[50:51]
    s_add_u32 s50, s50, 114688
    s_addc_u32 s51, s51, 0
    s_add_u32 s47, s47, 4096
    s_mov_b32 m0, s47
    s_nop 0
    global_load_lds_dwordx4 v10, s[50:51]
    s_add_u32 s50, s50, 114688
    s_addc_u32 s51, s51, 0
    s_add_u32 s47, s47, 4096
    s_mov_b32 m0, s47
    s_nop 0
    global_load_lds_dwordx4 v10, s[50:51]
    s_add_u32 s50, s50, 114688
    s_addc_u32 s51, s51, 0
    s_add_u32 s47, s47, 4096
    s_mov_b32 m0, s47
    s_nop 0
    global_load_lds_dwordx4 v10, s[50:51]
    s_add_u32 s50, s50, 114688
    s_addc_u32 s51, s51, 0
    s_add_u32 s47, s47, 4096
    s_mov_b32 m0, s47
    s_nop 0
    global_load_lds_dwordx4 v10, s[50:51]
    s_add_u32 s50, s50, 114688
    s_addc_u32 s51, s51, 0
    s_add_u32 s47, s47, 4096
    s_mov_b32 m0, s47
    s_nop 0
    global_load_lds_dwordx4 v10, s[50:51]
    s_add_u32 s50, s50, 114688
    s_addc_u32 s51, s51, 0
    s_add_u32 s47, s47, 4096
    s_mov_b32 m0, s47
    s_nop 0
    global_load_lds_dwordx4 v10, s[50:51]
    s_add_u32 s50, s50, 114688
    s_addc_u32 s51, s51, 0
    s_add_u32 s47, s47, 4096
    s_mov_b32 m0, s47
    s_nop 0
    global_load_lds_dwordx4 v10, s[50:51]
    s_add_u32 s50, s50, 114688
    s_addc_u32 s51, s51, 0
    s_add_u32 s47, s47, 4096
    s_mov_b32 s45, 0x0
    s_lshr_b32 s46, s42, 0
    s_and_b32 s46, s46, 0x1f
    s_mul_i32 s46, s46, 0x80
    s_add_u32 s45, s45, s46
    s_lshr_b32 s46, s40, 0
    s_and_b32 s46, s46, 0x3
    s_mul_i32 s46, s46, 0x7000
    s_add_u32 s45, s45, s46
    v_mov_b32 v10, s45
    s_mov_b32 s46, 0x10
    v_mad_u32_u24 v10, v4, s46, v10
    s_mov_b32 s46, 0x20
    v_mad_u32_u24 v10, v5, s46, v10
    s_mov_b32 s46, 0x40
    v_mad_u32_u24 v10, v6, s46, v10
    s_mov_b32 s46, 0xe00
    v_mad_u32_u24 v10, v7, s46, v10
    s_mov_b32 s46, 0x1c00
    v_mad_u32_u24 v10, v8, s46, v10
    s_mov_b32 s46, 0x3800
    v_mad_u32_u24 v10, v9, s46, v10
    s_mov_b32 s50, s18
    s_mov_b32 s51, s19
    s_lshl_b32 s47, s40, 10
    s_add_u32 s47, s47, 65536
    s_mov_b32 m0, s47
    s_nop 0
    global_load_lds_dwordx4 v10, s[50:51]
    s_add_u32 s50, s50, 114688
    s_addc_u32 s51, s51, 0
    s_add_u32 s47, s47, 4096
    s_mov_b32 m0, s47
    s_nop 0
    global_load_lds_dwordx4 v10, s[50:51]
    s_add_u32 s50, s50, 114688
    s_addc_u32 s51, s51, 0
    s_add_u32 s47, s47, 4096
    s_mov_b32 m0, s47
    s_nop 0
    global_load_lds_dwordx4 v10, s[50:51]
    s_add_u32 s50, s50, 114688
    s_addc_u32 s51, s51, 0
    s_add_u32 s47, s47, 4096
    s_mov_b32 m0, s47
    s_nop 0
    global_load_lds_dwordx4 v10, s[50:51]
    s_add_u32 s50, s50, 114688
    s_addc_u32 s51, s51, 0
    s_add_u32 s47, s47, 4096
    s_mov_b32 m0, s47
    s_nop 0
    global_load_lds_dwordx4 v10, s[50:51]
    s_add_u32 s50, s50, 114688
    s_addc_u32 s51, s51, 0
    s_add_u32 s47, s47, 4096
    s_mov_b32 m0, s47
    s_nop 0
    global_load_lds_dwordx4 v10, s[50:51]
    s_add_u32 s50, s50, 114688
    s_addc_u32 s51, s51, 0
    s_add_u32 s47, s47, 4096
    s_mov_b32 m0, s47
    s_nop 0
    global_load_lds_dwordx4 v10, s[50:51]
    s_add_u32 s50, s50, 114688
    s_addc_u32 s51, s51, 0
    s_add_u32 s47, s47, 4096
    s_mov_b32 m0, s47
    s_nop 0
    global_load_lds_dwordx4 v10, s[50:51]
    s_add_u32 s50, s50, 114688
    s_addc_u32 s51, s51, 0
    s_add_u32 s47, s47, 4096
    s_mov_b32 m0, s47
    s_nop 0
    global_load_lds_dwordx4 v10, s[50:51]
    s_add_u32 s50, s50, 114688
    s_addc_u32 s51, s51, 0
    s_add_u32 s47, s47, 4096
    s_mov_b32 m0, s47
    s_nop 0
    global_load_lds_dwordx4 v10, s[50:51]
    s_add_u32 s50, s50, 114688
    s_addc_u32 s51, s51, 0
    s_add_u32 s47, s47, 4096
    s_mov_b32 m0, s47
    s_nop 0
    global_load_lds_dwordx4 v10, s[50:51]
    s_add_u32 s50, s50, 114688
    s_addc_u32 s51, s51, 0
    s_add_u32 s47, s47, 4096
    s_mov_b32 m0, s47
    s_nop 0
    global_load_lds_dwordx4 v10, s[50:51]
    s_add_u32 s50, s50, 114688
    s_addc_u32 s51, s51, 0
    s_add_u32 s47, s47, 4096
    s_mov_b32 m0, s47
    s_nop 0
    global_load_lds_dwordx4 v10, s[50:51]
    s_add_u32 s50, s50, 114688
    s_addc_u32 s51, s51, 0
    s_add_u32 s47, s47, 4096
    s_mov_b32 m0, s47
    s_nop 0
    global_load_lds_dwordx4 v10, s[50:51]
    s_add_u32 s50, s50, 114688
    s_addc_u32 s51, s51, 0
    s_add_u32 s47, s47, 4096
    s_mov_b32 m0, s47
    s_nop 0
    global_load_lds_dwordx4 v10, s[50:51]
    s_add_u32 s50, s50, 114688
    s_addc_u32 s51, s51, 0
    s_add_u32 s47, s47, 4096
    s_mov_b32 m0, s47
    s_nop 0
    global_load_lds_dwordx4 v10, s[50:51]
    s_add_u32 s50, s50, 114688
    s_addc_u32 s51, s51, 0
    s_add_u32 s47, s47, 4096
    s_waitcnt vmcnt(0)
    s_barrier
    s_mov_b32 s45, 0x0
    s_lshr_b32 s46, s40, 0
    s_and_b32 s46, s46, 0x3
    s_mul_i32 s46, s46, 0x20
    s_add_u32 s45, s45, s46
    v_mov_b32 v10, s45
    s_mov_b32 s46, 0x8
    v_mad_u32_u24 v10, v4, s46, v10
    s_mov_b32 s46, 0x10
    v_mad_u32_u24 v10, v5, s46, v10
    s_mov_b32 s46, 0x80
    v_mad_u32_u24 v10, v6, s46, v10
    s_mov_b32 s46, 0x100
    v_mad_u32_u24 v10, v7, s46, v10
    s_mov_b32 s46, 0x10000
    v_mad_u32_u24 v10, v8, s46, v10
    s_mov_b32 s46, 0x400
    v_mad_u32_u24 v10, v9, s46, v10
    v_add_u32 v11, 0, v10
    ds_read_b64_tr_b16 a[0:1], v11 offset:0
    ds_read_b64_tr_b16 a[2:3], v11 offset:512
    ds_read_b64_tr_b16 a[4:5], v11 offset:2048
    ds_read_b64_tr_b16 a[6:7], v11 offset:2560
    ds_read_b64_tr_b16 a[8:9], v11 offset:4096
    ds_read_b64_tr_b16 a[10:11], v11 offset:4608
    ds_read_b64_tr_b16 a[12:13], v11 offset:6144
    ds_read_b64_tr_b16 a[14:15], v11 offset:6656
    s_waitcnt lgkmcnt(0)
    ds_read_b64_tr_b16 a[16:17], v11 offset:8192
    ds_read_b64_tr_b16 a[18:19], v11 offset:8704
    ds_read_b64_tr_b16 a[20:21], v11 offset:10240
    ds_read_b64_tr_b16 a[22:23], v11 offset:10752
    ds_read_b64_tr_b16 a[24:25], v11 offset:12288
    ds_read_b64_tr_b16 a[26:27], v11 offset:12800
    ds_read_b64_tr_b16 a[28:29], v11 offset:14336
    ds_read_b64_tr_b16 a[30:31], v11 offset:14848
    s_waitcnt lgkmcnt(0)
    ds_read_b64_tr_b16 a[32:33], v11 offset:16384
    ds_read_b64_tr_b16 a[34:35], v11 offset:16896
    ds_read_b64_tr_b16 a[36:37], v11 offset:18432
    ds_read_b64_tr_b16 a[38:39], v11 offset:18944
    ds_read_b64_tr_b16 a[40:41], v11 offset:20480
    ds_read_b64_tr_b16 a[42:43], v11 offset:20992
    ds_read_b64_tr_b16 a[44:45], v11 offset:22528
    ds_read_b64_tr_b16 a[46:47], v11 offset:23040
    s_waitcnt lgkmcnt(0)
    ds_read_b64_tr_b16 a[48:49], v11 offset:24576
    ds_read_b64_tr_b16 a[50:51], v11 offset:25088
    ds_read_b64_tr_b16 a[52:53], v11 offset:26624
    ds_read_b64_tr_b16 a[54:55], v11 offset:27136
    ds_read_b64_tr_b16 a[56:57], v11 offset:28672
    ds_read_b64_tr_b16 a[58:59], v11 offset:29184
    ds_read_b64_tr_b16 a[60:61], v11 offset:30720
    ds_read_b64_tr_b16 a[62:63], v11 offset:31232
    s_waitcnt lgkmcnt(0)
    v_add_u32 v11, 32768, v10
    ds_read_b64_tr_b16 a[64:65], v11 offset:0
    ds_read_b64_tr_b16 a[66:67], v11 offset:512
    ds_read_b64_tr_b16 a[68:69], v11 offset:2048
    ds_read_b64_tr_b16 a[70:71], v11 offset:2560
    ds_read_b64_tr_b16 a[72:73], v11 offset:4096
    ds_read_b64_tr_b16 a[74:75], v11 offset:4608
    ds_read_b64_tr_b16 a[76:77], v11 offset:6144
    ds_read_b64_tr_b16 a[78:79], v11 offset:6656
    s_waitcnt lgkmcnt(0)
    ds_read_b64_tr_b16 a[80:81], v11 offset:8192
    ds_read_b64_tr_b16 a[82:83], v11 offset:8704
    ds_read_b64_tr_b16 a[84:85], v11 offset:10240
    ds_read_b64_tr_b16 a[86:87], v11 offset:10752
    ds_read_b64_tr_b16 a[88:89], v11 offset:12288
    ds_read_b64_tr_b16 a[90:91], v11 offset:12800
    ds_read_b64_tr_b16 a[92:93], v11 offset:14336
    ds_read_b64_tr_b16 a[94:95], v11 offset:14848
    s_waitcnt lgkmcnt(0)
    ds_read_b64_tr_b16 a[96:97], v11 offset:16384
    ds_read_b64_tr_b16 a[98:99], v11 offset:16896
    ds_read_b64_tr_b16 a[100:101], v11 offset:18432
    ds_read_b64_tr_b16 a[102:103], v11 offset:18944
    ds_read_b64_tr_b16 a[104:105], v11 offset:20480
    ds_read_b64_tr_b16 a[106:107], v11 offset:20992
    ds_read_b64_tr_b16 a[108:109], v11 offset:22528
    ds_read_b64_tr_b16 a[110:111], v11 offset:23040
    s_waitcnt lgkmcnt(0)
    ds_read_b64_tr_b16 a[112:113], v11 offset:24576
    ds_read_b64_tr_b16 a[114:115], v11 offset:25088
    ds_read_b64_tr_b16 a[116:117], v11 offset:26624
    ds_read_b64_tr_b16 a[118:119], v11 offset:27136
    ds_read_b64_tr_b16 a[120:121], v11 offset:28672
    ds_read_b64_tr_b16 a[122:123], v11 offset:29184
    ds_read_b64_tr_b16 a[124:125], v11 offset:30720
    ds_read_b64_tr_b16 a[126:127], v11 offset:31232
    s_waitcnt lgkmcnt(0)
    s_waitcnt lgkmcnt(0)
    s_barrier
    s_lshl_b32 s45, s97, 15
    s_add_u32 s52, s45, 4194304
    s_lshl_b32 s46, s97, 5
    s_add_u32 s46, s46, s42
    s_lshl_b32 s46, s46, 7
    s_add_u32 s54, s46, 442368
    s_lshl_b32 s45, s42, 2
    s_add_u32 s45, s45, s40
    s_lshl_b32 s46, s45, 10
    s_mul_i32 s45, s97, 114688
    s_add_u32 s46, s46, s45
    s_add_u32 s53, s46, 125829120
    s_mov_b32 s45, 0x6a000
    s_lshr_b32 s46, s97, 0
    s_and_b32 s46, s46, 0x1
    s_mul_i32 s46, s46, 0x1000
    s_add_u32 s45, s45, s46
    v_mov_b32 v14, s45
    s_mov_b32 s46, 0x80
    v_mad_u32_u24 v14, v4, s46, v14
    s_mov_b32 s46, 0x100
    v_mad_u32_u24 v14, v5, s46, v14
    s_mov_b32 s46, 0x200
    v_mad_u32_u24 v14, v6, s46, v14
    s_mov_b32 s46, 0x400
    v_mad_u32_u24 v14, v7, s46, v14
    s_mov_b32 s46, 0x800
    v_mad_u32_u24 v14, v8, s46, v14
    s_mov_b32 s43, 0
L_gu_144:
    s_add_u32 s55, s43, 1
    s_cmp_lg_u32 s40, 0
    s_cbranch_scc1 L_nopoll_145
    s_mov_b32 exec_lo, 0xffffffff
    s_mov_b32 exec_hi, 0x0
L_wf_146:
    buffer_load_dword v15, v14, s[32:35], 0 offen sc1
    s_waitcnt vmcnt(0)
    v_cmp_gt_u32 vcc, s55, v15
    s_nop 0
    s_and_b32 vcc_lo, vcc_lo, 0xffffffff
    s_and_b32 vcc_hi, vcc_hi, 0x0
    s_cmp_eq_u64 vcc, 0
    s_cbranch_scc1 L_wfok_147
    s_add_u32 s44, s44, 1
    s_cmp_gt_u32 s44, 1048576
    s_cbranch_scc1 L_w_abort_100
    s_branch L_wf_146
L_wfok_147:
    s_mov_b64 exec, -1
L_wfskip_148:
L_nopoll_145:
    s_barrier
    s_lshl_b32 s45, s40, 11
    s_add_u32 s46, s52, s45
    s_add_u32 m0, s45, 0
    s_add_u32 s47, s46, 0
    buffer_load_dwordx4 v2, s[32:35], s47 offen offset:0 sc1 lds
    buffer_load_dwordx4 v2, s[32:35], s47 offen offset:1024 sc1 lds
    s_add_u32 m0, s45, 8192
    s_add_u32 s47, s46, 8192
    buffer_load_dwordx4 v2, s[32:35], s47 offen offset:0 sc1 lds
    buffer_load_dwordx4 v2, s[32:35], s47 offen offset:1024 sc1 lds
    s_add_u32 m0, s45, 16384
    s_add_u32 s47, s46, 16384
    buffer_load_dwordx4 v2, s[32:35], s47 offen offset:0 sc1 lds
    buffer_load_dwordx4 v2, s[32:35], s47 offen offset:1024 sc1 lds
    s_add_u32 m0, s45, 24576
    s_add_u32 s47, s46, 24576
    buffer_load_dwordx4 v2, s[32:35], s47 offen offset:0 sc1 lds
    buffer_load_dwordx4 v2, s[32:35], s47 offen offset:1024 sc1 lds
    s_waitcnt vmcnt(4)
    s_barrier
    ds_read_b128 v[48:51], v2 offset:0
    ds_read_b128 v[52:55], v2 offset:1024
    ds_read_b128 v[56:59], v2 offset:2048
    ds_read_b128 v[60:63], v2 offset:3072
    ds_read_b128 v[64:67], v2 offset:4096
    ds_read_b128 v[68:71], v2 offset:5120
    ds_read_b128 v[72:75], v2 offset:6144
    ds_read_b128 v[76:79], v2 offset:7168
    s_waitcnt lgkmcnt(7)
    v_mfma_f32_32x32x16_bf16 v[32:47], a[0:3], v[48:51], 0
    ds_read_b128 v[48:51], v2 offset:8192
    s_waitcnt lgkmcnt(7)
    v_mfma_f32_32x32x16_bf16 v[32:47], a[4:7], v[52:55], v[32:47]
    ds_read_b128 v[52:55], v2 offset:9216
    s_waitcnt lgkmcnt(7)
    v_mfma_f32_32x32x16_bf16 v[32:47], a[8:11], v[56:59], v[32:47]
    ds_read_b128 v[56:59], v2 offset:10240
    s_waitcnt lgkmcnt(7)
    v_mfma_f32_32x32x16_bf16 v[32:47], a[12:15], v[60:63], v[32:47]
    ds_read_b128 v[60:63], v2 offset:11264
    s_waitcnt lgkmcnt(7)
    v_mfma_f32_32x32x16_bf16 v[32:47], a[16:19], v[64:67], v[32:47]
    ds_read_b128 v[64:67], v2 offset:12288
    s_waitcnt lgkmcnt(7)
    v_mfma_f32_32x32x16_bf16 v[32:47], a[20:23], v[68:71], v[32:47]
    ds_read_b128 v[68:71], v2 offset:13312
    s_waitcnt lgkmcnt(7)
    v_mfma_f32_32x32x16_bf16 v[32:47], a[24:27], v[72:75], v[32:47]
    ds_read_b128 v[72:75], v2 offset:14336
    s_waitcnt lgkmcnt(7)
    v_mfma_f32_32x32x16_bf16 v[32:47], a[28:31], v[76:79], v[32:47]
    s_waitcnt vmcnt(0)
    s_barrier
    ds_read_b128 v[76:79], v2 offset:15360
    s_waitcnt lgkmcnt(7)
    v_mfma_f32_32x32x16_bf16 v[32:47], a[32:35], v[48:51], v[32:47]
    ds_read_b128 v[48:51], v2 offset:16384
    s_waitcnt lgkmcnt(7)
    v_mfma_f32_32x32x16_bf16 v[32:47], a[36:39], v[52:55], v[32:47]
    ds_read_b128 v[52:55], v2 offset:17408
    s_waitcnt lgkmcnt(7)
    v_mfma_f32_32x32x16_bf16 v[32:47], a[40:43], v[56:59], v[32:47]
    ds_read_b128 v[56:59], v2 offset:18432
    s_waitcnt lgkmcnt(7)
    v_mfma_f32_32x32x16_bf16 v[32:47], a[44:47], v[60:63], v[32:47]
    ds_read_b128 v[60:63], v2 offset:19456
    s_waitcnt lgkmcnt(7)
    v_mfma_f32_32x32x16_bf16 v[32:47], a[48:51], v[64:67], v[32:47]
    ds_read_b128 v[64:67], v2 offset:20480
    s_waitcnt lgkmcnt(7)
    v_mfma_f32_32x32x16_bf16 v[32:47], a[52:55], v[68:71], v[32:47]
    ds_read_b128 v[68:71], v2 offset:21504
    s_waitcnt lgkmcnt(7)
    v_mfma_f32_32x32x16_bf16 v[32:47], a[56:59], v[72:75], v[32:47]
    ds_read_b128 v[72:75], v2 offset:22528
    s_waitcnt lgkmcnt(7)
    v_mfma_f32_32x32x16_bf16 v[32:47], a[60:63], v[76:79], v[32:47]
    ds_read_b128 v[76:79], v2 offset:23552
    s_waitcnt lgkmcnt(7)
    v_mfma_f32_32x32x16_bf16 v[32:47], a[64:67], v[48:51], v[32:47]
    ds_read_b128 v[48:51], v2 offset:24576
    s_waitcnt lgkmcnt(7)
    v_mfma_f32_32x32x16_bf16 v[32:47], a[68:71], v[52:55], v[32:47]
    ds_read_b128 v[52:55], v2 offset:25600
    s_waitcnt lgkmcnt(7)
    v_mfma_f32_32x32x16_bf16 v[32:47], a[72:75], v[56:59], v[32:47]
    ds_read_b128 v[56:59], v2 offset:26624
    s_waitcnt lgkmcnt(7)
    v_mfma_f32_32x32x16_bf16 v[32:47], a[76:79], v[60:63], v[32:47]
    ds_read_b128 v[60:63], v2 offset:27648
    s_waitcnt lgkmcnt(7)
    v_mfma_f32_32x32x16_bf16 v[32:47], a[80:83], v[64:67], v[32:47]
    ds_read_b128 v[64:67], v2 offset:28672
    s_waitcnt lgkmcnt(7)
    v_mfma_f32_32x32x16_bf16 v[32:47], a[84:87], v[68:71], v[32:47]
    ds_read_b128 v[68:71], v2 offset:29696
    s_waitcnt lgkmcnt(7)
    v_mfma_f32_32x32x16_bf16 v[32:47], a[88:91], v[72:75], v[32:47]
    ds_read_b128 v[72:75], v2 offset:30720
    s_waitcnt lgkmcnt(7)
    v_mfma_f32_32x32x16_bf16 v[32:47], a[92:95], v[76:79], v[32:47]
    ds_read_b128 v[76:79], v2 offset:31744
    s_waitcnt lgkmcnt(7)
    v_mfma_f32_32x32x16_bf16 v[32:47], a[96:99], v[48:51], v[32:47]
    s_waitcnt lgkmcnt(6)
    v_mfma_f32_32x32x16_bf16 v[32:47], a[100:103], v[52:55], v[32:47]
    s_waitcnt lgkmcnt(5)
    v_mfma_f32_32x32x16_bf16 v[32:47], a[104:107], v[56:59], v[32:47]
    s_waitcnt lgkmcnt(4)
    v_mfma_f32_32x32x16_bf16 v[32:47], a[108:111], v[60:63], v[32:47]
    s_waitcnt lgkmcnt(3)
    v_mfma_f32_32x32x16_bf16 v[32:47], a[112:115], v[64:67], v[32:47]
    s_waitcnt lgkmcnt(2)
    v_mfma_f32_32x32x16_bf16 v[32:47], a[116:119], v[68:71], v[32:47]
    s_waitcnt lgkmcnt(1)
    v_mfma_f32_32x32x16_bf16 v[32:47], a[120:123], v[72:75], v[32:47]
    s_waitcnt lgkmcnt(0)
    v_mfma_f32_32x32x16_bf16 v[32:47], a[124:127], v[76:79], v[32:47]
    s_nop 11
    v_cvt_pk_bf16_f32 v20, v32, v33
    v_lshlrev_b32 v32, 16, v20
    v_and_b32 v33, 0xffff0000, v20
    v_cvt_pk_bf16_f32 v20, v40, v41
    v_lshlrev_b32 v40, 16, v20
    v_and_b32 v41, 0xffff0000, v20
    v_mul_f32 v21, 0xbfb8aa3b, v32
    v_exp_f32 v21, v21
    s_nop 0
    v_add_f32 v21, 1.0, v21
    v_rcp_f32 v21, v21
    s_nop 0
    v_mul_f32 v32, v32, v21
    v_mul_f32 v22, 0xbfb8aa3b, v33
    v_exp_f32 v22, v22
    s_nop 0
    v_add_f32 v22, 1.0, v22
    v_rcp_f32 v22, v22
    s_nop 0
    v_mul_f32 v33, v33, v22
    v_cvt_pk_bf16_f32 v20, v32, v33
    v_lshlrev_b32 v32, 16, v20
    v_and_b32 v33, 0xffff0000, v20
    v_mul_f32 v32, v32, v40
    v_mul_f32 v33, v33, v41
    v_cvt_pk_bf16_f32 v16, v32, v33
    v_cvt_pk_bf16_f32 v20, v34, v35
    v_lshlrev_b32 v34, 16, v20
    v_and_b32 v35, 0xffff0000, v20
    v_cvt_pk_bf16_f32 v20, v42, v43
    v_lshlrev_b32 v42, 16, v20
    v_and_b32 v43, 0xffff0000, v20
    v_mul_f32 v21, 0xbfb8aa3b, v34
    v_exp_f32 v21, v21
    s_nop 0
    v_add_f32 v21, 1.0, v21
    v_rcp_f32 v21, v21
    s_nop 0
    v_mul_f32 v34, v34, v21
    v_mul_f32 v22, 0xbfb8aa3b, v35
    v_exp_f32 v22, v22
    s_nop 0
    v_add_f32 v22, 1.0, v22
    v_rcp_f32 v22, v22
    s_nop 0
    v_mul_f32 v35, v35, v22
    v_cvt_pk_bf16_f32 v20, v34, v35
    v_lshlrev_b32 v34, 16, v20
    v_and_b32 v35, 0xffff0000, v20
    v_mul_f32 v34, v34, v42
    v_mul_f32 v35, v35, v43
    v_cvt_pk_bf16_f32 v17, v34, v35
    v_cvt_pk_bf16_f32 v20, v36, v37
    v_lshlrev_b32 v36, 16, v20
    v_and_b32 v37, 0xffff0000, v20
    v_cvt_pk_bf16_f32 v20, v44, v45
    v_lshlrev_b32 v44, 16, v20
    v_and_b32 v45, 0xffff0000, v20
    v_mul_f32 v21, 0xbfb8aa3b, v36
    v_exp_f32 v21, v21
    s_nop 0
    v_add_f32 v21, 1.0, v21
    v_rcp_f32 v21, v21
    s_nop 0
    v_mul_f32 v36, v36, v21
    v_mul_f32 v22, 0xbfb8aa3b, v37
    v_exp_f32 v22, v22
    s_nop 0
    v_add_f32 v22, 1.0, v22
    v_rcp_f32 v22, v22
    s_nop 0
    v_mul_f32 v37, v37, v22
    v_cvt_pk_bf16_f32 v20, v36, v37
    v_lshlrev_b32 v36, 16, v20
    v_and_b32 v37, 0xffff0000, v20
    v_mul_f32 v36, v36, v44
    v_mul_f32 v37, v37, v45
    v_cvt_pk_bf16_f32 v18, v36, v37
    v_cvt_pk_bf16_f32 v20, v38, v39
    v_lshlrev_b32 v38, 16, v20
    v_and_b32 v39, 0xffff0000, v20
    v_cvt_pk_bf16_f32 v20, v46, v47
    v_lshlrev_b32 v46, 16, v20
    v_and_b32 v47, 0xffff0000, v20
    v_mul_f32 v21, 0xbfb8aa3b, v38
    v_exp_f32 v21, v21
    s_nop 0
    v_add_f32 v21, 1.0, v21
    v_rcp_f32 v21, v21
    s_nop 0
    v_mul_f32 v38, v38, v21
    v_mul_f32 v22, 0xbfb8aa3b, v39
    v_exp_f32 v22, v22
    s_nop 0
    v_add_f32 v22, 1.0, v22
    v_rcp_f32 v22, v22
    s_nop 0
    v_mul_f32 v39, v39, v22
    v_cvt_pk_bf16_f32 v20, v38, v39
    v_lshlrev_b32 v38, 16, v20
    v_and_b32 v39, 0xffff0000, v20
    v_mul_f32 v38, v38, v46
    v_mul_f32 v39, v39, v47
    v_cvt_pk_bf16_f32 v19, v38, v39
    buffer_store_dwordx4 v[16:19], v2, s[32:35], s53 offen sc1
    s_add_u32 s53, s53, 229376
    s_waitcnt vmcnt(0)
    s_barrier
    s_cmp_lg_u32 s40, 3
    s_cbranch_scc1 L_nosig_149
    v_mov_b32 v13, s55
    v_mov_b32 v12, 0
    s_mov_b64 exec, 1
    buffer_store_dword v13, v12, s[32:35], s54 offen sc1
    s_mov_b64 exec, -1
L_nosig_149:
    s_add_u32 s52, s52, 65536
    s_add_u32 s43, s43, 1
    s_cmp_lt_u32 s43, 32
    s_cbranch_scc1 L_gu_144
    s_waitcnt vmcnt(0)
    s_endpgm
L_role_143:
    s_cmp_ge_u32 s41, 184
    s_cbranch_scc1 L_role_150
    s_sub_u32 s42, s41, 168
    s_lshr_b32 s97, s42, 3
    s_and_b32 s42, s42, 7
    s_mov_b32 s45, 0x0
    s_lshr_b32 s46, s42, 0
    s_and_b32 s46, s46, 0x7
    s_mul_i32 s46, s46, 0x80
    s_add_u32 s45, s45, s46
    s_lshr_b32 s46, s40, 0
    s_and_b32 s46, s46, 0x3
    s_mul_i32 s46, s46, 0x4000
    s_add_u32 s45, s45, s46
    v_mov_b32 v10, s45
    s_mov_b32 s46, 0x10
    v_mad_u32_u24 v10, v4, s46, v10
    s_mov_b32 s46, 0x20
    v_mad_u32_u24 v10, v5, s46, v10
    s_mov_b32 s46, 0x400
    v_mad_u32_u24 v10, v6, s46, v10
    s_mov_b32 s46, 0x800
    v_mad_u32_u24 v10, v7, s46, v10
    s_mov_b32 s46, 0x1000
    v_mad_u32_u24 v10, v8, s46, v10
    s_mov_b32 s46, 0x2000
    v_mad_u32_u24 v10, v9, s46, v10
    s_mov_b32 s50, s20
    s_mov_b32 s51, s21
    s_lshl_b32 s47, s40, 10
    s_add_u32 s47, s47, 0
    s_mov_b32 m0, s47
    s_nop 0
    global_load_lds_dwordx4 v10, s[50:51]
    s_add_u32 s50, s50, 65536
    s_addc_u32 s51, s51, 0
    s_add_u32 s47, s47, 4096
    s_mov_b32 m0, s47
    s_nop 0
    global_load_lds_dwordx4 v10, s[50:51]
    s_add_u32 s50, s50, 65536
    s_addc_u32 s51, s51, 0
    s_add_u32 s47, s47, 4096
    s_mov_b32 m0, s47
    s_nop 0
    global_load_lds_dwordx4 v10, s[50:51]
    s_add_u32 s50, s50, 65536
    s_addc_u32 s51, s51, 0
    s_add_u32 s47, s47, 4096
    s_mov_b32 m0, s47
    s_nop 0
    global_load_lds_dwordx4 v10, s[50:51]
    s_add_u32 s50, s50, 65536
    s_addc_u32 s51, s51, 0
    s_add_u32 s47, s47, 4096
    s_mov_b32 m0, s47
    s_nop 0
    global_load_lds_dwordx4 v10, s[50:51]
    s_add_u32 s50, s50, 65536
    s_addc_u32 s51, s51, 0
    s_add_u32 s47, s47, 4096
    s_mov_b32 m0, s47
    s_nop 0
    global_load_lds_dwordx4 v10, s[50:51]
    s_add_u32 s50, s50, 65536
    s_addc_u32 s51, s51, 0
    s_add_u32 s47, s47, 4096
    s_mov_b32 m0, s47
    s_nop 0
    global_load_lds_dwordx4 v10, s[50:51]
    s_add_u32 s50, s50, 65536
    s_addc_u32 s51, s51, 0
    s_add_u32 s47, s47, 4096
    s_mov_b32 m0, s47
    s_nop 0
    global_load_lds_dwordx4 v10, s[50:51]
    s_add_u32 s50, s50, 65536
    s_addc_u32 s51, s51, 0
    s_add_u32 s47, s47, 4096
    s_mov_b32 m0, s47
    s_nop 0
    global_load_lds_dwordx4 v10, s[50:51]
    s_add_u32 s50, s50, 65536
    s_addc_u32 s51, s51, 0
    s_add_u32 s47, s47, 4096
    s_mov_b32 m0, s47
    s_nop 0
    global_load_lds_dwordx4 v10, s[50:51]
    s_add_u32 s50, s50, 65536
    s_addc_u32 s51, s51, 0
    s_add_u32 s47, s47, 4096
    s_mov_b32 m0, s47
    s_nop 0
    global_load_lds_dwordx4 v10, s[50:51]
    s_add_u32 s50, s50, 65536
    s_addc_u32 s51, s51, 0
    s_add_u32 s47, s47, 4096
    s_mov_b32 m0, s47
    s_nop 0
    global_load_lds_dwordx4 v10, s[50:51]
    s_add_u32 s50, s50, 65536
    s_addc_u32 s51, s51, 0
    s_add_u32 s47, s47, 4096
    s_mov_b32 m0, s47
    s_nop 0
    global_load_lds_dwordx4 v10, s[50:51]
    s_add_u32 s50, s50, 65536
    s_addc_u32 s51, s51, 0
    s_add_u32 s47, s47, 4096
    s_mov_b32 m0, s47
    s_nop 0
    global_load_lds_dwordx4 v10, s[50:51]
    s_add_u32 s50, s50, 65536
    s_addc_u32 s51, s51, 0
    s_add_u32 s47, s47, 4096
    s_mov_b32 m0, s47
    s_nop 0
    global_load_lds_dwordx4 v10, s[50:51]
    s_add_u32 s50, s50, 65536
    s_addc_u32 s51, s51, 0
    s_add_u32 s47, s47, 4096
    s_mov_b32 m0, s47
    s_nop 0
    global_load_lds_dwordx4 v10, s[50:51]
    s_add_u32 s50, s50, 65536
    s_addc_u32 s51, s51, 0
    s_add_u32 s47, s47, 4096
    s_mov_b32 m0, s47
    s_nop 0
    global_load_lds_dwordx4 v10, s[50:51]
    s_add_u32 s50, s50, 65536
    s_addc_u32 s51, s51, 0
    s_add_u32 s47, s47, 4096
    s_mov_b32 m0, s47
    s_nop 0
    global_load_lds_dwordx4 v10, s[50:51]
    s_add_u32 s50, s50, 65536
    s_addc_u32 s51, s51, 0
    s_add_u32 s47, s47, 4096
    s_mov_b32 m0, s47
    s_nop 0
    global_load_lds_dwordx4 v10, s[50:51]
    s_add_u32 s50, s50, 65536
    s_addc_u32 s51, s51, 0
    s_add_u32 s47, s47, 4096
    s_mov_b32 m0, s47
    s_nop 0
    global_load_lds_dwordx4 v10, s[50:51]
    s_add_u32 s50, s50, 65536
    s_addc_u32 s51, s51, 0
    s_add_u32 s47, s47, 4096
    s_mov_b32 m0, s47
    s_nop 0
    global_load_lds_dwordx4 v10, s[50:51]
    s_add_u32 s50, s50, 65536
    s_addc_u32 s51, s51, 0
    s_add_u32 s47, s47, 4096
    s_mov_b32 m0, s47
    s_nop 0
    global_load_lds_dwordx4 v10, s[50:51]
    s_add_u32 s50, s50, 65536
    s_addc_u32 s51, s51, 0
    s_add_u32 s47, s47, 4096
    s_mov_b32 m0, s47
    s_nop 0
    global_load_lds_dwordx4 v10, s[50:51]
    s_add_u32 s50, s50, 65536
    s_addc_u32 s51, s51, 0
    s_add_u32 s47, s47, 4096
    s_mov_b32 m0, s47
    s_nop 0
    global_load_lds_dwordx4 v10, s[50:51]
    s_add_u32 s50, s50, 65536
    s_addc_u32 s51, s51, 0
    s_add_u32 s47, s47, 4096
    s_mov_b32 m0, s47
    s_nop 0
    global_load_lds_dwordx4 v10, s[50:51]
    s_add_u32 s50, s50, 65536
    s_addc_u32 s51, s51, 0
    s_add_u32 s47, s47, 4096
    s_mov_b32 m0, s47
    s_nop 0
    global_load_lds_dwordx4 v10, s[50:51]
    s_add_u32 s50, s50, 65536
    s_addc_u32 s51, s51, 0
    s_add_u32 s47, s47, 4096
    s_mov_b32 m0, s47
    s_nop 0
    global_load_lds_dwordx4 v10, s[50:51]
    s_add_u32 s50, s50, 65536
    s_addc_u32 s51, s51, 0
    s_add_u32 s47, s47, 4096
    s_mov_b32 m0, s47
    s_nop 0
    global_load_lds_dwordx4 v10, s[50:51]
    s_add_u32 s50, s50, 65536
    s_addc_u32 s51, s51, 0
    s_add_u32 s47, s47, 4096
    s_waitcnt vmcnt(0)
    s_barrier
    s_mov_b32 s45, 0x0
    s_lshr_b32 s46, s40, 0
    s_and_b32 s46, s46, 0x3
    s_mul_i32 s46, s46, 0x7000
    s_add_u32 s45, s45, s46
    v_mov_b32 v10, s45
    s_mov_b32 s46, 0x8
    v_mad_u32_u24 v10, v4, s46, v10
    s_mov_b32 s46, 0x10
    v_mad_u32_u24 v10, v5, s46, v10
    s_mov_b32 s46, 0x40
    v_mad_u32_u24 v10, v6, s46, v10
    s_mov_b32 s46, 0x80
    v_mad_u32_u24 v10, v7, s46, v10
    s_mov_b32 s46, 0x20
    v_mad_u32_u24 v10, v8, s46, v10
    s_mov_b32 s46, 0x100
    v_mad_u32_u24 v10, v9, s46, v10
    v_add_u32 v11, 0, v10
    ds_read_b64_tr_b16 a[0:1], v11 offset:0
    ds_read_b64_tr_b16 a[2:3], v11 offset:512
    ds_read_b64_tr_b16 a[4:5], v11 offset:1024
    ds_read_b64_tr_b16 a[6:7], v11 offset:1536
    ds_read_b64_tr_b16 a[8:9], v11 offset:2048
    ds_read_b64_tr_b16 a[10:11], v11 offset:2560
    ds_read_b64_tr_b16 a[12:13], v11 offset:3072
    ds_read_b64_tr_b16 a[14:15], v11 offset:3584
    s_waitcnt lgkmcnt(0)
    ds_read_b64_tr_b16 a[16:17], v11 offset:4096
    ds_read_b64_tr_b16 a[18:19], v11 offset:4608
    ds_read_b64_tr_b16 a[20:21], v11 offset:5120
    ds_read_b64_tr_b16 a[22:23], v11 offset:5632
    ds_read_b64_tr_b16 a[24:25], v11 offset:6144
    ds_read_b64_tr_b16 a[26:27], v11 offset:6656
    ds_read_b64_tr_b16 a[28:29], v11 offset:7168
    ds_read_b64_tr_b16 a[30:31], v11 offset:7680
    s_waitcnt lgkmcnt(0)
    ds_read_b64_tr_b16 a[32:33], v11 offset:8192
    ds_read_b64_tr_b16 a[34:35], v11 offset:8704
    ds_read_b64_tr_b16 a[36:37], v11 offset:9216
    ds_read_b64_tr_b16 a[38:39], v11 offset:9728
    ds_read_b64_tr_b16 a[40:41], v11 offset:10240
    ds_read_b64_tr_b16 a[42:43], v11 offset:10752
    ds_read_b64_tr_b16 a[44:45], v11 offset:11264
    ds_read_b64_tr_b16 a[46:47], v11 offset:11776
    s_waitcnt lgkmcnt(0)
    ds_read_b64_tr_b16 a[48:49], v11 offset:12288
    ds_read_b64_tr_b16 a[50:51], v11 offset:12800
    ds_read_b64_tr_b16 a[52:53], v11 offset:13312
    ds_read_b64_tr_b16 a[54:55], v11 offset:13824
    ds_read_b64_tr_b16 a[56:57], v11 offset:14336
    ds_read_b64_tr_b16 a[58:59], v11 offset:14848
    ds_read_b64_tr_b16 a[60:61], v11 offset:15360
    ds_read_b64_tr_b16 a[62:63], v11 offset:15872
    s_waitcnt lgkmcnt(0)
    ds_read_b64_tr_b16 a[64:65], v11 offset:16384
    ds_read_b64_tr_b16 a[66:67], v11 offset:16896
    ds_read_b64_tr_b16 a[68:69], v11 offset:17408
    ds_read_b64_tr_b16 a[70:71], v11 offset:17920
    ds_read_b64_tr_b16 a[72:73], v11 offset:18432
    ds_read_b64_tr_b16 a[74:75], v11 offset:18944
    ds_read_b64_tr_b16 a[76:77], v11 offset:19456
    ds_read_b64_tr_b16 a[78:79], v11 offset:19968
    s_waitcnt lgkmcnt(0)
    ds_read_b64_tr_b16 a[80:81], v11 offset:20480
    ds_read_b64_tr_b16 a[82:83], v11 offset:20992
    ds_read_b64_tr_b16 a[84:85], v11 offset:21504
    ds_read_b64_tr_b16 a[86:87], v11 offset:22016
    ds_read_b64_tr_b16 a[88:89], v11 offset:22528
    ds_read_b64_tr_b16 a[90:91], v11 offset:23040
    ds_read_b64_tr_b16 a[92:93], v11 offset:23552
    ds_read_b64_tr_b16 a[94:95], v11 offset:24064
    s_waitcnt lgkmcnt(0)
    ds_read_b64_tr_b16 a[96:97], v11 offset:24576
    ds_read_b64_tr_b16 a[98:99], v11 offset:25088
    ds_read_b64_tr_b16 a[100:101], v11 offset:25600
    ds_read_b64_tr_b16 a[102:103], v11 offset:26112
    ds_read_b64_tr_b16 a[104:105], v11 offset:26624
    ds_read_b64_tr_b16 a[106:107], v11 offset:27136
    ds_read_b64_tr_b16 a[108:109], v11 offset:27648
    ds_read_b64_tr_b16 a[110:111], v11 offset:28160
    s_waitcnt lgkmcnt(0)
    s_waitcnt lgkmcnt(0)
    s_barrier
    s_mov_b32 s45, 0x40
    s_lshr_b32 s46, s42, 0
    s_and_b32 s46, s46, 0x7
    s_mul_i32 s46, s46, 0x80
    s_add_u32 s45, s45, s46
    s_lshr_b32 s46, s40, 0
    s_and_b32 s46, s46, 0x3
    s_mul_i32 s46, s46, 0x4000
    s_add_u32 s45, s45, s46
    v_mov_b32 v10, s45
    s_mov_b32 s46, 0x10
    v_mad_u32_u24 v10, v4, s46, v10
    s_mov_b32 s46, 0x20
    v_mad_u32_u24 v10, v5, s46, v10
    s_mov_b32 s46, 0x400
    v_mad_u32_u24 v10, v6, s46, v10
    s_mov_b32 s46, 0x800
    v_mad_u32_u24 v10, v7, s46, v10
    s_mov_b32 s46, 0x1000
    v_mad_u32_u24 v10, v8, s46, v10
    s_mov_b32 s46, 0x2000
    v_mad_u32_u24 v10, v9, s46, v10
    s_mov_b32 s50, s20
    s_mov_b32 s51, s21
    s_lshl_b32 s47, s40, 10
    s_add_u32 s47, s47, 0
    s_mov_b32 m0, s47
    s_nop 0
    global_load_lds_dwordx4 v10, s[50:51]
    s_add_u32 s50, s50, 65536
    s_addc_u32 s51, s51, 0
    s_add_u32 s47, s47, 4096
    s_mov_b32 m0, s47
    s_nop 0
    global_load_lds_dwordx4 v10, s[50:51]
    s_add_u32 s50, s50, 65536
    s_addc_u32 s51, s51, 0
    s_add_u32 s47, s47, 4096
    s_mov_b32 m0, s47
    s_nop 0
    global_load_lds_dwordx4 v10, s[50:51]
    s_add_u32 s50, s50, 65536
    s_addc_u32 s51, s51, 0
    s_add_u32 s47, s47, 4096
    s_mov_b32 m0, s47
    s_nop 0
    global_load_lds_dwordx4 v10, s[50:51]
    s_add_u32 s50, s50, 65536
    s_addc_u32 s51, s51, 0
    s_add_u32 s47, s47, 4096
    s_mov_b32 m0, s47
    s_nop 0
    global_load_lds_dwordx4 v10, s[50:51]
    s_add_u32 s50, s50, 65536
    s_addc_u32 s51, s51, 0
    s_add_u32 s47, s47, 4096
    s_mov_b32 m0, s47
    s_nop 0
    global_load_lds_dwordx4 v10, s[50:51]
    s_add_u32 s50, s50, 65536
    s_addc_u32 s51, s51, 0
    s_add_u32 s47, s47, 4096
    s_mov_b32 m0, s47
    s_nop 0
    global_load_lds_dwordx4 v10, s[50:51]
    s_add_u32 s50, s50, 65536
    s_addc_u32 s51, s51, 0
    s_add_u32 s47, s47, 4096
    s_mov_b32 m0, s47
    s_nop 0
    global_load_lds_dwordx4 v10, s[50:51]
    s_add_u32 s50, s50, 65536
    s_addc_u32 s51, s51, 0
    s_add_u32 s47, s47, 4096
    s_mov_b32 m0, s47
    s_nop 0
    global_load_lds_dwordx4 v10, s[50:51]
    s_add_u32 s50, s50, 65536
    s_addc_u32 s51, s51, 0
    s_add_u32 s47, s47, 4096
    s_mov_b32 m0, s47
    s_nop 0
    global_load_lds_dwordx4 v10, s[50:51]
    s_add_u32 s50, s50, 65536
    s_addc_u32 s51, s51, 0
    s_add_u32 s47, s47, 4096
    s_mov_b32 m0, s47
    s_nop 0
    global_load_lds_dwordx4 v10, s[50:51]
    s_add_u32 s50, s50, 65536
    s_addc_u32 s51, s51, 0
    s_add_u32 s47, s47, 4096
    s_mov_b32 m0, s47
    s_nop 0
    global_load_lds_dwordx4 v10, s[50:51]
    s_add_u32 s50, s50, 65536
    s_addc_u32 s51, s51, 0
    s_add_u32 s47, s47, 4096
    s_mov_b32 m0, s47
    s_nop 0
    global_load_lds_dwordx4 v10, s[50:51]
    s_add_u32 s50, s50, 65536
    s_addc_u32 s51, s51, 0
    s_add_u32 s47, s47, 4096
    s_mov_b32 m0, s47
    s_nop 0
    global_load_lds_dwordx4 v10, s[50:51]
    s_add_u32 s50, s50, 65536
    s_addc_u32 s51, s51, 0
    s_add_u32 s47, s47, 4096
    s_mov_b32 m0, s47
    s_nop 0
    global_load_lds_dwordx4 v10, s[50:51]
    s_add_u32 s50, s50, 65536
    s_addc_u32 s51, s51, 0
    s_add_u32 s47, s47, 4096
    s_mov_b32 m0, s47
    s_nop 0
    global_load_lds_dwordx4 v10, s[50:51]
    s_add_u32 s50, s50, 65536
    s_addc_u32 s51, s51, 0
    s_add_u32 s47, s47, 4096
    s_mov_b32 m0, s47
    s_nop 0
    global_load_lds_dwordx4 v10, s[50:51]
    s_add_u32 s50, s50, 65536
    s_addc_u32 s51, s51, 0
    s_add_u32 s47, s47, 4096
    s_mov_b32 m0, s47
    s_nop 0
    global_load_lds_dwordx4 v10, s[50:51]
    s_add_u32 s50, s50, 65536
    s_addc_u32 s51, s51, 0
    s_add_u32 s47, s47, 4096
    s_mov_b32 m0, s47
    s_nop 0
    global_load_lds_dwordx4 v10, s[50:51]
    s_add_u32 s50, s50, 65536
    s_addc_u32 s51, s51, 0
    s_add_u32 s47, s47, 4096
    s_mov_b32 m0, s47
    s_nop 0
    global_load_lds_dwordx4 v10, s[50:51]
    s_add_u32 s50, s50, 65536
    s_addc_u32 s51, s51, 0
    s_add_u32 s47, s47, 4096
    s_mov_b32 m0, s47
    s_nop 0
    global_load_lds_dwordx4 v10, s[50:51]
    s_add_u32 s50, s50, 65536
    s_addc_u32 s51, s51, 0
    s_add_u32 s47, s47, 4096
    s_mov_b32 m0, s47
    s_nop 0
    global_load_lds_dwordx4 v10, s[50:51]
    s_add_u32 s50, s50, 65536
    s_addc_u32 s51, s51, 0
    s_add_u32 s47, s47, 4096
    s_mov_b32 m0, s47
    s_nop 0
    global_load_lds_dwordx4 v10, s[50:51]
    s_add_u32 s50, s50, 65536
    s_addc_u32 s51, s51, 0
    s_add_u32 s47, s47, 4096
    s_mov_b32 m0, s47
    s_nop 0
    global_load_lds_dwordx4 v10, s[50:51]
    s_add_u32 s50, s50, 65536
    s_addc_u32 s51, s51, 0
    s_add_u32 s47, s47, 4096
    s_mov_b32 m0, s47
    s_nop 0
    global_load_lds_dwordx4 v10, s[50:51]
    s_add_u32 s50, s50, 65536
    s_addc_u32 s51, s51, 0
    s_add_u32 s47, s47, 4096
    s_mov_b32 m0, s47
    s_nop 0
    global_load_lds_dwordx4 v10, s[50:51]
    s_add_u32 s50, s50, 65536
    s_addc_u32 s51, s51, 0
    s_add_u32 s47, s47, 4096
    s_mov_b32 m0, s47
    s_nop 0
    global_load_lds_dwordx4 v10, s[50:51]
    s_add_u32 s50, s50, 65536
    s_addc_u32 s51, s51, 0
    s_add_u32 s47, s47, 4096
    s_mov_b32 m0, s47
    s_nop 0
    global_load_lds_dwordx4 v10, s[50:51]
    s_add_u32 s50, s50, 65536
    s_addc_u32 s51, s51, 0
    s_add_u32 s47, s47, 4096
    s_waitcnt vmcnt(0)
    s_barrier
    s_mov_b32 s45, 0x0
    s_lshr_b32 s46, s40, 0
    s_and_b32 s46, s46, 0x3
    s_mul_i32 s46, s46, 0x7000
    s_add_u32 s45, s45, s46
    v_mov_b32 v10, s45
    s_mov_b32 s46, 0x8
    v_mad_u32_u24 v10, v4, s46, v10
    s_mov_b32 s46, 0x10
    v_mad_u32_u24 v10, v5, s46, v10
    s_mov_b32 s46, 0x40
    v_mad_u32_u24 v10, v6, s46, v10
    s_mov_b32 s46, 0x80
    v_mad_u32_u24 v10, v7, s46, v10
    s_mov_b32 s46, 0x20
    v_mad_u32_u24 v10, v8, s46, v10
    s_mov_b32 s46, 0x100
    v_mad_u32_u24 v10, v9, s46, v10
    v_add_u32 v11, 0, v10
    ds_read_b64_tr_b16 a[112:113], v11 offset:0
    ds_read_b64_tr_b16 a[114:115], v11 offset:512
    ds_read_b64_tr_b16 a[116:117], v11 offset:1024
    ds_read_b64_tr_b16 a[118:119], v11 offset:1536
    ds_read_b64_tr_b16 a[120:121], v11 offset:2048
    ds_read_b64_tr_b16 a[122:123], v11 offset:2560
    ds_read_b64_tr_b16 a[124:125], v11 offset:3072
    ds_read_b64_tr_b16 a[126:127], v11 offset:3584
    s_waitcnt lgkmcnt(0)
    ds_read_b64_tr_b16 a[128:129], v11 offset:4096
    ds_read_b64_tr_b16 a[130:131], v11 offset:4608
    ds_read_b64_tr_b16 a[132:133], v11 offset:5120
    ds_read_b64_tr_b16 a[134:135], v11 offset:5632
    ds_read_b64_tr_b16 a[136:137], v11 offset:6144
    ds_read_b64_tr_b16 a[138:139], v11 offset:6656
    ds_read_b64_tr_b16 a[140:141], v11 offset:7168
    ds_read_b64_tr_b16 a[142:143], v11 offset:7680
    s_waitcnt lgkmcnt(0)
    ds_read_b64_tr_b16 a[144:145], v11 offset:8192
    ds_read_b64_tr_b16 a[146:147], v11 offset:8704
    ds_read_b64_tr_b16 a[148:149], v11 offset:9216
    ds_read_b64_tr_b16 a[150:151], v11 offset:9728
    ds_read_b64_tr_b16 a[152:153], v11 offset:10240
    ds_read_b64_tr_b16 a[154:155], v11 offset:10752
    ds_read_b64_tr_b16 a[156:157], v11 offset:11264
    ds_read_b64_tr_b16 a[158:159], v11 offset:11776
    s_waitcnt lgkmcnt(0)
    ds_read_b64_tr_b16 a[160:161], v11 offset:12288
    ds_read_b64_tr_b16 a[162:163], v11 offset:12800
    ds_read_b64_tr_b16 a[164:165], v11 offset:13312
    ds_read_b64_tr_b16 a[166:167], v11 offset:13824
    ds_read_b64_tr_b16 a[168:169], v11 offset:14336
    ds_read_b64_tr_b16 a[170:171], v11 offset:14848
    ds_read_b64_tr_b16 a[172:173], v11 offset:15360
    ds_read_b64_tr_b16 a[174:175], v11 offset:15872
    s_waitcnt lgkmcnt(0)
    ds_read_b64_tr_b16 a[176:177], v11 offset:16384
    ds_read_b64_tr_b16 a[178:179], v11 offset:16896
    ds_read_b64_tr_b16 a[180:181], v11 offset:17408
    ds_read_b64_tr_b16 a[182:183], v11 offset:17920
    ds_read_b64_tr_b16 a[184:185], v11 offset:18432
    ds_read_b64_tr_b16 a[186:187], v11 offset:18944
    ds_read_b64_tr_b16 a[188:189], v11 offset:19456
    ds_read_b64_tr_b16 a[190:191], v11 offset:19968
    s_waitcnt lgkmcnt(0)
    ds_read_b64_tr_b16 a[192:193], v11 offset:20480
    ds_read_b64_tr_b16 a[194:195], v11 offset:20992
    ds_read_b64_tr_b16 a[196:197], v11 offset:21504
    ds_read_b64_tr_b16 a[198:199], v11 offset:22016
    ds_read_b64_tr_b16 a[200:201], v11 offset:22528
    ds_read_b64_tr_b16 a[202:203], v11 offset:23040
    ds_read_b64_tr_b16 a[204:205], v11 offset:23552
    ds_read_b64_tr_b16 a[206:207], v11 offset:24064
    s_waitcnt lgkmcnt(0)
    ds_read_b64_tr_b16 a[208:209], v11 offset:24576
    ds_read_b64_tr_b16 a[210:211], v11 offset:25088
    ds_read_b64_tr_b16 a[212:213], v11 offset:25600
    ds_read_b64_tr_b16 a[214:215], v11 offset:26112
    ds_read_b64_tr_b16 a[216:217], v11 offset:26624
    ds_read_b64_tr_b16 a[218:219], v11 offset:27136
    ds_read_b64_tr_b16 a[220:221], v11 offset:27648
    ds_read_b64_tr_b16 a[222:223], v11 offset:28160
    s_waitcnt lgkmcnt(0)
    s_waitcnt lgkmcnt(0)
    s_barrier
    s_mov_b32 s45, 0x2800
    s_lshr_b32 s46, s42, 0
    s_and_b32 s46, s46, 0x7
    s_mul_i32 s46, s46, 0x100
    s_add_u32 s45, s45, s46
    s_lshr_b32 s46, s40, 0
    s_and_b32 s46, s46, 0x3
    s_mul_i32 s46, s46, 0x20
    s_add_u32 s45, s45, s46
    v_mov_b32 v3, s45
    s_mov_b32 s46, 0x10
    v_mad_u32_u24 v3, v9, s46, v3
    buffer_load_dwordx4 v[24:27], v3, s[32:35], 0 offen sc1
    buffer_load_dwordx4 v[192:195], v3, s[32:35], 0 offen offset:128 sc1
    s_mov_b32 s45, 0x0
    s_lshr_b32 s46, s42, 0
    s_and_b32 s46, s46, 0x7
    s_mul_i32 s46, s46, 0x80
    s_add_u32 s45, s45, s46
    s_lshr_b32 s46, s40, 0
    s_and_b32 s46, s46, 0x3
    s_mul_i32 s46, s46, 0x10
    s_add_u32 s45, s45, s46
    v_mov_b32 v3, s45
    s_mov_b32 s46, 0x400
    v_mad_u32_u24 v3, v4, s46, v3
    s_mov_b32 s46, 0x800
    v_mad_u32_u24 v3, v5, s46, v3
    s_mov_b32 s46, 0x1000
    v_mad_u32_u24 v3, v6, s46, v3
    s_mov_b32 s46, 0x2000
    v_mad_u32_u24 v3, v7, s46, v3
    s_mov_b32 s46, 0x4000
    v_mad_u32_u24 v3, v8, s46, v3
    s_mov_b32 s46, 0x8
    v_mad_u32_u24 v3, v9, s46, v3
    s_mov_b32 s45, 0x6c000
    s_lshr_b32 s46, s40, 0
    s_and_b32 s46, s46, 0x3
    s_mul_i32 s46, s46, 0x380
    s_add_u32 s45, s45, s46
    s_lshr_b32 s46, s97, 0
    s_and_b32 s46, s46, 0x1
    s_mul_i32 s46, s46, 0x1000
    s_add_u32 s45, s45, s46
    v_mov_b32 v14, s45
    s_mov_b32 s46, 0x80
    v_mad_u32_u24 v14, v4, s46, v14
    s_mov_b32 s46, 0x100
    v_mad_u32_u24 v14, v5, s46, v14
    s_mov_b32 s46, 0x200
    v_mad_u32_u24 v14, v6, s46, v14
    s_mul_i32 s45, s40, 28672
    s_mul_i32 s46, s97, 114688
    s_add_u32 s45, s45, s46
    s_add_u32 s52, s45, 125829120
    s_lshl_b32 s53, s97, 15
    s_lshl_b32 s45, s40, 12
    v_add_u32 v10, s45, v2
    s_lshl_b32 s45, s40, 10
    v_add_u32 v11, s45, v2
    s_mov_b32 s60, s26
    s_and_b32 s61, s27, 0xffff
    s_mov_b32 s62, 2097152
    s_mov_b32 s63, 0x00020000
    s_mov_b32 s43, 0
L_dn_151:
    s_add_u32 s55, s43, 1
    s_mov_b32 exec_lo, 0x7f
    s_mov_b32 exec_hi, 0x0
L_wf_152:
    buffer_load_dword v15, v14, s[32:35], 0 offen sc1
    s_waitcnt vmcnt(0)
    v_cmp_gt_u32 vcc, s55, v15
    s_nop 0
    s_and_b32 vcc_lo, vcc_lo, 0x7f
    s_and_b32 vcc_hi, vcc_hi, 0x0
    s_cmp_eq_u64 vcc, 0
    s_cbranch_scc1 L_wfok_153
    s_add_u32 s44, s44, 1
    s_cmp_gt_u32 s44, 1048576
    s_cbranch_scc1 L_w_abort_100
    s_branch L_wf_152
L_wfok_153:
    s_mov_b64 exec, -1
L_wfskip_154:
    s_add_u32 s45, s52, 0
    buffer_load_dwordx4 v[64:67], v2, s[32:35], s45 offen offset:0 sc1
    buffer_load_dwordx4 v[68:71], v2, s[32:35], s45 offen offset:1024 sc1
    buffer_load_dwordx4 v[72:75], v2, s[32:35], s45 offen offset:2048 sc1
    buffer_load_dwordx4 v[76:79], v2, s[32:35], s45 offen offset:3072 sc1
    s_add_u32 s45, s52, 4096
    buffer_load_dwordx4 v[80:83], v2, s[32:35], s45 offen offset:0 sc1
    buffer_load_dwordx4 v[84:87], v2, s[32:35], s45 offen offset:1024 sc1
    buffer_load_dwordx4 v[88:91], v2, s[32:35], s45 offen offset:2048 sc1
    buffer_load_dwordx4 v[92:95], v2, s[32:35], s45 offen offset:3072 sc1
    s_add_u32 s45, s52, 8192
    buffer_load_dwordx4 v[96:99], v2, s[32:35], s45 offen offset:0 sc1
    buffer_load_dwordx4 v[100:103], v2, s[32:35], s45 offen offset:1024 sc1
    buffer_load_dwordx4 v[104:107], v2, s[32:35], s45 offen offset:2048 sc1
    buffer_load_dwordx4 v[108:111], v2, s[32:35], s45 offen offset:3072 sc1
    s_add_u32 s45, s52, 12288
    buffer_load_dwordx4 v[112:115], v2, s[32:35], s45 offen offset:0 sc1
    buffer_load_dwordx4 v[116:119], v2, s[32:35], s45 offen offset:1024 sc1
    buffer_load_dwordx4 v[120:123], v2, s[32:35], s45 offen offset:2048 sc1
    buffer_load_dwordx4 v[124:127], v2, s[32:35], s45 offen offset:3072 sc1
    s_add_u32 s45, s52, 16384
    buffer_load_dwordx4 v[128:131], v2, s[32:35], s45 offen offset:0 sc1
    buffer_load_dwordx4 v[132:135], v2, s[32:35], s45 offen offset:1024 sc1
    buffer_load_dwordx4 v[136:139], v2, s[32:35], s45 offen offset:2048 sc1
    buffer_load_dwordx4 v[140:143], v2, s[32:35], s45 offen offset:3072 sc1
    s_add_u32 s45, s52, 20480
    buffer_load_dwordx4 v[144:147], v2, s[32:35], s45 offen offset:0 sc1
    buffer_load_dwordx4 v[148:151], v2, s[32:35], s45 offen offset:1024 sc1
    buffer_load_dwordx4 v[152:155], v2, s[32:35], s45 offen offset:2048 sc1
    buffer_load_dwordx4 v[156:159], v2, s[32:35], s45 offen offset:3072 sc1
    s_add_u32 s45, s52, 24576
    buffer_load_dwordx4 v[160:163], v2, s[32:35], s45 offen offset:0 sc1
    buffer_load_dwordx4 v[164:167], v2, s[32:35], s45 offen offset:1024 sc1
    buffer_load_dwordx4 v[168:171], v2, s[32:35], s45 offen offset:2048 sc1
    buffer_load_dwordx4 v[172:175], v2, s[32:35], s45 offen offset:3072 sc1
    s_add_u32 s46, s53, 6291456
    buffer_load_dwordx2 v[28:29], v3, s[32:35], s46 offen sc1
    buffer_load_dwordx2 v[30:31], v3, s[32:35], s46 offen offset:64 sc1
    s_waitcnt vmcnt(29)
    v_mfma_f32_32x32x16_bf16 v[32:47], a[0:3], v[64:67], 0
    v_mfma_f32_32x32x16_bf16 v[176:191], a[112:115], v[64:67], 0
    s_waitcnt vmcnt(28)
    v_mfma_f32_32x32x16_bf16 v[32:47], a[4:7], v[68:71], v[32:47]
    v_mfma_f32_32x32x16_bf16 v[176:191], a[116:119], v[68:71], v[176:191]
    s_waitcnt vmcnt(27)
    v_mfma_f32_32x32x16_bf16 v[32:47], a[8:11], v[72:75], v[32:47]
    v_mfma_f32_32x32x16_bf16 v[176:191], a[120:123], v[72:75], v[176:191]
    s_waitcnt vmcnt(26)
    v_mfma_f32_32x32x16_bf16 v[32:47], a[12:15], v[76:79], v[32:47]
    v_mfma_f32_32x32x16_bf16 v[176:191], a[124:127], v[76:79], v[176:191]
    s_waitcnt vmcnt(25)
    v_mfma_f32_32x32x16_bf16 v[32:47], a[16:19], v[80:83], v[32:47]
    v_mfma_f32_32x32x16_bf16 v[176:191], a[128:131], v[80:83], v[176:191]
    s_waitcnt vmcnt(24)
    v_mfma_f32_32x32x16_bf16 v[32:47], a[20:23], v[84:87], v[32:47]
    v_mfma_f32_32x32x16_bf16 v[176:191], a[132:135], v[84:87], v[176:191]
    s_waitcnt vmcnt(23)
    v_mfma_f32_32x32x16_bf16 v[32:47], a[24:27], v[88:91], v[32:47]
    v_mfma_f32_32x32x16_bf16 v[176:191], a[136:139], v[88:91], v[176:191]
    s_waitcnt vmcnt(22)
    v_mfma_f32_32x32x16_bf16 v[32:47], a[28:31], v[92:95], v[32:47]
    v_mfma_f32_32x32x16_bf16 v[176:191], a[140:143], v[92:95], v[176:191]
    s_waitcnt vmcnt(21)
    v_mfma_f32_32x32x16_bf16 v[32:47], a[32:35], v[96:99], v[32:47]
    v_mfma_f32_32x32x16_bf16 v[176:191], a[144:147], v[96:99], v[176:191]
    s_waitcnt vmcnt(20)
    v_mfma_f32_32x32x16_bf16 v[32:47], a[36:39], v[100:103], v[32:47]
    v_mfma_f32_32x32x16_bf16 v[176:191], a[148:151], v[100:103], v[176:191]
    s_waitcnt vmcnt(19)
    v_mfma_f32_32x32x16_bf16 v[32:47], a[40:43], v[104:107], v[32:47]
    v_mfma_f32_32x32x16_bf16 v[176:191], a[152:155], v[104:107], v[176:191]
    s_waitcnt vmcnt(18)
    v_mfma_f32_32x32x16_bf16 v[32:47], a[44:47], v[108:111], v[32:47]
    v_mfma_f32_32x32x16_bf16 v[176:191], a[156:159], v[108:111], v[176:191]
    s_waitcnt vmcnt(17)
    v_mfma_f32_32x32x16_bf16 v[32:47], a[48:51], v[112:115], v[32:47]
    v_mfma_f32_32x32x16_bf16 v[176:191], a[160:163], v[112:115], v[176:191]
    s_waitcnt vmcnt(16)
    v_mfma_f32_32x32x16_bf16 v[32:47], a[52:55], v[116:119], v[32:47]
    v_mfma_f32_32x32x16_bf16 v[176:191], a[164:167], v[116:119], v[176:191]
    s_waitcnt vmcnt(15)
    v_mfma_f32_32x32x16_bf16 v[32:47], a[56:59], v[120:123], v[32:47]
    v_mfma_f32_32x32x16_bf16 v[176:191], a[168:171], v[120:123], v[176:191]
    s_waitcnt vmcnt(14)
    v_mfma_f32_32x32x16_bf16 v[32:47], a[60:63], v[124:127], v[32:47]
    v_mfma_f32_32x32x16_bf16 v[176:191], a[172:175], v[124:127], v[176:191]
    s_waitcnt vmcnt(13)
    v_mfma_f32_32x32x16_bf16 v[32:47], a[64:67], v[128:131], v[32:47]
    v_mfma_f32_32x32x16_bf16 v[176:191], a[176:179], v[128:131], v[176:191]
    s_waitcnt vmcnt(12)
    v_mfma_f32_32x32x16_bf16 v[32:47], a[68:71], v[132:135], v[32:47]
    v_mfma_f32_32x32x16_bf16 v[176:191], a[180:183], v[132:135], v[176:191]
    s_waitcnt vmcnt(11)
    v_mfma_f32_32x32x16_bf16 v[32:47], a[72:75], v[136:139], v[32:47]
    v_mfma_f32_32x32x16_bf16 v[176:191], a[184:187], v[136:139], v[176:191]
    s_waitcnt vmcnt(10)
    v_mfma_f32_32x32x16_bf16 v[32:47], a[76:79], v[140:143], v[32:47]
    v_mfma_f32_32x32x16_bf16 v[176:191], a[188:191], v[140:143], v[176:191]
    s_waitcnt vmcnt(9)
    v_mfma_f32_32x32x16_bf16 v[32:47], a[80:83], v[144:147], v[32:47]
    v_mfma_f32_32x32x16_bf16 v[176:191], a[192:195], v[144:147], v[176:191]
    s_waitcnt vmcnt(8)
    v_mfma_f32_32x32x16_bf16 v[32:47], a[84:87], v[148:151], v[32:47]
    v_mfma_f32_32x32x16_bf16 v[176:191], a[196:199], v[148:151], v[176:191]
    s_waitcnt vmcnt(7)
    v_mfma_f32_32x32x16_bf16 v[32:47], a[88:91], v[152:155], v[32:47]
    v_mfma_f32_32x32x16_bf16 v[176:191], a[200:203], v[152:155], v[176:191]
    s_waitcnt vmcnt(6)
    v_mfma_f32_32x32x16_bf16 v[32:47], a[92:95], v[156:159], v[32:47]
    v_mfma_f32_32x32x16_bf16 v[176:191], a[204:207], v[156:159], v[176:191]
    s_waitcnt vmcnt(5)
    v_mfma_f32_32x32x16_bf16 v[32:47], a[96:99], v[160:163], v[32:47]
    v_mfma_f32_32x32x16_bf16 v[176:191], a[208:211], v[160:163], v[176:191]
    s_waitcnt vmcnt(4)
    v_mfma_f32_32x32x16_bf16 v[32:47], a[100:103], v[164:167], v[32:47]
    v_mfma_f32_32x32x16_bf16 v[176:191], a[212:215], v[164:167], v[176:191]
    s_waitcnt vmcnt(3)
    v_mfma_f32_32x32x16_bf16 v[32:47], a[104:107], v[168:171], v[32:47]
    v_mfma_f32_32x32x16_bf16 v[176:191], a[216:219], v[168:171], v[176:191]
    s_waitcnt vmcnt(2)
    v_mfma_f32_32x32x16_bf16 v[32:47], a[108:111], v[172:175], v[32:47]
    v_mfma_f32_32x32x16_bf16 v[176:191], a[220:223], v[172:175], v[176:191]
    s_nop 9
    ds_write_b128 v10, v[32:35] offset:0
    ds_write_b128 v10, v[36:39] offset:1024
    ds_write_b128 v10, v[40:43] offset:2048
    ds_write_b128 v10, v[44:47] offset:3072
    ds_write_b128 v10, v[176:179] offset:16384
    ds_write_b128 v10, v[180:183] offset:17408
    ds_write_b128 v10, v[184:187] offset:18432
    ds_write_b128 v10, v[188:191] offset:19456
    s_waitcnt lgkmcnt(0)
    s_barrier
    ds_read_b128 v[64:67], v11 offset:0
    ds_read_b128 v[68:71], v11 offset:4096
    ds_read_b128 v[72:75], v11 offset:8192
    ds_read_b128 v[76:79], v11 offset:12288
    ds_read_b128 v[80:83], v11 offset:16384
    ds_read_b128 v[84:87], v11 offset:20480
    ds_read_b128 v[88:91], v11 offset:24576
    ds_read_b128 v[92:95], v11 offset:28672
    s_waitcnt lgkmcnt(6)
    v_add_f32 v64, v64, v68
    s_waitcnt lgkmcnt(4)
    v_add_f32 v72, v72, v76
    v_add_f32 v64, v64, v72
    v_add_f32 v65, v65, v69
    v_add_f32 v73, v73, v77
    v_add_f32 v65, v65, v73
    v_add_f32 v66, v66, v70
    v_add_f32 v74, v74, v78
    v_add_f32 v66, v66, v74
    v_add_f32 v67, v67, v71
    v_add_f32 v75, v75, v79
    v_add_f32 v67, v67, v75
    s_waitcnt lgkmcnt(2)
    v_add_f32 v80, v80, v84
    s_waitcnt lgkmcnt(0)
    v_add_f32 v88, v88, v92
    v_add_f32 v80, v80, v88
    v_add_f32 v81, v81, v85
    v_add_f32 v89, v89, v93
    v_add_f32 v81, v81, v89
    v_add_f32 v82, v82, v86
    v_add_f32 v90, v90, v94
    v_add_f32 v82, v82, v90
    v_add_f32 v83, v83, v87
    v_add_f32 v91, v91, v95
    v_add_f32 v83, v83, v91
    s_barrier
    v_cvt_pk_bf16_f32 v20, v64, v65
    v_lshlrev_b32 v64, 16, v20
    v_and_b32 v65, 0xffff0000, v20
    v_mul_f32 v64, v64, v24
    v_mul_f32 v65, v65, v25
    v_cvt_pk_bf16_f32 v20, v64, v65
    v_lshlrev_b32 v64, 16, v20
    v_and_b32 v65, 0xffff0000, v20
    s_waitcnt vmcnt(1)
    v_lshlrev_b32 v21, 16, v28
    v_and_b32 v22, 0xffff0000, v28
    v_add_f32 v64, v64, v21
    v_add_f32 v65, v65, v22
    v_cvt_pk_bf16_f32 v16, v64, v65
    v_cvt_pk_bf16_f32 v20, v66, v67
    v_lshlrev_b32 v66, 16, v20
    v_and_b32 v67, 0xffff0000, v20
    v_mul_f32 v66, v66, v26
    v_mul_f32 v67, v67, v27
    v_cvt_pk_bf16_f32 v20, v66, v67
    v_lshlrev_b32 v66, 16, v20
    v_and_b32 v67, 0xffff0000, v20
    v_lshlrev_b32 v21, 16, v29
    v_and_b32 v22, 0xffff0000, v29
    v_add_f32 v66, v66, v21
    v_add_f32 v67, v67, v22
    v_cvt_pk_bf16_f32 v17, v66, v67
    buffer_store_dwordx2 v[16:17], v3, s[60:63], s53 offen offset:0
    v_cvt_pk_bf16_f32 v20, v80, v81
    v_lshlrev_b32 v80, 16, v20
    v_and_b32 v81, 0xffff0000, v20
    v_mul_f32 v80, v80, v192
    v_mul_f32 v81, v81, v193
    v_cvt_pk_bf16_f32 v20, v80, v81
    v_lshlrev_b32 v80, 16, v20
    v_and_b32 v81, 0xffff0000, v20
    s_waitcnt vmcnt(1)
    v_lshlrev_b32 v21, 16, v30
    v_and_b32 v22, 0xffff0000, v30
    v_add_f32 v80, v80, v21
    v_add_f32 v81, v81, v22
    v_cvt_pk_bf16_f32 v18, v80, v81
    v_cvt_pk_bf16_f32 v20, v82, v83
    v_lshlrev_b32 v82, 16, v20
    v_and_b32 v83, 0xffff0000, v20
    v_mul_f32 v82, v82, v194
    v_mul_f32 v83, v83, v195
    v_cvt_pk_bf16_f32 v20, v82, v83
    v_lshlrev_b32 v82, 16, v20
    v_and_b32 v83, 0xffff0000, v20
    v_lshlrev_b32 v21, 16, v31
    v_and_b32 v22, 0xffff0000, v31
    v_add_f32 v82, v82, v21
    v_add_f32 v83, v83, v22
    v_cvt_pk_bf16_f32 v19, v82, v83
    buffer_store_dwordx2 v[18:19], v3, s[60:63], s53 offen offset:64
    s_add_u32 s53, s53, 65536
    s_add_u32 s52, s52, 229376
    s_add_u32 s43, s43, 1
    s_cmp_lt_u32 s43, 32
    s_cbranch_scc1 L_dn_151
    s_waitcnt vmcnt(0)
    s_waitcnt vmcnt(0)
    s_endpgm
L_role_150:
    s_cmp_ge_u32 s41, 216
    s_cbranch_scc1 L_role_155
    s_cmp_lt_u32 s40, 2
    s_cbranch_scc1 L_ln2x_156
    s_endpgm
L_ln2x_156:
    s_sub_u32 s42, s41, 184
    s_lshr_b32 s97, s42, 4
    s_and_b32 s42, s42, 15
    s_lshl_b32 s42, s42, 1
    s_add_u32 s42, s42, s40
    v_lshlrev_b32 v12, 5, v1
    s_mov_b32 s45, 4096
    buffer_load_dwordx4 v[16:19], v12, s[32:35], s45 offen sc1
    buffer_load_dwordx4 v[20:23], v12, s[32:35], s45 offen offset:16 sc1
    s_mov_b32 s45, 6144
    buffer_load_dwordx4 v[24:27], v12, s[32:35], s45 offen sc1
    buffer_load_dwordx4 v[28:31], v12, s[32:35], s45 offen offset:16 sc1
    s_mov_b32 s45, 8192
    buffer_load_dwordx4 v[32:35], v12, s[32:35], s45 offen sc1
    buffer_load_dwordx4 v[36:39], v12, s[32:35], s45 offen offset:16 sc1
    s_waitcnt vmcnt(1)
    v_add_f32 v32, 1.0, v32
    v_add_f32 v33, 1.0, v33
    v_cvt_pk_bf16_f32 v13, v32, v33
    v_lshlrev_b32 v32, 16, v13
    v_and_b32 v33, 0xffff0000, v13
    v_add_f32 v34, 1.0, v34
    v_add_f32 v35, 1.0, v35
    v_cvt_pk_bf16_f32 v13, v34, v35
    v_lshlrev_b32 v34, 16, v13
    v_and_b32 v35, 0xffff0000, v13
    s_waitcnt vmcnt(0)
    v_add_f32 v36, 1.0, v36
    v_add_f32 v37, 1.0, v37
    v_cvt_pk_bf16_f32 v13, v36, v37
    v_lshlrev_b32 v36, 16, v13
    v_and_b32 v37, 0xffff0000, v13
    v_add_f32 v38, 1.0, v38
    v_add_f32 v39, 1.0, v39
    v_cvt_pk_bf16_f32 v13, v38, v39
    v_lshlrev_b32 v38, 16, v13
    v_and_b32 v39, 0xffff0000, v13
    s_mov_b32 s45, 0x5800000
    s_lshr_b32 s46, s42, 0
    s_and_b32 s46, s46, 0x1f
    s_mul_i32 s46, s46, 0x800
    s_add_u32 s45, s45, s46
    v_mov_b32 v3, s45
    s_mov_b32 s46, 0x10
    v_mad_u32_u24 v3, v4, s46, v3
    s_mov_b32 s46, 0x20
    v_mad_u32_u24 v3, v5, s46, v3
    s_mov_b32 s46, 0x40
    v_mad_u32_u24 v3, v6, s46, v3
    s_mov_b32 s46, 0x80
    v_mad_u32_u24 v3, v7, s46, v3
    s_mov_b32 s46, 0x100
    v_mad_u32_u24 v3, v8, s46, v3
    s_mov_b32 s46, 0x200
    v_mad_u32_u24 v3, v9, s46, v3
    s_mov_b32 s45, 0x0
    s_lshr_b32 s46, s42, 0
    s_and_b32 s46, s46, 0x1f
    s_mul_i32 s46, s46, 0x400
    s_add_u32 s45, s45, s46
    v_mov_b32 v10, s45
    s_mov_b32 s46, 0x10
    v_mad_u32_u24 v10, v4, s46, v10
    s_mov_b32 s46, 0x20
    v_mad_u32_u24 v10, v5, s46, v10
    s_mov_b32 s46, 0x40
    v_mad_u32_u24 v10, v6, s46, v10
    s_mov_b32 s46, 0x80
    v_mad_u32_u24 v10, v7, s46, v10
    s_mov_b32 s46, 0x100
    v_mad_u32_u24 v10, v8, s46, v10
    s_mov_b32 s46, 0x200
    v_mad_u32_u24 v10, v9, s46, v10
    s_mov_b32 s45, 0x400000
    s_lshr_b32 s46, s42, 0
    s_and_b32 s46, s46, 0x1f
    s_mul_i32 s46, s46, 0x10
    s_add_u32 s45, s45, s46
    v_mov_b32 v11, s45
    s_mov_b32 s46, 0x200
    v_mad_u32_u24 v11, v4, s46, v11
    s_mov_b32 s46, 0x400
    v_mad_u32_u24 v11, v5, s46, v11
    s_mov_b32 s46, 0x800
    v_mad_u32_u24 v11, v6, s46, v11
    s_mov_b32 s46, 0x1000
    v_mad_u32_u24 v11, v7, s46, v11
    s_mov_b32 s46, 0x2000
    v_mad_u32_u24 v11, v8, s46, v11
    s_mov_b32 s46, 0x4000
    v_mad_u32_u24 v11, v9, s46, v11
    s_mov_b32 s45, 0x66000
    s_lshr_b32 s46, s97, 0
    s_and_b32 s46, s46, 0x1
    s_mul_i32 s46, s46, 0x800
    s_add_u32 s45, s45, s46
    v_mov_b32 v14, s45
    s_mov_b32 s46, 0x80
    v_mad_u32_u24 v14, v4, s46, v14
    s_mov_b32 s46, 0x100
    v_mad_u32_u24 v14, v5, s46, v14
    s_mov_b32 s46, 0x200
    v_mad_u32_u24 v14, v6, s46, v14
    s_mov_b32 s46, 0x400
    v_mad_u32_u24 v14, v7, s46, v14
    s_lshl_b32 s45, s42, 7
    s_lshl_b32 s46, s97, 12
    s_add_u32 s45, s45, s46
    s_add_u32 s54, s45, 434176
    s_mov_b32 s60, s4
    s_and_b32 s61, s5, 0xffff
    s_mov_b32 s62, 2097152
    s_mov_b32 s63, 0x00020000
    s_lshl_b32 s52, s97, 19
    s_lshl_b32 s53, s97, 15
    s_mov_b32 s43, 0
L_ln2_157:
    s_add_u32 s55, s43, 1
    buffer_load_dwordx4 v[40:43], v10, s[60:63], s53 offen
    s_and_b32 s48, s43, 1
    s_lshl_b32 s48, s48, 12
    s_lshr_b32 s58, s43, 1
    s_add_u32 s58, s58, 1
    s_mov_b32 exec_lo, 0xffff
    s_mov_b32 exec_hi, 0x0
L_wf_158:
    buffer_load_dword v44, v14, s[32:35], s48 offen sc1
    s_waitcnt vmcnt(0)
    v_cmp_gt_u32 vcc, s58, v44
    s_nop 0
    s_and_b32 vcc_lo, vcc_lo, 0xffff
    s_and_b32 vcc_hi, vcc_hi, 0x0
    s_cmp_eq_u64 vcc, 0
    s_cbranch_scc1 L_wfok_159
    s_add_u32 s44, s44, 1
    s_cmp_gt_u32 s44, 1048576
    s_cbranch_scc1 L_w_abort_100
    s_branch L_wf_158
L_wfok_159:
    s_mov_b64 exec, -1
L_wfskip_160:
    s_add_u32 s45, s52, 0
    buffer_load_dwordx4 v[64:67], v3, s[32:35], s45 offen sc1
    buffer_load_dwordx4 v[68:71], v3, s[32:35], s45 offen offset:1024 sc1
    s_add_u32 s45, s52, 65536
    buffer_load_dwordx4 v[72:75], v3, s[32:35], s45 offen sc1
    buffer_load_dwordx4 v[76:79], v3, s[32:35], s45 offen offset:1024 sc1
    s_add_u32 s45, s52, 131072
    buffer_load_dwordx4 v[80:83], v3, s[32:35], s45 offen sc1
    buffer_load_dwordx4 v[84:87], v3, s[32:35], s45 offen offset:1024 sc1
    s_add_u32 s45, s52, 196608
    buffer_load_dwordx4 v[88:91], v3, s[32:35], s45 offen sc1
    buffer_load_dwordx4 v[92:95], v3, s[32:35], s45 offen offset:1024 sc1
    s_add_u32 s45, s52, 262144
    buffer_load_dwordx4 v[96:99], v3, s[32:35], s45 offen sc1
    buffer_load_dwordx4 v[100:103], v3, s[32:35], s45 offen offset:1024 sc1
    s_add_u32 s45, s52, 327680
    buffer_load_dwordx4 v[104:107], v3, s[32:35], s45 offen sc1
    buffer_load_dwordx4 v[108:111], v3, s[32:35], s45 offen offset:1024 sc1
    s_add_u32 s45, s52, 393216
    buffer_load_dwordx4 v[112:115], v3, s[32:35], s45 offen sc1
    buffer_load_dwordx4 v[116:119], v3, s[32:35], s45 offen offset:1024 sc1
    s_add_u32 s45, s52, 458752
    buffer_load_dwordx4 v[120:123], v3, s[32:35], s45 offen sc1
    buffer_load_dwordx4 v[124:127], v3, s[32:35], s45 offen offset:1024 sc1
    v_and_b32 v49, 0xffff0000, v40
    v_lshlrev_b32 v48, 16, v40
    v_and_b32 v51, 0xffff0000, v41
    v_lshlrev_b32 v50, 16, v41
    v_and_b32 v53, 0xffff0000, v42
    v_lshlrev_b32 v52, 16, v42
    v_and_b32 v55, 0xffff0000, v43
    v_lshlrev_b32 v54, 16, v43
    s_waitcnt vmcnt(13)
    v_pk_add_f32 v[64:65], v[64:65], v[72:73]
    v_pk_add_f32 v[66:67], v[66:67], v[74:75]
    s_waitcnt vmcnt(12)
    v_pk_add_f32 v[68:69], v[68:69], v[76:77]
    v_pk_add_f32 v[70:71], v[70:71], v[78:79]
    s_waitcnt vmcnt(11)
    v_pk_add_f32 v[64:65], v[64:65], v[80:81]
    v_pk_add_f32 v[66:67], v[66:67], v[82:83]
    s_waitcnt vmcnt(10)
    v_pk_add_f32 v[68:69], v[68:69], v[84:85]
    v_pk_add_f32 v[70:71], v[70:71], v[86:87]
    s_waitcnt vmcnt(9)
    v_pk_add_f32 v[64:65], v[64:65], v[88:89]
    v_pk_add_f32 v[66:67], v[66:67], v[90:91]
    s_waitcnt vmcnt(8)
    v_pk_add_f32 v[68:69], v[68:69], v[92:93]
    v_pk_add_f32 v[70:71], v[70:71], v[94:95]
    s_waitcnt vmcnt(7)
    v_pk_add_f32 v[64:65], v[64:65], v[96:97]
    v_pk_add_f32 v[66:67], v[66:67], v[98:99]
    s_waitcnt vmcnt(6)
    v_pk_add_f32 v[68:69], v[68:69], v[100:101]
    v_pk_add_f32 v[70:71], v[70:71], v[102:103]
    s_waitcnt vmcnt(5)
    v_pk_add_f32 v[64:65], v[64:65], v[104:105]
    v_pk_add_f32 v[66:67], v[66:67], v[106:107]
    s_waitcnt vmcnt(4)
    v_pk_add_f32 v[68:69], v[68:69], v[108:109]
    v_pk_add_f32 v[70:71], v[70:71], v[110:111]
    s_waitcnt vmcnt(3)
    v_pk_add_f32 v[64:65], v[64:65], v[112:113]
    v_pk_add_f32 v[66:67], v[66:67], v[114:115]
    s_waitcnt vmcnt(2)
    v_pk_add_f32 v[68:69], v[68:69], v[116:117]
    v_pk_add_f32 v[70:71], v[70:71], v[118:119]
    s_waitcnt vmcnt(1)
    v_pk_add_f32 v[64:65], v[64:65], v[120:121]
    v_pk_add_f32 v[66:67], v[66:67], v[122:123]
    s_waitcnt vmcnt(0)
    v_pk_add_f32 v[68:69], v[68:69], v[124:125]
    v_pk_add_f32 v[70:71], v[70:71], v[126:127]
    v_cvt_pk_bf16_f32 v13, v64, v65
    v_lshlrev_b32 v64, 16, v13
    v_and_b32 v65, 0xffff0000, v13
    v_mul_f32 v64, v64, v16
    v_mul_f32 v65, v65, v17
    v_cvt_pk_bf16_f32 v13, v64, v65
    v_lshlrev_b32 v64, 16, v13
    v_and_b32 v65, 0xffff0000, v13
    v_add_f32 v48, v48, v64
    v_add_f32 v49, v49, v65
    v_cvt_pk_bf16_f32 v56, v48, v49
    v_cvt_pk_bf16_f32 v13, v66, v67
    v_lshlrev_b32 v66, 16, v13
    v_and_b32 v67, 0xffff0000, v13
    v_mul_f32 v66, v66, v18
    v_mul_f32 v67, v67, v19
    v_cvt_pk_bf16_f32 v13, v66, v67
    v_lshlrev_b32 v66, 16, v13
    v_and_b32 v67, 0xffff0000, v13
    v_add_f32 v50, v50, v66
    v_add_f32 v51, v51, v67
    v_cvt_pk_bf16_f32 v57, v50, v51
    v_cvt_pk_bf16_f32 v13, v68, v69
    v_lshlrev_b32 v68, 16, v13
    v_and_b32 v69, 0xffff0000, v13
    v_mul_f32 v68, v68, v20
    v_mul_f32 v69, v69, v21
    v_cvt_pk_bf16_f32 v13, v68, v69
    v_lshlrev_b32 v68, 16, v13
    v_and_b32 v69, 0xffff0000, v13
    v_add_f32 v52, v52, v68
    v_add_f32 v53, v53, v69
    v_cvt_pk_bf16_f32 v58, v52, v53
    v_cvt_pk_bf16_f32 v13, v70, v71
    v_lshlrev_b32 v70, 16, v13
    v_and_b32 v71, 0xffff0000, v13
    v_mul_f32 v70, v70, v22
    v_mul_f32 v71, v71, v23
    v_cvt_pk_bf16_f32 v13, v70, v71
    v_lshlrev_b32 v70, 16, v13
    v_and_b32 v71, 0xffff0000, v13
    v_add_f32 v54, v54, v70
    v_add_f32 v55, v55, v71
    v_cvt_pk_bf16_f32 v59, v54, v55
    s_add_u32 s46, s53, 6291456
    buffer_store_dwordx4 v[56:59], v10, s[32:35], s46 offen sc1
    v_and_b32 v49, 0xffff0000, v56
    v_lshlrev_b32 v48, 16, v56
    v_and_b32 v51, 0xffff0000, v57
    v_lshlrev_b32 v50, 16, v57
    v_and_b32 v53, 0xffff0000, v58
    v_lshlrev_b32 v52, 16, v58
    v_and_b32 v55, 0xffff0000, v59
    v_lshlrev_b32 v54, 16, v59
    v_add_f32 v12, v48, v49
    v_add_f32 v12, v12, v50
    v_add_f32 v12, v12, v51
    v_add_f32 v12, v12, v52
    v_add_f32 v12, v12, v53
    v_add_f32 v12, v12, v54
    v_add_f32 v12, v12, v55
    s_nop 1
    v_add_f32_dpp v12, v12, v12 row_ror:8 row_mask:0xf bank_mask:0xf
    s_nop 1
    v_add_f32_dpp v12, v12, v12 row_ror:4 row_mask:0xf bank_mask:0xf
    s_nop 1
    v_add_f32_dpp v12, v12, v12 row_ror:2 row_mask:0xf bank_mask:0xf
    s_nop 1
    v_add_f32_dpp v12, v12, v12 row_ror:1 row_mask:0xf bank_mask:0xf
    v_mov_b32 v13, v12
    s_nop 1
    v_permlane16_swap_b32 v12, v13
    v_add_f32 v12, v12, v13
    v_mov_b32 v13, v12
    s_nop 1
    v_permlane32_swap_b32 v12, v13
    v_add_f32 v12, v12, v13
    v_mul_f32 v15, 0x3b000000, v12
    v_sub_f32 v13, v48, v15
    v_mul_f32 v46, v13, v13
    v_sub_f32 v13, v49, v15
    v_fmac_f32 v46, v13, v13
    v_sub_f32 v13, v50, v15
    v_fmac_f32 v46, v13, v13
    v_sub_f32 v13, v51, v15
    v_fmac_f32 v46, v13, v13
    v_sub_f32 v13, v52, v15
    v_fmac_f32 v46, v13, v13
    v_sub_f32 v13, v53, v15
    v_fmac_f32 v46, v13, v13
    v_sub_f32 v13, v54, v15
    v_fmac_f32 v46, v13, v13
    v_sub_f32 v13, v55, v15
    v_fmac_f32 v46, v13, v13
    s_nop 1
    v_add_f32_dpp v46, v46, v46 row_ror:8 row_mask:0xf bank_mask:0xf
    s_nop 1
    v_add_f32_dpp v46, v46, v46 row_ror:4 row_mask:0xf bank_mask:0xf
    s_nop 1
    v_add_f32_dpp v46, v46, v46 row_ror:2 row_mask:0xf bank_mask:0xf
    s_nop 1
    v_add_f32_dpp v46, v46, v46 row_ror:1 row_mask:0xf bank_mask:0xf
    v_mov_b32 v13, v46
    s_nop 1
    v_permlane16_swap_b32 v46, v13
    v_add_f32 v46, v46, v13
    v_mov_b32 v13, v46
    s_nop 1
    v_permlane32_swap_b32 v46, v13
    v_add_f32 v46, v46, v13
    v_mul_f32 v46, 0x3b000000, v46
    v_cvt_pk_bf16_f32 v13, v15, v46
    v_lshlrev_b32 v15, 16, v13
    v_and_b32 v46, 0xffff0000, v13
    v_add_f32 v46, 0x3727c5ac, v46
    v_cvt_pk_bf16_f32 v13, v46, v46
    v_lshlrev_b32 v46, 16, v13
    v_and_b32 v12, 0xffff0000, v13
    v_sqrt_f32 v46, v46
    s_nop 0
    v_cvt_pk_bf16_f32 v13, v46, v46
    v_lshlrev_b32 v46, 16, v13
    v_and_b32 v12, 0xffff0000, v13
    v_rcp_f32 v46, v46
    v_sub_f32 v48, v48, v15
    v_sub_f32 v49, v49, v15
    v_cvt_pk_bf16_f32 v13, v48, v49
    v_lshlrev_b32 v48, 16, v13
    v_and_b32 v49, 0xffff0000, v13
    v_mul_f32 v48, v48, v46
    v_mul_f32 v49, v49, v46
    v_cvt_pk_bf16_f32 v13, v48, v49
    v_lshlrev_b32 v48, 16, v13
    v_and_b32 v49, 0xffff0000, v13
    v_sub_f32 v50, v50, v15
    v_sub_f32 v51, v51, v15
    v_cvt_pk_bf16_f32 v13, v50, v51
    v_lshlrev_b32 v50, 16, v13
    v_and_b32 v51, 0xffff0000, v13
    v_mul_f32 v50, v50, v46
    v_mul_f32 v51, v51, v46
    v_cvt_pk_bf16_f32 v13, v50, v51
    v_lshlrev_b32 v50, 16, v13
    v_and_b32 v51, 0xffff0000, v13
    v_sub_f32 v52, v52, v15
    v_sub_f32 v53, v53, v15
    v_cvt_pk_bf16_f32 v13, v52, v53
    v_lshlrev_b32 v52, 16, v13
    v_and_b32 v53, 0xffff0000, v13
    v_mul_f32 v52, v52, v46
    v_mul_f32 v53, v53, v46
    v_cvt_pk_bf16_f32 v13, v52, v53
    v_lshlrev_b32 v52, 16, v13
    v_and_b32 v53, 0xffff0000, v13
    v_sub_f32 v54, v54, v15
    v_sub_f32 v55, v55, v15
    v_cvt_pk_bf16_f32 v13, v54, v55
    v_lshlrev_b32 v54, 16, v13
    v_and_b32 v55, 0xffff0000, v13
    v_mul_f32 v54, v54, v46
    v_mul_f32 v55, v55, v46
    v_cvt_pk_bf16_f32 v13, v54, v55
    v_lshlrev_b32 v54, 16, v13
    v_and_b32 v55, 0xffff0000, v13
    v_mul_f32 v48, v48, v32
    v_mul_f32 v49, v49, v33
    v_cvt_pk_bf16_f32 v13, v48, v49
    v_lshlrev_b32 v48, 16, v13
    v_and_b32 v49, 0xffff0000, v13
    v_add_f32 v48, v48, v24
    v_add_f32 v49, v49, v25
    v_cvt_pk_bf16_f32 v60, v48, v49
    v_mul_f32 v50, v50, v34
    v_mul_f32 v51, v51, v35
    v_cvt_pk_bf16_f32 v13, v50, v51
    v_lshlrev_b32 v50, 16, v13
    v_and_b32 v51, 0xffff0000, v13
    v_add_f32 v50, v50, v26
    v_add_f32 v51, v51, v27
    v_cvt_pk_bf16_f32 v61, v50, v51
    v_mul_f32 v52, v52, v36
    v_mul_f32 v53, v53, v37
    v_cvt_pk_bf16_f32 v13, v52, v53
    v_lshlrev_b32 v52, 16, v13
    v_and_b32 v53, 0xffff0000, v13
    v_add_f32 v52, v52, v28
    v_add_f32 v53, v53, v29
    v_cvt_pk_bf16_f32 v62, v52, v53
    v_mul_f32 v54, v54, v38
    v_mul_f32 v55, v55, v39
    v_cvt_pk_bf16_f32 v13, v54, v55
    v_lshlrev_b32 v54, 16, v13
    v_and_b32 v55, 0xffff0000, v13
    v_add_f32 v54, v54, v30
    v_add_f32 v55, v55, v31
    v_cvt_pk_bf16_f32 v63, v54, v55
    buffer_store_dwordx4 v[60:63], v11, s[32:35], s53 offen sc1
    s_waitcnt vmcnt(0)
    v_mov_b32 v13, s55
    v_mov_b32 v12, 0
    s_mov_b64 exec, 1
    buffer_store_dword v13, v12, s[32:35], s54 offen sc1
    s_mov_b64 exec, -1
    s_add_u32 s52, s52, 1048576
    s_add_u32 s53, s53, 65536
    s_add_u32 s43, s43, 1
    s_cmp_lt_u32 s43, 32
    s_cbranch_scc1 L_ln2_157
    s_waitcnt vmcnt(0)
    s_endpgm
L_role_155:
    s_endpgm
L_w_abort_100:
    s_mov_b64 exec, 1
    v_mov_b32 v30, s41
    v_add_u32 v30, 0xbad00000, v30
    v_mov_b32 v31, 258052
    buffer_store_dword v30, v31, s[32:35], 0 offen sc1
    s_waitcnt vmcnt(0)
    s_endpgm
L_exit:
    s_endpgm
.section .rodata,"a"
.p2align 6
.amdhsa_kernel adaLN_cond__memory_aug_recurrent_mem_tr__swiglu_ffn__prompt_kernel
  .amdhsa_next_free_vgpr 512
  .amdhsa_next_free_sgpr 102
  .amdhsa_accum_offset 256
  .amdhsa_group_segment_fixed_size 0
  .amdhsa_kernarg_size 128
  .amdhsa_user_sgpr_count 2
  .amdhsa_user_sgpr_kernarg_segment_ptr 1
  .amdhsa_system_sgpr_workgroup_id_x 1
.end_amdhsa_kernel
```
